```python
import torch

def _softmax(x, axis=-1):
    return torch.softmax(x, dim=axis)
def _gelu(x):
    return torch.nn.functional.gelu(x, approximate="tanh")
def _silu(x):
    return torch.nn.functional.silu(x)
def _sigmoid(x):
    return torch.sigmoid(x)
def _layernorm(x, axis=-1, eps=1e-5):
    m = x.mean(dim=axis, keepdim=True)
    v = x.var(dim=axis, keepdim=True, unbiased=False)
    return (x - m) / torch.sqrt(v + eps)
def _scatter_add(tgt, idx, src, axis=0):
    return tgt.clone().index_add_(axis, idx, src)
def _segment_sum(src, seg, n):
    out = torch.zeros((n,) + src.shape[1:], dtype=src.dtype)
    return out.index_add_(0, seg, src)
def _pad(x, pw):
    flat = tuple(v for pair in reversed(pw) for v in pair)
    return torch.nn.functional.pad(x, flat)

kernel_name = 'concat_heads__gqa_block_cached__gqa_block_cached__near_ridge'

def setup_inputs():

    _w = (lambda a: (lambda t: t.to(torch.bfloat16) if t.is_floating_point() else t)(torch.as_tensor(a)))
    def _A_setup():
        B, Sq, D = 8, 240, 640
        Hq, Hkv, Sk, Dh = 32, 32, 1024, 192
        assert Hq % Hkv == 0, (Hq, Hkv)
        return {
            "x": _w((lambda *s: torch.randn(*s, dtype=torch.bfloat16) * 0.8)(B, Sq, D)),
            "k_cache": _w((lambda *s: torch.randn(*s, dtype=torch.bfloat16) * 0.8)(B, Hkv, Sk, Dh)),
            "v_cache": _w((lambda *s: torch.randn(*s, dtype=torch.bfloat16) * 0.05)(B, Hkv, Sk, Dh)),
            "wq": _w((lambda *s: torch.randn(*s, dtype=torch.bfloat16) * 0.8)(D, Hq * Dh) * (D ** -0.5)),
            "wo": _w((lambda *s: torch.randn(*s, dtype=torch.bfloat16) * 0.05)(Hq * Dh, D) * ((Hq * Dh) ** -0.5)),
        }
    _A_in = _A_setup()

    def _B_setup():
        B, Sq, D = 8, 240, 640
        Hq, Hkv, Sk, Dh = 32, 32, 1024, 192
        assert Hq % Hkv == 0, (Hq, Hkv)
        return {
            "x": _w((lambda *s: torch.randn(*s, dtype=torch.bfloat16) * 0.8)(B, Sq, D)),
            "k_cache": _w((lambda *s: torch.randn(*s, dtype=torch.bfloat16) * 0.8)(B, Hkv, Sk, Dh)),
            "v_cache": _w((lambda *s: torch.randn(*s, dtype=torch.bfloat16) * 0.05)(B, Hkv, Sk, Dh)),
            "wq": _w((lambda *s: torch.randn(*s, dtype=torch.bfloat16) * 0.8)(D, Hq * Dh) * (D ** -0.5)),
            "wo": _w((lambda *s: torch.randn(*s, dtype=torch.bfloat16) * 0.05)(Hq * Dh, D) * ((Hq * Dh) ** -0.5)),
        }
    _B_in = _B_setup()

    return {
        "A_x": _A_in["x"],
        "A_k_cache": _A_in["k_cache"],
        "A_v_cache": _A_in["v_cache"],
        "A_wq": _A_in["wq"],
        "A_wo": _A_in["wo"],
        "B_x": _B_in["x"],
        "B_k_cache": _B_in["k_cache"],
        "B_v_cache": _B_in["v_cache"],
        "B_wq": _B_in["wq"],
        "B_wo": _B_in["wo"],
    }

def reference(A_x, A_k_cache, A_v_cache, A_wq, A_wo, B_x, B_k_cache, B_v_cache, B_wq, B_wo):
    def _A_ref(x, k_cache, v_cache, wq, wo):
        B, Sq, D = x.shape
        Hq, Dh = 32, 192
        Hkv = k_cache.shape[1]
        rep = Hq // Hkv
        q = (lambda x, *d: x.permute(*d))((x @ wq).reshape(B, Sq, Hq, Dh), 0, 2, 1, 3)
        k = (lambda x, n, axis: torch.repeat_interleave(x, n, dim=axis))(k_cache, rep, axis=1)
        v = (lambda x, n, axis: torch.repeat_interleave(x, n, dim=axis))(v_cache, rep, axis=1)
        scores = torch.einsum("bhqd,bhkd->bhqk", q, k) * (Dh ** -0.5)
        p = _softmax(scores, axis=-1)
        o = torch.einsum("bhqk,bhkd->bhqd", p, v)
        return (lambda x, *d: x.permute(*d))(o, 0, 2, 1, 3).reshape(B, Sq, Hq * Dh) @ wo

    def _B_ref(x, k_cache, v_cache, wq, wo):
        B, Sq, D = x.shape
        Hq, Dh = 32, 192
        Hkv = k_cache.shape[1]
        rep = Hq // Hkv
        q = (lambda x, *d: x.permute(*d))((x @ wq).reshape(B, Sq, Hq, Dh), 0, 2, 1, 3)
        k = (lambda x, n, axis: torch.repeat_interleave(x, n, dim=axis))(k_cache, rep, axis=1)
        v = (lambda x, n, axis: torch.repeat_interleave(x, n, dim=axis))(v_cache, rep, axis=1)
        scores = torch.einsum("bhqd,bhkd->bhqk", q, k) * (Dh ** -0.5)
        p = _softmax(scores, axis=-1)
        o = torch.einsum("bhqk,bhkd->bhqd", p, v)
        return (lambda x, *d: x.permute(*d))(o, 0, 2, 1, 3).reshape(B, Sq, Hq * Dh) @ wo

    a = _A_ref(A_x, A_k_cache, A_v_cache, A_wq, A_wo)
    b = _B_ref(B_x, B_k_cache, B_v_cache, B_wq, B_wo)
    return torch.concatenate([a, b], axis=-1)
```

```asm
; @launch grid=(256,1,1) block=(256,1,1) lds=163840
.amdgcn_target "amdgcn-amd-amdhsa--gfx950"

.macro mm f, d, fa, a, fb, b, c
v_mfma_f32_16x16x32_bf16 \f[\d:\d+3], \fa[\a:\a+3], \fb[\b:\b+3], \f[\c:\c+3]
.endm
.macro mz f, d, fa, a, fb, b
v_mfma_f32_16x16x32_bf16 \f[\d:\d+3], \fa[\a:\a+3], \fb[\b:\b+3], 0
.endm
.macro tr d, a, o
ds_read_b64_tr_b16 v[\d:\d+1], v\a offset:\o
.endm

.text
.globl concat_heads__gqa_block_cached__gqa_block_cached__near_ridge_kernel
.p2align 8
.type concat_heads__gqa_block_cached__gqa_block_cached__near_ridge_kernel,@function
concat_heads__gqa_block_cached__gqa_block_cached__near_ridge_kernel:
s_cmp_ge_u32 s2, 256
s_cbranch_scc1 L_end
s_and_b32 s3, s2, 1
s_mul_i32 s3, s3, 4
s_xor_b32 s2, s2, s3
s_bfe_u32 s87, s2, 0x10002
s_mul_i32 s3, s87, 40
s_load_dwordx2 s[4:5], s[0:1], s3 offset:0
s_load_dwordx2 s[8:9], s[0:1], s3 offset:24
s_load_dwordx2 s[12:13], s[0:1], s3 offset:8
s_load_dwordx2 s[16:17], s[0:1], s3 offset:16
s_load_dwordx2 s[96:97], s[0:1], s3 offset:32
s_load_dwordx2 s[64:65], s[0:1], 80
s_load_dwordx2 s[72:73], s[0:1], 88
s_load_dwordx2 s[68:69], s[0:1], 96
s_lshr_b32 s100, s2, 3
s_getpc_b64 s[48:49]
L_pc:
s_lshl_b32 s50, s100, 6
v_add_u32 v2, s50, v0
v_lshlrev_b32 v2, 7, v2
v_min_u32 v2, L_code_end-L_pc-4, v2
v_mov_b32 v3, s49
v_add_co_u32 v2, vcc, s48, v2
s_nop 1
v_addc_co_u32 v3, vcc, 0, v3, vcc
v_cmp_gt_u32 vcc, 64, v0
s_and_saveexec_b64 s[48:49], vcc
s_cbranch_execz L_nopf
global_load_dword v254, v[2:3], off
L_nopf:
s_mov_b64 exec, -1
v_lshrrev_b32 v1, 6, v0
v_and_b32 v0, 63, v0
v_readfirstlane_b32 s24, v1
s_bfe_u32 s101, s2, 0x10001
s_lshl_b32 s101, s101, 2
s_lshr_b32 s52, s100, 3
s_add_u32 s101, s101, s52
s_and_b32 s84, s2, 1
s_lshl_b32 s84, s84, 3
s_and_b32 s53, s100, 7
s_add_u32 s84, s84, s53
v_lshrrev_b32 v1, 3, v0
v_and_b32 v2, 7, v0
v_and_b32 v3, 6, v1
v_xor_b32 v3, v3, v2
v_lshlrev_b32 v3, 4, v3
v_mul_u32_u24 v4, 1280, v1
v_add_u32 v252, v3, v4
s_mul_i32 s34, s24, 81920
s_add_u32 s95, s34, 1280
s_mov_b32 s91, s34
s_lshl_b32 s52, s24, 13
s_add_u32 s44, s52, 24832
s_add_u32 s45, s52, 49664
s_cmp_eq_u32 s24, 3
s_cselect_b32 s44, 148992, s44
s_cselect_b32 s45, 155136, s45
s_mul_i32 s48, s101, 307200
s_mov_b32 s6, 307200
s_mov_b32 s7, 0x20000
s_mov_b32 s10, 7864320
s_mov_b32 s11, 0x20000
v_add_u32 v3, 0, v1
v_mul_u32_u24 v4, 43, v3
v_lshrrev_b32 v8, 7, v4
v_mul_u32_u24 v5, 3, v8
v_sub_u32 v5, v3, v5
v_lshlrev_b32 v5, 7, v5
v_bfe_u32 v6, v8, 1, 1
v_lshlrev_b32 v6, 2, v6
v_xor_b32 v6, v6, v2
v_lshl_add_u32 v5, v6, 4, v5
v_lshrrev_b32 v6, 2, v8
v_and_b32 v7, 3, v8
v_lshl_add_u32 v6, v6, 4, v7
v_mul_u32_u24 v6, 12288, v6
v_add_u32 v5, v5, v6
v_subrev_u32 v249, 0, v5
v_add_u32 v3, 8, v1
v_mul_u32_u24 v4, 43, v3
v_lshrrev_b32 v9, 7, v4
v_mul_u32_u24 v5, 3, v9
v_sub_u32 v5, v3, v5
v_lshlrev_b32 v5, 7, v5
v_bfe_u32 v6, v9, 1, 1
v_lshlrev_b32 v6, 2, v6
v_xor_b32 v6, v6, v2
v_lshl_add_u32 v5, v6, 4, v5
v_lshrrev_b32 v6, 2, v9
v_and_b32 v7, 3, v9
v_lshl_add_u32 v6, v6, 4, v7
v_mul_u32_u24 v6, 12288, v6
v_add_u32 v5, v5, v6
v_subrev_u32 v250, 1024, v5
v_add_u32 v3, 16, v1
v_mul_u32_u24 v4, 43, v3
v_lshrrev_b32 v10, 7, v4
v_mul_u32_u24 v5, 3, v10
v_sub_u32 v5, v3, v5
v_lshlrev_b32 v5, 7, v5
v_bfe_u32 v6, v10, 1, 1
v_lshlrev_b32 v6, 2, v6
v_xor_b32 v6, v6, v2
v_lshl_add_u32 v5, v6, 4, v5
v_lshrrev_b32 v6, 2, v10
v_and_b32 v7, 3, v10
v_lshl_add_u32 v6, v6, 4, v7
v_mul_u32_u24 v6, 12288, v6
v_add_u32 v5, v5, v6
v_subrev_u32 v251, 2048, v5
s_mul_i32 s33, s84, 384
s_and_b32 s52, s24, 1
s_lshl_b32 s52, s52, 5
s_lshr_b32 s53, s24, 1
s_lshl_b32 s50, s53, 3
s_add_u32 s52, s52, s50
s_mul_i32 s52, s52, 12288
s_add_u32 s52, s52, s33
s_mul_i32 s53, s53, 8
s_mul_i32 s50, s24, 6144
s_add_u32 s53, s53, s50
s_waitcnt lgkmcnt(0)
s_add_u32 s4, s4, s48
s_addc_u32 s5, s5, 0
s_add_u32 m0, s44, 0
s_add_u32 s51, s34, 0
buffer_load_dwordx4 v252, s[4:7], s51 offen lds
s_add_u32 s51, s34, 9216
buffer_load_dwordx4 v252, s[4:7], s51 offen offset:1024 lds
s_add_u32 s51, s34, 18432
buffer_load_dwordx4 v252, s[4:7], s51 offen offset:2048 lds
s_add_u32 s51, s34, 27648
buffer_load_dwordx4 v252, s[4:7], s51 offen offset:3072 lds
s_add_u32 m0, s44, 4096
s_add_u32 s51, s34, 40960
buffer_load_dwordx4 v252, s[4:7], s51 offen lds
s_add_u32 s51, s34, 50176
buffer_load_dwordx4 v252, s[4:7], s51 offen offset:1024 lds
s_add_u32 s51, s34, 59392
s_cmp_eq_u32 s24, 3
s_cbranch_scc1 L_x3_0
buffer_load_dwordx4 v252, s[4:7], s51 offen offset:2048 lds
s_add_u32 s51, s34, 68608
buffer_load_dwordx4 v252, s[4:7], s51 offen offset:3072 lds
L_x3_0:
s_add_u32 s34, s34, 128
s_cmp_eq_u32 s34, s95
s_cselect_b32 s55, 1280, 0
s_sub_u32 s34, s34, s55
s_add_u32 m0, s53, 74496
s_add_u32 s41, s52, 0
buffer_load_dwordx4 v249, s[8:11], s41 offen lds
buffer_load_dwordx4 v250, s[8:11], s41 offen offset:1024 lds
buffer_load_dwordx4 v251, s[8:11], s41 offen offset:2048 lds
s_add_u32 m0, s53, 77568
s_add_u32 s41, s52, 49152
buffer_load_dwordx4 v249, s[8:11], s41 offen lds
buffer_load_dwordx4 v250, s[8:11], s41 offen offset:1024 lds
buffer_load_dwordx4 v251, s[8:11], s41 offen offset:2048 lds
v_lshlrev_b32 v253, 4, v0
v_and_b32 v5, 6, v8
v_xor_b32 v5, v5, v2
v_lshlrev_b32 v5, 4, v5
v_lshl_add_u32 v144, v1, 7, v5
v_and_b32 v5, 6, v9
v_xor_b32 v5, v5, v2
v_lshlrev_b32 v5, 4, v5
v_lshl_add_u32 v145, v1, 7, v5
v_and_b32 v5, 6, v10
v_xor_b32 v5, v5, v2
v_lshlrev_b32 v5, 4, v5
v_lshl_add_u32 v146, v1, 7, v5
v_and_b32 v1, 15, v0
v_lshrrev_b32 v2, 4, v0
v_and_b32 v3, 6, v1
v_xor_b32 v4, v2, v3
v_lshlrev_b32 v4, 4, v4
v_mul_u32_u24 v5, 384, v1
v_add_u32 v236, v5, v4
v_xor_b32 v6, 64, v4
v_add_u32 v237, v5, v6
v_lshlrev_b32 v5, 7, v1
v_add_u32 v5, s44, v5
v_add_u32 v244, v5, v4
v_add_u32 v245, v5, v6
v_lshrrev_b32 v1, 2, v0
v_and_b32 v3, 6, v1
v_bfe_u32 v4, v0, 1, 1
v_xor_b32 v4, v4, v3
v_lshlrev_b32 v4, 4, v4
v_and_b32 v5, 1, v0
v_lshlrev_b32 v5, 3, v5
v_mul_u32_u24 v6, 384, v1
v_add_u32 v5, v5, v6
v_xor_b32 v6, 0, v4
v_add_u32 v238, v5, v6
v_xor_b32 v6, 32, v4
v_add_u32 v239, v5, v6
v_xor_b32 v6, 64, v4
v_add_u32 v240, v5, v6
v_xor_b32 v6, 96, v4
v_add_u32 v241, v5, v6
v_and_b32 v3, 1, v2
v_mul_u32_u24 v3, 12296, v3
v_add_u32 v3, 74496, v3
v_lshrrev_b32 v4, 1, v2
v_lshlrev_b32 v4, 2, v4
v_bfe_u32 v5, v0, 2, 2
v_add_u32 v4, v4, v5
v_mul_u32_u24 v4, 384, v4
v_add_u32 v3, v3, v4
v_bfe_u32 v4, v0, 3, 1
v_lshlrev_b32 v4, 2, v4
v_and_b32 v5, 3, v0
v_xor_b32 v4, v4, v5
v_lshlrev_b32 v4, 4, v4
v_add_u32 v242, v3, v4
v_xor_b32 v4, 64, v4
v_add_u32 v243, v3, v4
s_lshl_b32 s42, s24, 8
s_add_u32 s42, s42, 161536
v_lshl_add_u32 v246, v2, 4, s42
s_mul_i32 s48, s101, 12582912
s_add_u32 s12, s12, s48
s_addc_u32 s13, s13, 0
s_mov_b32 s14, 12582912
s_mov_b32 s15, 0x20000
s_add_u32 s16, s16, s48
s_addc_u32 s17, s17, 0
s_mov_b32 s18, 12582912
s_mov_b32 s19, 0x20000
s_lshl_b32 s48, s87, 3
s_add_u32 s48, s48, s101
s_mul_i32 s48, s48, 2949120
s_add_u32 s20, s68, s48
s_addc_u32 s21, s69, 0
s_mov_b32 s22, 2949120
s_mov_b32 s23, 0x20000
s_mov_b32 s98, 7864320
s_mov_b32 s99, 0x20000
s_mov_b32 s66, 4915200
s_mov_b32 s67, 0x20000
s_mov_b32 s74, 256
s_mov_b32 s75, 0x20000
s_cmp_ge_u32 s100, 30
s_cselect_b32 s88, 1, 0
s_min_u32 s35, s100, 29
s_and_b32 s25, s2, 1
s_mul_i32 s26, s35, 52
s_lshr_b32 s26, s26, 8
s_mul_i32 s27, s26, 5
s_sub_u32 s27, s35, s27
s_lshl_b32 s26, s26, 1
s_and_b32 s28, s24, 1
s_add_u32 s26, s26, s28
s_mul_i32 s29, s26, 43
s_lshr_b32 s29, s29, 7
s_mul_i32 s30, s29, 3
s_sub_u32 s26, s26, s30
s_and_b32 s30, s2, 7
s_lshl_b32 s86, s30, 2
s_and_b32 s85, s86, 24
s_and_b32 s30, s2, 6
s_lshl_b32 s30, s30, 1
s_add_u32 s30, s30, s29
s_mul_i32 s31, s30, 2949120
s_add_u32 s60, s68, s31
s_addc_u32 s61, s69, 0
s_mov_b32 s62, 2949120
s_mov_b32 s63, 0x20000
s_add_u32 s68, s68, 50331648
s_addc_u32 s69, s69, 0
s_mov_b32 s70, 24117248
s_mov_b32 s71, 0x20000
s_lshl_b32 s31, s25, 1
s_lshr_b32 s32, s24, 1
s_add_u32 s31, s31, s32
s_mul_i32 s76, s31, 368640
s_mul_i32 s36, s26, 30720
s_add_u32 s76, s76, s36
s_mul_i32 s77, s31, 983040
s_lshl_b32 s36, s27, 8
s_add_u32 s77, s77, s36
s_xor_b32 s36, s28, s25
s_lshl_b32 s36, s36, 7
s_add_u32 s77, s77, s36
s_mul_i32 s78, s32, 74496
s_lshl_b32 s36, s28, 13
s_add_u32 s78, s78, s36
s_add_u32 s78, s78, 1024
s_and_b32 s30, s30, 7
s_mul_i32 s30, s30, 240
s_mul_i32 s36, s26, 80
s_add_u32 s30, s30, s36
s_mul_i32 s79, s30, 2560
s_mul_i32 s36, s87, 1280
s_add_u32 s79, s79, s36
s_lshl_b32 s36, s27, 8
s_add_u32 s79, s79, s36
s_lshl_b32 s36, s31, 6
s_add_u32 s79, s79, s36
s_lshl_b32 s36, s2, 2
s_add_u32 s36, s36, s24
s_mul_i32 s80, s36, 20480
s_xor_b32 s36, s36, 4
s_mul_i32 s81, s36, 20480
s_lshl_b32 s36, s2, 7
s_add_u32 s82, s36, 22020096
s_xor_b32 s36, s36, 128
s_add_u32 s83, s36, 22020096
s_and_b32 s48, s2, 3
s_lshl_b32 s48, s48, 5
s_add_u32 s48, s48, s100
s_mul_i32 s54, s48, 30720
s_mul_i32 s31, s84, 393216
s_mul_i32 s46, s84, 92160
s_mul_i32 s48, s24, 24576
s_add_u32 s46, s46, s48
s_mov_b32 s101, s100
s_mov_b32 s87, 0
s_mov_b32 s25, 0
s_mov_b32 s26, 24832
s_mov_b32 s27, 49664
s_mov_b32 s28, 74496
s_mov_b32 s29, 99328
s_mov_b32 s30, 124160
s_mov_b32 s49, 0
s_mov_b32 s48, 74496
s_mov_b32 s38, 0x3dd53b95
s_mov_b32 s39, 0x3dd53b95
s_mov_b32 s37, 0x53800000
s_mov_b32 s36, 0
s_mov_b64 exec, 0
s_cmp_eq_u32 s24, 0
s_cbranch_scc1 L_pg3
s_cmp_eq_u32 s24, 1
s_cbranch_scc1 L_pg5
s_cmp_eq_u32 s24, 2
s_cbranch_scc1 L_pg7
s_cmp_eq_u32 s24, 3
s_cbranch_scc1 L_pg9
L_ir1:
s_mov_b64 exec, -1
L_ir1x:
s_add_u32 m0, s45, 0
s_add_u32 s51, s34, 0
buffer_load_dwordx4 v252, s[4:7], s51 offen lds
s_add_u32 s51, s34, 9216
buffer_load_dwordx4 v252, s[4:7], s51 offen offset:1024 lds
s_add_u32 s51, s34, 18432
buffer_load_dwordx4 v252, s[4:7], s51 offen offset:2048 lds
s_add_u32 s51, s34, 27648
buffer_load_dwordx4 v252, s[4:7], s51 offen offset:3072 lds
s_add_u32 m0, s45, 4096
s_add_u32 s51, s34, 40960
buffer_load_dwordx4 v252, s[4:7], s51 offen lds
s_add_u32 s51, s34, 50176
buffer_load_dwordx4 v252, s[4:7], s51 offen offset:1024 lds
s_add_u32 s51, s34, 59392
s_cmp_eq_u32 s24, 3
s_cbranch_scc1 L_x3_1
buffer_load_dwordx4 v252, s[4:7], s51 offen offset:2048 lds
s_add_u32 s51, s34, 68608
buffer_load_dwordx4 v252, s[4:7], s51 offen offset:3072 lds
L_x3_1:
s_add_u32 s34, s34, 128
s_cmp_eq_u32 s34, s95
s_cselect_b32 s55, 1280, 0
s_sub_u32 s34, s34, s55
s_add_u32 m0, s53, 99328
s_add_u32 s41, s52, 786432
buffer_load_dwordx4 v249, s[8:11], s41 offen lds
buffer_load_dwordx4 v250, s[8:11], s41 offen offset:1024 lds
buffer_load_dwordx4 v251, s[8:11], s41 offen offset:2048 lds
s_add_u32 m0, s53, 102400
s_add_u32 s41, s52, 835584
buffer_load_dwordx4 v249, s[8:11], s41 offen lds
buffer_load_dwordx4 v250, s[8:11], s41 offen offset:1024 lds
buffer_load_dwordx4 v251, s[8:11], s41 offen offset:2048 lds
s_cmp_eq_u32 s24, 3
s_cbranch_scc1 L_v3
s_branch L_v4
L_end:
s_endpgm
.p2align 12
L_v4:
L_pg3:
s_cbranch_execz L_pg2
s_mul_i32 s40, s24, 3072
s_and_b32 s41, s24, 1
s_lshl_b32 s41, s41, 2
s_lshr_b32 s42, s24, 1
s_lshl_b32 s42, s42, 5
s_add_u32 s41, s41, s42
s_mul_i32 s41, s41, 12288
s_add_u32 s33, s33, s41
s_add_u32 s94, s33, 7864320
s_mul_i32 s41, s2, 5
s_lshr_b32 s42, s2, 4
s_add_u32 s41, s41, s42
s_and_b32 s41, s41, 15
s_min_u32 s92, s41, 14
s_mov_b32 s93, s92
s_mov_b32 s89, s31
s_mul_i32 s55, s92, 13
s_lshr_b32 s55, s55, 6
s_mul_i32 s55, s55, 101376
s_mul_i32 s31, s92, 6144
s_add_u32 s31, s31, s55
s_add_u32 s31, s31, s89
s_lshr_b32 s41, s101, 3
s_lshl_b32 s41, s41, 1
s_and_b32 s42, s101, 7
s_add_u32 s41, s41, s42
s_mul_i32 s41, s41, 5
s_lshr_b32 s41, s41, 2
s_cmp_ge_u32 s41, 10
s_cselect_b32 s42, 10, 0
s_sub_u32 s41, s41, s42
s_mul_i32 s0, s41, 786432
s_lshl_b32 s1, s41, 7
s_mov_b32 s32, s31
s_mov_b32 s90, s33
s_add_u32 s33, s33, 1572864
s_waitcnt vmcnt(14)
s_barrier
tr 192,242,0
tr 194,242,3072
tr 196,242,6144
tr 198,242,9216
ds_read_b128 v[224:227], v244
ds_read_b128 v[228:231], v245
ds_read_b128 a[192:195], v244
ds_read_b128 a[196:199], v245
ds_read_b128 a[200:203], v244 offset:2048
ds_read_b128 a[204:207], v245 offset:2048
ds_read_b128 a[208:211], v244 offset:4096
ds_read_b128 a[212:215], v245 offset:4096
ds_read_b128 a[216:219], v244 offset:6144
ds_read_b128 a[220:223], v245 offset:6144
tr 200,242,8
tr 202,242,3080
tr 204,242,6152
tr 206,242,9224
s_waitcnt lgkmcnt(12)
v_max3_f32 v216, |v224|, |v225|, |v226|
v_max3_f32 v216, v216, |v227|, |v228|
v_max3_f32 v216, v216, |v229|, |v230|
v_max3_f32 v216, v216, |v231|, |v231|
v_max3_f32 v247, |v192|, |v193|, |v194|
v_max3_f32 v247, v247, |v195|, |v196|
v_max3_f32 v247, v247, |v197|, |v198|
v_max3_f32 v247, v247, |v199|, |v199|
v_mul_f32 v247, v247, v216
v_and_b32 v247, 0x7f800000, v247
v_mul_f32 v247, 0x43c00000, v247
v_min_f32 v247, 0x71800000, v247
s_nop 0
v_readlane_b32 s57, v247, 0
v_readlane_b32 s58, v247, 21
v_readlane_b32 s59, v247, 42
s_nop 3
s_min_u32 s57, s57, s58
s_min_u32 s57, s57, s59
v_mov_b32 v247, s57
v_mov_b32 v188, v247
v_mov_b32 v189, v247
v_mov_b32 v190, v247
v_mov_b32 v191, v247
s_nop 1
s_waitcnt lgkmcnt(11)
mm v,0,v,192,a,192,188
tr 208,243,0
s_waitcnt lgkmcnt(11)
mm v,0,v,196,a,196,0
tr 210,243,3072
s_waitcnt lgkmcnt(11)
mm v,48,v,192,a,200,188
tr 212,243,6144
s_waitcnt lgkmcnt(11)
mm v,48,v,196,a,204,48
tr 214,243,9216
s_waitcnt lgkmcnt(11)
mm v,96,v,192,a,208,188
s_waitcnt lgkmcnt(10)
mm v,96,v,196,a,212,96
s_waitcnt lgkmcnt(9)
mm v,144,v,192,a,216,188
s_waitcnt lgkmcnt(8)
mm v,144,v,196,a,220,144
s_waitcnt lgkmcnt(4)
mm v,4,v,200,a,192,188
tr 192,243,8
s_add_u32 m0, s44, 0
mm v,4,v,204,a,196,4
tr 194,243,3080
s_add_u32 s51, s34, 0
mm v,52,v,200,a,200,188
tr 196,243,6152
mm v,52,v,204,a,204,52
tr 198,243,9224
mm v,100,v,200,a,208,188
buffer_load_dwordx4 v252, s[4:7], s51 offen lds
mm v,100,v,204,a,212,100
s_add_u32 s51, s34, 9216
mm v,148,v,200,a,216,188
buffer_load_dwordx4 v252, s[4:7], s51 offen offset:1024 lds
mm v,148,v,204,a,220,148
s_add_u32 s51, s34, 18432
s_waitcnt lgkmcnt(6)
mm v,8,v,208,a,192,188
tr 200,242,128
s_waitcnt lgkmcnt(5)
mm v,8,v,212,a,196,8
tr 202,242,3200
mm v,56,v,208,a,200,188
tr 204,242,6272
mm v,56,v,212,a,204,56
tr 206,242,9344
mm v,104,v,208,a,208,188
buffer_load_dwordx4 v252, s[4:7], s51 offen offset:2048 lds
mm v,104,v,212,a,212,104
s_add_u32 s51, s34, 27648
mm v,152,v,208,a,216,188
mm v,152,v,212,a,220,152
s_waitcnt lgkmcnt(6)
mm v,12,v,192,a,192,188
tr 208,242,136
s_waitcnt lgkmcnt(5)
mm v,12,v,196,a,196,12
tr 210,242,3208
mm v,60,v,192,a,200,188
tr 212,242,6280
mm v,60,v,196,a,204,60
tr 214,242,9352
mm v,108,v,192,a,208,188
buffer_load_dwordx4 v252, s[4:7], s51 offen offset:3072 lds
mm v,108,v,196,a,212,108
s_add_u32 m0, s44, 4096
s_add_u32 s51, s34, 40960
mm v,156,v,192,a,216,188
mm v,156,v,196,a,220,156
s_waitcnt lgkmcnt(4)
mm v,16,v,200,a,192,188
tr 192,243,128
s_waitcnt vmcnt(10)
mm v,16,v,204,a,196,16
tr 194,243,3200
buffer_load_dwordx4 v252, s[4:7], s51 offen lds
mm v,64,v,200,a,200,188
tr 196,243,6272
s_add_u32 s51, s34, 50176
mm v,64,v,204,a,204,64
tr 198,243,9344
mm v,112,v,200,a,208,188
ds_read_b128 a[224:227], v244 offset:24832
mm v,112,v,204,a,212,112
ds_read_b128 a[228:231], v245 offset:24832
mm v,160,v,200,a,216,188
ds_read_b128 a[232:235], v244 offset:26880
mm v,160,v,204,a,220,160
ds_read_b128 a[236:239], v245 offset:26880
s_waitcnt lgkmcnt(8)
mm v,20,v,208,a,192,188
tr 200,243,136
buffer_load_dwordx4 v252, s[4:7], s51 offen offset:1024 lds
mm v,20,v,212,a,196,20
tr 202,243,3208
s_add_u32 s51, s34, 59392
mm v,68,v,208,a,200,188
tr 204,243,6280
mm v,68,v,212,a,204,68
tr 206,243,9352
mm v,116,v,208,a,208,188
ds_read_b128 a[240:243], v244 offset:28928
mm v,116,v,212,a,212,116
ds_read_b128 a[244:247], v245 offset:28928
s_waitcnt lgkmcnt(12)
mm v,164,v,208,a,216,188
ds_read_b128 a[248:251], v244 offset:30976
buffer_load_dwordx4 v252, s[4:7], s51 offen offset:2048 lds
mm v,164,v,212,a,220,164
ds_read_b128 a[252:255], v245 offset:30976
s_add_u32 s51, s34, 68608
mm v,24,v,192,a,192,188
tr 208,242,256
s_waitcnt lgkmcnt(13)
mm v,24,v,196,a,196,24
tr 210,242,3328
mm v,72,v,192,a,200,188
tr 212,242,6400
mm v,72,v,196,a,204,72
tr 214,242,9472
mm v,120,v,192,a,208,188
mm v,120,v,196,a,212,120
buffer_load_dwordx4 v252, s[4:7], s51 offen offset:3072 lds
mm v,168,v,192,a,216,188
s_add_u32 s34, s34, 128
s_cmp_eq_u32 s34, s95
s_cselect_b32 s55, 1280, 0
mm v,168,v,196,a,220,168
s_sub_u32 s34, s34, s55
s_add_u32 m0, s30, s40
s_waitcnt lgkmcnt(10)
mm v,28,v,200,a,192,188
tr 192,242,264
s_waitcnt lgkmcnt(9)
mm v,28,v,204,a,196,28
tr 194,242,3336
mm v,76,v,200,a,200,188
tr 196,242,6408
mm v,76,v,204,a,204,76
tr 198,242,9480
mm v,124,v,200,a,208,188
buffer_load_dwordx4 v249, s[8:11], s33 offen lds
mm v,124,v,204,a,212,124
mm v,172,v,200,a,216,188
mm v,172,v,204,a,220,172
s_waitcnt lgkmcnt(6)
mm v,32,v,208,a,192,188
tr 200,243,256
s_waitcnt lgkmcnt(5)
mm v,32,v,212,a,196,32
tr 202,243,3328
mm v,80,v,208,a,200,188
tr 204,243,6400
mm v,80,v,212,a,204,80
tr 206,243,9472
mm v,128,v,208,a,208,188
buffer_load_dwordx4 v250, s[8:11], s33 offen offset:1024 lds
mm v,128,v,212,a,212,128
mm v,176,v,208,a,216,188
s_waitcnt lgkmcnt(4)
mm v,176,v,212,a,220,176
buffer_load_dwordx4 v251, s[8:11], s33 offen offset:2048 lds
mm v,36,v,192,a,192,188
tr 208,243,264
s_add_u32 s33, s33, 786432
mm v,36,v,196,a,196,36
tr 210,243,3336
s_cmp_eq_u32 s33, s94
s_cselect_b32 s55, 7864320, 0
mm v,84,v,192,a,200,188
tr 212,243,6408
s_sub_u32 s33, s33, s55
mm v,84,v,196,a,204,84
tr 214,243,9480
mm v,132,v,192,a,208,188
s_sub_u32 s42, s29, s48
s_mov_b32 s48, s29
v_add_u32 v242, s42, v242
mm v,132,v,196,a,212,132
v_add_u32 v243, s42, v243
mm v,180,v,192,a,216,188
mm v,180,v,196,a,220,180
s_waitcnt lgkmcnt(6)
mm v,40,v,200,a,192,188
s_waitcnt vmcnt(11) lgkmcnt(0)
s_barrier
mm v,40,v,204,a,196,40
tr 192,242,0
s_mov_b32 s43, s28
mm v,88,v,200,a,200,188
tr 194,242,3072
s_mov_b32 s28, s29
mm v,88,v,204,a,204,88
tr 196,242,6144
s_mov_b32 s29, s30
mm v,136,v,200,a,208,188
tr 198,242,9216
mm v,136,v,204,a,212,136
s_mov_b32 s30, s43
mm v,184,v,200,a,216,188
mm v,184,v,204,a,220,184
mm v,44,v,208,a,192,188
tr 200,242,8
mm v,44,v,212,a,196,44
tr 202,242,3080
mm v,92,v,208,a,200,188
tr 204,242,6152
mm v,92,v,212,a,204,92
tr 206,242,9224
mm v,140,v,208,a,208,188
mm v,140,v,212,a,212,140
mm v,188,v,208,a,216,188
mm v,188,v,212,a,220,188
s_waitcnt lgkmcnt(4)
mm v,0,v,192,a,224,0
tr 208,243,0
s_add_u32 m0, s45, 0
mm v,0,v,196,a,228,0
tr 210,243,3072
s_add_u32 s51, s34, 0
mm v,48,v,192,a,232,48
tr 212,243,6144
mm v,48,v,196,a,236,48
tr 214,243,9216
mm v,96,v,192,a,240,96
buffer_load_dwordx4 v252, s[4:7], s51 offen lds
mm v,96,v,196,a,244,96
s_add_u32 s51, s34, 9216
mm v,144,v,192,a,248,144
s_waitcnt lgkmcnt(4)
mm v,144,v,196,a,252,144
buffer_load_dwordx4 v252, s[4:7], s51 offen offset:1024 lds
mm v,4,v,200,a,224,4
tr 192,243,8
s_add_u32 s51, s34, 18432
mm v,4,v,204,a,228,4
tr 194,243,3080
mm v,52,v,200,a,232,52
tr 196,243,6152
mm v,52,v,204,a,236,52
tr 198,243,9224
mm v,100,v,200,a,240,100
mm v,100,v,204,a,244,100
mm v,148,v,200,a,248,148
buffer_load_dwordx4 v252, s[4:7], s51 offen offset:2048 lds
mm v,148,v,204,a,252,148
s_add_u32 s51, s34, 27648
s_waitcnt lgkmcnt(6)
mm v,8,v,208,a,224,8
tr 200,242,128
s_waitcnt lgkmcnt(5)
mm v,8,v,212,a,228,8
tr 202,242,3200
mm v,56,v,208,a,232,56
tr 204,242,6272
mm v,56,v,212,a,236,56
tr 206,242,9344
mm v,104,v,208,a,240,104
mm v,104,v,212,a,244,104
buffer_load_dwordx4 v252, s[4:7], s51 offen offset:3072 lds
mm v,152,v,208,a,248,152
s_add_u32 m0, s45, 4096
s_add_u32 s51, s34, 40960
mm v,152,v,212,a,252,152
s_waitcnt lgkmcnt(6)
mm v,12,v,192,a,224,12
tr 208,242,136
s_waitcnt lgkmcnt(5)
mm v,12,v,196,a,228,12
tr 210,242,3208
mm v,60,v,192,a,232,60
tr 212,242,6280
mm v,60,v,196,a,236,60
tr 214,242,9352
mm v,108,v,192,a,240,108
buffer_load_dwordx4 v252, s[4:7], s51 offen lds
mm v,108,v,196,a,244,108
s_add_u32 s51, s34, 50176
mm v,156,v,192,a,248,156
mm v,156,v,196,a,252,156
s_waitcnt lgkmcnt(4)
mm v,16,v,200,a,224,16
tr 192,243,128
s_waitcnt vmcnt(8)
mm v,16,v,204,a,228,16
tr 194,243,3200
mm v,64,v,200,a,232,64
tr 196,243,6272
mm v,64,v,204,a,236,64
tr 198,243,9344
mm v,112,v,200,a,240,112
ds_read_b128 a[192:195], v244
buffer_load_dwordx4 v252, s[4:7], s51 offen offset:1024 lds
mm v,112,v,204,a,244,112
ds_read_b128 a[196:199], v245
s_add_u32 s51, s34, 59392
mm v,160,v,200,a,248,160
ds_read_b128 a[200:203], v244 offset:2048
mm v,160,v,204,a,252,160
ds_read_b128 a[204:207], v245 offset:2048
s_waitcnt lgkmcnt(10)
mm v,20,v,208,a,224,20
tr 200,243,136
s_waitcnt lgkmcnt(9)
mm v,20,v,212,a,228,20
tr 202,243,3208
mm v,68,v,208,a,232,68
tr 204,243,6280
mm v,68,v,212,a,236,68
tr 206,243,9352
mm v,116,v,208,a,240,116
ds_read_b128 a[208:211], v244 offset:4096
buffer_load_dwordx4 v252, s[4:7], s51 offen offset:2048 lds
mm v,116,v,212,a,244,116
ds_read_b128 a[212:215], v245 offset:4096
s_add_u32 s51, s34, 68608
mm v,164,v,208,a,248,164
ds_read_b128 a[216:219], v244 offset:6144
mm v,164,v,212,a,252,164
ds_read_b128 a[220:223], v245 offset:6144
s_waitcnt lgkmcnt(14)
mm v,24,v,192,a,224,24
tr 208,242,256
s_waitcnt lgkmcnt(13)
mm v,24,v,196,a,228,24
tr 210,242,3328
mm v,72,v,192,a,232,72
tr 212,242,6400
buffer_load_dwordx4 v252, s[4:7], s51 offen offset:3072 lds
mm v,72,v,196,a,236,72
tr 214,242,9472
mm v,120,v,192,a,240,120
s_add_u32 s34, s34, 128
s_cmp_eq_u32 s34, s95
s_cselect_b32 s55, 1280, 0
mm v,120,v,196,a,244,120
s_sub_u32 s34, s34, s55
s_add_u32 m0, s30, s40
mm v,168,v,192,a,248,168
mm v,168,v,196,a,252,168
s_waitcnt lgkmcnt(10)
mm v,28,v,200,a,224,28
tr 192,242,264
s_waitcnt lgkmcnt(9)
mm v,28,v,204,a,228,28
tr 194,242,3336
mm v,76,v,200,a,232,76
tr 196,242,6408
mm v,76,v,204,a,236,76
tr 198,242,9480
mm v,124,v,200,a,240,124
buffer_load_dwordx4 v249, s[8:11], s33 offen lds
mm v,124,v,204,a,244,124
mm v,172,v,200,a,248,172
mm v,172,v,204,a,252,172
s_waitcnt lgkmcnt(4)
mm v,32,v,208,a,224,32
tr 200,243,256
buffer_load_dwordx4 v250, s[8:11], s33 offen offset:1024 lds
mm v,32,v,212,a,228,32
tr 202,243,3328
mm v,80,v,208,a,232,80
tr 204,243,6400
mm v,80,v,212,a,236,80
tr 206,243,9472
mm v,128,v,208,a,240,128
mm v,128,v,212,a,244,128
s_waitcnt lgkmcnt(4)
mm v,176,v,208,a,248,176
buffer_load_dwordx4 v251, s[8:11], s33 offen offset:2048 lds
mm v,176,v,212,a,252,176
s_add_u32 s33, s33, 786432
s_cmp_eq_u32 s33, s94
s_cselect_b32 s55, 7864320, 0
mm v,36,v,192,a,224,36
tr 208,243,264
s_sub_u32 s33, s33, s55
mm v,36,v,196,a,228,36
tr 210,243,3336
mm v,84,v,192,a,232,84
tr 212,243,6408
mm v,84,v,196,a,236,84
tr 214,243,9480
mm v,132,v,192,a,240,132
s_sub_u32 s42, s29, s48
s_mov_b32 s48, s29
v_add_u32 v242, s42, v242
mm v,132,v,196,a,244,132
v_add_u32 v243, s42, v243
mm v,180,v,192,a,248,180
mm v,180,v,196,a,252,180
s_waitcnt lgkmcnt(6)
mm v,40,v,200,a,224,40
s_waitcnt vmcnt(11) lgkmcnt(0)
s_barrier
mm v,40,v,204,a,228,40
tr 192,242,0
s_mov_b32 s43, s28
mm v,88,v,200,a,232,88
tr 194,242,3072
s_mov_b32 s28, s29
mm v,88,v,204,a,236,88
tr 196,242,6144
s_mov_b32 s29, s30
mm v,136,v,200,a,240,136
tr 198,242,9216
mm v,136,v,204,a,244,136
s_mov_b32 s30, s43
mm v,184,v,200,a,248,184
mm v,184,v,204,a,252,184
mm v,44,v,208,a,224,44
tr 200,242,8
mm v,44,v,212,a,228,44
tr 202,242,3080
mm v,92,v,208,a,232,92
tr 204,242,6152
mm v,92,v,212,a,236,92
tr 206,242,9224
mm v,140,v,208,a,240,140
mm v,140,v,212,a,244,140
mm v,188,v,208,a,248,188
mm v,188,v,212,a,252,188
s_waitcnt lgkmcnt(4)
mm v,0,v,192,a,192,0
tr 208,243,0
s_add_u32 m0, s44, 0
mm v,0,v,196,a,196,0
tr 210,243,3072
s_add_u32 s51, s34, 0
mm v,48,v,192,a,200,48
tr 212,243,6144
mm v,48,v,196,a,204,48
tr 214,243,9216
mm v,96,v,192,a,208,96
buffer_load_dwordx4 v252, s[4:7], s51 offen lds
mm v,96,v,196,a,212,96
s_add_u32 s51, s34, 9216
mm v,144,v,192,a,216,144
s_waitcnt lgkmcnt(4)
mm v,144,v,196,a,220,144
buffer_load_dwordx4 v252, s[4:7], s51 offen offset:1024 lds
mm v,4,v,200,a,192,4
tr 192,243,8
s_add_u32 s51, s34, 18432
mm v,4,v,204,a,196,4
tr 194,243,3080
mm v,52,v,200,a,200,52
tr 196,243,6152
mm v,52,v,204,a,204,52
tr 198,243,9224
mm v,100,v,200,a,208,100
mm v,100,v,204,a,212,100
mm v,148,v,200,a,216,148
buffer_load_dwordx4 v252, s[4:7], s51 offen offset:2048 lds
mm v,148,v,204,a,220,148
s_add_u32 s51, s34, 27648
s_waitcnt lgkmcnt(6)
mm v,8,v,208,a,192,8
tr 200,242,128
s_waitcnt lgkmcnt(5)
mm v,8,v,212,a,196,8
tr 202,242,3200
mm v,56,v,208,a,200,56
tr 204,242,6272
mm v,56,v,212,a,204,56
tr 206,242,9344
mm v,104,v,208,a,208,104
mm v,104,v,212,a,212,104
buffer_load_dwordx4 v252, s[4:7], s51 offen offset:3072 lds
mm v,152,v,208,a,216,152
s_add_u32 m0, s44, 4096
s_add_u32 s51, s34, 40960
mm v,152,v,212,a,220,152
s_waitcnt lgkmcnt(6)
mm v,12,v,192,a,192,12
tr 208,242,136
s_waitcnt lgkmcnt(5)
mm v,12,v,196,a,196,12
tr 210,242,3208
mm v,60,v,192,a,200,60
tr 212,242,6280
mm v,60,v,196,a,204,60
tr 214,242,9352
mm v,108,v,192,a,208,108
buffer_load_dwordx4 v252, s[4:7], s51 offen lds
mm v,108,v,196,a,212,108
s_add_u32 s51, s34, 50176
mm v,156,v,192,a,216,156
mm v,156,v,196,a,220,156
s_waitcnt lgkmcnt(4)
mm v,16,v,200,a,192,16
L_pg5:
s_cbranch_execz L_pg4
tr 192,243,128
s_waitcnt vmcnt(8)
mm v,16,v,204,a,196,16
tr 194,243,3200
mm v,64,v,200,a,200,64
tr 196,243,6272
mm v,64,v,204,a,204,64
tr 198,243,9344
mm v,112,v,200,a,208,112
ds_read_b128 a[224:227], v244 offset:24832
buffer_load_dwordx4 v252, s[4:7], s51 offen offset:1024 lds
mm v,112,v,204,a,212,112
ds_read_b128 a[228:231], v245 offset:24832
s_add_u32 s51, s34, 59392
mm v,160,v,200,a,216,160
ds_read_b128 a[232:235], v244 offset:26880
mm v,160,v,204,a,220,160
ds_read_b128 a[236:239], v245 offset:26880
s_waitcnt lgkmcnt(10)
mm v,20,v,208,a,192,20
tr 200,243,136
s_waitcnt lgkmcnt(9)
mm v,20,v,212,a,196,20
tr 202,243,3208
mm v,68,v,208,a,200,68
tr 204,243,6280
mm v,68,v,212,a,204,68
tr 206,243,9352
mm v,116,v,208,a,208,116
ds_read_b128 a[240:243], v244 offset:28928
buffer_load_dwordx4 v252, s[4:7], s51 offen offset:2048 lds
mm v,116,v,212,a,212,116
ds_read_b128 a[244:247], v245 offset:28928
s_add_u32 s51, s34, 68608
mm v,164,v,208,a,216,164
ds_read_b128 a[248:251], v244 offset:30976
mm v,164,v,212,a,220,164
ds_read_b128 a[252:255], v245 offset:30976
s_waitcnt lgkmcnt(14)
mm v,24,v,192,a,192,24
tr 208,242,256
s_waitcnt lgkmcnt(13)
mm v,24,v,196,a,196,24
tr 210,242,3328
mm v,72,v,192,a,200,72
tr 212,242,6400
buffer_load_dwordx4 v252, s[4:7], s51 offen offset:3072 lds
mm v,72,v,196,a,204,72
tr 214,242,9472
mm v,120,v,192,a,208,120
s_add_u32 s34, s34, 128
s_cmp_eq_u32 s34, s95
s_cselect_b32 s55, 1280, 0
mm v,120,v,196,a,212,120
s_sub_u32 s34, s34, s55
s_add_u32 m0, s30, s40
mm v,168,v,192,a,216,168
mm v,168,v,196,a,220,168
s_waitcnt lgkmcnt(10)
mm v,28,v,200,a,192,28
tr 192,242,264
s_waitcnt lgkmcnt(9)
mm v,28,v,204,a,196,28
tr 194,242,3336
mm v,76,v,200,a,200,76
tr 196,242,6408
mm v,76,v,204,a,204,76
tr 198,242,9480
mm v,124,v,200,a,208,124
buffer_load_dwordx4 v249, s[8:11], s33 offen lds
mm v,124,v,204,a,212,124
mm v,172,v,200,a,216,172
mm v,172,v,204,a,220,172
s_waitcnt lgkmcnt(4)
mm v,32,v,208,a,192,32
tr 200,243,256
buffer_load_dwordx4 v250, s[8:11], s33 offen offset:1024 lds
mm v,32,v,212,a,196,32
tr 202,243,3328
mm v,80,v,208,a,200,80
tr 204,243,6400
mm v,80,v,212,a,204,80
tr 206,243,9472
mm v,128,v,208,a,208,128
mm v,128,v,212,a,212,128
s_waitcnt lgkmcnt(4)
mm v,176,v,208,a,216,176
buffer_load_dwordx4 v251, s[8:11], s33 offen offset:2048 lds
mm v,176,v,212,a,220,176
s_add_u32 s33, s33, 786432
s_cmp_eq_u32 s33, s94
s_cselect_b32 s55, 7864320, 0
mm v,36,v,192,a,192,36
tr 208,243,264
s_sub_u32 s33, s33, s55
mm v,36,v,196,a,196,36
tr 210,243,3336
mm v,84,v,192,a,200,84
tr 212,243,6408
mm v,84,v,196,a,204,84
tr 214,243,9480
mm v,132,v,192,a,208,132
s_sub_u32 s42, s29, s48
s_mov_b32 s48, s29
v_add_u32 v242, s42, v242
mm v,132,v,196,a,212,132
v_add_u32 v243, s42, v243
mm v,180,v,192,a,216,180
mm v,180,v,196,a,220,180
s_waitcnt lgkmcnt(6)
mm v,40,v,200,a,192,40
s_waitcnt vmcnt(11) lgkmcnt(0)
s_barrier
mm v,40,v,204,a,196,40
tr 192,242,0
s_mov_b32 s43, s28
mm v,88,v,200,a,200,88
tr 194,242,3072
s_mov_b32 s28, s29
mm v,88,v,204,a,204,88
tr 196,242,6144
s_mov_b32 s29, s30
mm v,136,v,200,a,208,136
tr 198,242,9216
mm v,136,v,204,a,212,136
s_mov_b32 s30, s43
mm v,184,v,200,a,216,184
mm v,184,v,204,a,220,184
mm v,44,v,208,a,192,44
tr 200,242,8
mm v,44,v,212,a,196,44
tr 202,242,3080
mm v,92,v,208,a,200,92
tr 204,242,6152
mm v,92,v,212,a,204,92
tr 206,242,9224
mm v,140,v,208,a,208,140
mm v,140,v,212,a,212,140
mm v,188,v,208,a,216,188
mm v,188,v,212,a,220,188
s_waitcnt lgkmcnt(4)
mm v,0,v,192,a,224,0
tr 208,243,0
s_add_u32 m0, s45, 0
mm v,0,v,196,a,228,0
tr 210,243,3072
s_add_u32 s51, s34, 0
mm v,48,v,192,a,232,48
tr 212,243,6144
mm v,48,v,196,a,236,48
tr 214,243,9216
mm v,96,v,192,a,240,96
buffer_load_dwordx4 v252, s[4:7], s51 offen lds
mm v,96,v,196,a,244,96
s_add_u32 s51, s34, 9216
mm v,144,v,192,a,248,144
s_waitcnt lgkmcnt(4)
mm v,144,v,196,a,252,144
buffer_load_dwordx4 v252, s[4:7], s51 offen offset:1024 lds
mm v,4,v,200,a,224,4
tr 192,243,8
s_add_u32 s51, s34, 18432
mm v,4,v,204,a,228,4
tr 194,243,3080
mm v,52,v,200,a,232,52
tr 196,243,6152
mm v,52,v,204,a,236,52
tr 198,243,9224
mm v,100,v,200,a,240,100
mm v,100,v,204,a,244,100
mm v,148,v,200,a,248,148
buffer_load_dwordx4 v252, s[4:7], s51 offen offset:2048 lds
mm v,148,v,204,a,252,148
s_add_u32 s51, s34, 27648
s_waitcnt lgkmcnt(6)
mm v,8,v,208,a,224,8
tr 200,242,128
s_waitcnt lgkmcnt(5)
mm v,8,v,212,a,228,8
tr 202,242,3200
mm v,56,v,208,a,232,56
tr 204,242,6272
mm v,56,v,212,a,236,56
tr 206,242,9344
mm v,104,v,208,a,240,104
mm v,104,v,212,a,244,104
buffer_load_dwordx4 v252, s[4:7], s51 offen offset:3072 lds
mm v,152,v,208,a,248,152
s_add_u32 m0, s45, 4096
s_add_u32 s51, s34, 40960
mm v,152,v,212,a,252,152
s_waitcnt lgkmcnt(6)
mm v,12,v,192,a,224,12
tr 208,242,136
s_waitcnt lgkmcnt(5)
mm v,12,v,196,a,228,12
tr 210,242,3208
mm v,60,v,192,a,232,60
tr 212,242,6280
mm v,60,v,196,a,236,60
tr 214,242,9352
mm v,108,v,192,a,240,108
buffer_load_dwordx4 v252, s[4:7], s51 offen lds
mm v,108,v,196,a,244,108
s_add_u32 s51, s34, 50176
mm v,156,v,192,a,248,156
mm v,156,v,196,a,252,156
s_waitcnt lgkmcnt(4)
mm v,16,v,200,a,224,16
tr 192,243,128
s_waitcnt vmcnt(8)
mm v,16,v,204,a,228,16
tr 194,243,3200
mm v,64,v,200,a,232,64
tr 196,243,6272
mm v,64,v,204,a,236,64
tr 198,243,9344
mm v,112,v,200,a,240,112
ds_read_b128 a[192:195], v244
buffer_load_dwordx4 v252, s[4:7], s51 offen offset:1024 lds
mm v,112,v,204,a,244,112
ds_read_b128 a[196:199], v245
s_add_u32 s51, s34, 59392
mm v,160,v,200,a,248,160
ds_read_b128 a[200:203], v244 offset:2048
mm v,160,v,204,a,252,160
ds_read_b128 a[204:207], v245 offset:2048
s_waitcnt lgkmcnt(10)
mm v,20,v,208,a,224,20
tr 200,243,136
s_waitcnt lgkmcnt(9)
mm v,20,v,212,a,228,20
tr 202,243,3208
mm v,68,v,208,a,232,68
tr 204,243,6280
mm v,68,v,212,a,236,68
tr 206,243,9352
mm v,116,v,208,a,240,116
ds_read_b128 a[208:211], v244 offset:4096
buffer_load_dwordx4 v252, s[4:7], s51 offen offset:2048 lds
mm v,116,v,212,a,244,116
ds_read_b128 a[212:215], v245 offset:4096
s_add_u32 s51, s34, 68608
mm v,164,v,208,a,248,164
ds_read_b128 a[216:219], v244 offset:6144
mm v,164,v,212,a,252,164
ds_read_b128 a[220:223], v245 offset:6144
s_waitcnt lgkmcnt(14)
mm v,24,v,192,a,224,24
tr 208,242,256
s_waitcnt lgkmcnt(13)
mm v,24,v,196,a,228,24
tr 210,242,3328
mm v,72,v,192,a,232,72
tr 212,242,6400
buffer_load_dwordx4 v252, s[4:7], s51 offen offset:3072 lds
mm v,72,v,196,a,236,72
tr 214,242,9472
mm v,120,v,192,a,240,120
s_add_u32 s34, s34, 128
s_cmp_eq_u32 s34, s95
s_cselect_b32 s55, 1280, 0
mm v,120,v,196,a,244,120
s_sub_u32 s34, s34, s55
s_add_u32 m0, s30, s40
mm v,168,v,192,a,248,168
mm v,168,v,196,a,252,168
s_waitcnt lgkmcnt(10)
mm v,28,v,200,a,224,28
tr 192,242,264
s_waitcnt lgkmcnt(9)
mm v,28,v,204,a,228,28
tr 194,242,3336
mm v,76,v,200,a,232,76
tr 196,242,6408
mm v,76,v,204,a,236,76
tr 198,242,9480
mm v,124,v,200,a,240,124
buffer_load_dwordx4 v249, s[8:11], s33 offen lds
mm v,124,v,204,a,244,124
mm v,172,v,200,a,248,172
mm v,172,v,204,a,252,172
s_waitcnt lgkmcnt(4)
mm v,32,v,208,a,224,32
tr 200,243,256
buffer_load_dwordx4 v250, s[8:11], s33 offen offset:1024 lds
mm v,32,v,212,a,228,32
tr 202,243,3328
mm v,80,v,208,a,232,80
tr 204,243,6400
mm v,80,v,212,a,236,80
tr 206,243,9472
mm v,128,v,208,a,240,128
mm v,128,v,212,a,244,128
s_waitcnt lgkmcnt(4)
mm v,176,v,208,a,248,176
buffer_load_dwordx4 v251, s[8:11], s33 offen offset:2048 lds
mm v,176,v,212,a,252,176
s_add_u32 s33, s33, 786432
s_cmp_eq_u32 s33, s94
s_cselect_b32 s55, 7864320, 0
mm v,36,v,192,a,224,36
tr 208,243,264
s_sub_u32 s33, s33, s55
mm v,36,v,196,a,228,36
tr 210,243,3336
mm v,84,v,192,a,232,84
tr 212,243,6408
mm v,84,v,196,a,236,84
tr 214,243,9480
mm v,132,v,192,a,240,132
s_sub_u32 s42, s29, s48
s_mov_b32 s48, s29
v_add_u32 v242, s42, v242
mm v,132,v,196,a,244,132
v_add_u32 v243, s42, v243
mm v,180,v,192,a,248,180
mm v,180,v,196,a,252,180
s_waitcnt lgkmcnt(6)
mm v,40,v,200,a,224,40
s_waitcnt vmcnt(11) lgkmcnt(0)
s_barrier
mm v,40,v,204,a,228,40
tr 192,242,0
s_mov_b32 s43, s28
mm v,88,v,200,a,232,88
tr 194,242,3072
s_mov_b32 s28, s29
mm v,88,v,204,a,236,88
tr 196,242,6144
s_mov_b32 s29, s30
mm v,136,v,200,a,240,136
tr 198,242,9216
mm v,136,v,204,a,244,136
s_mov_b32 s30, s43
mm v,184,v,200,a,248,184
mm v,184,v,204,a,252,184
mm v,44,v,208,a,224,44
tr 200,242,8
mm v,44,v,212,a,228,44
tr 202,242,3080
mm v,92,v,208,a,232,92
tr 204,242,6152
mm v,92,v,212,a,236,92
tr 206,242,9224
mm v,140,v,208,a,240,140
mm v,140,v,212,a,244,140
mm v,188,v,208,a,248,188
mm v,188,v,212,a,252,188
s_waitcnt lgkmcnt(4)
mm v,0,v,192,a,192,0
tr 208,243,0
s_add_u32 m0, s44, 0
mm v,0,v,196,a,196,0
tr 210,243,3072
s_add_u32 s51, s34, 0
mm v,48,v,192,a,200,48
tr 212,243,6144
mm v,48,v,196,a,204,48
tr 214,243,9216
mm v,96,v,192,a,208,96
buffer_load_dwordx4 v252, s[4:7], s51 offen lds
mm v,96,v,196,a,212,96
s_add_u32 s51, s34, 9216
mm v,144,v,192,a,216,144
s_waitcnt lgkmcnt(4)
mm v,144,v,196,a,220,144
buffer_load_dwordx4 v252, s[4:7], s51 offen offset:1024 lds
mm v,4,v,200,a,192,4
tr 192,243,8
s_add_u32 s51, s34, 18432
mm v,4,v,204,a,196,4
tr 194,243,3080
mm v,52,v,200,a,200,52
tr 196,243,6152
mm v,52,v,204,a,204,52
tr 198,243,9224
mm v,100,v,200,a,208,100
mm v,100,v,204,a,212,100
mm v,148,v,200,a,216,148
buffer_load_dwordx4 v252, s[4:7], s51 offen offset:2048 lds
mm v,148,v,204,a,220,148
s_add_u32 s51, s34, 27648
s_waitcnt lgkmcnt(6)
mm v,8,v,208,a,192,8
tr 200,242,128
s_waitcnt lgkmcnt(5)
mm v,8,v,212,a,196,8
tr 202,242,3200
mm v,56,v,208,a,200,56
tr 204,242,6272
mm v,56,v,212,a,204,56
tr 206,242,9344
mm v,104,v,208,a,208,104
mm v,104,v,212,a,212,104
buffer_load_dwordx4 v252, s[4:7], s51 offen offset:3072 lds
mm v,152,v,208,a,216,152
s_add_u32 m0, s44, 4096
s_add_u32 s51, s34, 40960
mm v,152,v,212,a,220,152
s_waitcnt lgkmcnt(6)
mm v,12,v,192,a,192,12
tr 208,242,136
s_waitcnt lgkmcnt(5)
mm v,12,v,196,a,196,12
tr 210,242,3208
mm v,60,v,192,a,200,60
tr 212,242,6280
mm v,60,v,196,a,204,60
tr 214,242,9352
mm v,108,v,192,a,208,108
buffer_load_dwordx4 v252, s[4:7], s51 offen lds
mm v,108,v,196,a,212,108
s_add_u32 s51, s34, 50176
mm v,156,v,192,a,216,156
mm v,156,v,196,a,220,156
s_waitcnt lgkmcnt(4)
mm v,16,v,200,a,192,16
tr 192,243,128
s_waitcnt vmcnt(8)
mm v,16,v,204,a,196,16
tr 194,243,3200
mm v,64,v,200,a,200,64
tr 196,243,6272
mm v,64,v,204,a,204,64
tr 198,243,9344
mm v,112,v,200,a,208,112
ds_read_b128 a[224:227], v244 offset:24832
buffer_load_dwordx4 v252, s[4:7], s51 offen offset:1024 lds
mm v,112,v,204,a,212,112
ds_read_b128 a[228:231], v245 offset:24832
s_add_u32 s51, s34, 59392
mm v,160,v,200,a,216,160
ds_read_b128 a[232:235], v244 offset:26880
mm v,160,v,204,a,220,160
ds_read_b128 a[236:239], v245 offset:26880
s_waitcnt lgkmcnt(10)
mm v,20,v,208,a,192,20
tr 200,243,136
s_waitcnt lgkmcnt(9)
mm v,20,v,212,a,196,20
tr 202,243,3208
mm v,68,v,208,a,200,68
tr 204,243,6280
mm v,68,v,212,a,204,68
tr 206,243,9352
mm v,116,v,208,a,208,116
ds_read_b128 a[240:243], v244 offset:28928
buffer_load_dwordx4 v252, s[4:7], s51 offen offset:2048 lds
mm v,116,v,212,a,212,116
ds_read_b128 a[244:247], v245 offset:28928
s_add_u32 s51, s34, 68608
mm v,164,v,208,a,216,164
ds_read_b128 a[248:251], v244 offset:30976
mm v,164,v,212,a,220,164
ds_read_b128 a[252:255], v245 offset:30976
s_waitcnt lgkmcnt(14)
mm v,24,v,192,a,192,24
tr 208,242,256
s_waitcnt lgkmcnt(13)
mm v,24,v,196,a,196,24
tr 210,242,3328
mm v,72,v,192,a,200,72
tr 212,242,6400
buffer_load_dwordx4 v252, s[4:7], s51 offen offset:3072 lds
mm v,72,v,196,a,204,72
tr 214,242,9472
mm v,120,v,192,a,208,120
s_add_u32 s34, s34, 128
s_cmp_eq_u32 s34, s95
s_cselect_b32 s55, 1280, 0
mm v,120,v,196,a,212,120
s_sub_u32 s34, s34, s55
s_add_u32 m0, s30, s40
mm v,168,v,192,a,216,168
mm v,168,v,196,a,220,168
s_waitcnt lgkmcnt(10)
mm v,28,v,200,a,192,28
tr 192,242,264
s_waitcnt lgkmcnt(9)
mm v,28,v,204,a,196,28
tr 194,242,3336
mm v,76,v,200,a,200,76
tr 196,242,6408
mm v,76,v,204,a,204,76
tr 198,242,9480
mm v,124,v,200,a,208,124
buffer_load_dwordx4 v249, s[8:11], s33 offen lds
mm v,124,v,204,a,212,124
mm v,172,v,200,a,216,172
mm v,172,v,204,a,220,172
s_waitcnt lgkmcnt(4)
mm v,32,v,208,a,192,32
tr 200,243,256
buffer_load_dwordx4 v250, s[8:11], s33 offen offset:1024 lds
mm v,32,v,212,a,196,32
tr 202,243,3328
mm v,80,v,208,a,200,80
tr 204,243,6400
mm v,80,v,212,a,204,80
tr 206,243,9472
mm v,128,v,208,a,208,128
mm v,128,v,212,a,212,128
s_waitcnt lgkmcnt(4)
mm v,176,v,208,a,216,176
buffer_load_dwordx4 v251, s[8:11], s33 offen offset:2048 lds
mm v,176,v,212,a,220,176
s_add_u32 s33, s33, 786432
s_cmp_eq_u32 s33, s94
s_cselect_b32 s55, 7864320, 0
mm v,36,v,192,a,192,36
tr 208,243,264
s_sub_u32 s33, s33, s55
mm v,36,v,196,a,196,36
tr 210,243,3336
mm v,84,v,192,a,200,84
tr 212,243,6408
mm v,84,v,196,a,204,84
tr 214,243,9480
mm v,132,v,192,a,208,132
s_sub_u32 s42, s29, s48
s_mov_b32 s48, s29
v_add_u32 v242, s42, v242
mm v,132,v,196,a,212,132
v_add_u32 v243, s42, v243
mm v,180,v,192,a,216,180
mm v,180,v,196,a,220,180
s_waitcnt lgkmcnt(6)
mm v,40,v,200,a,192,40
s_waitcnt vmcnt(11) lgkmcnt(0)
s_barrier
mm v,40,v,204,a,196,40
tr 192,242,0
s_mov_b32 s43, s28
mm v,88,v,200,a,200,88
tr 194,242,3072
s_mov_b32 s28, s29
mm v,88,v,204,a,204,88
tr 196,242,6144
s_mov_b32 s29, s30
mm v,136,v,200,a,208,136
tr 198,242,9216
mm v,136,v,204,a,212,136
s_mov_b32 s30, s43
mm v,184,v,200,a,216,184
mm v,184,v,204,a,220,184
mm v,44,v,208,a,192,44
tr 200,242,8
mm v,44,v,212,a,196,44
tr 202,242,3080
mm v,92,v,208,a,200,92
tr 204,242,6152
mm v,92,v,212,a,204,92
tr 206,242,9224
mm v,140,v,208,a,208,140
mm v,140,v,212,a,212,140
mm v,188,v,208,a,216,188
L_pg2:
s_cbranch_execz L_ir1
mm v,188,v,212,a,220,188
s_waitcnt lgkmcnt(4)
mm v,0,v,192,a,224,0
tr 208,243,0
s_add_u32 m0, s45, 0
mm v,0,v,196,a,228,0
tr 210,243,3072
s_add_u32 s51, s34, 0
mm v,48,v,192,a,232,48
tr 212,243,6144
mm v,48,v,196,a,236,48
tr 214,243,9216
mm v,96,v,192,a,240,96
buffer_load_dwordx4 v252, s[4:7], s51 offen lds
mm v,96,v,196,a,244,96
s_add_u32 s51, s34, 9216
mm v,144,v,192,a,248,144
s_waitcnt lgkmcnt(4)
mm v,144,v,196,a,252,144
buffer_load_dwordx4 v252, s[4:7], s51 offen offset:1024 lds
mm v,4,v,200,a,224,4
tr 192,243,8
s_add_u32 s51, s34, 18432
mm v,4,v,204,a,228,4
tr 194,243,3080
mm v,52,v,200,a,232,52
tr 196,243,6152
mm v,52,v,204,a,236,52
tr 198,243,9224
mm v,100,v,200,a,240,100
mm v,100,v,204,a,244,100
mm v,148,v,200,a,248,148
buffer_load_dwordx4 v252, s[4:7], s51 offen offset:2048 lds
mm v,148,v,204,a,252,148
s_add_u32 s51, s34, 27648
s_waitcnt lgkmcnt(6)
mm v,8,v,208,a,224,8
tr 200,242,128
s_waitcnt lgkmcnt(5)
mm v,8,v,212,a,228,8
tr 202,242,3200
mm v,56,v,208,a,232,56
tr 204,242,6272
mm v,56,v,212,a,236,56
tr 206,242,9344
mm v,104,v,208,a,240,104
mm v,104,v,212,a,244,104
buffer_load_dwordx4 v252, s[4:7], s51 offen offset:3072 lds
mm v,152,v,208,a,248,152
s_add_u32 m0, s45, 4096
s_add_u32 s51, s34, 40960
mm v,152,v,212,a,252,152
s_waitcnt lgkmcnt(6)
mm v,12,v,192,a,224,12
tr 208,242,136
s_waitcnt lgkmcnt(5)
mm v,12,v,196,a,228,12
tr 210,242,3208
mm v,60,v,192,a,232,60
tr 212,242,6280
mm v,60,v,196,a,236,60
tr 214,242,9352
mm v,108,v,192,a,240,108
buffer_load_dwordx4 v252, s[4:7], s51 offen lds
mm v,108,v,196,a,244,108
s_add_u32 s51, s34, 50176
mm v,156,v,192,a,248,156
mm v,156,v,196,a,252,156
s_waitcnt lgkmcnt(4)
mm v,16,v,200,a,224,16
tr 192,243,128
s_waitcnt vmcnt(8)
mm v,16,v,204,a,228,16
tr 194,243,3200
mm v,64,v,200,a,232,64
tr 196,243,6272
mm v,64,v,204,a,236,64
tr 198,243,9344
mm v,112,v,200,a,240,112
ds_read_b128 a[192:195], v244
buffer_load_dwordx4 v252, s[4:7], s51 offen offset:1024 lds
mm v,112,v,204,a,244,112
ds_read_b128 a[196:199], v245
s_add_u32 s51, s34, 59392
mm v,160,v,200,a,248,160
ds_read_b128 a[200:203], v244 offset:2048
mm v,160,v,204,a,252,160
ds_read_b128 a[204:207], v245 offset:2048
s_waitcnt lgkmcnt(10)
mm v,20,v,208,a,224,20
tr 200,243,136
s_waitcnt lgkmcnt(9)
mm v,20,v,212,a,228,20
tr 202,243,3208
mm v,68,v,208,a,232,68
tr 204,243,6280
mm v,68,v,212,a,236,68
tr 206,243,9352
mm v,116,v,208,a,240,116
ds_read_b128 a[208:211], v244 offset:4096
buffer_load_dwordx4 v252, s[4:7], s51 offen offset:2048 lds
mm v,116,v,212,a,244,116
ds_read_b128 a[212:215], v245 offset:4096
s_add_u32 s51, s34, 68608
mm v,164,v,208,a,248,164
ds_read_b128 a[216:219], v244 offset:6144
mm v,164,v,212,a,252,164
ds_read_b128 a[220:223], v245 offset:6144
s_waitcnt lgkmcnt(14)
mm v,24,v,192,a,224,24
tr 208,242,256
s_waitcnt lgkmcnt(13)
mm v,24,v,196,a,228,24
tr 210,242,3328
mm v,72,v,192,a,232,72
tr 212,242,6400
buffer_load_dwordx4 v252, s[4:7], s51 offen offset:3072 lds
mm v,72,v,196,a,236,72
tr 214,242,9472
mm v,120,v,192,a,240,120
s_add_u32 s34, s34, 128
s_cmp_eq_u32 s34, s95
s_cselect_b32 s55, 1280, 0
mm v,120,v,196,a,244,120
s_sub_u32 s34, s34, s55
s_add_u32 m0, s30, s40
mm v,168,v,192,a,248,168
mm v,168,v,196,a,252,168
s_waitcnt lgkmcnt(10)
mm v,28,v,200,a,224,28
tr 192,242,264
s_waitcnt lgkmcnt(9)
mm v,28,v,204,a,228,28
tr 194,242,3336
mm v,76,v,200,a,232,76
tr 196,242,6408
mm v,76,v,204,a,236,76
tr 198,242,9480
mm v,124,v,200,a,240,124
buffer_load_dwordx4 v249, s[8:11], s33 offen lds
mm v,124,v,204,a,244,124
mm v,172,v,200,a,248,172
mm v,172,v,204,a,252,172
s_waitcnt lgkmcnt(4)
mm v,32,v,208,a,224,32
tr 200,243,256
buffer_load_dwordx4 v250, s[8:11], s33 offen offset:1024 lds
mm v,32,v,212,a,228,32
tr 202,243,3328
mm v,80,v,208,a,232,80
tr 204,243,6400
mm v,80,v,212,a,236,80
tr 206,243,9472
mm v,128,v,208,a,240,128
mm v,128,v,212,a,244,128
s_waitcnt lgkmcnt(4)
mm v,176,v,208,a,248,176
buffer_load_dwordx4 v251, s[8:11], s33 offen offset:2048 lds
mm v,176,v,212,a,252,176
s_add_u32 s33, s33, 786432
s_cmp_eq_u32 s33, s94
s_cselect_b32 s55, 7864320, 0
mm v,36,v,192,a,224,36
tr 208,243,264
s_sub_u32 s33, s33, s55
mm v,36,v,196,a,228,36
tr 210,243,3336
mm v,84,v,192,a,232,84
tr 212,243,6408
mm v,84,v,196,a,236,84
tr 214,243,9480
mm v,132,v,192,a,240,132
s_sub_u32 s42, s29, s48
s_mov_b32 s48, s29
v_add_u32 v242, s42, v242
mm v,132,v,196,a,244,132
v_add_u32 v243, s42, v243
mm v,180,v,192,a,248,180
mm v,180,v,196,a,252,180
s_waitcnt lgkmcnt(6)
mm v,40,v,200,a,224,40
s_waitcnt vmcnt(11) lgkmcnt(0)
s_barrier
mm v,40,v,204,a,228,40
tr 192,242,0
s_mov_b32 s43, s28
mm v,88,v,200,a,232,88
tr 194,242,3072
s_mov_b32 s28, s29
mm v,88,v,204,a,236,88
tr 196,242,6144
s_mov_b32 s29, s30
mm v,136,v,200,a,240,136
tr 198,242,9216
mm v,136,v,204,a,244,136
s_mov_b32 s30, s43
mm v,184,v,200,a,248,184
mm v,184,v,204,a,252,184
mm v,44,v,208,a,224,44
tr 200,242,8
mm v,44,v,212,a,228,44
tr 202,242,3080
mm v,92,v,208,a,232,92
tr 204,242,6152
mm v,92,v,212,a,236,92
tr 206,242,9224
mm v,140,v,208,a,240,140
mm v,140,v,212,a,244,140
mm v,188,v,208,a,248,188
mm v,188,v,212,a,252,188
s_waitcnt lgkmcnt(4)
mm v,0,v,192,a,192,0
tr 208,243,0
s_add_u32 m0, s44, 0
mm v,0,v,196,a,196,0
tr 210,243,3072
s_add_u32 s51, s34, 0
mm v,48,v,192,a,200,48
tr 212,243,6144
mm v,48,v,196,a,204,48
tr 214,243,9216
mm v,96,v,192,a,208,96
buffer_load_dwordx4 v252, s[4:7], s51 offen lds
mm v,96,v,196,a,212,96
s_add_u32 s51, s34, 9216
mm v,144,v,192,a,216,144
s_waitcnt lgkmcnt(4)
mm v,144,v,196,a,220,144
buffer_load_dwordx4 v252, s[4:7], s51 offen offset:1024 lds
mm v,4,v,200,a,192,4
tr 192,243,8
s_add_u32 s51, s34, 18432
mm v,4,v,204,a,196,4
tr 194,243,3080
mm v,52,v,200,a,200,52
tr 196,243,6152
mm v,52,v,204,a,204,52
tr 198,243,9224
mm v,100,v,200,a,208,100
mm v,100,v,204,a,212,100
mm v,148,v,200,a,216,148
buffer_load_dwordx4 v252, s[4:7], s51 offen offset:2048 lds
mm v,148,v,204,a,220,148
s_add_u32 s51, s34, 27648
s_waitcnt lgkmcnt(6)
mm v,8,v,208,a,192,8
tr 200,242,128
s_waitcnt lgkmcnt(5)
mm v,8,v,212,a,196,8
tr 202,242,3200
mm v,56,v,208,a,200,56
tr 204,242,6272
mm v,56,v,212,a,204,56
tr 206,242,9344
mm v,104,v,208,a,208,104
mm v,104,v,212,a,212,104
buffer_load_dwordx4 v252, s[4:7], s51 offen offset:3072 lds
mm v,152,v,208,a,216,152
s_add_u32 m0, s44, 4096
s_add_u32 s51, s34, 40960
mm v,152,v,212,a,220,152
s_waitcnt lgkmcnt(6)
mm v,12,v,192,a,192,12
tr 208,242,136
s_waitcnt lgkmcnt(5)
mm v,12,v,196,a,196,12
tr 210,242,3208
mm v,60,v,192,a,200,60
tr 212,242,6280
mm v,60,v,196,a,204,60
tr 214,242,9352
mm v,108,v,192,a,208,108
buffer_load_dwordx4 v252, s[4:7], s51 offen lds
mm v,108,v,196,a,212,108
s_add_u32 s51, s34, 50176
mm v,156,v,192,a,216,156
mm v,156,v,196,a,220,156
s_waitcnt lgkmcnt(4)
mm v,16,v,200,a,192,16
tr 192,243,128
s_waitcnt vmcnt(8)
mm v,16,v,204,a,196,16
tr 194,243,3200
mm v,64,v,200,a,200,64
tr 196,243,6272
mm v,64,v,204,a,204,64
tr 198,243,9344
mm v,112,v,200,a,208,112
ds_read_b128 a[224:227], v244 offset:24832
buffer_load_dwordx4 v252, s[4:7], s51 offen offset:1024 lds
mm v,112,v,204,a,212,112
ds_read_b128 a[228:231], v245 offset:24832
s_add_u32 s51, s34, 59392
mm v,160,v,200,a,216,160
ds_read_b128 a[232:235], v244 offset:26880
mm v,160,v,204,a,220,160
ds_read_b128 a[236:239], v245 offset:26880
s_waitcnt lgkmcnt(10)
mm v,20,v,208,a,192,20
tr 200,243,136
s_waitcnt lgkmcnt(9)
mm v,20,v,212,a,196,20
tr 202,243,3208
mm v,68,v,208,a,200,68
tr 204,243,6280
mm v,68,v,212,a,204,68
tr 206,243,9352
mm v,116,v,208,a,208,116
ds_read_b128 a[240:243], v244 offset:28928
buffer_load_dwordx4 v252, s[4:7], s51 offen offset:2048 lds
mm v,116,v,212,a,212,116
ds_read_b128 a[244:247], v245 offset:28928
s_add_u32 s51, s34, 68608
mm v,164,v,208,a,216,164
ds_read_b128 a[248:251], v244 offset:30976
mm v,164,v,212,a,220,164
ds_read_b128 a[252:255], v245 offset:30976
s_waitcnt lgkmcnt(14)
mm v,24,v,192,a,192,24
tr 208,242,256
s_waitcnt lgkmcnt(13)
mm v,24,v,196,a,196,24
tr 210,242,3328
mm v,72,v,192,a,200,72
tr 212,242,6400
buffer_load_dwordx4 v252, s[4:7], s51 offen offset:3072 lds
mm v,72,v,196,a,204,72
tr 214,242,9472
mm v,120,v,192,a,208,120
s_add_u32 s34, s34, 128
s_cmp_eq_u32 s34, s95
s_cselect_b32 s55, 1280, 0
mm v,120,v,196,a,212,120
s_sub_u32 s34, s34, s55
s_add_u32 m0, s30, s40
mm v,168,v,192,a,216,168
mm v,168,v,196,a,220,168
s_waitcnt lgkmcnt(10)
mm v,28,v,200,a,192,28
tr 192,242,264
s_waitcnt lgkmcnt(9)
mm v,28,v,204,a,196,28
tr 194,242,3336
mm v,76,v,200,a,200,76
tr 196,242,6408
mm v,76,v,204,a,204,76
tr 198,242,9480
mm v,124,v,200,a,208,124
buffer_load_dwordx4 v249, s[8:11], s33 offen lds
mm v,124,v,204,a,212,124
mm v,172,v,200,a,216,172
mm v,172,v,204,a,220,172
s_waitcnt lgkmcnt(4)
mm v,32,v,208,a,192,32
tr 200,243,256
buffer_load_dwordx4 v250, s[8:11], s33 offen offset:1024 lds
mm v,32,v,212,a,196,32
tr 202,243,3328
mm v,80,v,208,a,200,80
tr 204,243,6400
mm v,80,v,212,a,204,80
tr 206,243,9472
mm v,128,v,208,a,208,128
mm v,128,v,212,a,212,128
s_waitcnt lgkmcnt(4)
mm v,176,v,208,a,216,176
buffer_load_dwordx4 v251, s[8:11], s33 offen offset:2048 lds
mm v,176,v,212,a,220,176
s_add_u32 s33, s33, 786432
s_cmp_eq_u32 s33, s94
s_cselect_b32 s55, 7864320, 0
mm v,36,v,192,a,192,36
tr 208,243,264
s_sub_u32 s33, s33, s55
mm v,36,v,196,a,196,36
tr 210,243,3336
mm v,84,v,192,a,200,84
tr 212,243,6408
mm v,84,v,196,a,204,84
tr 214,243,9480
mm v,132,v,192,a,208,132
s_sub_u32 s42, s29, s48
s_mov_b32 s48, s29
v_add_u32 v242, s42, v242
mm v,132,v,196,a,212,132
v_add_u32 v243, s42, v243
mm v,180,v,192,a,216,180
mm v,180,v,196,a,220,180
s_waitcnt lgkmcnt(6)
mm v,40,v,200,a,192,40
s_waitcnt vmcnt(11) lgkmcnt(0)
s_barrier
mm v,40,v,204,a,196,40
tr 192,242,0
s_mov_b32 s43, s28
mm v,88,v,200,a,200,88
tr 194,242,3072
s_mov_b32 s28, s29
mm v,88,v,204,a,204,88
tr 196,242,6144
s_mov_b32 s29, s30
mm v,136,v,200,a,208,136
tr 198,242,9216
mm v,136,v,204,a,212,136
s_mov_b32 s30, s43
mm v,184,v,200,a,216,184
mm v,184,v,204,a,220,184
mm v,44,v,208,a,192,44
tr 200,242,8
mm v,44,v,212,a,196,44
tr 202,242,3080
mm v,92,v,208,a,200,92
tr 204,242,6152
mm v,92,v,212,a,204,92
tr 206,242,9224
mm v,140,v,208,a,208,140
mm v,140,v,212,a,212,140
mm v,188,v,208,a,216,188
mm v,188,v,212,a,220,188
s_waitcnt lgkmcnt(4)
mm v,0,v,192,a,224,0
tr 208,243,0
s_add_u32 m0, s45, 0
mm v,0,v,196,a,228,0
tr 210,243,3072
s_add_u32 s51, s34, 0
mm v,48,v,192,a,232,48
tr 212,243,6144
mm v,48,v,196,a,236,48
tr 214,243,9216
mm v,96,v,192,a,240,96
buffer_load_dwordx4 v252, s[4:7], s51 offen lds
mm v,96,v,196,a,244,96
s_add_u32 s51, s34, 9216
mm v,144,v,192,a,248,144
s_waitcnt lgkmcnt(4)
mm v,144,v,196,a,252,144
buffer_load_dwordx4 v252, s[4:7], s51 offen offset:1024 lds
mm v,4,v,200,a,224,4
tr 192,243,8
s_add_u32 s51, s34, 18432
mm v,4,v,204,a,228,4
tr 194,243,3080
mm v,52,v,200,a,232,52
tr 196,243,6152
mm v,52,v,204,a,236,52
tr 198,243,9224
mm v,100,v,200,a,240,100
mm v,100,v,204,a,244,100
mm v,148,v,200,a,248,148
buffer_load_dwordx4 v252, s[4:7], s51 offen offset:2048 lds
mm v,148,v,204,a,252,148
s_add_u32 s51, s34, 27648
s_waitcnt lgkmcnt(6)
mm v,8,v,208,a,224,8
tr 200,242,128
s_waitcnt lgkmcnt(5)
mm v,8,v,212,a,228,8
tr 202,242,3200
mm v,56,v,208,a,232,56
tr 204,242,6272
mm v,56,v,212,a,236,56
tr 206,242,9344
mm v,104,v,208,a,240,104
mm v,104,v,212,a,244,104
buffer_load_dwordx4 v252, s[4:7], s51 offen offset:3072 lds
mm v,152,v,208,a,248,152
s_add_u32 m0, s45, 4096
s_add_u32 s51, s34, 40960
mm v,152,v,212,a,252,152
s_waitcnt lgkmcnt(6)
mm v,12,v,192,a,224,12
tr 208,242,136
s_waitcnt lgkmcnt(5)
mm v,12,v,196,a,228,12
tr 210,242,3208
mm v,60,v,192,a,232,60
tr 212,242,6280
mm v,60,v,196,a,236,60
tr 214,242,9352
mm v,108,v,192,a,240,108
buffer_load_dwordx4 v252, s[4:7], s51 offen lds
mm v,108,v,196,a,244,108
s_add_u32 s51, s34, 50176
mm v,156,v,192,a,248,156
mm v,156,v,196,a,252,156
s_waitcnt lgkmcnt(4)
mm v,16,v,200,a,224,16
tr 192,243,128
s_waitcnt vmcnt(8)
mm v,16,v,204,a,228,16
tr 194,243,3200
mm v,64,v,200,a,232,64
tr 196,243,6272
mm v,64,v,204,a,236,64
tr 198,243,9344
mm v,112,v,200,a,240,112
ds_read_b128 a[192:195], v244
buffer_load_dwordx4 v252, s[4:7], s51 offen offset:1024 lds
mm v,112,v,204,a,244,112
ds_read_b128 a[196:199], v245
s_add_u32 s51, s34, 59392
mm v,160,v,200,a,248,160
ds_read_b128 a[200:203], v244 offset:2048
mm v,160,v,204,a,252,160
ds_read_b128 a[204:207], v245 offset:2048
s_waitcnt lgkmcnt(10)
mm v,20,v,208,a,224,20
tr 200,243,136
s_waitcnt lgkmcnt(9)
mm v,20,v,212,a,228,20
tr 202,243,3208
mm v,68,v,208,a,232,68
tr 204,243,6280
mm v,68,v,212,a,236,68
tr 206,243,9352
mm v,116,v,208,a,240,116
ds_read_b128 a[208:211], v244 offset:4096
buffer_load_dwordx4 v252, s[4:7], s51 offen offset:2048 lds
mm v,116,v,212,a,244,116
ds_read_b128 a[212:215], v245 offset:4096
s_add_u32 s51, s34, 68608
mm v,164,v,208,a,248,164
ds_read_b128 a[216:219], v244 offset:6144
mm v,164,v,212,a,252,164
ds_read_b128 a[220:223], v245 offset:6144
s_waitcnt lgkmcnt(14)
mm v,24,v,192,a,224,24
tr 208,242,256
s_waitcnt lgkmcnt(13)
mm v,24,v,196,a,228,24
tr 210,242,3328
mm v,72,v,192,a,232,72
tr 212,242,6400
buffer_load_dwordx4 v252, s[4:7], s51 offen offset:3072 lds
mm v,72,v,196,a,236,72
tr 214,242,9472
mm v,120,v,192,a,240,120
s_add_u32 s34, s34, 128
s_cmp_eq_u32 s34, s95
s_cselect_b32 s55, 1280, 0
mm v,120,v,196,a,244,120
s_sub_u32 s34, s34, s55
s_add_u32 m0, s30, s40
mm v,168,v,192,a,248,168
mm v,168,v,196,a,252,168
s_waitcnt lgkmcnt(10)
mm v,28,v,200,a,224,28
tr 192,242,264
s_waitcnt lgkmcnt(9)
mm v,28,v,204,a,228,28
tr 194,242,3336
mm v,76,v,200,a,232,76
tr 196,242,6408
mm v,76,v,204,a,236,76
L_pg4:
s_cbranch_execz L_ir1
tr 198,242,9480
mm v,124,v,200,a,240,124
buffer_load_dwordx4 v249, s[8:11], s33 offen lds
mm v,124,v,204,a,244,124
mm v,172,v,200,a,248,172
mm v,172,v,204,a,252,172
s_waitcnt lgkmcnt(4)
mm v,32,v,208,a,224,32
tr 200,243,256
buffer_load_dwordx4 v250, s[8:11], s33 offen offset:1024 lds
mm v,32,v,212,a,228,32
tr 202,243,3328
mm v,80,v,208,a,232,80
tr 204,243,6400
mm v,80,v,212,a,236,80
tr 206,243,9472
mm v,128,v,208,a,240,128
mm v,128,v,212,a,244,128
s_waitcnt lgkmcnt(4)
mm v,176,v,208,a,248,176
buffer_load_dwordx4 v251, s[8:11], s33 offen offset:2048 lds
mm v,176,v,212,a,252,176
s_add_u32 s33, s33, 786432
s_cmp_eq_u32 s33, s94
s_cselect_b32 s55, 7864320, 0
mm v,36,v,192,a,224,36
tr 208,243,264
s_sub_u32 s33, s33, s55
mm v,36,v,196,a,228,36
tr 210,243,3336
mm v,84,v,192,a,232,84
tr 212,243,6408
mm v,84,v,196,a,236,84
tr 214,243,9480
mm v,132,v,192,a,240,132
s_sub_u32 s42, s29, s48
s_mov_b32 s48, s29
v_add_u32 v242, s42, v242
mm v,132,v,196,a,244,132
v_add_u32 v243, s42, v243
mm v,180,v,192,a,248,180
mm v,180,v,196,a,252,180
s_waitcnt lgkmcnt(6)
mm v,40,v,200,a,224,40
s_waitcnt vmcnt(11) lgkmcnt(0)
s_barrier
mm v,40,v,204,a,228,40
tr 192,242,0
s_mov_b32 s43, s28
mm v,88,v,200,a,232,88
tr 194,242,3072
s_mov_b32 s28, s29
mm v,88,v,204,a,236,88
tr 196,242,6144
s_mov_b32 s29, s30
mm v,136,v,200,a,240,136
tr 198,242,9216
mm v,136,v,204,a,244,136
s_mov_b32 s30, s43
mm v,184,v,200,a,248,184
mm v,184,v,204,a,252,184
mm v,44,v,208,a,224,44
tr 200,242,8
mm v,44,v,212,a,228,44
tr 202,242,3080
mm v,92,v,208,a,232,92
tr 204,242,6152
mm v,92,v,212,a,236,92
tr 206,242,9224
mm v,140,v,208,a,240,140
mm v,140,v,212,a,244,140
mm v,188,v,208,a,248,188
mm v,188,v,212,a,252,188
s_waitcnt lgkmcnt(6)
mm v,0,v,192,a,192,0
tr 208,243,0
s_waitcnt lgkmcnt(5)
mm v,0,v,196,a,196,0
tr 210,243,3072
mm v,48,v,192,a,200,48
tr 212,243,6144
mm v,48,v,196,a,204,48
tr 214,243,9216
mm v,96,v,192,a,208,96
mm v,96,v,196,a,212,96
mm v,144,v,192,a,216,144
mm v,144,v,196,a,220,144
s_waitcnt lgkmcnt(6)
mm v,4,v,200,a,192,4
tr 192,243,8
s_waitcnt lgkmcnt(5)
mm v,4,v,204,a,196,4
tr 194,243,3080
mm v,52,v,200,a,200,52
tr 196,243,6152
mm v,52,v,204,a,204,52
tr 198,243,9224
mm v,100,v,200,a,208,100
mm v,100,v,204,a,212,100
mm v,148,v,200,a,216,148
mm v,148,v,204,a,220,148
s_waitcnt lgkmcnt(6)
mm v,8,v,208,a,192,8
tr 200,242,128
s_waitcnt lgkmcnt(5)
mm v,8,v,212,a,196,8
tr 202,242,3200
mm v,56,v,208,a,200,56
tr 204,242,6272
mm v,56,v,212,a,204,56
tr 206,242,9344
mm v,104,v,208,a,208,104
mm v,104,v,212,a,212,104
mm v,152,v,208,a,216,152
mm v,152,v,212,a,220,152
s_waitcnt lgkmcnt(6)
mm v,12,v,192,a,192,12
tr 208,242,136
s_waitcnt lgkmcnt(5)
mm v,12,v,196,a,196,12
tr 210,242,3208
mm v,60,v,192,a,200,60
tr 212,242,6280
mm v,60,v,196,a,204,60
tr 214,242,9352
mm v,108,v,192,a,208,108
mm v,108,v,196,a,212,108
mm v,156,v,192,a,216,156
mm v,156,v,196,a,220,156
s_waitcnt lgkmcnt(4)
mm v,16,v,200,a,192,16
tr 192,243,128
s_waitcnt vmcnt(3)
mm v,16,v,204,a,196,16
tr 194,243,3200
mm v,64,v,200,a,200,64
tr 196,243,6272
mm v,64,v,204,a,204,64
tr 198,243,9344
mm v,112,v,200,a,208,112
ds_read_b128 a[224:227], v244 offset:24832
mm v,112,v,204,a,212,112
ds_read_b128 a[228:231], v245 offset:24832
mm v,160,v,200,a,216,160
ds_read_b128 a[232:235], v244 offset:26880
mm v,160,v,204,a,220,160
ds_read_b128 a[236:239], v245 offset:26880
s_waitcnt lgkmcnt(10)
mm v,20,v,208,a,192,20
tr 200,243,136
s_waitcnt lgkmcnt(9)
mm v,20,v,212,a,196,20
tr 202,243,3208
mm v,68,v,208,a,200,68
tr 204,243,6280
mm v,68,v,212,a,204,68
tr 206,243,9352
mm v,116,v,208,a,208,116
ds_read_b128 a[240:243], v244 offset:28928
mm v,116,v,212,a,212,116
ds_read_b128 a[244:247], v245 offset:28928
mm v,164,v,208,a,216,164
ds_read_b128 a[248:251], v244 offset:30976
mm v,164,v,212,a,220,164
ds_read_b128 a[252:255], v245 offset:30976
s_waitcnt lgkmcnt(14)
mm v,24,v,192,a,192,24
tr 208,242,256
s_waitcnt lgkmcnt(13)
mm v,24,v,196,a,196,24
tr 210,242,3328
mm v,72,v,192,a,200,72
tr 212,242,6400
mm v,72,v,196,a,204,72
tr 214,242,9472
mm v,120,v,192,a,208,120
mm v,120,v,196,a,212,120
mm v,168,v,192,a,216,168
mm v,168,v,196,a,220,168
s_waitcnt lgkmcnt(10)
mm v,28,v,200,a,192,28
tr 192,242,264
s_waitcnt lgkmcnt(9)
mm v,28,v,204,a,196,28
tr 194,242,3336
mm v,76,v,200,a,200,76
tr 196,242,6408
mm v,76,v,204,a,204,76
tr 198,242,9480
mm v,124,v,200,a,208,124
mm v,124,v,204,a,212,124
mm v,172,v,200,a,216,172
mm v,172,v,204,a,220,172
s_waitcnt lgkmcnt(6)
mm v,32,v,208,a,192,32
tr 200,243,256
s_waitcnt lgkmcnt(5)
mm v,32,v,212,a,196,32
tr 202,243,3328
mm v,80,v,208,a,200,80
tr 204,243,6400
mm v,80,v,212,a,204,80
tr 206,243,9472
mm v,128,v,208,a,208,128
mm v,128,v,212,a,212,128
mm v,176,v,208,a,216,176
mm v,176,v,212,a,220,176
s_waitcnt lgkmcnt(6)
mm v,36,v,192,a,192,36
tr 208,243,264
s_waitcnt lgkmcnt(5)
mm v,36,v,196,a,196,36
tr 210,243,3336
mm v,84,v,192,a,200,84
tr 212,243,6408
mm v,84,v,196,a,204,84
tr 214,243,9480
mm v,132,v,192,a,208,132
s_sub_u32 s42, s29, s48
s_mov_b32 s48, s29
v_add_u32 v242, s42, v242
mm v,132,v,196,a,212,132
v_add_u32 v243, s42, v243
mm v,180,v,192,a,216,180
mm v,180,v,196,a,220,180
s_waitcnt lgkmcnt(6)
mm v,40,v,200,a,192,40
s_waitcnt vmcnt(0) lgkmcnt(0)
s_barrier
mm v,40,v,204,a,196,40
tr 192,242,0
s_mov_b32 s43, s28
mm v,88,v,200,a,200,88
tr 194,242,3072
s_mov_b32 s28, s29
mm v,88,v,204,a,204,88
tr 196,242,6144
s_mov_b32 s29, s30
mm v,136,v,200,a,208,136
tr 198,242,9216
mm v,136,v,204,a,212,136
s_mov_b32 s30, s43
mm v,184,v,200,a,216,184
mm v,184,v,204,a,220,184
mm v,44,v,208,a,192,44
tr 200,242,8
mm v,44,v,212,a,196,44
tr 202,242,3080
mm v,92,v,208,a,200,92
tr 204,242,6152
mm v,92,v,212,a,204,92
tr 206,242,9224
mm v,140,v,208,a,208,140
mm v,140,v,212,a,212,140
mm v,188,v,208,a,216,188
mm v,188,v,212,a,220,188
s_waitcnt lgkmcnt(6)
mm v,0,v,192,a,224,0
tr 208,243,0
s_waitcnt lgkmcnt(5)
mm v,0,v,196,a,228,0
tr 210,243,3072
mm v,48,v,192,a,232,48
tr 212,243,6144
mm v,48,v,196,a,236,48
tr 214,243,9216
mm v,96,v,192,a,240,96
mm v,96,v,196,a,244,96
mm v,144,v,192,a,248,144
mm v,144,v,196,a,252,144
s_waitcnt lgkmcnt(6)
mm v,4,v,200,a,224,4
tr 192,243,8
s_waitcnt lgkmcnt(5)
mm v,4,v,204,a,228,4
tr 194,243,3080
mm v,52,v,200,a,232,52
tr 196,243,6152
mm v,52,v,204,a,236,52
tr 198,243,9224
mm v,100,v,200,a,240,100
mm v,100,v,204,a,244,100
mm v,148,v,200,a,248,148
mm v,148,v,204,a,252,148
s_waitcnt lgkmcnt(6)
mm v,8,v,208,a,224,8
tr 200,242,128
s_waitcnt lgkmcnt(5)
mm v,8,v,212,a,228,8
tr 202,242,3200
mm v,56,v,208,a,232,56
tr 204,242,6272
mm v,56,v,212,a,236,56
tr 206,242,9344
mm v,104,v,208,a,240,104
mm v,104,v,212,a,244,104
mm v,152,v,208,a,248,152
mm v,152,v,212,a,252,152
s_waitcnt lgkmcnt(6)
mm v,12,v,192,a,224,12
tr 208,242,136
s_waitcnt lgkmcnt(5)
mm v,12,v,196,a,228,12
tr 210,242,3208
mm v,60,v,192,a,232,60
tr 212,242,6280
mm v,60,v,196,a,236,60
tr 214,242,9352
mm v,108,v,192,a,240,108
mm v,108,v,196,a,244,108
mm v,156,v,192,a,248,156
mm v,156,v,196,a,252,156
s_waitcnt lgkmcnt(6)
mm v,16,v,200,a,224,16
tr 192,243,128
s_waitcnt lgkmcnt(5)
mm v,16,v,204,a,228,16
tr 194,243,3200
mm v,64,v,200,a,232,64
tr 196,243,6272
mm v,64,v,204,a,236,64
tr 198,243,9344
mm v,112,v,200,a,240,112
mm v,112,v,204,a,244,112
mm v,160,v,200,a,248,160
mm v,160,v,204,a,252,160
s_waitcnt lgkmcnt(6)
mm v,20,v,208,a,224,20
tr 200,243,136
s_waitcnt lgkmcnt(5)
mm v,20,v,212,a,228,20
tr 202,243,3208
mm v,68,v,208,a,232,68
tr 204,243,6280
mm v,68,v,212,a,236,68
tr 206,243,9352
mm v,116,v,208,a,240,116
mm v,116,v,212,a,244,116
mm v,164,v,208,a,248,164
mm v,164,v,212,a,252,164
s_waitcnt lgkmcnt(6)
mm v,24,v,192,a,224,24
tr 208,242,256
s_waitcnt lgkmcnt(5)
mm v,24,v,196,a,228,24
tr 210,242,3328
mm v,72,v,192,a,232,72
tr 212,242,6400
mm v,72,v,196,a,236,72
tr 214,242,9472
mm v,120,v,192,a,240,120
mm v,120,v,196,a,244,120
mm v,168,v,192,a,248,168
mm v,168,v,196,a,252,168
s_waitcnt lgkmcnt(6)
mm v,28,v,200,a,224,28
tr 192,242,264
s_waitcnt lgkmcnt(5)
mm v,28,v,204,a,228,28
tr 194,242,3336
mm v,76,v,200,a,232,76
tr 196,242,6408
mm v,76,v,204,a,236,76
tr 198,242,9480
mm v,124,v,200,a,240,124
mm v,124,v,204,a,244,124
mm v,172,v,200,a,248,172
mm v,172,v,204,a,252,172
s_waitcnt lgkmcnt(6)
mm v,32,v,208,a,224,32
tr 200,243,256
s_waitcnt lgkmcnt(5)
mm v,32,v,212,a,228,32
tr 202,243,3328
mm v,80,v,208,a,232,80
tr 204,243,6400
mm v,80,v,212,a,236,80
tr 206,243,9472
mm v,128,v,208,a,240,128
mm v,128,v,212,a,244,128
mm v,176,v,208,a,248,176
mm v,176,v,212,a,252,176
s_waitcnt lgkmcnt(6)
mm v,36,v,192,a,224,36
tr 208,243,264
s_waitcnt lgkmcnt(5)
mm v,36,v,196,a,228,36
tr 210,243,3336
mm v,84,v,192,a,232,84
tr 212,243,6408
mm v,84,v,196,a,236,84
tr 214,243,9480
mm v,132,v,192,a,240,132
s_sub_u32 s42, s29, s49
s_mov_b32 s49, s29
v_add_u32 v238, s42, v238
mm v,132,v,196,a,244,132
v_add_u32 v239, s42, v239
v_add_u32 v240, s42, v240
mm v,180,v,192,a,248,180
v_add_u32 v241, s42, v241
mm v,180,v,196,a,252,180
s_waitcnt lgkmcnt(6)
mm v,40,v,200,a,224,40
s_waitcnt lgkmcnt(0)
s_barrier
mm v,40,v,204,a,228,40
ds_read_b128 a[192:195], v236
s_mov_b32 s43, s28
mm v,88,v,200,a,232,88
ds_read_b128 a[196:199], v237
s_mov_b32 s28, s29
mm v,88,v,204,a,236,88
ds_read_b128 a[200:203], v236 offset:128
s_mov_b32 s29, s30
mm v,136,v,200,a,240,136
ds_read_b128 a[204:207], v237 offset:128
s_mov_b32 s30, s43
mm v,136,v,204,a,244,136
ds_read_b128 a[208:211], v236 offset:256
mm v,184,v,200,a,248,184
ds_read_b128 a[212:215], v237 offset:256
mm v,184,v,204,a,252,184
mm v,44,v,208,a,224,44
mm v,44,v,212,a,228,44
mm v,92,v,208,a,232,92
mm v,92,v,212,a,236,92
mm v,140,v,208,a,240,140
mm v,140,v,212,a,244,140
mm v,188,v,208,a,248,188
mm v,188,v,212,a,252,188
L_head_4:
L_pg73:
s_cbranch_execz L_ir72
v_mul_f32 v224, 0xbdd53b95, v247
v_mul_f32 v225, 0xbdd53b95, v247
v_pk_fma_f32 v[0:1], v[0:1], s[38:39], v[224:225]
v_pk_fma_f32 v[2:3], v[2:3], s[38:39], v[224:225]
v_pk_fma_f32 v[4:5], v[4:5], s[38:39], v[224:225]
v_pk_fma_f32 v[6:7], v[6:7], s[38:39], v[224:225]
v_cvt_pk_bf16_f32 v0, v0, v1
v_cvt_pk_bf16_f32 v1, v2, v3
v_cvt_pk_bf16_f32 v2, v4, v5
v_cvt_pk_bf16_f32 v3, v6, v7
v_pk_fma_f32 v[48:49], v[48:49], s[38:39], v[224:225]
v_pk_fma_f32 v[50:51], v[50:51], s[38:39], v[224:225]
v_pk_fma_f32 v[52:53], v[52:53], s[38:39], v[224:225]
v_pk_fma_f32 v[54:55], v[54:55], s[38:39], v[224:225]
v_cvt_pk_bf16_f32 v48, v48, v49
v_cvt_pk_bf16_f32 v49, v50, v51
v_cvt_pk_bf16_f32 v50, v52, v53
v_cvt_pk_bf16_f32 v51, v54, v55
v_pk_fma_f32 v[96:97], v[96:97], s[38:39], v[224:225]
v_pk_fma_f32 v[98:99], v[98:99], s[38:39], v[224:225]
v_pk_fma_f32 v[100:101], v[100:101], s[38:39], v[224:225]
v_pk_fma_f32 v[102:103], v[102:103], s[38:39], v[224:225]
v_cvt_pk_bf16_f32 v96, v96, v97
v_cvt_pk_bf16_f32 v97, v98, v99
v_cvt_pk_bf16_f32 v98, v100, v101
v_cvt_pk_bf16_f32 v99, v102, v103
v_pk_fma_f32 v[144:145], v[144:145], s[38:39], v[224:225]
v_pk_fma_f32 v[146:147], v[146:147], s[38:39], v[224:225]
v_pk_fma_f32 v[148:149], v[148:149], s[38:39], v[224:225]
v_pk_fma_f32 v[150:151], v[150:151], s[38:39], v[224:225]
v_cvt_pk_bf16_f32 v144, v144, v145
v_cvt_pk_bf16_f32 v145, v146, v147
v_cvt_pk_bf16_f32 v146, v148, v149
v_cvt_pk_bf16_f32 v147, v150, v151
v_pk_fma_f32 v[8:9], v[8:9], s[38:39], v[224:225]
v_pk_fma_f32 v[10:11], v[10:11], s[38:39], v[224:225]
v_pk_fma_f32 v[12:13], v[12:13], s[38:39], v[224:225]
v_pk_fma_f32 v[14:15], v[14:15], s[38:39], v[224:225]
v_cvt_pk_bf16_f32 v8, v8, v9
v_cvt_pk_bf16_f32 v9, v10, v11
v_cvt_pk_bf16_f32 v10, v12, v13
v_cvt_pk_bf16_f32 v11, v14, v15
v_pk_fma_f32 v[56:57], v[56:57], s[38:39], v[224:225]
v_pk_fma_f32 v[58:59], v[58:59], s[38:39], v[224:225]
v_pk_fma_f32 v[60:61], v[60:61], s[38:39], v[224:225]
v_pk_fma_f32 v[62:63], v[62:63], s[38:39], v[224:225]
v_cvt_pk_bf16_f32 v56, v56, v57
v_cvt_pk_bf16_f32 v57, v58, v59
v_cvt_pk_bf16_f32 v58, v60, v61
v_cvt_pk_bf16_f32 v59, v62, v63
v_pk_fma_f32 v[104:105], v[104:105], s[38:39], v[224:225]
v_pk_fma_f32 v[106:107], v[106:107], s[38:39], v[224:225]
v_pk_fma_f32 v[108:109], v[108:109], s[38:39], v[224:225]
v_pk_fma_f32 v[110:111], v[110:111], s[38:39], v[224:225]
v_cvt_pk_bf16_f32 v104, v104, v105
v_cvt_pk_bf16_f32 v105, v106, v107
v_cvt_pk_bf16_f32 v106, v108, v109
v_cvt_pk_bf16_f32 v107, v110, v111
v_pk_fma_f32 v[152:153], v[152:153], s[38:39], v[224:225]
v_pk_fma_f32 v[154:155], v[154:155], s[38:39], v[224:225]
v_pk_fma_f32 v[156:157], v[156:157], s[38:39], v[224:225]
v_pk_fma_f32 v[158:159], v[158:159], s[38:39], v[224:225]
v_cvt_pk_bf16_f32 v152, v152, v153
v_cvt_pk_bf16_f32 v153, v154, v155
v_cvt_pk_bf16_f32 v154, v156, v157
v_cvt_pk_bf16_f32 v155, v158, v159
v_pk_fma_f32 v[16:17], v[16:17], s[38:39], v[224:225]
v_pk_fma_f32 v[18:19], v[18:19], s[38:39], v[224:225]
v_pk_fma_f32 v[20:21], v[20:21], s[38:39], v[224:225]
v_pk_fma_f32 v[22:23], v[22:23], s[38:39], v[224:225]
v_cvt_pk_bf16_f32 v16, v16, v17
v_cvt_pk_bf16_f32 v17, v18, v19
v_cvt_pk_bf16_f32 v18, v20, v21
v_cvt_pk_bf16_f32 v19, v22, v23
v_pk_fma_f32 v[64:65], v[64:65], s[38:39], v[224:225]
v_pk_fma_f32 v[66:67], v[66:67], s[38:39], v[224:225]
v_pk_fma_f32 v[68:69], v[68:69], s[38:39], v[224:225]
v_pk_fma_f32 v[70:71], v[70:71], s[38:39], v[224:225]
v_cvt_pk_bf16_f32 v64, v64, v65
v_cvt_pk_bf16_f32 v65, v66, v67
v_cvt_pk_bf16_f32 v66, v68, v69
v_cvt_pk_bf16_f32 v67, v70, v71
v_pk_fma_f32 v[112:113], v[112:113], s[38:39], v[224:225]
v_pk_fma_f32 v[114:115], v[114:115], s[38:39], v[224:225]
v_pk_fma_f32 v[116:117], v[116:117], s[38:39], v[224:225]
v_pk_fma_f32 v[118:119], v[118:119], s[38:39], v[224:225]
v_cvt_pk_bf16_f32 v112, v112, v113
v_cvt_pk_bf16_f32 v113, v114, v115
v_cvt_pk_bf16_f32 v114, v116, v117
v_cvt_pk_bf16_f32 v115, v118, v119
v_pk_fma_f32 v[160:161], v[160:161], s[38:39], v[224:225]
v_pk_fma_f32 v[162:163], v[162:163], s[38:39], v[224:225]
v_pk_fma_f32 v[164:165], v[164:165], s[38:39], v[224:225]
v_pk_fma_f32 v[166:167], v[166:167], s[38:39], v[224:225]
v_cvt_pk_bf16_f32 v160, v160, v161
v_cvt_pk_bf16_f32 v161, v162, v163
v_cvt_pk_bf16_f32 v162, v164, v165
v_cvt_pk_bf16_f32 v163, v166, v167
v_pk_fma_f32 v[24:25], v[24:25], s[38:39], v[224:225]
v_pk_fma_f32 v[26:27], v[26:27], s[38:39], v[224:225]
v_pk_fma_f32 v[28:29], v[28:29], s[38:39], v[224:225]
v_pk_fma_f32 v[30:31], v[30:31], s[38:39], v[224:225]
v_cvt_pk_bf16_f32 v24, v24, v25
v_cvt_pk_bf16_f32 v25, v26, v27
v_cvt_pk_bf16_f32 v26, v28, v29
v_cvt_pk_bf16_f32 v27, v30, v31
v_pk_fma_f32 v[72:73], v[72:73], s[38:39], v[224:225]
v_pk_fma_f32 v[74:75], v[74:75], s[38:39], v[224:225]
v_pk_fma_f32 v[76:77], v[76:77], s[38:39], v[224:225]
v_pk_fma_f32 v[78:79], v[78:79], s[38:39], v[224:225]
v_cvt_pk_bf16_f32 v72, v72, v73
v_cvt_pk_bf16_f32 v73, v74, v75
v_cvt_pk_bf16_f32 v74, v76, v77
v_cvt_pk_bf16_f32 v75, v78, v79
v_pk_fma_f32 v[120:121], v[120:121], s[38:39], v[224:225]
v_pk_fma_f32 v[122:123], v[122:123], s[38:39], v[224:225]
v_pk_fma_f32 v[124:125], v[124:125], s[38:39], v[224:225]
v_pk_fma_f32 v[126:127], v[126:127], s[38:39], v[224:225]
v_cvt_pk_bf16_f32 v120, v120, v121
v_cvt_pk_bf16_f32 v121, v122, v123
v_cvt_pk_bf16_f32 v122, v124, v125
v_cvt_pk_bf16_f32 v123, v126, v127
v_pk_fma_f32 v[168:169], v[168:169], s[38:39], v[224:225]
v_pk_fma_f32 v[170:171], v[170:171], s[38:39], v[224:225]
v_pk_fma_f32 v[172:173], v[172:173], s[38:39], v[224:225]
v_pk_fma_f32 v[174:175], v[174:175], s[38:39], v[224:225]
v_cvt_pk_bf16_f32 v168, v168, v169
v_cvt_pk_bf16_f32 v169, v170, v171
v_cvt_pk_bf16_f32 v170, v172, v173
v_cvt_pk_bf16_f32 v171, v174, v175
v_pk_fma_f32 v[32:33], v[32:33], s[38:39], v[224:225]
v_pk_fma_f32 v[34:35], v[34:35], s[38:39], v[224:225]
v_pk_fma_f32 v[36:37], v[36:37], s[38:39], v[224:225]
v_pk_fma_f32 v[38:39], v[38:39], s[38:39], v[224:225]
v_cvt_pk_bf16_f32 v32, v32, v33
v_cvt_pk_bf16_f32 v33, v34, v35
v_cvt_pk_bf16_f32 v34, v36, v37
v_cvt_pk_bf16_f32 v35, v38, v39
v_pk_fma_f32 v[80:81], v[80:81], s[38:39], v[224:225]
v_pk_fma_f32 v[82:83], v[82:83], s[38:39], v[224:225]
v_pk_fma_f32 v[84:85], v[84:85], s[38:39], v[224:225]
v_pk_fma_f32 v[86:87], v[86:87], s[38:39], v[224:225]
v_cvt_pk_bf16_f32 v80, v80, v81
v_cvt_pk_bf16_f32 v81, v82, v83
v_cvt_pk_bf16_f32 v82, v84, v85
v_cvt_pk_bf16_f32 v83, v86, v87
v_pk_fma_f32 v[128:129], v[128:129], s[38:39], v[224:225]
v_pk_fma_f32 v[130:131], v[130:131], s[38:39], v[224:225]
v_pk_fma_f32 v[132:133], v[132:133], s[38:39], v[224:225]
v_pk_fma_f32 v[134:135], v[134:135], s[38:39], v[224:225]
v_cvt_pk_bf16_f32 v128, v128, v129
v_cvt_pk_bf16_f32 v129, v130, v131
v_cvt_pk_bf16_f32 v130, v132, v133
v_cvt_pk_bf16_f32 v131, v134, v135
v_pk_fma_f32 v[176:177], v[176:177], s[38:39], v[224:225]
v_pk_fma_f32 v[178:179], v[178:179], s[38:39], v[224:225]
v_pk_fma_f32 v[180:181], v[180:181], s[38:39], v[224:225]
v_pk_fma_f32 v[182:183], v[182:183], s[38:39], v[224:225]
v_cvt_pk_bf16_f32 v176, v176, v177
v_cvt_pk_bf16_f32 v177, v178, v179
v_cvt_pk_bf16_f32 v178, v180, v181
v_cvt_pk_bf16_f32 v179, v182, v183
v_pk_fma_f32 v[40:41], v[40:41], s[38:39], v[224:225]
v_pk_fma_f32 v[42:43], v[42:43], s[38:39], v[224:225]
v_pk_fma_f32 v[44:45], v[44:45], s[38:39], v[224:225]
v_pk_fma_f32 v[46:47], v[46:47], s[38:39], v[224:225]
v_cvt_pk_bf16_f32 v40, v40, v41
v_cvt_pk_bf16_f32 v41, v42, v43
v_cvt_pk_bf16_f32 v42, v44, v45
v_cvt_pk_bf16_f32 v43, v46, v47
v_pk_fma_f32 v[88:89], v[88:89], s[38:39], v[224:225]
v_pk_fma_f32 v[90:91], v[90:91], s[38:39], v[224:225]
v_pk_fma_f32 v[92:93], v[92:93], s[38:39], v[224:225]
v_pk_fma_f32 v[94:95], v[94:95], s[38:39], v[224:225]
v_cvt_pk_bf16_f32 v88, v88, v89
v_cvt_pk_bf16_f32 v89, v90, v91
v_cvt_pk_bf16_f32 v90, v92, v93
v_cvt_pk_bf16_f32 v91, v94, v95
v_pk_fma_f32 v[136:137], v[136:137], s[38:39], v[224:225]
v_pk_fma_f32 v[138:139], v[138:139], s[38:39], v[224:225]
v_pk_fma_f32 v[140:141], v[140:141], s[38:39], v[224:225]
v_pk_fma_f32 v[142:143], v[142:143], s[38:39], v[224:225]
v_cvt_pk_bf16_f32 v136, v136, v137
v_cvt_pk_bf16_f32 v137, v138, v139
v_cvt_pk_bf16_f32 v138, v140, v141
v_cvt_pk_bf16_f32 v139, v142, v143
v_pk_fma_f32 v[184:185], v[184:185], s[38:39], v[224:225]
v_pk_fma_f32 v[186:187], v[186:187], s[38:39], v[224:225]
v_pk_fma_f32 v[188:189], v[188:189], s[38:39], v[224:225]
v_pk_fma_f32 v[190:191], v[190:191], s[38:39], v[224:225]
v_cvt_pk_bf16_f32 v184, v184, v185
v_cvt_pk_bf16_f32 v185, v186, v187
v_cvt_pk_bf16_f32 v186, v188, v189
v_cvt_pk_bf16_f32 v187, v190, v191
v_mov_b32 v164, 0xff800000
v_mov_b32 v172, 0xff800000
v_mov_b32 v180, 0xff800000
v_mov_b32 v188, 0xff800000
L_prol_4:
v_and_b32 v224, 48, v253
v_mov_b32 v225, 0x3f803f80
v_cmp_eq_u32 vcc, 0, v224
s_nop 1
v_cndmask_b32 v232, 0, v225, vcc
v_cndmask_b32 v233, 0, v225, vcc
v_cndmask_b32 v234, 0, v225, vcc
v_cndmask_b32 v235, 0, v225, vcc
s_waitcnt lgkmcnt(5)
mz v,132,a,192,v,0
L_pg21:
s_cbranch_execz L_ir20
L_pg75:
s_cbranch_execz L_ir74
ds_read_b128 a[216:219], v236 offset:6144
s_waitcnt lgkmcnt(5)
mm v,132,a,196,v,8,132
s_waitcnt lgkmcnt(4)
mm v,132,a,200,v,16,132
ds_read_b128 a[220:223], v237 offset:6144
s_waitcnt lgkmcnt(4)
mm v,132,a,204,v,24,132
s_waitcnt lgkmcnt(3)
mm v,132,a,208,v,32,132
ds_read_b128 a[224:227], v236 offset:6272
s_waitcnt lgkmcnt(3)
mm v,132,a,212,v,40,132
mz v,140,a,192,v,48
ds_read_b128 a[228:231], v237 offset:6272
mm v,140,a,196,v,56,140
mm v,140,a,200,v,64,140
ds_read_b128 a[232:235], v236 offset:6400
mm v,140,a,204,v,72,140
mm v,140,a,208,v,80,140
ds_read_b128 a[236:239], v237 offset:6400
mm v,140,a,212,v,88,140
mz v,148,a,192,v,96
v_max3_f32 v225, v132, v133, v134
v_max3_f32 v225, v225, v135, v164
v_mov_b32 v224, v225
s_nop 1
v_permlane32_swap_b32 v224, v225
mm v,148,a,196,v,104,148
v_max_f32 v225, v225, v224
v_mov_b32 v224, v225
s_nop 1
v_permlane16_swap_b32 v224, v225
mm v,148,a,200,v,112,148
v_max_f32 v225, v225, v224
v_add_f32 v225, 0x40900000, v225
v_sub_f32 v164, 0, v225
v_sub_f32 v165, 0, v225
mm v,148,a,204,v,120,148
v_sub_f32 v166, 0, v225
v_sub_f32 v167, 0, v225
v_sub_f32 v132, v132, v225
v_sub_f32 v133, v133, v225
mm v,148,a,208,v,128,148
v_sub_f32 v134, v134, v225
v_sub_f32 v135, v135, v225
v_exp_f32 v132, v132
v_exp_f32 v133, v133
mm v,148,a,212,v,136,148
v_exp_f32 v134, v134
v_exp_f32 v135, v135
v_cvt_pk_bf16_f32 v4, v132, v133
v_cvt_pk_bf16_f32 v5, v134, v135
mz v,156,a,192,v,144
v_max3_f32 v225, v140, v141, v142
v_max3_f32 v225, v225, v143, v172
v_mov_b32 v224, v225
s_nop 1
v_permlane32_swap_b32 v224, v225
mm v,156,a,196,v,152,156
v_max_f32 v225, v225, v224
v_mov_b32 v224, v225
s_nop 1
v_permlane16_swap_b32 v224, v225
mm v,156,a,200,v,160,156
v_max_f32 v225, v225, v224
v_add_f32 v225, 0x40900000, v225
v_sub_f32 v172, 0, v225
v_sub_f32 v173, 0, v225
mm v,156,a,204,v,168,156
v_sub_f32 v174, 0, v225
v_sub_f32 v175, 0, v225
v_sub_f32 v140, v140, v225
v_sub_f32 v141, v141, v225
mm v,156,a,208,v,176,156
v_sub_f32 v142, v142, v225
v_sub_f32 v143, v143, v225
v_exp_f32 v140, v140
v_exp_f32 v141, v141
mm v,156,a,212,v,184,156
v_exp_f32 v142, v142
v_exp_f32 v143, v143
v_cvt_pk_bf16_f32 v20, v140, v141
v_cvt_pk_bf16_f32 v21, v142, v143
s_waitcnt lgkmcnt(4)
mm v,132,a,216,v,0,164
ds_read_b128 a[192:195], v236 offset:12288
v_max3_f32 v225, v148, v149, v150
v_max3_f32 v225, v225, v151, v180
v_mov_b32 v224, v225
s_nop 1
v_permlane32_swap_b32 v224, v225
mm v,132,a,220,v,8,132
s_waitcnt lgkmcnt(3)
v_max_f32 v225, v225, v224
v_mov_b32 v224, v225
s_nop 1
v_permlane16_swap_b32 v224, v225
mm v,132,a,224,v,16,132
ds_read_b128 a[196:199], v237 offset:12288
v_max_f32 v225, v225, v224
v_add_f32 v225, 0x40900000, v225
v_sub_f32 v180, 0, v225
v_sub_f32 v181, 0, v225
mm v,132,a,228,v,24,132
s_waitcnt lgkmcnt(2)
v_sub_f32 v182, 0, v225
v_sub_f32 v183, 0, v225
v_sub_f32 v148, v148, v225
v_sub_f32 v149, v149, v225
mm v,132,a,232,v,32,132
ds_read_b128 a[200:203], v236 offset:12416
v_sub_f32 v150, v150, v225
v_sub_f32 v151, v151, v225
v_exp_f32 v148, v148
v_exp_f32 v149, v149
mm v,132,a,236,v,40,132
v_exp_f32 v150, v150
v_exp_f32 v151, v151
v_cvt_pk_bf16_f32 v36, v148, v149
v_cvt_pk_bf16_f32 v37, v150, v151
mm v,140,a,216,v,48,172
ds_read_b128 a[204:207], v237 offset:12416
v_max3_f32 v225, v156, v157, v158
v_max3_f32 v225, v225, v159, v188
v_mov_b32 v224, v225
s_nop 1
v_permlane32_swap_b32 v224, v225
mm v,140,a,220,v,56,140
v_max_f32 v225, v225, v224
v_mov_b32 v224, v225
s_nop 1
v_permlane16_swap_b32 v224, v225
mm v,140,a,224,v,64,140
ds_read_b128 a[208:211], v236 offset:12544
v_max_f32 v225, v225, v224
v_add_f32 v225, 0x40900000, v225
v_sub_f32 v188, 0, v225
v_sub_f32 v189, 0, v225
mm v,140,a,228,v,72,140
v_sub_f32 v190, 0, v225
v_sub_f32 v191, 0, v225
v_sub_f32 v156, v156, v225
v_sub_f32 v157, v157, v225
mm v,140,a,232,v,80,140
ds_read_b128 a[212:215], v237 offset:12544
v_sub_f32 v158, v158, v225
v_sub_f32 v159, v159, v225
v_exp_f32 v156, v156
v_exp_f32 v157, v157
mm v,140,a,236,v,88,140
v_exp_f32 v158, v158
v_exp_f32 v159, v159
v_cvt_pk_bf16_f32 v52, v156, v157
v_cvt_pk_bf16_f32 v53, v158, v159
mm v,148,a,216,v,96,180
v_exp_f32 v132, v132
mm v,148,a,220,v,104,148
v_exp_f32 v133, v133
mm v,148,a,224,v,112,148
v_exp_f32 v134, v134
mm v,148,a,228,v,120,148
v_exp_f32 v135, v135
mm v,148,a,232,v,128,148
v_cvt_pk_bf16_f32 v6, v132, v133
mm v,148,a,236,v,136,148
v_cvt_pk_bf16_f32 v7, v134, v135
mm v,156,a,216,v,144,188
v_exp_f32 v140, v140
mm v,156,a,220,v,152,156
v_exp_f32 v141, v141
mm v,156,a,224,v,160,156
v_exp_f32 v142, v142
mm v,156,a,228,v,168,156
v_exp_f32 v143, v143
mm v,156,a,232,v,176,156
v_cvt_pk_bf16_f32 v22, v140, v141
mm v,156,a,236,v,184,156
v_cvt_pk_bf16_f32 v23, v142, v143
s_waitcnt lgkmcnt(4)
mm v,132,a,192,v,0,164
ds_read_b128 a[216:219], v236 offset:18432
v_exp_f32 v148, v148
mm v,132,a,196,v,8,132
s_waitcnt lgkmcnt(3)
v_exp_f32 v149, v149
mm v,132,a,200,v,16,132
ds_read_b128 a[220:223], v237 offset:18432
v_exp_f32 v150, v150
mm v,132,a,204,v,24,132
s_waitcnt lgkmcnt(2)
v_exp_f32 v151, v151
mm v,132,a,208,v,32,132
ds_read_b128 a[224:227], v236 offset:18560
v_cvt_pk_bf16_f32 v38, v148, v149
mm v,132,a,212,v,40,132
v_cvt_pk_bf16_f32 v39, v150, v151
mm v,140,a,192,v,48,172
ds_read_b128 a[228:231], v237 offset:18560
v_exp_f32 v156, v156
mm v,140,a,196,v,56,140
v_exp_f32 v157, v157
mm v,140,a,200,v,64,140
ds_read_b128 a[232:235], v236 offset:18688
v_exp_f32 v158, v158
mm v,140,a,204,v,72,140
v_exp_f32 v159, v159
mm v,140,a,208,v,80,140
ds_read_b128 a[236:239], v237 offset:18688
v_cvt_pk_bf16_f32 v54, v156, v157
mm v,140,a,212,v,88,140
s_sub_u32 s47, s26, s25
v_add_u32 v236, s47, v236
v_add_u32 v237, s47, v237
v_cvt_pk_bf16_f32 v55, v158, v159
mm v,148,a,192,v,96,180
v_exp_f32 v132, v132
mm v,148,a,196,v,104,148
v_exp_f32 v133, v133
mm v,148,a,200,v,112,148
v_exp_f32 v134, v134
mm v,148,a,204,v,120,148
v_exp_f32 v135, v135
mm v,148,a,208,v,128,148
v_cvt_pk_bf16_f32 v12, v132, v133
mm v,148,a,212,v,136,148
v_cvt_pk_bf16_f32 v13, v134, v135
mm v,156,a,192,v,144,188
v_exp_f32 v140, v140
mm v,156,a,196,v,152,156
v_exp_f32 v141, v141
mm v,156,a,200,v,160,156
v_exp_f32 v142, v142
mm v,156,a,204,v,168,156
v_exp_f32 v143, v143
mm v,156,a,208,v,176,156
v_cvt_pk_bf16_f32 v28, v140, v141
mm v,156,a,212,v,184,156
s_waitcnt lgkmcnt(0)
s_barrier
v_cvt_pk_bf16_f32 v29, v142, v143
mm v,132,a,216,v,0,164
ds_read_b128 a[192:195], v236
s_mov_b32 s43, s25
v_exp_f32 v148, v148
mm v,132,a,220,v,8,132
ds_read_b128 a[196:199], v237
s_mov_b32 s25, s26
v_exp_f32 v149, v149
mm v,132,a,224,v,16,132
ds_read_b128 a[200:203], v236 offset:128
s_mov_b32 s26, s27
v_exp_f32 v150, v150
mm v,132,a,228,v,24,132
ds_read_b128 a[204:207], v237 offset:128
s_mov_b32 s27, s43
v_exp_f32 v151, v151
mm v,132,a,232,v,32,132
ds_read_b128 a[208:211], v236 offset:256
v_cvt_pk_bf16_f32 v44, v148, v149
mm v,132,a,236,v,40,132
ds_read_b128 a[212:215], v237 offset:256
v_cvt_pk_bf16_f32 v45, v150, v151
mm v,140,a,216,v,48,172
tr 192,238,0
v_exp_f32 v156, v156
mm v,140,a,220,v,56,140
tr 194,238,6144
v_exp_f32 v157, v157
mm v,140,a,224,v,64,140
tr 196,238,12288
v_exp_f32 v158, v158
mm v,140,a,228,v,72,140
tr 198,238,18432
v_exp_f32 v159, v159
mm v,140,a,232,v,80,140
tr 200,239,0
v_cvt_pk_bf16_f32 v60, v156, v157
mm v,140,a,236,v,88,140
tr 202,239,6144
v_cvt_pk_bf16_f32 v61, v158, v159
mm v,148,a,216,v,96,180
tr 204,239,12288
v_exp_f32 v132, v132
mm v,148,a,220,v,104,148
tr 206,239,18432
v_exp_f32 v133, v133
mm v,148,a,224,v,112,148
tr 208,240,0
v_exp_f32 v134, v134
mm v,148,a,228,v,120,148
tr 210,240,6144
v_exp_f32 v135, v135
mm v,148,a,232,v,128,148
tr 212,240,12288
v_cvt_pk_bf16_f32 v14, v132, v133
mm v,148,a,236,v,136,148
tr 214,240,18432
v_cvt_pk_bf16_f32 v15, v134, v135
mm v,156,a,216,v,144,188
v_exp_f32 v140, v140
mm v,156,a,220,v,152,156
v_exp_f32 v141, v141
mm v,156,a,224,v,160,156
v_exp_f32 v142, v142
mm v,156,a,228,v,168,156
v_exp_f32 v143, v143
mm v,156,a,232,v,176,156
v_cvt_pk_bf16_f32 v30, v140, v141
mm v,156,a,236,v,184,156
v_cvt_pk_bf16_f32 v31, v142, v143
v_exp_f32 v148, v148
v_exp_f32 v149, v149
v_exp_f32 v150, v150
v_exp_f32 v151, v151
v_cvt_pk_bf16_f32 v46, v148, v149
v_cvt_pk_bf16_f32 v47, v150, v151
s_waitcnt lgkmcnt(4)
v_max3_f32 v248, |v192|, |v193|, |v194|
v_max3_f32 v248, v248, |v195|, |v196|
v_max3_f32 v248, v248, |v197|, |v198|
v_max3_f32 v248, v248, |v199|, |v200|
v_max3_f32 v248, v248, |v201|, |v202|
v_max3_f32 v248, v248, |v203|, |v204|
v_max3_f32 v248, v248, |v205|, |v206|
v_max3_f32 v248, v248, |v207|, |v207|
v_and_b32 v248, 0x7f800000, v248
v_mul_f32 v248, 0x41400000, v248
v_min_f32 v248, 0x71800000, v248
s_nop 0
v_readlane_b32 s57, v248, 0
v_readlane_b32 s58, v248, 21
v_readlane_b32 s59, v248, 42
s_nop 3
s_min_u32 s57, s57, s58
s_min_u32 s57, s57, s59
v_mov_b32 v248, s57
v_accvgpr_write_b32 a252, v248
v_accvgpr_write_b32 a253, v248
v_accvgpr_write_b32 a254, v248
v_accvgpr_write_b32 a255, v248
mm v,132,a,192,v,0,164
mm v,132,a,196,v,8,132
tr 216,241,0
mm v,132,a,200,v,16,132
tr 218,241,6144
mm v,132,a,204,v,24,132
v_exp_f32 v156, v156
mm v,132,a,208,v,32,132
tr 220,241,12288
mm v,132,a,212,v,40,132
v_exp_f32 v157, v157
mm a,0,v,4,v,192,252
tr 222,241,18432
mm a,0,v,12,v,196,0
v_exp_f32 v158, v158
mm a,4,v,20,v,192,252
ds_read_b128 a[216:219], v236 offset:6144
v_cvt_pk_bf16_f32 v62, v156, v157
mm a,4,v,28,v,196,4
v_exp_f32 v159, v159
mm a,8,v,36,v,192,252
ds_read_b128 a[220:223], v237 offset:6144
v_cvt_pk_bf16_f32 v63, v158, v159
mm a,8,v,44,v,196,8
mm a,12,v,52,v,192,252
mm a,12,v,60,v,196,12
mm v,140,a,192,v,48,172
v_exp_f32 v132, v132
mm v,140,a,196,v,56,140
tr 192,238,128
mm v,140,a,200,v,64,140
v_exp_f32 v133, v133
mm v,140,a,204,v,72,140
tr 194,238,6272
mm v,140,a,208,v,80,140
v_exp_f32 v134, v134
mm v,140,a,212,v,88,140
tr 196,238,12416
v_cvt_pk_bf16_f32 v68, v132, v133
mm a,16,v,4,v,200,252
s_mov_b32 s35, 6
v_exp_f32 v135, v135
mm a,16,v,12,v,204,16
tr 198,238,18560
v_cvt_pk_bf16_f32 v69, v134, v135
mm a,20,v,20,v,200,252
mm a,20,v,28,v,204,20
ds_read_b128 a[224:227], v236 offset:6272
mm a,24,v,36,v,200,252
mm a,24,v,44,v,204,24
ds_read_b128 a[228:231], v237 offset:6272
mm a,28,v,52,v,200,252
mm a,28,v,60,v,204,28
mm v,148,a,192,v,96,180
v_exp_f32 v140, v140
mm v,148,a,196,v,104,148
tr 200,239,128
mm v,148,a,200,v,112,148
v_exp_f32 v141, v141
mm v,148,a,204,v,120,148
tr 202,239,6272
mm v,148,a,208,v,128,148
s_waitcnt lgkmcnt(15)
v_exp_f32 v142, v142
mm v,148,a,212,v,136,148
tr 204,239,12416
v_cvt_pk_bf16_f32 v84, v140, v141
mm a,32,v,4,v,208,252
s_waitcnt lgkmcnt(15)
v_exp_f32 v143, v143
mm a,32,v,12,v,212,32
tr 206,239,18560
v_cvt_pk_bf16_f32 v85, v142, v143
mm a,36,v,20,v,208,252
mm a,36,v,28,v,212,36
ds_read_b128 a[232:235], v236 offset:6400
mm a,40,v,36,v,208,252
mm a,40,v,44,v,212,40
ds_read_b128 a[236:239], v237 offset:6400
mm a,44,v,52,v,208,252
mm a,44,v,60,v,212,44
mm v,156,a,192,v,144,188
v_exp_f32 v148, v148
mm v,156,a,196,v,152,156
mm v,156,a,200,v,160,156
v_exp_f32 v149, v149
mm v,156,a,204,v,168,156
mm v,156,a,208,v,176,156
v_exp_f32 v150, v150
mm v,156,a,212,v,184,156
v_cvt_pk_bf16_f32 v100, v148, v149
mz a,240,v,232,v,4
v_exp_f32 v151, v151
mm a,240,v,232,v,12,240
s_waitcnt lgkmcnt(13)
v_cvt_pk_bf16_f32 v101, v150, v151
mm v,132,a,216,v,0,164
s_waitcnt lgkmcnt(12)
mm v,132,a,220,v,8,132
tr 208,240,128
s_waitcnt lgkmcnt(8)
mm v,132,a,224,v,16,132
tr 210,240,6272
s_waitcnt lgkmcnt(8)
mm v,132,a,228,v,24,132
s_waitcnt lgkmcnt(3)
v_exp_f32 v156, v156
mm v,132,a,232,v,32,132
tr 212,240,12416
s_waitcnt lgkmcnt(3)
mm v,132,a,236,v,40,132
v_exp_f32 v157, v157
mm a,48,v,4,v,216,252
tr 214,240,18560
mm a,48,v,12,v,220,48
v_exp_f32 v158, v158
mm a,52,v,20,v,216,252
ds_read_b128 a[192:195], v236 offset:12288
v_cvt_pk_bf16_f32 v116, v156, v157
mm a,52,v,28,v,220,52
v_exp_f32 v159, v159
mm a,56,v,36,v,216,252
ds_read_b128 a[196:199], v237 offset:12288
v_cvt_pk_bf16_f32 v117, v158, v159
mm a,56,v,44,v,220,56
mm a,60,v,52,v,216,252
mm a,60,v,60,v,220,60
mm v,140,a,216,v,48,172
v_exp_f32 v132, v132
mm v,140,a,220,v,56,140
tr 216,241,128
mm v,140,a,224,v,64,140
v_exp_f32 v133, v133
mm v,140,a,228,v,72,140
tr 218,241,6272
mm v,140,a,232,v,80,140
v_exp_f32 v134, v134
mm v,140,a,236,v,88,140
tr 220,241,12416
v_cvt_pk_bf16_f32 v70, v132, v133
mm a,64,v,4,v,192,252
v_exp_f32 v135, v135
mm a,64,v,12,v,196,64
tr 222,241,18560
v_cvt_pk_bf16_f32 v71, v134, v135
mm a,68,v,20,v,192,252
mm a,68,v,28,v,196,68
ds_read_b128 a[200:203], v236 offset:12416
mm a,72,v,36,v,192,252
mm a,72,v,44,v,196,72
ds_read_b128 a[204:207], v237 offset:12416
mm a,76,v,52,v,192,252
mm a,76,v,60,v,196,76
mm v,148,a,216,v,96,180
v_exp_f32 v140, v140
mm v,148,a,220,v,104,148
tr 192,238,256
mm v,148,a,224,v,112,148
v_exp_f32 v141, v141
mm v,148,a,228,v,120,148
tr 194,238,6400
mm v,148,a,232,v,128,148
v_exp_f32 v142, v142
mm v,148,a,236,v,136,148
tr 196,238,12544
v_cvt_pk_bf16_f32 v86, v140, v141
mm a,80,v,4,v,200,252
v_exp_f32 v143, v143
mm a,80,v,12,v,204,80
tr 198,238,18688
v_cvt_pk_bf16_f32 v87, v142, v143
mm a,84,v,20,v,200,252
mm a,84,v,28,v,204,84
ds_read_b128 a[208:211], v236 offset:12544
mm a,88,v,36,v,200,252
mm a,88,v,44,v,204,88
ds_read_b128 a[212:215], v237 offset:12544
mm a,92,v,52,v,200,252
mm a,92,v,60,v,204,92
L_pg25:
s_cbranch_execz L_ir24
mm v,156,a,216,v,144,188
v_exp_f32 v148, v148
mm v,156,a,220,v,152,156
mm v,156,a,224,v,160,156
v_exp_f32 v149, v149
mm v,156,a,228,v,168,156
mm v,156,a,232,v,176,156
v_exp_f32 v150, v150
mm v,156,a,236,v,184,156
v_cvt_pk_bf16_f32 v102, v148, v149
mz a,244,v,232,v,20
v_exp_f32 v151, v151
mm a,244,v,232,v,28,244
s_waitcnt lgkmcnt(13)
v_cvt_pk_bf16_f32 v103, v150, v151
mm v,132,a,192,v,0,164
s_waitcnt lgkmcnt(12)
mm v,132,a,196,v,8,132
tr 200,239,256
s_waitcnt lgkmcnt(8)
mm v,132,a,200,v,16,132
tr 202,239,6400
s_waitcnt lgkmcnt(8)
mm v,132,a,204,v,24,132
s_waitcnt lgkmcnt(3)
v_exp_f32 v156, v156
mm v,132,a,208,v,32,132
tr 204,239,12544
s_waitcnt lgkmcnt(3)
mm v,132,a,212,v,40,132
v_exp_f32 v157, v157
mm a,96,v,4,v,208,252
tr 206,239,18688
mm a,96,v,12,v,212,96
v_exp_f32 v158, v158
mm a,100,v,20,v,208,252
ds_read_b128 a[216:219], v236 offset:18432
v_cvt_pk_bf16_f32 v118, v156, v157
mm a,100,v,28,v,212,100
v_exp_f32 v159, v159
mm a,104,v,36,v,208,252
ds_read_b128 a[220:223], v237 offset:18432
v_cvt_pk_bf16_f32 v119, v158, v159
mm a,104,v,44,v,212,104
mm a,108,v,52,v,208,252
mm a,108,v,60,v,212,108
mm v,140,a,192,v,48,172
v_exp_f32 v132, v132
mm v,140,a,196,v,56,140
tr 208,240,256
mm v,140,a,200,v,64,140
v_exp_f32 v133, v133
mm v,140,a,204,v,72,140
tr 210,240,6400
mm v,140,a,208,v,80,140
v_exp_f32 v134, v134
mm v,140,a,212,v,88,140
tr 212,240,12544
v_cvt_pk_bf16_f32 v76, v132, v133
mm a,112,v,4,v,216,252
v_exp_f32 v135, v135
mm a,112,v,12,v,220,112
tr 214,240,18688
v_cvt_pk_bf16_f32 v77, v134, v135
mm a,116,v,20,v,216,252
mm a,116,v,28,v,220,116
ds_read_b128 a[224:227], v236 offset:18560
mm a,120,v,36,v,216,252
mm a,120,v,44,v,220,120
ds_read_b128 a[228:231], v237 offset:18560
mm a,124,v,52,v,216,252
mm a,124,v,60,v,220,124
mm v,148,a,192,v,96,180
v_exp_f32 v140, v140
mm v,148,a,196,v,104,148
tr 216,241,256
mm v,148,a,200,v,112,148
v_exp_f32 v141, v141
mm v,148,a,204,v,120,148
tr 218,241,6400
mm v,148,a,208,v,128,148
v_exp_f32 v142, v142
mm v,148,a,212,v,136,148
tr 220,241,12544
v_cvt_pk_bf16_f32 v92, v140, v141
mm a,128,v,4,v,192,252
v_exp_f32 v143, v143
mm a,128,v,12,v,196,128
tr 222,241,18688
v_cvt_pk_bf16_f32 v93, v142, v143
mm a,132,v,20,v,192,252
mm a,132,v,28,v,196,132
ds_read_b128 a[232:235], v236 offset:18688
mm a,136,v,36,v,192,252
mm a,136,v,44,v,196,136
ds_read_b128 a[236:239], v237 offset:18688
s_sub_u32 s42, s29, s49
mm a,140,v,52,v,192,252
s_mov_b32 s49, s29
v_add_u32 v238, s42, v238
v_add_u32 v239, s42, v239
mm a,140,v,60,v,196,140
v_add_u32 v240, s42, v240
v_add_u32 v241, s42, v241
mm v,156,a,192,v,144,188
s_sub_u32 s47, s26, s25
v_exp_f32 v148, v148
mm v,156,a,196,v,152,156
v_add_u32 v236, s47, v236
v_add_u32 v237, s47, v237
mm v,156,a,200,v,160,156
v_exp_f32 v149, v149
mm v,156,a,204,v,168,156
mm v,156,a,208,v,176,156
v_exp_f32 v150, v150
mm v,156,a,212,v,184,156
v_cvt_pk_bf16_f32 v108, v148, v149
mz a,248,v,232,v,36
v_exp_f32 v151, v151
mm a,248,v,232,v,44,248
s_waitcnt lgkmcnt(13)
v_cvt_pk_bf16_f32 v109, v150, v151
mm v,132,a,216,v,0,164
s_waitcnt lgkmcnt(0)
s_barrier
mm v,132,a,220,v,8,132
tr 192,238,0
s_mov_b32 s43, s28
mm v,132,a,224,v,16,132
tr 194,238,6144
s_mov_b32 s28, s29
mm v,132,a,228,v,24,132
s_mov_b32 s29, s30
v_exp_f32 v156, v156
mm v,132,a,232,v,32,132
tr 196,238,12288
s_mov_b32 s30, s43
mm v,132,a,236,v,40,132
s_mov_b32 s43, s25
v_exp_f32 v157, v157
mm a,144,v,4,v,200,252
tr 198,238,18432
s_mov_b32 s25, s26
mm a,144,v,12,v,204,144
s_mov_b32 s26, s27
v_exp_f32 v158, v158
mm a,148,v,20,v,200,252
ds_read_b128 a[192:195], v236
v_cvt_pk_bf16_f32 v124, v156, v157
mm a,148,v,28,v,204,148
s_mov_b32 s27, s43
v_exp_f32 v159, v159
mm a,152,v,36,v,200,252
ds_read_b128 a[196:199], v237
v_cvt_pk_bf16_f32 v125, v158, v159
mm a,152,v,44,v,204,152
mm a,156,v,52,v,200,252
mm a,156,v,60,v,204,156
mm v,140,a,216,v,48,172
v_exp_f32 v132, v132
mm v,140,a,220,v,56,140
tr 200,239,0
mm v,140,a,224,v,64,140
v_exp_f32 v133, v133
mm v,140,a,228,v,72,140
tr 202,239,6144
mm v,140,a,232,v,80,140
v_exp_f32 v134, v134
mm v,140,a,236,v,88,140
tr 204,239,12288
v_cvt_pk_bf16_f32 v78, v132, v133
mm a,160,v,4,v,208,252
v_exp_f32 v135, v135
mm a,160,v,12,v,212,160
tr 206,239,18432
v_cvt_pk_bf16_f32 v79, v134, v135
mm a,164,v,20,v,208,252
mm a,164,v,28,v,212,164
ds_read_b128 a[200:203], v236 offset:128
mm a,168,v,36,v,208,252
mm a,168,v,44,v,212,168
ds_read_b128 a[204:207], v237 offset:128
mm a,172,v,52,v,208,252
mm a,172,v,60,v,212,172
mm v,148,a,216,v,96,180
v_exp_f32 v140, v140
mm v,148,a,220,v,104,148
tr 208,240,0
mm v,148,a,224,v,112,148
v_exp_f32 v141, v141
mm v,148,a,228,v,120,148
tr 210,240,6144
mm v,148,a,232,v,128,148
v_exp_f32 v142, v142
mm v,148,a,236,v,136,148
tr 212,240,12288
v_cvt_pk_bf16_f32 v94, v140, v141
mm a,176,v,4,v,216,252
v_exp_f32 v143, v143
mm a,176,v,12,v,220,176
tr 214,240,18432
v_cvt_pk_bf16_f32 v95, v142, v143
mm a,180,v,20,v,216,252
mm a,180,v,28,v,220,180
ds_read_b128 a[208:211], v236 offset:256
mm a,184,v,36,v,216,252
mm a,184,v,44,v,220,184
ds_read_b128 a[212:215], v237 offset:256
mm a,188,v,52,v,216,252
mm a,188,v,60,v,220,188
mm v,156,a,216,v,144,188
v_exp_f32 v148, v148
mm v,156,a,220,v,152,156
mm v,156,a,224,v,160,156
v_exp_f32 v149, v149
mm v,156,a,228,v,168,156
mm v,156,a,232,v,176,156
v_exp_f32 v150, v150
mm v,156,a,236,v,184,156
v_cvt_pk_bf16_f32 v110, v148, v149
mz a,252,v,232,v,52
v_exp_f32 v151, v151
mm a,252,v,232,v,60,252
s_waitcnt lgkmcnt(13)
v_cvt_pk_bf16_f32 v111, v150, v151
.p2align 3
L_loop_4:
mm v,132,a,192,v,0,164
s_waitcnt lgkmcnt(12)
mm v,132,a,196,v,8,132
tr 216,241,0
s_waitcnt lgkmcnt(8)
mm v,132,a,200,v,16,132
tr 218,241,6144
s_waitcnt lgkmcnt(8)
mm v,132,a,204,v,24,132
s_waitcnt lgkmcnt(3)
v_exp_f32 v156, v156
mm v,132,a,208,v,32,132
tr 220,241,12288
s_waitcnt lgkmcnt(3)
mm v,132,a,212,v,40,132
v_exp_f32 v157, v157
mm a,0,v,68,v,192,0
tr 222,241,18432
mm a,0,v,76,v,196,0
v_exp_f32 v158, v158
mm a,4,v,84,v,192,4
ds_read_b128 a[216:219], v236 offset:6144
v_cvt_pk_bf16_f32 v126, v156, v157
mm a,4,v,92,v,196,4
v_exp_f32 v159, v159
mm a,8,v,100,v,192,8
ds_read_b128 a[220:223], v237 offset:6144
v_cvt_pk_bf16_f32 v127, v158, v159
mm a,8,v,108,v,196,8
mm a,12,v,116,v,192,12
mm a,12,v,124,v,196,12
mm v,140,a,192,v,48,172
v_exp_f32 v132, v132
mm v,140,a,196,v,56,140
tr 192,238,128
mm v,140,a,200,v,64,140
v_exp_f32 v133, v133
mm v,140,a,204,v,72,140
tr 194,238,6272
mm v,140,a,208,v,80,140
v_exp_f32 v134, v134
mm v,140,a,212,v,88,140
tr 196,238,12416
v_cvt_pk_bf16_f32 v4, v132, v133
mm a,16,v,68,v,200,16
v_exp_f32 v135, v135
mm a,16,v,76,v,204,16
tr 198,238,18560
v_cvt_pk_bf16_f32 v5, v134, v135
mm a,20,v,84,v,200,20
mm a,20,v,92,v,204,20
ds_read_b128 a[224:227], v236 offset:6272
mm a,24,v,100,v,200,24
mm a,24,v,108,v,204,24
ds_read_b128 a[228:231], v237 offset:6272
mm a,28,v,116,v,200,28
mm a,28,v,124,v,204,28
mm v,148,a,192,v,96,180
v_exp_f32 v140, v140
mm v,148,a,196,v,104,148
tr 200,239,128
mm v,148,a,200,v,112,148
v_exp_f32 v141, v141
mm v,148,a,204,v,120,148
tr 202,239,6272
mm v,148,a,208,v,128,148
v_exp_f32 v142, v142
mm v,148,a,212,v,136,148
tr 204,239,12416
v_cvt_pk_bf16_f32 v20, v140, v141
mm a,32,v,68,v,208,32
v_exp_f32 v143, v143
mm a,32,v,76,v,212,32
tr 206,239,18560
v_cvt_pk_bf16_f32 v21, v142, v143
mm a,36,v,84,v,208,36
mm a,36,v,92,v,212,36
ds_read_b128 a[232:235], v236 offset:6400
mm a,40,v,100,v,208,40
mm a,40,v,108,v,212,40
ds_read_b128 a[236:239], v237 offset:6400
mm a,44,v,116,v,208,44
mm a,44,v,124,v,212,44
mm v,156,a,192,v,144,188
v_exp_f32 v148, v148
mm v,156,a,196,v,152,156
mm v,156,a,200,v,160,156
v_exp_f32 v149, v149
mm v,156,a,204,v,168,156
mm v,156,a,208,v,176,156
v_exp_f32 v150, v150
mm v,156,a,212,v,184,156
v_cvt_pk_bf16_f32 v36, v148, v149
mm a,240,v,232,v,68,240
v_exp_f32 v151, v151
mm a,240,v,232,v,76,240
s_waitcnt lgkmcnt(13)
v_cvt_pk_bf16_f32 v37, v150, v151
mm v,132,a,216,v,0,164
s_waitcnt lgkmcnt(12)
mm v,132,a,220,v,8,132
tr 208,240,128
s_waitcnt lgkmcnt(8)
mm v,132,a,224,v,16,132
tr 210,240,6272
s_waitcnt lgkmcnt(8)
mm v,132,a,228,v,24,132
s_waitcnt lgkmcnt(3)
v_exp_f32 v156, v156
mm v,132,a,232,v,32,132
tr 212,240,12416
s_waitcnt lgkmcnt(3)
mm v,132,a,236,v,40,132
v_exp_f32 v157, v157
mm a,48,v,68,v,216,48
tr 214,240,18560
mm a,48,v,76,v,220,48
v_exp_f32 v158, v158
mm a,52,v,84,v,216,52
ds_read_b128 a[192:195], v236 offset:12288
v_cvt_pk_bf16_f32 v52, v156, v157
mm a,52,v,92,v,220,52
v_exp_f32 v159, v159
mm a,56,v,100,v,216,56
ds_read_b128 a[196:199], v237 offset:12288
v_cvt_pk_bf16_f32 v53, v158, v159
mm a,56,v,108,v,220,56
mm a,60,v,116,v,216,60
mm a,60,v,124,v,220,60
mm v,140,a,216,v,48,172
v_exp_f32 v132, v132
mm v,140,a,220,v,56,140
tr 216,241,128
mm v,140,a,224,v,64,140
v_exp_f32 v133, v133
mm v,140,a,228,v,72,140
tr 218,241,6272
mm v,140,a,232,v,80,140
v_exp_f32 v134, v134
mm v,140,a,236,v,88,140
tr 220,241,12416
v_cvt_pk_bf16_f32 v6, v132, v133
mm a,64,v,68,v,192,64
v_exp_f32 v135, v135
mm a,64,v,76,v,196,64
tr 222,241,18560
v_cvt_pk_bf16_f32 v7, v134, v135
mm a,68,v,84,v,192,68
mm a,68,v,92,v,196,68
ds_read_b128 a[200:203], v236 offset:12416
mm a,72,v,100,v,192,72
mm a,72,v,108,v,196,72
ds_read_b128 a[204:207], v237 offset:12416
mm a,76,v,116,v,192,76
mm a,76,v,124,v,196,76
mm v,148,a,216,v,96,180
v_exp_f32 v140, v140
mm v,148,a,220,v,104,148
tr 192,238,256
mm v,148,a,224,v,112,148
v_exp_f32 v141, v141
mm v,148,a,228,v,120,148
tr 194,238,6400
mm v,148,a,232,v,128,148
v_exp_f32 v142, v142
mm v,148,a,236,v,136,148
tr 196,238,12544
v_cvt_pk_bf16_f32 v22, v140, v141
mm a,80,v,68,v,200,80
v_exp_f32 v143, v143
mm a,80,v,76,v,204,80
tr 198,238,18688
v_cvt_pk_bf16_f32 v23, v142, v143
mm a,84,v,84,v,200,84
mm a,84,v,92,v,204,84
ds_read_b128 a[208:211], v236 offset:12544
mm a,88,v,100,v,200,88
mm a,88,v,108,v,204,88
ds_read_b128 a[212:215], v237 offset:12544
mm a,92,v,116,v,200,92
mm a,92,v,124,v,204,92
mm v,156,a,216,v,144,188
v_exp_f32 v148, v148
mm v,156,a,220,v,152,156
mm v,156,a,224,v,160,156
v_exp_f32 v149, v149
mm v,156,a,228,v,168,156
mm v,156,a,232,v,176,156
v_exp_f32 v150, v150
mm v,156,a,236,v,184,156
v_cvt_pk_bf16_f32 v38, v148, v149
mm a,244,v,232,v,84,244
v_exp_f32 v151, v151
mm a,244,v,232,v,92,244
s_waitcnt lgkmcnt(13)
v_cvt_pk_bf16_f32 v39, v150, v151
mm v,132,a,192,v,0,164
s_waitcnt lgkmcnt(12)
mm v,132,a,196,v,8,132
tr 200,239,256
s_waitcnt lgkmcnt(8)
mm v,132,a,200,v,16,132
tr 202,239,6400
s_waitcnt lgkmcnt(8)
mm v,132,a,204,v,24,132
s_waitcnt lgkmcnt(3)
v_exp_f32 v156, v156
mm v,132,a,208,v,32,132
tr 204,239,12544
s_waitcnt lgkmcnt(3)
mm v,132,a,212,v,40,132
v_exp_f32 v157, v157
mm a,96,v,68,v,208,96
tr 206,239,18688
mm a,96,v,76,v,212,96
v_exp_f32 v158, v158
mm a,100,v,84,v,208,100
ds_read_b128 a[216:219], v236 offset:18432
v_cvt_pk_bf16_f32 v54, v156, v157
mm a,100,v,92,v,212,100
v_exp_f32 v159, v159
mm a,104,v,100,v,208,104
ds_read_b128 a[220:223], v237 offset:18432
v_cvt_pk_bf16_f32 v55, v158, v159
mm a,104,v,108,v,212,104
mm a,108,v,116,v,208,108
mm a,108,v,124,v,212,108
mm v,140,a,192,v,48,172
v_exp_f32 v132, v132
mm v,140,a,196,v,56,140
tr 208,240,256
mm v,140,a,200,v,64,140
v_exp_f32 v133, v133
mm v,140,a,204,v,72,140
tr 210,240,6400
mm v,140,a,208,v,80,140
v_exp_f32 v134, v134
mm v,140,a,212,v,88,140
tr 212,240,12544
v_cvt_pk_bf16_f32 v12, v132, v133
mm a,112,v,68,v,216,112
v_exp_f32 v135, v135
mm a,112,v,76,v,220,112
tr 214,240,18688
v_cvt_pk_bf16_f32 v13, v134, v135
mm a,116,v,84,v,216,116
mm a,116,v,92,v,220,116
ds_read_b128 a[224:227], v236 offset:18560
mm a,120,v,100,v,216,120
mm a,120,v,108,v,220,120
ds_read_b128 a[228:231], v237 offset:18560
mm a,124,v,116,v,216,124
mm a,124,v,124,v,220,124
mm v,148,a,192,v,96,180
v_exp_f32 v140, v140
mm v,148,a,196,v,104,148
tr 216,241,256
mm v,148,a,200,v,112,148
v_exp_f32 v141, v141
mm v,148,a,204,v,120,148
tr 218,241,6400
mm v,148,a,208,v,128,148
v_exp_f32 v142, v142
mm v,148,a,212,v,136,148
tr 220,241,12544
v_cvt_pk_bf16_f32 v28, v140, v141
mm a,128,v,68,v,192,128
v_exp_f32 v143, v143
mm a,128,v,76,v,196,128
tr 222,241,18688
v_cvt_pk_bf16_f32 v29, v142, v143
mm a,132,v,84,v,192,132
mm a,132,v,92,v,196,132
ds_read_b128 a[232:235], v236 offset:18688
mm a,136,v,100,v,192,136
mm a,136,v,108,v,196,136
ds_read_b128 a[236:239], v237 offset:18688
s_sub_u32 s42, s29, s49
mm a,140,v,116,v,192,140
s_mov_b32 s49, s29
v_add_u32 v238, s42, v238
v_add_u32 v239, s42, v239
mm a,140,v,124,v,196,140
v_add_u32 v240, s42, v240
v_add_u32 v241, s42, v241
mm v,156,a,192,v,144,188
s_sub_u32 s47, s26, s25
v_exp_f32 v148, v148
mm v,156,a,196,v,152,156
v_add_u32 v236, s47, v236
v_add_u32 v237, s47, v237
mm v,156,a,200,v,160,156
v_exp_f32 v149, v149
mm v,156,a,204,v,168,156
mm v,156,a,208,v,176,156
v_exp_f32 v150, v150
mm v,156,a,212,v,184,156
v_cvt_pk_bf16_f32 v44, v148, v149
mm a,248,v,232,v,100,248
v_exp_f32 v151, v151
mm a,248,v,232,v,108,248
s_waitcnt lgkmcnt(13)
v_cvt_pk_bf16_f32 v45, v150, v151
mm v,132,a,216,v,0,164
s_waitcnt lgkmcnt(0)
s_barrier
mm v,132,a,220,v,8,132
tr 192,238,0
s_mov_b32 s43, s28
mm v,132,a,224,v,16,132
tr 194,238,6144
s_mov_b32 s28, s29
mm v,132,a,228,v,24,132
s_mov_b32 s29, s30
v_exp_f32 v156, v156
mm v,132,a,232,v,32,132
tr 196,238,12288
s_mov_b32 s30, s43
mm v,132,a,236,v,40,132
s_mov_b32 s43, s25
v_exp_f32 v157, v157
mm a,144,v,68,v,200,144
tr 198,238,18432
s_mov_b32 s25, s26
mm a,144,v,76,v,204,144
s_mov_b32 s26, s27
v_exp_f32 v158, v158
mm a,148,v,84,v,200,148
ds_read_b128 a[192:195], v236
v_cvt_pk_bf16_f32 v60, v156, v157
mm a,148,v,92,v,204,148
s_mov_b32 s27, s43
v_exp_f32 v159, v159
mm a,152,v,100,v,200,152
ds_read_b128 a[196:199], v237
v_cvt_pk_bf16_f32 v61, v158, v159
mm a,152,v,108,v,204,152
mm a,156,v,116,v,200,156
mm a,156,v,124,v,204,156
mm v,140,a,216,v,48,172
v_exp_f32 v132, v132
mm v,140,a,220,v,56,140
tr 200,239,0
mm v,140,a,224,v,64,140
v_exp_f32 v133, v133
mm v,140,a,228,v,72,140
tr 202,239,6144
mm v,140,a,232,v,80,140
v_exp_f32 v134, v134
mm v,140,a,236,v,88,140
tr 204,239,12288
v_cvt_pk_bf16_f32 v14, v132, v133
mm a,160,v,68,v,208,160
v_exp_f32 v135, v135
mm a,160,v,76,v,212,160
tr 206,239,18432
v_cvt_pk_bf16_f32 v15, v134, v135
mm a,164,v,84,v,208,164
mm a,164,v,92,v,212,164
ds_read_b128 a[200:203], v236 offset:128
mm a,168,v,100,v,208,168
mm a,168,v,108,v,212,168
ds_read_b128 a[204:207], v237 offset:128
mm a,172,v,116,v,208,172
mm a,172,v,124,v,212,172
L_pg29:
s_cbranch_execz L_ir28
mm v,148,a,216,v,96,180
v_exp_f32 v140, v140
mm v,148,a,220,v,104,148
tr 208,240,0
mm v,148,a,224,v,112,148
v_exp_f32 v141, v141
mm v,148,a,228,v,120,148
tr 210,240,6144
mm v,148,a,232,v,128,148
v_exp_f32 v142, v142
mm v,148,a,236,v,136,148
tr 212,240,12288
v_cvt_pk_bf16_f32 v30, v140, v141
mm a,176,v,68,v,216,176
v_exp_f32 v143, v143
mm a,176,v,76,v,220,176
tr 214,240,18432
v_cvt_pk_bf16_f32 v31, v142, v143
mm a,180,v,84,v,216,180
mm a,180,v,92,v,220,180
ds_read_b128 a[208:211], v236 offset:256
mm a,184,v,100,v,216,184
mm a,184,v,108,v,220,184
ds_read_b128 a[212:215], v237 offset:256
mm a,188,v,116,v,216,188
mm a,188,v,124,v,220,188
mm v,156,a,216,v,144,188
v_exp_f32 v148, v148
mm v,156,a,220,v,152,156
mm v,156,a,224,v,160,156
v_exp_f32 v149, v149
mm v,156,a,228,v,168,156
mm v,156,a,232,v,176,156
v_exp_f32 v150, v150
mm v,156,a,236,v,184,156
v_cvt_pk_bf16_f32 v46, v148, v149
mm a,252,v,232,v,116,252
v_exp_f32 v151, v151
mm a,252,v,232,v,124,252
s_waitcnt lgkmcnt(13)
v_cvt_pk_bf16_f32 v47, v150, v151
mm v,132,a,192,v,0,164
s_waitcnt lgkmcnt(12)
mm v,132,a,196,v,8,132
tr 216,241,0
s_waitcnt lgkmcnt(8)
mm v,132,a,200,v,16,132
tr 218,241,6144
s_waitcnt lgkmcnt(8)
mm v,132,a,204,v,24,132
s_waitcnt lgkmcnt(3)
v_exp_f32 v156, v156
mm v,132,a,208,v,32,132
tr 220,241,12288
s_waitcnt lgkmcnt(3)
mm v,132,a,212,v,40,132
v_exp_f32 v157, v157
mm a,0,v,4,v,192,0
tr 222,241,18432
mm a,0,v,12,v,196,0
v_exp_f32 v158, v158
mm a,4,v,20,v,192,4
ds_read_b128 a[216:219], v236 offset:6144
v_cvt_pk_bf16_f32 v62, v156, v157
mm a,4,v,28,v,196,4
v_exp_f32 v159, v159
mm a,8,v,36,v,192,8
ds_read_b128 a[220:223], v237 offset:6144
v_cvt_pk_bf16_f32 v63, v158, v159
mm a,8,v,44,v,196,8
mm a,12,v,52,v,192,12
mm a,12,v,60,v,196,12
mm v,140,a,192,v,48,172
v_exp_f32 v132, v132
mm v,140,a,196,v,56,140
tr 192,238,128
mm v,140,a,200,v,64,140
v_exp_f32 v133, v133
mm v,140,a,204,v,72,140
tr 194,238,6272
mm v,140,a,208,v,80,140
v_exp_f32 v134, v134
mm v,140,a,212,v,88,140
tr 196,238,12416
v_cvt_pk_bf16_f32 v68, v132, v133
mm a,16,v,4,v,200,16
s_sub_u32 s35, s35, 1
v_exp_f32 v135, v135
mm a,16,v,12,v,204,16
tr 198,238,18560
v_cvt_pk_bf16_f32 v69, v134, v135
mm a,20,v,20,v,200,20
mm a,20,v,28,v,204,20
ds_read_b128 a[224:227], v236 offset:6272
mm a,24,v,36,v,200,24
mm a,24,v,44,v,204,24
ds_read_b128 a[228:231], v237 offset:6272
mm a,28,v,52,v,200,28
mm a,28,v,60,v,204,28
mm v,148,a,192,v,96,180
v_exp_f32 v140, v140
mm v,148,a,196,v,104,148
tr 200,239,128
mm v,148,a,200,v,112,148
v_exp_f32 v141, v141
mm v,148,a,204,v,120,148
tr 202,239,6272
mm v,148,a,208,v,128,148
v_exp_f32 v142, v142
mm v,148,a,212,v,136,148
tr 204,239,12416
v_cvt_pk_bf16_f32 v84, v140, v141
mm a,32,v,4,v,208,32
v_exp_f32 v143, v143
mm a,32,v,12,v,212,32
tr 206,239,18560
v_cvt_pk_bf16_f32 v85, v142, v143
mm a,36,v,20,v,208,36
mm a,36,v,28,v,212,36
ds_read_b128 a[232:235], v236 offset:6400
mm a,40,v,36,v,208,40
mm a,40,v,44,v,212,40
ds_read_b128 a[236:239], v237 offset:6400
mm a,44,v,52,v,208,44
mm a,44,v,60,v,212,44
mm v,156,a,192,v,144,188
v_exp_f32 v148, v148
mm v,156,a,196,v,152,156
mm v,156,a,200,v,160,156
v_exp_f32 v149, v149
mm v,156,a,204,v,168,156
mm v,156,a,208,v,176,156
v_exp_f32 v150, v150
mm v,156,a,212,v,184,156
v_cvt_pk_bf16_f32 v100, v148, v149
mm a,240,v,232,v,4,240
v_exp_f32 v151, v151
mm a,240,v,232,v,12,240
s_waitcnt lgkmcnt(13)
v_cvt_pk_bf16_f32 v101, v150, v151
mm v,132,a,216,v,0,164
s_waitcnt lgkmcnt(12)
mm v,132,a,220,v,8,132
tr 208,240,128
s_waitcnt lgkmcnt(8)
mm v,132,a,224,v,16,132
tr 210,240,6272
s_waitcnt lgkmcnt(8)
mm v,132,a,228,v,24,132
s_waitcnt lgkmcnt(3)
v_exp_f32 v156, v156
mm v,132,a,232,v,32,132
tr 212,240,12416
s_waitcnt lgkmcnt(3)
mm v,132,a,236,v,40,132
v_exp_f32 v157, v157
mm a,48,v,4,v,216,48
tr 214,240,18560
mm a,48,v,12,v,220,48
v_exp_f32 v158, v158
mm a,52,v,20,v,216,52
ds_read_b128 a[192:195], v236 offset:12288
v_cvt_pk_bf16_f32 v116, v156, v157
mm a,52,v,28,v,220,52
v_exp_f32 v159, v159
mm a,56,v,36,v,216,56
ds_read_b128 a[196:199], v237 offset:12288
v_cvt_pk_bf16_f32 v117, v158, v159
mm a,56,v,44,v,220,56
mm a,60,v,52,v,216,60
mm a,60,v,60,v,220,60
mm v,140,a,216,v,48,172
v_exp_f32 v132, v132
mm v,140,a,220,v,56,140
tr 216,241,128
mm v,140,a,224,v,64,140
v_exp_f32 v133, v133
mm v,140,a,228,v,72,140
tr 218,241,6272
mm v,140,a,232,v,80,140
v_exp_f32 v134, v134
mm v,140,a,236,v,88,140
tr 220,241,12416
v_cvt_pk_bf16_f32 v70, v132, v133
mm a,64,v,4,v,192,64
v_exp_f32 v135, v135
mm a,64,v,12,v,196,64
tr 222,241,18560
v_cvt_pk_bf16_f32 v71, v134, v135
mm a,68,v,20,v,192,68
mm a,68,v,28,v,196,68
ds_read_b128 a[200:203], v236 offset:12416
mm a,72,v,36,v,192,72
mm a,72,v,44,v,196,72
ds_read_b128 a[204:207], v237 offset:12416
mm a,76,v,52,v,192,76
mm a,76,v,60,v,196,76
mm v,148,a,216,v,96,180
v_exp_f32 v140, v140
mm v,148,a,220,v,104,148
tr 192,238,256
mm v,148,a,224,v,112,148
v_exp_f32 v141, v141
mm v,148,a,228,v,120,148
tr 194,238,6400
mm v,148,a,232,v,128,148
v_exp_f32 v142, v142
mm v,148,a,236,v,136,148
tr 196,238,12544
v_cvt_pk_bf16_f32 v86, v140, v141
mm a,80,v,4,v,200,80
v_exp_f32 v143, v143
mm a,80,v,12,v,204,80
tr 198,238,18688
v_cvt_pk_bf16_f32 v87, v142, v143
mm a,84,v,20,v,200,84
mm a,84,v,28,v,204,84
ds_read_b128 a[208:211], v236 offset:12544
mm a,88,v,36,v,200,88
mm a,88,v,44,v,204,88
ds_read_b128 a[212:215], v237 offset:12544
mm a,92,v,52,v,200,92
mm a,92,v,60,v,204,92
mm v,156,a,216,v,144,188
v_exp_f32 v148, v148
mm v,156,a,220,v,152,156
mm v,156,a,224,v,160,156
v_exp_f32 v149, v149
mm v,156,a,228,v,168,156
mm v,156,a,232,v,176,156
v_exp_f32 v150, v150
mm v,156,a,236,v,184,156
v_cvt_pk_bf16_f32 v102, v148, v149
mm a,244,v,232,v,20,244
v_exp_f32 v151, v151
mm a,244,v,232,v,28,244
s_waitcnt lgkmcnt(13)
v_cvt_pk_bf16_f32 v103, v150, v151
mm v,132,a,192,v,0,164
s_waitcnt lgkmcnt(12)
mm v,132,a,196,v,8,132
tr 200,239,256
s_waitcnt lgkmcnt(8)
mm v,132,a,200,v,16,132
tr 202,239,6400
s_waitcnt lgkmcnt(8)
mm v,132,a,204,v,24,132
s_waitcnt lgkmcnt(3)
v_exp_f32 v156, v156
mm v,132,a,208,v,32,132
tr 204,239,12544
s_waitcnt lgkmcnt(3)
mm v,132,a,212,v,40,132
v_exp_f32 v157, v157
mm a,96,v,4,v,208,96
tr 206,239,18688
mm a,96,v,12,v,212,96
v_exp_f32 v158, v158
mm a,100,v,20,v,208,100
ds_read_b128 a[216:219], v236 offset:18432
v_cvt_pk_bf16_f32 v118, v156, v157
mm a,100,v,28,v,212,100
v_exp_f32 v159, v159
mm a,104,v,36,v,208,104
ds_read_b128 a[220:223], v237 offset:18432
v_cvt_pk_bf16_f32 v119, v158, v159
mm a,104,v,44,v,212,104
mm a,108,v,52,v,208,108
mm a,108,v,60,v,212,108
mm v,140,a,192,v,48,172
v_exp_f32 v132, v132
mm v,140,a,196,v,56,140
tr 208,240,256
mm v,140,a,200,v,64,140
v_exp_f32 v133, v133
mm v,140,a,204,v,72,140
tr 210,240,6400
mm v,140,a,208,v,80,140
v_exp_f32 v134, v134
mm v,140,a,212,v,88,140
tr 212,240,12544
v_cvt_pk_bf16_f32 v76, v132, v133
mm a,112,v,4,v,216,112
v_exp_f32 v135, v135
mm a,112,v,12,v,220,112
tr 214,240,18688
v_cvt_pk_bf16_f32 v77, v134, v135
mm a,116,v,20,v,216,116
mm a,116,v,28,v,220,116
ds_read_b128 a[224:227], v236 offset:18560
mm a,120,v,36,v,216,120
mm a,120,v,44,v,220,120
ds_read_b128 a[228:231], v237 offset:18560
mm a,124,v,52,v,216,124
mm a,124,v,60,v,220,124
mm v,148,a,192,v,96,180
v_exp_f32 v140, v140
mm v,148,a,196,v,104,148
tr 216,241,256
mm v,148,a,200,v,112,148
v_exp_f32 v141, v141
mm v,148,a,204,v,120,148
tr 218,241,6400
mm v,148,a,208,v,128,148
v_exp_f32 v142, v142
mm v,148,a,212,v,136,148
tr 220,241,12544
v_cvt_pk_bf16_f32 v92, v140, v141
mm a,128,v,4,v,192,128
v_exp_f32 v143, v143
mm a,128,v,12,v,196,128
tr 222,241,18688
v_cvt_pk_bf16_f32 v93, v142, v143
mm a,132,v,20,v,192,132
mm a,132,v,28,v,196,132
ds_read_b128 a[232:235], v236 offset:18688
mm a,136,v,36,v,192,136
mm a,136,v,44,v,196,136
ds_read_b128 a[236:239], v237 offset:18688
s_sub_u32 s42, s29, s49
mm a,140,v,52,v,192,140
s_mov_b32 s49, s29
v_add_u32 v238, s42, v238
v_add_u32 v239, s42, v239
mm a,140,v,60,v,196,140
v_add_u32 v240, s42, v240
v_add_u32 v241, s42, v241
mm v,156,a,192,v,144,188
s_sub_u32 s47, s26, s25
v_exp_f32 v148, v148
mm v,156,a,196,v,152,156
v_add_u32 v236, s47, v236
v_add_u32 v237, s47, v237
mm v,156,a,200,v,160,156
v_exp_f32 v149, v149
mm v,156,a,204,v,168,156
mm v,156,a,208,v,176,156
v_exp_f32 v150, v150
mm v,156,a,212,v,184,156
v_cvt_pk_bf16_f32 v108, v148, v149
mm a,248,v,232,v,36,248
v_exp_f32 v151, v151
mm a,248,v,232,v,44,248
s_waitcnt lgkmcnt(13)
v_cvt_pk_bf16_f32 v109, v150, v151
mm v,132,a,216,v,0,164
s_waitcnt lgkmcnt(0)
s_barrier
mm v,132,a,220,v,8,132
tr 192,238,0
s_mov_b32 s43, s28
mm v,132,a,224,v,16,132
tr 194,238,6144
s_mov_b32 s28, s29
mm v,132,a,228,v,24,132
s_mov_b32 s29, s30
v_exp_f32 v156, v156
mm v,132,a,232,v,32,132
tr 196,238,12288
s_mov_b32 s30, s43
mm v,132,a,236,v,40,132
s_mov_b32 s43, s25
v_exp_f32 v157, v157
mm a,144,v,4,v,200,144
tr 198,238,18432
s_mov_b32 s25, s26
mm a,144,v,12,v,204,144
s_mov_b32 s26, s27
v_exp_f32 v158, v158
mm a,148,v,20,v,200,148
ds_read_b128 a[192:195], v236
v_cvt_pk_bf16_f32 v124, v156, v157
mm a,148,v,28,v,204,148
s_mov_b32 s27, s43
v_exp_f32 v159, v159
mm a,152,v,36,v,200,152
ds_read_b128 a[196:199], v237
v_cvt_pk_bf16_f32 v125, v158, v159
mm a,152,v,44,v,204,152
mm a,156,v,52,v,200,156
mm a,156,v,60,v,204,156
mm v,140,a,216,v,48,172
v_exp_f32 v132, v132
mm v,140,a,220,v,56,140
tr 200,239,0
mm v,140,a,224,v,64,140
v_exp_f32 v133, v133
mm v,140,a,228,v,72,140
tr 202,239,6144
mm v,140,a,232,v,80,140
v_exp_f32 v134, v134
mm v,140,a,236,v,88,140
tr 204,239,12288
v_cvt_pk_bf16_f32 v78, v132, v133
mm a,160,v,4,v,208,160
v_exp_f32 v135, v135
mm a,160,v,12,v,212,160
tr 206,239,18432
v_cvt_pk_bf16_f32 v79, v134, v135
mm a,164,v,20,v,208,164
mm a,164,v,28,v,212,164
ds_read_b128 a[200:203], v236 offset:128
mm a,168,v,36,v,208,168
mm a,168,v,44,v,212,168
ds_read_b128 a[204:207], v237 offset:128
mm a,172,v,52,v,208,172
mm a,172,v,60,v,212,172
mm v,148,a,216,v,96,180
v_exp_f32 v140, v140
mm v,148,a,220,v,104,148
tr 208,240,0
mm v,148,a,224,v,112,148
v_exp_f32 v141, v141
mm v,148,a,228,v,120,148
tr 210,240,6144
mm v,148,a,232,v,128,148
v_exp_f32 v142, v142
mm v,148,a,236,v,136,148
tr 212,240,12288
v_cvt_pk_bf16_f32 v94, v140, v141
mm a,176,v,4,v,216,176
v_exp_f32 v143, v143
mm a,176,v,12,v,220,176
tr 214,240,18432
v_cvt_pk_bf16_f32 v95, v142, v143
mm a,180,v,20,v,216,180
mm a,180,v,28,v,220,180
ds_read_b128 a[208:211], v236 offset:256
mm a,184,v,36,v,216,184
mm a,184,v,44,v,220,184
ds_read_b128 a[212:215], v237 offset:256
mm a,188,v,52,v,216,188
mm a,188,v,60,v,220,188
mm v,156,a,216,v,144,188
v_exp_f32 v148, v148
mm v,156,a,220,v,152,156
mm v,156,a,224,v,160,156
v_exp_f32 v149, v149
mm v,156,a,228,v,168,156
mm v,156,a,232,v,176,156
v_exp_f32 v150, v150
mm v,156,a,236,v,184,156
v_cvt_pk_bf16_f32 v110, v148, v149
mm a,252,v,232,v,52,252
v_exp_f32 v151, v151
mm a,252,v,232,v,60,252
s_waitcnt lgkmcnt(1)
v_cvt_pk_bf16_f32 v111, v150, v151
s_cmp_lg_u32 s35, 0
s_cbranch_scc1 L_loop_4
s_cmp_lg_u32 s36, 0
s_cbranch_scc1 L_tail2_4
L_tail1_4:
mm v,132,a,192,v,0,164
s_add_u32 s33, s33, 6144
s_add_u32 s94, s94, 6144
s_add_u32 s33, s33, s0
mm v,132,a,196,v,8,132
tr 216,241,0
s_add_u32 s34, s34, s1
mm v,132,a,200,v,16,132
tr 218,241,6144
s_add_u32 m0, s44, 0
mm v,132,a,204,v,24,132
s_add_u32 s51, s34, 0
v_exp_f32 v156, v156
mm v,132,a,208,v,32,132
tr 220,241,12288
s_waitcnt lgkmcnt(3)
mm v,132,a,212,v,40,132
v_exp_f32 v157, v157
mm a,0,v,68,v,192,0
tr 222,241,18432
mm a,0,v,76,v,196,0
v_exp_f32 v158, v158
mm a,4,v,84,v,192,4
ds_read_b128 a[216:219], v236 offset:6144
v_cvt_pk_bf16_f32 v126, v156, v157
mm a,4,v,92,v,196,4
v_exp_f32 v159, v159
mm a,8,v,100,v,192,8
ds_read_b128 a[220:223], v237 offset:6144
v_cvt_pk_bf16_f32 v127, v158, v159
mm a,8,v,108,v,196,8
buffer_load_dwordx4 v252, s[4:7], s51 offen lds
mm a,12,v,116,v,192,12
s_add_u32 s51, s34, 9216
mm a,12,v,124,v,196,12
mm v,140,a,192,v,48,172
v_exp_f32 v132, v132
mm v,140,a,196,v,56,140
tr 192,238,128
mm v,140,a,200,v,64,140
v_exp_f32 v133, v133
mm v,140,a,204,v,72,140
tr 194,238,6272
mm v,140,a,208,v,80,140
v_exp_f32 v134, v134
mm v,140,a,212,v,88,140
tr 196,238,12416
v_cvt_pk_bf16_f32 v4, v132, v133
mm a,16,v,68,v,200,16
v_exp_f32 v135, v135
mm a,16,v,76,v,204,16
tr 198,238,18560
v_cvt_pk_bf16_f32 v5, v134, v135
mm a,20,v,84,v,200,20
buffer_load_dwordx4 v252, s[4:7], s51 offen offset:1024 lds
mm a,20,v,92,v,204,20
ds_read_b128 a[224:227], v236 offset:6272
s_add_u32 s51, s34, 18432
mm a,24,v,100,v,200,24
mm a,24,v,108,v,204,24
ds_read_b128 a[228:231], v237 offset:6272
mm a,28,v,116,v,200,28
mm a,28,v,124,v,204,28
mm v,148,a,192,v,96,180
v_exp_f32 v140, v140
mm v,148,a,196,v,104,148
tr 200,239,128
mm v,148,a,200,v,112,148
v_exp_f32 v141, v141
mm v,148,a,204,v,120,148
tr 202,239,6272
mm v,148,a,208,v,128,148
v_exp_f32 v142, v142
mm v,148,a,212,v,136,148
tr 204,239,12416
v_cvt_pk_bf16_f32 v20, v140, v141
mm a,32,v,68,v,208,32
v_exp_f32 v143, v143
mm a,32,v,76,v,212,32
tr 206,239,18560
v_cvt_pk_bf16_f32 v21, v142, v143
mm a,36,v,84,v,208,36
buffer_load_dwordx4 v252, s[4:7], s51 offen offset:2048 lds
mm a,36,v,92,v,212,36
ds_read_b128 a[232:235], v236 offset:6400
s_add_u32 s51, s34, 27648
mm a,40,v,100,v,208,40
mm a,40,v,108,v,212,40
ds_read_b128 a[236:239], v237 offset:6400
mm a,44,v,116,v,208,44
mm a,44,v,124,v,212,44
mm v,156,a,192,v,144,188
v_exp_f32 v148, v148
mm v,156,a,196,v,152,156
mm v,156,a,200,v,160,156
v_exp_f32 v149, v149
mm v,156,a,204,v,168,156
mm v,156,a,208,v,176,156
v_exp_f32 v150, v150
mm v,156,a,212,v,184,156
v_cvt_pk_bf16_f32 v36, v148, v149
mm a,240,v,232,v,68,240
v_exp_f32 v151, v151
mm a,240,v,232,v,76,240
s_waitcnt lgkmcnt(13)
v_cvt_pk_bf16_f32 v37, v150, v151
mm v,132,a,216,v,0,164
s_waitcnt lgkmcnt(12)
mm v,132,a,220,v,8,132
tr 208,240,128
s_waitcnt lgkmcnt(8)
mm v,132,a,224,v,16,132
tr 210,240,6272
s_waitcnt lgkmcnt(8)
mm v,132,a,228,v,24,132
s_waitcnt lgkmcnt(3)
v_exp_f32 v156, v156
mm v,132,a,232,v,32,132
tr 212,240,12416
s_waitcnt lgkmcnt(3)
mm v,132,a,236,v,40,132
v_exp_f32 v157, v157
mm a,48,v,68,v,216,48
tr 214,240,18560
mm a,48,v,76,v,220,48
v_exp_f32 v158, v158
mm a,52,v,84,v,216,52
ds_read_b128 a[192:195], v236 offset:12288
v_cvt_pk_bf16_f32 v52, v156, v157
mm a,52,v,92,v,220,52
v_exp_f32 v159, v159
mm a,56,v,100,v,216,56
ds_read_b128 a[196:199], v237 offset:12288
v_cvt_pk_bf16_f32 v53, v158, v159
mm a,56,v,108,v,220,56
L_pg40:
s_cbranch_execz L_ir39
buffer_load_dwordx4 v252, s[4:7], s51 offen offset:3072 lds
mm a,60,v,116,v,216,60
s_add_u32 m0, s44, 4096
s_add_u32 s51, s34, 40960
mm a,60,v,124,v,220,60
mm v,140,a,216,v,48,172
v_exp_f32 v132, v132
mm v,140,a,220,v,56,140
tr 216,241,128
mm v,140,a,224,v,64,140
v_exp_f32 v133, v133
mm v,140,a,228,v,72,140
tr 218,241,6272
mm v,140,a,232,v,80,140
v_exp_f32 v134, v134
mm v,140,a,236,v,88,140
tr 220,241,12416
v_cvt_pk_bf16_f32 v6, v132, v133
mm a,64,v,68,v,192,64
v_exp_f32 v135, v135
mm a,64,v,76,v,196,64
tr 222,241,18560
v_cvt_pk_bf16_f32 v7, v134, v135
mm a,68,v,84,v,192,68
buffer_load_dwordx4 v252, s[4:7], s51 offen lds
mm a,68,v,92,v,196,68
ds_read_b128 a[200:203], v236 offset:12416
s_add_u32 s51, s34, 50176
mm a,72,v,100,v,192,72
mm a,72,v,108,v,196,72
ds_read_b128 a[204:207], v237 offset:12416
mm a,76,v,116,v,192,76
mm a,76,v,124,v,196,76
mm v,148,a,216,v,96,180
v_exp_f32 v140, v140
mm v,148,a,220,v,104,148
tr 192,238,256
mm v,148,a,224,v,112,148
v_exp_f32 v141, v141
mm v,148,a,228,v,120,148
tr 194,238,6400
mm v,148,a,232,v,128,148
v_exp_f32 v142, v142
mm v,148,a,236,v,136,148
tr 196,238,12544
v_cvt_pk_bf16_f32 v22, v140, v141
mm a,80,v,68,v,200,80
v_exp_f32 v143, v143
mm a,80,v,76,v,204,80
tr 198,238,18688
v_cvt_pk_bf16_f32 v23, v142, v143
mm a,84,v,84,v,200,84
mm a,84,v,92,v,204,84
ds_read_b128 a[208:211], v236 offset:12544
mm a,88,v,100,v,200,88
buffer_load_dwordx4 v252, s[4:7], s51 offen offset:1024 lds
mm a,88,v,108,v,204,88
ds_read_b128 a[212:215], v237 offset:12544
s_add_u32 s51, s34, 59392
mm a,92,v,116,v,200,92
mm a,92,v,124,v,204,92
mm v,156,a,216,v,144,188
v_exp_f32 v148, v148
mm v,156,a,220,v,152,156
mm v,156,a,224,v,160,156
v_exp_f32 v149, v149
mm v,156,a,228,v,168,156
mm v,156,a,232,v,176,156
v_exp_f32 v150, v150
mm v,156,a,236,v,184,156
v_cvt_pk_bf16_f32 v38, v148, v149
mm a,244,v,232,v,84,244
v_exp_f32 v151, v151
mm a,244,v,232,v,92,244
s_waitcnt lgkmcnt(13)
v_cvt_pk_bf16_f32 v39, v150, v151
mm v,132,a,192,v,0,164
s_waitcnt lgkmcnt(12)
mm v,132,a,196,v,8,132
tr 200,239,256
s_waitcnt lgkmcnt(8)
mm v,132,a,200,v,16,132
tr 202,239,6400
s_waitcnt lgkmcnt(8)
mm v,132,a,204,v,24,132
s_waitcnt lgkmcnt(3)
v_exp_f32 v156, v156
mm v,132,a,208,v,32,132
tr 204,239,12544
s_waitcnt lgkmcnt(3)
mm v,132,a,212,v,40,132
v_exp_f32 v157, v157
mm a,96,v,68,v,208,96
tr 206,239,18688
mm a,96,v,76,v,212,96
v_exp_f32 v158, v158
mm a,100,v,84,v,208,100
ds_read_b128 a[216:219], v236 offset:18432
v_cvt_pk_bf16_f32 v54, v156, v157
mm a,100,v,92,v,212,100
v_exp_f32 v159, v159
mm a,104,v,100,v,208,104
ds_read_b128 a[220:223], v237 offset:18432
v_cvt_pk_bf16_f32 v55, v158, v159
mm a,104,v,108,v,212,104
buffer_load_dwordx4 v252, s[4:7], s51 offen offset:2048 lds
mm a,108,v,116,v,208,108
s_add_u32 s51, s34, 68608
mm a,108,v,124,v,212,108
mm v,140,a,192,v,48,172
v_exp_f32 v132, v132
mm v,140,a,196,v,56,140
tr 208,240,256
mm v,140,a,200,v,64,140
v_exp_f32 v133, v133
mm v,140,a,204,v,72,140
tr 210,240,6400
mm v,140,a,208,v,80,140
v_exp_f32 v134, v134
mm v,140,a,212,v,88,140
tr 212,240,12544
v_cvt_pk_bf16_f32 v12, v132, v133
mm a,112,v,68,v,216,112
v_exp_f32 v135, v135
mm a,112,v,76,v,220,112
tr 214,240,18688
v_cvt_pk_bf16_f32 v13, v134, v135
mm a,116,v,84,v,216,116
mm a,116,v,92,v,220,116
ds_read_b128 a[224:227], v236 offset:18560
mm a,120,v,100,v,216,120
buffer_load_dwordx4 v252, s[4:7], s51 offen offset:3072 lds
mm a,120,v,108,v,220,120
ds_read_b128 a[228:231], v237 offset:18560
s_add_u32 s34, s34, 128
mm a,124,v,116,v,216,124
s_cmp_eq_u32 s34, s95
s_cselect_b32 s55, 1280, 0
s_sub_u32 s34, s34, s55
mm a,124,v,124,v,220,124
mm v,148,a,192,v,96,180
v_exp_f32 v140, v140
mm v,148,a,196,v,104,148
tr 216,241,256
mm v,148,a,200,v,112,148
v_exp_f32 v141, v141
mm v,148,a,204,v,120,148
tr 218,241,6400
mm v,148,a,208,v,128,148
v_exp_f32 v142, v142
mm v,148,a,212,v,136,148
tr 220,241,12544
v_cvt_pk_bf16_f32 v28, v140, v141
mm a,128,v,68,v,192,128
v_exp_f32 v143, v143
mm a,128,v,76,v,196,128
tr 222,241,18688
v_cvt_pk_bf16_f32 v29, v142, v143
mm a,132,v,84,v,192,132
mm a,132,v,92,v,196,132
ds_read_b128 a[232:235], v236 offset:18688
mm a,136,v,100,v,192,136
mm a,136,v,108,v,196,136
ds_read_b128 a[236:239], v237 offset:18688
s_sub_u32 s42, s29, s49
mm a,140,v,116,v,192,140
s_mov_b32 s49, s29
v_add_u32 v238, s42, v238
v_add_u32 v239, s42, v239
mm a,140,v,124,v,196,140
v_add_u32 v240, s42, v240
v_add_u32 v241, s42, v241
mm v,156,a,192,v,144,188
s_sub_u32 s47, s26, s25
v_exp_f32 v148, v148
mm v,156,a,196,v,152,156
v_add_u32 v236, s47, v236
v_add_u32 v237, s47, v237
mm v,156,a,200,v,160,156
v_exp_f32 v149, v149
mm v,156,a,204,v,168,156
mm v,156,a,208,v,176,156
v_exp_f32 v150, v150
mm v,156,a,212,v,184,156
v_cvt_pk_bf16_f32 v44, v148, v149
mm a,248,v,232,v,100,248
v_exp_f32 v151, v151
mm a,248,v,232,v,108,248
s_waitcnt lgkmcnt(13)
v_cvt_pk_bf16_f32 v45, v150, v151
mm v,132,a,216,v,0,164
s_waitcnt lgkmcnt(0)
s_barrier
mm v,132,a,220,v,8,132
tr 192,238,0
s_mov_b32 s43, s28
mm v,132,a,224,v,16,132
tr 194,238,6144
s_mov_b32 s28, s29
mm v,132,a,228,v,24,132
s_mov_b32 s29, s30
v_exp_f32 v156, v156
mm v,132,a,232,v,32,132
tr 196,238,12288
s_mov_b32 s30, s43
mm v,132,a,236,v,40,132
s_mov_b32 s43, s25
v_exp_f32 v157, v157
mm a,144,v,68,v,200,144
tr 198,238,18432
s_mov_b32 s25, s26
mm a,144,v,76,v,204,144
s_mov_b32 s26, s27
v_exp_f32 v158, v158
mm a,148,v,84,v,200,148
ds_read_b128 a[192:195], v236
v_cvt_pk_bf16_f32 v60, v156, v157
mm a,148,v,92,v,204,148
s_mov_b32 s27, s43
v_exp_f32 v159, v159
mm a,152,v,100,v,200,152
ds_read_b128 a[196:199], v237
v_cvt_pk_bf16_f32 v61, v158, v159
mm a,152,v,108,v,204,152
mm a,156,v,116,v,200,156
mm a,156,v,124,v,204,156
mm v,140,a,216,v,48,172
v_exp_f32 v132, v132
mm v,140,a,220,v,56,140
tr 200,239,0
mm v,140,a,224,v,64,140
v_exp_f32 v133, v133
mm v,140,a,228,v,72,140
tr 202,239,6144
mm v,140,a,232,v,80,140
v_exp_f32 v134, v134
mm v,140,a,236,v,88,140
tr 204,239,12288
v_cvt_pk_bf16_f32 v14, v132, v133
mm a,160,v,68,v,208,160
v_exp_f32 v135, v135
mm a,160,v,76,v,212,160
tr 206,239,18432
v_cvt_pk_bf16_f32 v15, v134, v135
mm a,164,v,84,v,208,164
mm a,164,v,92,v,212,164
ds_read_b128 a[200:203], v236 offset:128
mm a,168,v,100,v,208,168
mm a,168,v,108,v,212,168
ds_read_b128 a[204:207], v237 offset:128
mm a,172,v,116,v,208,172
mm a,172,v,124,v,212,172
mm v,148,a,216,v,96,180
v_exp_f32 v140, v140
mm v,148,a,220,v,104,148
tr 208,240,0
mm v,148,a,224,v,112,148
v_exp_f32 v141, v141
mm v,148,a,228,v,120,148
tr 210,240,6144
mm v,148,a,232,v,128,148
v_exp_f32 v142, v142
mm v,148,a,236,v,136,148
tr 212,240,12288
v_cvt_pk_bf16_f32 v30, v140, v141
mm a,176,v,68,v,216,176
v_exp_f32 v143, v143
mm a,176,v,76,v,220,176
tr 214,240,18432
v_cvt_pk_bf16_f32 v31, v142, v143
mm a,180,v,84,v,216,180
mm a,180,v,92,v,220,180
ds_read_b128 a[208:211], v236 offset:256
mm a,184,v,100,v,216,184
mm a,184,v,108,v,220,184
ds_read_b128 a[212:215], v237 offset:256
mm a,188,v,116,v,216,188
mm a,188,v,124,v,220,188
mm v,156,a,216,v,144,188
v_exp_f32 v148, v148
mm v,156,a,220,v,152,156
mm v,156,a,224,v,160,156
v_exp_f32 v149, v149
mm v,156,a,228,v,168,156
mm v,156,a,232,v,176,156
v_exp_f32 v150, v150
mm v,156,a,236,v,184,156
v_cvt_pk_bf16_f32 v46, v148, v149
mm a,252,v,232,v,116,252
v_exp_f32 v151, v151
mm a,252,v,232,v,124,252
s_waitcnt lgkmcnt(13)
v_cvt_pk_bf16_f32 v47, v150, v151
mm v,132,a,192,v,0,164
s_add_u32 m0, s30, s40
s_waitcnt lgkmcnt(7)
mm v,132,a,196,v,8,132
tr 216,241,0
buffer_load_dwordx4 v249, s[8:11], s33 offen lds
mm v,132,a,200,v,16,132
tr 218,241,6144
s_waitcnt lgkmcnt(8)
mm v,132,a,204,v,24,132
s_waitcnt lgkmcnt(3)
v_exp_f32 v156, v156
mm v,132,a,208,v,32,132
tr 220,241,12288
s_waitcnt lgkmcnt(3)
mm v,132,a,212,v,40,132
v_exp_f32 v157, v157
mm a,0,v,4,v,192,0
tr 222,241,18432
mm a,0,v,12,v,196,0
v_exp_f32 v158, v158
mm a,4,v,20,v,192,4
ds_read_b128 a[216:219], v236 offset:6144
v_cvt_pk_bf16_f32 v62, v156, v157
mm a,4,v,28,v,196,4
v_exp_f32 v159, v159
mm a,8,v,36,v,192,8
ds_read_b128 a[220:223], v237 offset:6144
v_cvt_pk_bf16_f32 v63, v158, v159
mm a,8,v,44,v,196,8
mm a,12,v,52,v,192,12
buffer_load_dwordx4 v250, s[8:11], s33 offen offset:1024 lds
mm a,12,v,60,v,196,12
mm v,140,a,192,v,48,172
v_exp_f32 v132, v132
mm v,140,a,196,v,56,140
tr 192,238,128
mm v,140,a,200,v,64,140
v_exp_f32 v133, v133
mm v,140,a,204,v,72,140
tr 194,238,6272
mm v,140,a,208,v,80,140
v_exp_f32 v134, v134
mm v,140,a,212,v,88,140
tr 196,238,12416
v_cvt_pk_bf16_f32 v68, v132, v133
mm a,16,v,4,v,200,16
buffer_load_dwordx4 v251, s[8:11], s33 offen offset:2048 lds
v_exp_f32 v135, v135
mm a,16,v,12,v,204,16
tr 198,238,18560
v_cvt_pk_bf16_f32 v69, v134, v135
mm a,20,v,20,v,200,20
s_add_u32 s33, s33, 786432
s_cmp_eq_u32 s33, s94
s_cselect_b32 s55, 7864320, 0
mm a,20,v,28,v,204,20
ds_read_b128 a[224:227], v236 offset:6272
s_sub_u32 s33, s33, s55
mm a,24,v,36,v,200,24
s_add_u32 m0, s45, 0
s_add_u32 s51, s34, 0
mm a,24,v,44,v,204,24
ds_read_b128 a[228:231], v237 offset:6272
mm a,28,v,52,v,200,28
mm a,28,v,60,v,204,28
mm v,148,a,192,v,96,180
v_exp_f32 v140, v140
mm v,148,a,196,v,104,148
tr 200,239,128
mm v,148,a,200,v,112,148
v_exp_f32 v141, v141
mm v,148,a,204,v,120,148
tr 202,239,6272
mm v,148,a,208,v,128,148
v_exp_f32 v142, v142
mm v,148,a,212,v,136,148
tr 204,239,12416
v_cvt_pk_bf16_f32 v84, v140, v141
mm a,32,v,4,v,208,32
v_exp_f32 v143, v143
mm a,32,v,12,v,212,32
tr 206,239,18560
v_cvt_pk_bf16_f32 v85, v142, v143
mm a,36,v,20,v,208,36
mm a,36,v,28,v,212,36
ds_read_b128 a[232:235], v236 offset:6400
mm a,40,v,36,v,208,40
buffer_load_dwordx4 v252, s[4:7], s51 offen lds
mm a,40,v,44,v,212,40
ds_read_b128 a[236:239], v237 offset:6400
s_add_u32 s51, s34, 9216
mm a,44,v,52,v,208,44
mm a,44,v,60,v,212,44
mm v,156,a,192,v,144,188
v_exp_f32 v148, v148
mm v,156,a,196,v,152,156
mm v,156,a,200,v,160,156
v_exp_f32 v149, v149
mm v,156,a,204,v,168,156
mm v,156,a,208,v,176,156
v_exp_f32 v150, v150
mm v,156,a,212,v,184,156
v_cvt_pk_bf16_f32 v100, v148, v149
mm a,240,v,232,v,4,240
v_exp_f32 v151, v151
mm a,240,v,232,v,12,240
s_waitcnt lgkmcnt(13)
v_cvt_pk_bf16_f32 v101, v150, v151
mm v,132,a,216,v,0,164
s_waitcnt lgkmcnt(6)
mm v,132,a,220,v,8,132
tr 208,240,128
buffer_load_dwordx4 v252, s[4:7], s51 offen offset:1024 lds
mm v,132,a,224,v,16,132
tr 210,240,6272
s_add_u32 s51, s34, 18432
mm v,132,a,228,v,24,132
s_waitcnt lgkmcnt(3)
v_exp_f32 v156, v156
mm v,132,a,232,v,32,132
tr 212,240,12416
s_waitcnt lgkmcnt(3)
mm v,132,a,236,v,40,132
v_exp_f32 v157, v157
mm a,48,v,4,v,216,48
tr 214,240,18560
mm a,48,v,12,v,220,48
v_exp_f32 v158, v158
mm a,52,v,20,v,216,52
ds_read_b128 a[192:195], v236 offset:12288
v_cvt_pk_bf16_f32 v116, v156, v157
mm a,52,v,28,v,220,52
v_exp_f32 v159, v159
mm a,56,v,36,v,216,56
ds_read_b128 a[196:199], v237 offset:12288
v_cvt_pk_bf16_f32 v117, v158, v159
mm a,56,v,44,v,220,56
mm a,60,v,52,v,216,60
mm a,60,v,60,v,220,60
mm v,140,a,216,v,48,172
buffer_load_dwordx4 v252, s[4:7], s51 offen offset:2048 lds
v_exp_f32 v132, v132
mm v,140,a,220,v,56,140
tr 216,241,128
s_add_u32 s51, s34, 27648
mm v,140,a,224,v,64,140
v_exp_f32 v133, v133
mm v,140,a,228,v,72,140
tr 218,241,6272
mm v,140,a,232,v,80,140
v_exp_f32 v134, v134
mm v,140,a,236,v,88,140
tr 220,241,12416
v_cvt_pk_bf16_f32 v70, v132, v133
mm a,64,v,4,v,192,64
v_exp_f32 v135, v135
mm a,64,v,12,v,196,64
tr 222,241,18560
v_cvt_pk_bf16_f32 v71, v134, v135
mm a,68,v,20,v,192,68
mm a,68,v,28,v,196,68
ds_read_b128 a[200:203], v236 offset:12416
mm a,72,v,36,v,192,72
mm a,72,v,44,v,196,72
ds_read_b128 a[204:207], v237 offset:12416
mm a,76,v,52,v,192,76
mm a,76,v,60,v,196,76
buffer_load_dwordx4 v252, s[4:7], s51 offen offset:3072 lds
mm v,148,a,216,v,96,180
s_add_u32 m0, s45, 4096
v_exp_f32 v140, v140
mm v,148,a,220,v,104,148
tr 192,238,256
s_add_u32 s51, s34, 40960
mm v,148,a,224,v,112,148
v_exp_f32 v141, v141
mm v,148,a,228,v,120,148
tr 194,238,6400
mm v,148,a,232,v,128,148
v_exp_f32 v142, v142
mm v,148,a,236,v,136,148
tr 196,238,12544
v_cvt_pk_bf16_f32 v86, v140, v141
mm a,80,v,4,v,200,80
v_exp_f32 v143, v143
mm a,80,v,12,v,204,80
tr 198,238,18688
v_cvt_pk_bf16_f32 v87, v142, v143
mm a,84,v,20,v,200,84
mm a,84,v,28,v,204,84
ds_read_b128 a[208:211], v236 offset:12544
mm a,88,v,36,v,200,88
mm a,88,v,44,v,204,88
ds_read_b128 a[212:215], v237 offset:12544
mm a,92,v,52,v,200,92
buffer_load_dwordx4 v252, s[4:7], s51 offen lds
mm a,92,v,60,v,204,92
s_add_u32 s51, s34, 50176
mm v,156,a,216,v,144,188
v_exp_f32 v148, v148
mm v,156,a,220,v,152,156
mm v,156,a,224,v,160,156
v_exp_f32 v149, v149
mm v,156,a,228,v,168,156
mm v,156,a,232,v,176,156
v_exp_f32 v150, v150
mm v,156,a,236,v,184,156
v_cvt_pk_bf16_f32 v102, v148, v149
mm a,244,v,232,v,20,244
v_exp_f32 v151, v151
mm a,244,v,232,v,28,244
s_waitcnt lgkmcnt(13)
v_cvt_pk_bf16_f32 v103, v150, v151
mm v,132,a,192,v,0,164
s_waitcnt lgkmcnt(12)
mm v,132,a,196,v,8,132
tr 200,239,256
s_waitcnt lgkmcnt(8)
mm v,132,a,200,v,16,132
tr 202,239,6400
s_waitcnt lgkmcnt(2)
mm v,132,a,204,v,24,132
buffer_load_dwordx4 v252, s[4:7], s51 offen offset:1024 lds
v_exp_f32 v156, v156
mm v,132,a,208,v,32,132
tr 204,239,12544
s_add_u32 s51, s34, 59392
mm v,132,a,212,v,40,132
v_exp_f32 v157, v157
mm a,96,v,4,v,208,96
tr 206,239,18688
mm a,96,v,12,v,212,96
v_exp_f32 v158, v158
mm a,100,v,20,v,208,100
ds_read_b128 a[216:219], v236 offset:18432
v_cvt_pk_bf16_f32 v118, v156, v157
mm a,100,v,28,v,212,100
v_exp_f32 v159, v159
mm a,104,v,36,v,208,104
ds_read_b128 a[220:223], v237 offset:18432
v_cvt_pk_bf16_f32 v119, v158, v159
mm a,104,v,44,v,212,104
mm a,108,v,52,v,208,108
mm a,108,v,60,v,212,108
mm v,140,a,192,v,48,172
v_exp_f32 v132, v132
mm v,140,a,196,v,56,140
tr 208,240,256
mm v,140,a,200,v,64,140
buffer_load_dwordx4 v252, s[4:7], s51 offen offset:2048 lds
v_exp_f32 v133, v133
mm v,140,a,204,v,72,140
tr 210,240,6400
s_add_u32 s51, s34, 68608
mm v,140,a,208,v,80,140
v_exp_f32 v134, v134
mm v,140,a,212,v,88,140
tr 212,240,12544
v_cvt_pk_bf16_f32 v76, v132, v133
mm a,112,v,4,v,216,112
v_exp_f32 v135, v135
mm a,112,v,12,v,220,112
tr 214,240,18688
v_cvt_pk_bf16_f32 v77, v134, v135
mm a,116,v,20,v,216,116
mm a,116,v,28,v,220,116
ds_read_b128 a[224:227], v236 offset:18560
mm a,120,v,36,v,216,120
mm a,120,v,44,v,220,120
ds_read_b128 a[228:231], v237 offset:18560
mm a,124,v,52,v,216,124
buffer_load_dwordx4 v252, s[4:7], s51 offen offset:3072 lds
mm a,124,v,60,v,220,124
s_add_u32 s34, s34, 128
s_cmp_eq_u32 s34, s95
s_cselect_b32 s55, 1280, 0
mm v,148,a,192,v,96,180
s_sub_u32 s34, s34, s55
v_exp_f32 v140, v140
mm v,148,a,196,v,104,148
tr 216,241,256
mm v,148,a,200,v,112,148
L_pg45:
s_cbranch_execz L_ir44
v_exp_f32 v141, v141
mm v,148,a,204,v,120,148
tr 218,241,6400
mm v,148,a,208,v,128,148
v_exp_f32 v142, v142
mm v,148,a,212,v,136,148
tr 220,241,12544
v_cvt_pk_bf16_f32 v92, v140, v141
mm a,128,v,4,v,192,128
v_exp_f32 v143, v143
mm a,128,v,12,v,196,128
tr 222,241,18688
v_cvt_pk_bf16_f32 v93, v142, v143
mm a,132,v,20,v,192,132
mm a,132,v,28,v,196,132
ds_read_b128 a[232:235], v236 offset:18688
mm a,136,v,36,v,192,136
mm a,136,v,44,v,196,136
ds_read_b128 a[236:239], v237 offset:18688
s_sub_u32 s42, s29, s49
mm a,140,v,52,v,192,140
s_mov_b32 s49, s29
v_add_u32 v238, s42, v238
v_add_u32 v239, s42, v239
mm a,140,v,60,v,196,140
v_add_u32 v240, s42, v240
v_add_u32 v241, s42, v241
mm v,156,a,192,v,144,188
v_exp_f32 v148, v148
mm v,156,a,196,v,152,156
mm v,156,a,200,v,160,156
v_exp_f32 v149, v149
mm v,156,a,204,v,168,156
mm v,156,a,208,v,176,156
v_exp_f32 v150, v150
mm v,156,a,212,v,184,156
v_cvt_pk_bf16_f32 v108, v148, v149
mm a,248,v,232,v,36,248
v_exp_f32 v151, v151
mm a,248,v,232,v,44,248
s_waitcnt lgkmcnt(13)
v_cvt_pk_bf16_f32 v109, v150, v151
mm v,132,a,216,v,0,164
s_waitcnt lgkmcnt(0)
s_barrier
mm v,132,a,220,v,8,132
tr 192,238,0
s_mov_b32 s43, s28
mm v,132,a,224,v,16,132
tr 194,238,6144
s_mov_b32 s28, s29
mm v,132,a,228,v,24,132
s_mov_b32 s29, s30
v_exp_f32 v156, v156
mm v,132,a,232,v,32,132
tr 196,238,12288
s_mov_b32 s30, s43
mm v,132,a,236,v,40,132
s_add_u32 m0, s30, s40
v_exp_f32 v157, v157
mm a,144,v,4,v,200,144
tr 198,238,18432
mm a,144,v,12,v,204,144
v_exp_f32 v158, v158
mm a,148,v,20,v,200,148
v_cvt_pk_bf16_f32 v124, v156, v157
mm a,148,v,28,v,204,148
v_exp_f32 v159, v159
mm a,152,v,36,v,200,152
v_cvt_pk_bf16_f32 v125, v158, v159
mm a,152,v,44,v,204,152
buffer_load_dwordx4 v249, s[8:11], s33 offen lds
mm a,156,v,52,v,200,156
mm a,156,v,60,v,204,156
mm v,140,a,216,v,48,172
v_exp_f32 v132, v132
mm v,140,a,220,v,56,140
tr 200,239,0
mm v,140,a,224,v,64,140
v_exp_f32 v133, v133
mm v,140,a,228,v,72,140
tr 202,239,6144
mm v,140,a,232,v,80,140
v_exp_f32 v134, v134
mm v,140,a,236,v,88,140
tr 204,239,12288
v_cvt_pk_bf16_f32 v78, v132, v133
mm a,160,v,4,v,208,160
v_exp_f32 v135, v135
mm a,160,v,12,v,212,160
tr 206,239,18432
v_cvt_pk_bf16_f32 v79, v134, v135
mm a,164,v,20,v,208,164
buffer_load_dwordx4 v250, s[8:11], s33 offen offset:1024 lds
mm a,164,v,28,v,212,164
mm a,168,v,36,v,208,168
mm a,168,v,44,v,212,168
mm a,172,v,52,v,208,172
mm a,172,v,60,v,212,172
mm v,148,a,216,v,96,180
v_exp_f32 v140, v140
mm v,148,a,220,v,104,148
tr 208,240,0
mm v,148,a,224,v,112,148
buffer_load_dwordx4 v251, s[8:11], s33 offen offset:2048 lds
v_exp_f32 v141, v141
mm v,148,a,228,v,120,148
tr 210,240,6144
s_add_u32 s33, s33, 786432
mm v,148,a,232,v,128,148
v_exp_f32 v142, v142
mm v,148,a,236,v,136,148
tr 212,240,12288
v_cvt_pk_bf16_f32 v94, v140, v141
mm a,176,v,4,v,216,176
v_exp_f32 v143, v143
mm a,176,v,12,v,220,176
tr 214,240,18432
v_cvt_pk_bf16_f32 v95, v142, v143
mm a,180,v,20,v,216,180
s_cmp_eq_u32 s33, s94
s_cselect_b32 s55, 7864320, 0
s_sub_u32 s33, s33, s55
mm a,180,v,28,v,220,180
mm a,184,v,36,v,216,184
mm a,184,v,44,v,220,184
mm a,188,v,52,v,216,188
mm a,188,v,60,v,220,188
mm v,156,a,216,v,144,188
v_exp_f32 v148, v148
mm v,156,a,220,v,152,156
mm v,156,a,224,v,160,156
v_exp_f32 v149, v149
mm v,156,a,228,v,168,156
mm v,156,a,232,v,176,156
v_exp_f32 v150, v150
mm v,156,a,236,v,184,156
v_cvt_pk_bf16_f32 v110, v148, v149
mm a,252,v,232,v,52,252
v_exp_f32 v151, v151
mm a,252,v,232,v,60,252
s_waitcnt lgkmcnt(10)
v_cvt_pk_bf16_f32 v111, v150, v151
mm a,0,v,68,v,192,0
s_waitcnt lgkmcnt(8)
mm a,0,v,76,v,196,0
mm a,4,v,84,v,192,4
v_exp_f32 v156, v156
v_exp_f32 v157, v157
mm a,4,v,92,v,196,4
v_exp_f32 v158, v158
v_exp_f32 v159, v159
mm a,8,v,100,v,192,8
v_cvt_pk_bf16_f32 v126, v156, v157
v_cvt_pk_bf16_f32 v127, v158, v159
mm a,8,v,108,v,196,8
s_nop 0
s_waitcnt lgkmcnt(4)
mm a,12,v,116,v,192,12
tr 216,241,0
v_bfe_u32 v134, v253, 4, 4
mm a,12,v,124,v,196,12
tr 218,241,6144
v_lshrrev_b32 v135, 8, v253
mm a,240,v,232,v,68,240
mm a,240,v,232,v,76,240
mm a,244,v,232,v,84,244
mm a,244,v,232,v,92,244
mm a,248,v,232,v,100,248
mm a,248,v,232,v,108,248
mm a,252,v,232,v,116,252
mm a,252,v,232,v,124,252
mm a,16,v,68,v,200,16
tr 220,241,12288
v_lshlrev_b32 v135, 2, v135
mm a,16,v,76,v,204,16
tr 222,241,18432
mm a,20,v,84,v,200,20
tr 192,238,128
v_sub_u32 v134, v134, v135
mm a,20,v,92,v,204,20
tr 194,238,6272
v_min_u32 v134, 4, v134
mm a,24,v,100,v,200,24
tr 196,238,12416
v_lshlrev_b32 v134, 4, v134
mm a,24,v,108,v,204,24
tr 198,238,18560
mm a,28,v,116,v,200,28
v_mov_b32 v140, 0x3f80
v_mov_b32 v141, 0
mm a,28,v,124,v,204,28
s_waitcnt lgkmcnt(8)
v_lshlrev_b64 v[132:133], v134, v[140:141]
v_cmp_gt_u32 vcc, 64, v134
mm a,32,v,68,v,208,32
tr 200,239,128
v_accvgpr_read_b32 v232, a240
v_mov_b32 v140, 0
mm a,32,v,76,v,212,32
tr 202,239,6272
v_accvgpr_read_b32 v233, a244
v_mov_b32 v134, 0
mm a,36,v,84,v,208,36
tr 204,239,12416
v_accvgpr_read_b32 v234, a248
v_mov_b32 v135, 0
mm a,36,v,92,v,212,36
tr 206,239,18560
v_cndmask_b32 v132, 0, v132, vcc
mm a,40,v,100,v,208,40
v_accvgpr_read_b32 v235, a252
v_add_f32 v224, v232, v233
mm a,40,v,108,v,212,40
v_add_f32 v224, v224, v234
v_add_f32 v224, v224, v235
mm a,44,v,116,v,208,44
v_cmp_ngt_f32 s[52:53], s37, v224
v_mov_b32 v143, v133
v_mov_b32 v142, v132
mm a,44,v,124,v,212,44
s_waitcnt lgkmcnt(8)
v_rcp_f32 v232, v232
mm a,48,v,68,v,216,48
tr 208,240,128
s_waitcnt vmcnt(14)
mm a,48,v,76,v,220,48
tr 210,240,6272
ds_read_b128 a[192:195], v244
mm a,52,v,84,v,216,52
tr 212,240,12416
ds_read_b128 a[196:199], v245
mm a,52,v,92,v,220,52
tr 214,240,18560
s_waitcnt lgkmcnt(10)
mm a,56,v,100,v,216,56
ds_read_b128 a[200:203], v244 offset:2048
v_rcp_f32 v233, v233
mm a,56,v,108,v,220,56
ds_read_b128 a[204:207], v245 offset:2048
v_rcp_f32 v234, v234
mm a,60,v,116,v,216,60
ds_read_b128 a[208:211], v244 offset:4096
v_rcp_f32 v235, v235
mm a,60,v,124,v,220,60
s_lshl_b32 s101, s24, 8
s_add_u32 s101, s101, 161536
v_bfe_u32 v225, v253, 4, 4
mm a,64,v,68,v,192,64
tr 216,241,128
v_lshl_add_u32 v225, v225, 2, s101
mm a,64,v,76,v,196,64
tr 218,241,6272
ds_read_b128 a[212:215], v245 offset:4096
mm a,68,v,84,v,192,68
tr 220,241,12416
ds_read_b128 a[216:219], v244 offset:6144
mm a,68,v,92,v,196,68
tr 222,241,18560
mm a,72,v,100,v,192,72
ds_write_b32 v225, v232
ds_read_b128 a[220:223], v245 offset:6144
mm a,72,v,108,v,196,72
ds_write_b32 v225, v233 offset:64
ds_read_b128 v[36:39], v244
mm a,76,v,116,v,192,76
ds_write_b32 v225, v234 offset:128
ds_read_b128 v[44:47], v245
mm a,76,v,124,v,196,76
ds_write_b32 v225, v235 offset:192
s_waitcnt lgkmcnt(15)
mm a,80,v,68,v,200,80
tr 192,238,256
mm a,80,v,76,v,204,80
tr 194,238,6400
mm a,84,v,84,v,200,84
tr 196,238,12544
mm a,84,v,92,v,204,84
tr 198,238,18688
s_waitcnt lgkmcnt(5)
s_add_u32 m0, s44, 0
mm a,88,v,100,v,200,88
s_cmp_lg_u64 s[52:53], 0
s_cselect_b32 s52, 1, 0
s_lshl_b32 s101, s24, 2
mm a,88,v,108,v,204,88
s_add_u32 s101, s101, 161280
v_mov_b32 v224, s52
v_mov_b32 v225, s101
mm a,92,v,116,v,200,92
ds_write_b32 v225, v224
v_mov_b32 v254, 161280
mm a,92,v,124,v,204,92
s_add_u32 s51, s34, 0
buffer_load_dwordx4 v252, s[4:7], s51 offen lds
ds_read_b128 v[232:235], v246
v_accvgpr_read_b32 v4, a0
v_accvgpr_read_b32 v5, a1
mm a,96,v,68,v,208,96
tr 200,239,256
s_add_u32 s51, s34, 9216
v_accvgpr_read_b32 v6, a2
v_accvgpr_read_b32 v7, a3
v_accvgpr_read_b32 v12, a16
v_accvgpr_read_b32 v13, a17
mm a,96,v,76,v,212,96
tr 202,239,6400
v_accvgpr_read_b32 v14, a18
v_accvgpr_read_b32 v15, a19
mm a,100,v,84,v,208,100
tr 204,239,12544
s_waitcnt lgkmcnt(3)
v_mul_f32_e64 v148, -v248, v232
v_mul_f32_e64 v149, -v248, v233
v_mul_f32_e64 v150, -v248, v234
v_mul_f32_e64 v151, -v248, v235
mm a,100,v,92,v,212,100
tr 206,239,18688
v_fma_f32 v4, v4, v232, v148
v_fma_f32 v5, v5, v233, v149
v_fma_f32 v6, v6, v234, v150
mm a,104,v,100,v,208,104
buffer_load_dwordx4 v252, s[4:7], s51 offen offset:1024 lds
v_fma_f32 v7, v7, v235, v151
v_fma_f32 v12, v12, v232, v148
v_fma_f32 v13, v13, v233, v149
v_fma_f32 v14, v14, v234, v150
mm a,104,v,108,v,212,104
s_add_u32 s51, s34, 18432
v_fma_f32 v15, v15, v235, v151
v_cvt_pk_bf16_f32 v4, v4, v5
v_cvt_pk_bf16_f32 v5, v6, v7
mm a,108,v,116,v,208,108
v_cvt_pk_bf16_f32 v6, v12, v13
v_cvt_pk_bf16_f32 v7, v14, v15
mm a,108,v,124,v,212,108
mm a,112,v,68,v,216,112
tr 208,240,256
mm a,112,v,76,v,220,112
tr 210,240,6400
mz v,20,v,4,v,132
mz v,28,v,4,v,140
mm a,116,v,84,v,216,116
tr 212,240,12544
ds_read_b128 v[232:235], v246 offset:64
v_accvgpr_read_b32 v4, a4
v_accvgpr_read_b32 v5, a5
v_accvgpr_read_b32 v6, a6
v_accvgpr_read_b32 v7, a7
v_accvgpr_read_b32 v12, a20
v_accvgpr_read_b32 v13, a21
v_accvgpr_read_b32 v14, a22
v_accvgpr_read_b32 v15, a23
v_cvt_pk_bf16_f32 v20, v20, v21
v_cvt_pk_bf16_f32 v21, v22, v23
v_cvt_pk_bf16_f32 v22, v28, v29
v_cvt_pk_bf16_f32 v23, v30, v31
mm a,116,v,92,v,220,116
tr 214,240,18688
s_add_u32 s50, s46, 0
buffer_store_dwordx4 v[20:23], v253, s[20:23], s50 offen sc1
s_waitcnt lgkmcnt(1)
v_mul_f32_e64 v148, -v248, v232
v_mul_f32_e64 v149, -v248, v233
mm a,120,v,100,v,216,120
buffer_load_dwordx4 v252, s[4:7], s51 offen offset:2048 lds
v_mul_f32_e64 v150, -v248, v234
v_mul_f32_e64 v151, -v248, v235
v_fma_f32 v4, v4, v232, v148
v_fma_f32 v5, v5, v233, v149
mm a,120,v,108,v,220,120
s_add_u32 s51, s34, 27648
v_fma_f32 v6, v6, v234, v150
v_fma_f32 v7, v7, v235, v151
v_fma_f32 v12, v12, v232, v148
mm a,124,v,116,v,216,124
buffer_load_dwordx4 v252, s[4:7], s51 offen offset:3072 lds
v_fma_f32 v13, v13, v233, v149
v_fma_f32 v14, v14, v234, v150
v_fma_f32 v15, v15, v235, v151
v_cvt_pk_bf16_f32 v4, v4, v5
mm a,124,v,124,v,220,124
s_add_u32 m0, s44, 4096
s_add_u32 s51, s34, 40960
v_cvt_pk_bf16_f32 v5, v6, v7
v_cvt_pk_bf16_f32 v6, v12, v13
v_cvt_pk_bf16_f32 v7, v14, v15
mm a,128,v,68,v,192,128
tr 216,241,256
mm a,128,v,76,v,196,128
tr 218,241,6400
mz v,20,v,4,v,132
mz v,28,v,4,v,140
mm a,132,v,84,v,192,132
tr 220,241,12544
ds_read_b128 v[232:235], v246 offset:128
v_accvgpr_read_b32 v4, a8
v_accvgpr_read_b32 v5, a9
v_accvgpr_read_b32 v6, a10
v_accvgpr_read_b32 v7, a11
v_accvgpr_read_b32 v12, a24
v_accvgpr_read_b32 v13, a25
v_accvgpr_read_b32 v14, a26
v_accvgpr_read_b32 v15, a27
v_cvt_pk_bf16_f32 v20, v20, v21
mm a,132,v,92,v,196,132
tr 222,241,18688
v_cvt_pk_bf16_f32 v21, v22, v23
v_cvt_pk_bf16_f32 v22, v28, v29
v_cvt_pk_bf16_f32 v23, v30, v31
mm a,136,v,100,v,192,136
s_sub_u32 s42, s29, s48
s_mov_b32 s48, s29
s_add_u32 s50, s46, 6144
buffer_store_dwordx4 v[20:23], v253, s[20:23], s50 offen sc1
s_waitcnt lgkmcnt(1)
v_add_u32 v242, s42, v242
v_mul_f32_e64 v148, -v248, v232
mm a,136,v,108,v,196,136
buffer_load_dwordx4 v252, s[4:7], s51 offen lds
v_mul_f32_e64 v149, -v248, v233
v_mul_f32_e64 v150, -v248, v234
v_mul_f32_e64 v151, -v248, v235
mm a,140,v,116,v,192,140
s_add_u32 s51, s34, 50176
v_add_u32 v243, s42, v243
v_fma_f32 v4, v4, v232, v148
v_fma_f32 v5, v5, v233, v149
v_fma_f32 v6, v6, v234, v150
v_fma_f32 v7, v7, v235, v151
mm a,140,v,124,v,196,140
v_fma_f32 v12, v12, v232, v148
v_fma_f32 v13, v13, v233, v149
v_fma_f32 v14, v14, v234, v150
mm a,144,v,68,v,200,144
v_fma_f32 v15, v15, v235, v151
v_cvt_pk_bf16_f32 v4, v4, v5
v_cvt_pk_bf16_f32 v5, v6, v7
v_cvt_pk_bf16_f32 v6, v12, v13
mm a,144,v,76,v,204,144
v_cvt_pk_bf16_f32 v7, v14, v15
mm a,148,v,84,v,200,148
mm a,148,v,92,v,204,148
mz v,20,v,4,v,132
mz v,28,v,4,v,140
mm a,152,v,100,v,200,152
buffer_load_dwordx4 v252, s[4:7], s51 offen offset:1024 lds
ds_read_b128 v[232:235], v246 offset:192
v_accvgpr_read_b32 v4, a12
v_accvgpr_read_b32 v5, a13
v_accvgpr_read_b32 v6, a14
v_accvgpr_read_b32 v7, a15
v_accvgpr_read_b32 v12, a28
v_accvgpr_read_b32 v13, a29
v_accvgpr_read_b32 v14, a30
v_accvgpr_read_b32 v15, a31
v_cvt_pk_bf16_f32 v20, v20, v21
v_cvt_pk_bf16_f32 v21, v22, v23
v_cvt_pk_bf16_f32 v22, v28, v29
mm a,152,v,108,v,204,152
s_add_u32 s51, s34, 59392
v_cvt_pk_bf16_f32 v23, v30, v31
mm a,156,v,116,v,200,156
s_add_u32 s50, s46, 12288
buffer_store_dwordx4 v[20:23], v253, s[20:23], s50 offen sc1
s_waitcnt lgkmcnt(0)
v_mul_f32_e64 v148, -v248, v232
v_mul_f32_e64 v149, -v248, v233
v_mul_f32_e64 v150, -v248, v234
mm a,156,v,124,v,204,156
s_waitcnt vmcnt(20) lgkmcnt(0)
s_barrier
v_mul_f32_e64 v151, -v248, v235
v_fma_f32 v4, v4, v232, v148
v_fma_f32 v5, v5, v233, v149
mm a,160,v,68,v,208,160
ds_read_b128 v[228:231], v254
s_mov_b32 s43, s28
v_fma_f32 v6, v6, v234, v150
v_fma_f32 v7, v7, v235, v151
v_fma_f32 v12, v12, v232, v148
v_fma_f32 v13, v13, v233, v149
mm a,160,v,76,v,212,160
s_mov_b32 s28, s29
s_mov_b32 s29, s30
s_mov_b32 s30, s43
tr 192,242,0
v_fma_f32 v14, v14, v234, v150
v_fma_f32 v15, v15, v235, v151
v_cvt_pk_bf16_f32 v4, v4, v5
mm a,164,v,84,v,208,164
buffer_load_dwordx4 v252, s[4:7], s51 offen offset:2048 lds
v_cvt_pk_bf16_f32 v5, v6, v7
v_cvt_pk_bf16_f32 v6, v12, v13
v_cvt_pk_bf16_f32 v7, v14, v15
mm a,164,v,92,v,212,164
s_add_u32 s51, s34, 68608
tr 194,242,3072
mz v,20,v,4,v,132
mz v,28,v,4,v,140
mm a,168,v,100,v,208,168
tr 196,242,6144
mm a,168,v,108,v,212,168
tr 198,242,9216
mm a,172,v,116,v,208,172
mm a,172,v,124,v,212,172
mm a,176,v,68,v,216,176
buffer_load_dwordx4 v252, s[4:7], s51 offen offset:3072 lds
tr 200,242,8
mm a,176,v,76,v,220,176
s_add_u32 s34, s34, 128
s_cmp_eq_u32 s34, s95
s_cselect_b32 s55, 1280, 0
v_accvgpr_write_b32 a24, v140
mm a,180,v,84,v,216,180
s_sub_u32 s34, s34, s55
tr 202,242,3080
v_accvgpr_write_b32 a25, v141
s_waitcnt lgkmcnt(6)
v_or3_b32 v228, v228, v229, v230
v_or_b32 v228, v228, v231
mm a,180,v,92,v,220,180
tr 204,242,6152
v_cvt_pk_bf16_f32 v20, v20, v21
v_cvt_pk_bf16_f32 v21, v22, v23
v_readfirstlane_b32 s52, v228
mm a,184,v,100,v,216,184
tr 206,242,9224
v_accvgpr_write_b32 a26, v142
mm a,184,v,108,v,220,184
v_cvt_pk_bf16_f32 v22, v28, v29
v_cvt_pk_bf16_f32 v23, v30, v31
v_accvgpr_write_b32 a27, v143
mm a,188,v,116,v,216,188
s_add_u32 s50, s46, 18432
buffer_store_dwordx4 v[20:23], v253, s[20:23], s50 offen sc1
mm a,188,v,124,v,220,188
v_accvgpr_write_b32 a28, 0
v_accvgpr_write_b32 a29, 0
s_and_b32 s53, s52, 1
s_andn2_b32 s53, s53, s87
s_cbranch_scc1 L_slow_4
s_mov_b32 s87, 0
s_waitcnt lgkmcnt(4)
v_max3_f32 v224, |v36|, |v37|, |v38|
v_max3_f32 v224, v224, |v39|, |v44|
v_max3_f32 v224, v224, |v45|, |v46|
v_max3_f32 v224, v224, |v47|, |v47|
v_max3_f32 v247, |v192|, |v193|, |v194|
v_max3_f32 v247, v247, |v195|, |v196|
v_max3_f32 v247, v247, |v197|, |v198|
v_max3_f32 v247, v247, |v199|, |v199|
v_mul_f32 v247, v247, v224
v_and_b32 v247, 0x7f800000, v247
v_mul_f32 v247, 0x43c00000, v247
v_min_f32 v247, 0x71800000, v247
s_nop 0
v_readlane_b32 s57, v247, 0
v_readlane_b32 s58, v247, 21
v_readlane_b32 s59, v247, 42
s_nop 3
s_min_u32 s57, s57, s58
s_min_u32 s57, s57, s59
v_mov_b32 v247, s57
v_mov_b32 v188, v247
v_mov_b32 v189, v247
v_mov_b32 v190, v247
v_mov_b32 v191, v247
s_nop 1
v_accvgpr_write_b32 a0, v236
v_accvgpr_write_b32 a1, v237
v_accvgpr_write_b32 a2, v238
v_accvgpr_write_b32 a3, v239
mm v,0,v,192,a,192,188
L_pg41:
s_cbranch_execz L_ir39
tr 208,243,0
s_add_u32 m0, s30, s40
mm v,0,v,196,a,196,0
tr 210,243,3072
mm v,48,v,192,a,200,188
tr 212,243,6144
v_accvgpr_read_b32 v216, a44
v_accvgpr_read_b32 v217, a45
mm v,48,v,196,a,204,48
tr 214,243,9216
mm v,96,v,192,a,208,188
buffer_load_dwordx4 v249, s[8:11], s33 offen lds
mm v,96,v,196,a,212,96
v_accvgpr_read_b32 v218, a46
v_accvgpr_read_b32 v219, a47
mm v,144,v,192,a,216,188
v_accvgpr_read_b32 v220, a60
v_accvgpr_read_b32 v221, a61
mm v,144,v,196,a,220,144
s_waitcnt lgkmcnt(4)
v_accvgpr_read_b32 v222, a62
v_accvgpr_read_b32 v223, a63
mm v,4,v,200,a,192,188
tr 192,243,8
v_mul_f32_e64 v236, -v248, v232
mm v,4,v,204,a,196,4
tr 194,243,3080
v_mul_f32_e64 v237, -v248, v233
mm v,52,v,200,a,200,188
tr 196,243,6152
v_mul_f32_e64 v238, -v248, v234
mm v,52,v,204,a,204,52
tr 198,243,9224
mm v,100,v,200,a,208,188
buffer_load_dwordx4 v250, s[8:11], s33 offen offset:1024 lds
mm v,100,v,204,a,212,100
v_mul_f32_e64 v239, -v248, v235
v_fma_f32 v216, v216, v232, v236
mm v,148,v,200,a,216,188
v_fma_f32 v217, v217, v233, v237
v_fma_f32 v218, v218, v234, v238
mm v,148,v,204,a,220,148
s_waitcnt lgkmcnt(4)
v_fma_f32 v219, v219, v235, v239
v_fma_f32 v220, v220, v232, v236
mm v,8,v,208,a,192,188
tr 200,242,128
v_fma_f32 v221, v221, v233, v237
mm v,8,v,212,a,196,8
tr 202,242,3200
v_fma_f32 v222, v222, v234, v238
mm v,56,v,208,a,200,188
tr 204,242,6272
buffer_load_dwordx4 v251, s[8:11], s33 offen offset:2048 lds
mm v,56,v,212,a,204,56
tr 206,242,9344
mm v,104,v,208,a,208,188
s_add_u32 s33, s33, 786432
s_cmp_eq_u32 s33, s94
s_cselect_b32 s55, 7864320, 0
mm v,104,v,212,a,212,104
s_sub_u32 s33, s33, s55
v_fma_f32 v223, v223, v235, v239
v_cvt_pk_bf16_f32 v216, v216, v217
mm v,152,v,208,a,216,188
v_cvt_pk_bf16_f32 v217, v218, v219
v_cvt_pk_bf16_f32 v218, v220, v221
mm v,152,v,212,a,220,152
s_waitcnt lgkmcnt(6)
v_cvt_pk_bf16_f32 v219, v222, v223
mm v,12,v,192,a,192,188
tr 208,242,136
s_waitcnt lgkmcnt(5)
mm v,12,v,196,a,196,12
tr 210,242,3208
mz v,224,v,216,a,26
mz v,228,v,216,a,24
mm v,60,v,192,a,200,188
tr 212,242,6280
v_accvgpr_read_b32 v216, a76
mm v,60,v,196,a,204,60
tr 214,242,9352
mm v,108,v,192,a,208,188
v_accvgpr_read_b32 v217, a77
v_accvgpr_read_b32 v218, a78
mm v,108,v,196,a,212,108
v_accvgpr_read_b32 v219, a79
v_accvgpr_read_b32 v220, a92
mm v,156,v,192,a,216,188
v_accvgpr_read_b32 v221, a93
v_accvgpr_read_b32 v222, a94
mm v,156,v,196,a,220,156
s_waitcnt lgkmcnt(4)
v_accvgpr_read_b32 v223, a95
v_cvt_pk_bf16_f32 v224, v224, v225
mm v,16,v,200,a,192,188
tr 192,243,128
s_waitcnt vmcnt(18)
mm v,16,v,204,a,196,16
tr 194,243,3200
v_cvt_pk_bf16_f32 v225, v226, v227
mm v,64,v,200,a,200,188
tr 196,243,6272
v_cvt_pk_bf16_f32 v226, v228, v229
mm v,64,v,204,a,204,64
tr 198,243,9344
s_waitcnt lgkmcnt(4)
mm v,112,v,200,a,208,188
ds_read_b128 a[224:227], v244 offset:24832
v_cvt_pk_bf16_f32 v227, v230, v231
mm v,112,v,204,a,212,112
ds_read_b128 a[228:231], v245 offset:24832
s_add_u32 s50, s46, 18432
mm v,160,v,200,a,216,188
ds_read_b128 a[232:235], v244 offset:26880
buffer_store_dwordx4 v[224:227], v253, s[20:23], s50 offen offset:1024 sc1
mm v,160,v,204,a,220,160
ds_read_b128 a[236:239], v245 offset:26880
v_fma_f32 v216, v216, v232, v236
mm v,20,v,208,a,192,188
tr 200,243,136
v_fma_f32 v217, v217, v233, v237
mm v,20,v,212,a,196,20
tr 202,243,3208
v_fma_f32 v218, v218, v234, v238
mm v,68,v,208,a,200,188
tr 204,243,6280
v_fma_f32 v219, v219, v235, v239
mm v,68,v,212,a,204,68
tr 206,243,9352
s_waitcnt lgkmcnt(8)
mm v,116,v,208,a,208,188
ds_read_b128 a[240:243], v244 offset:28928
v_fma_f32 v220, v220, v232, v236
mm v,116,v,212,a,212,116
ds_read_b128 a[244:247], v245 offset:28928
v_fma_f32 v221, v221, v233, v237
mm v,164,v,208,a,216,188
ds_read_b128 a[248:251], v244 offset:30976
v_fma_f32 v222, v222, v234, v238
mm v,164,v,212,a,220,164
ds_read_b128 a[252:255], v245 offset:30976
v_fma_f32 v223, v223, v235, v239
mm v,24,v,192,a,192,188
tr 208,242,256
v_cvt_pk_bf16_f32 v216, v216, v217
mm v,24,v,196,a,196,24
tr 210,242,3328
v_cvt_pk_bf16_f32 v217, v218, v219
mm v,72,v,192,a,200,188
tr 212,242,6400
v_cvt_pk_bf16_f32 v218, v220, v221
mm v,72,v,196,a,204,72
tr 214,242,9472
mm v,120,v,192,a,208,188
s_waitcnt lgkmcnt(4)
v_cvt_pk_bf16_f32 v219, v222, v223
mm v,120,v,196,a,212,120
s_add_u32 m0, s45, 0
s_add_u32 s51, s34, 0
mz v,224,v,216,a,26
mz v,228,v,216,a,24
mm v,168,v,192,a,216,188
buffer_load_dwordx4 v252, s[4:7], s51 offen lds
mm v,168,v,196,a,220,168
s_add_u32 s51, s34, 9216
v_accvgpr_read_b32 v216, a108
v_accvgpr_read_b32 v217, a109
mm v,28,v,200,a,192,188
tr 192,242,264
v_accvgpr_read_b32 v218, a110
mm v,28,v,204,a,196,28
tr 194,242,3336
v_accvgpr_read_b32 v219, a111
mm v,76,v,200,a,200,188
tr 196,242,6408
v_accvgpr_read_b32 v220, a124
mm v,76,v,204,a,204,76
tr 198,242,9480
mm v,124,v,200,a,208,188
buffer_load_dwordx4 v252, s[4:7], s51 offen offset:1024 lds
mm v,124,v,204,a,212,124
s_add_u32 s51, s34, 18432
v_accvgpr_read_b32 v221, a125
v_accvgpr_read_b32 v222, a126
mm v,172,v,200,a,216,188
s_waitcnt lgkmcnt(4)
v_accvgpr_read_b32 v223, a127
v_cvt_pk_bf16_f32 v224, v224, v225
mm v,172,v,204,a,220,172
buffer_load_dwordx4 v252, s[4:7], s51 offen offset:2048 lds
mm v,32,v,208,a,192,188
tr 200,243,256
s_add_u32 s51, s34, 27648
mm v,32,v,212,a,196,32
tr 202,243,3328
v_cvt_pk_bf16_f32 v225, v226, v227
mm v,80,v,208,a,200,188
tr 204,243,6400
v_cvt_pk_bf16_f32 v226, v228, v229
mm v,80,v,212,a,204,80
tr 206,243,9472
mm v,128,v,208,a,208,188
s_waitcnt lgkmcnt(4)
v_cvt_pk_bf16_f32 v227, v230, v231
mm v,128,v,212,a,212,128
buffer_load_dwordx4 v252, s[4:7], s51 offen offset:3072 lds
mm v,176,v,208,a,216,188
s_add_u32 m0, s45, 4096
s_add_u32 s51, s34, 40960
s_add_u32 s50, s46, 18432
mm v,176,v,212,a,220,176
buffer_store_dwordx4 v[224:227], v253, s[20:23], s50 offen offset:2048 sc1
mm v,36,v,192,a,192,188
tr 208,243,264
v_fma_f32 v216, v216, v232, v236
mm v,36,v,196,a,196,36
tr 210,243,3336
v_fma_f32 v217, v217, v233, v237
mm v,84,v,192,a,200,188
tr 212,243,6408
v_fma_f32 v218, v218, v234, v238
mm v,84,v,196,a,204,84
tr 214,243,9480
s_waitcnt lgkmcnt(6)
mm v,132,v,192,a,208,188
s_sub_u32 s42, s29, s48
s_mov_b32 s48, s29
v_add_u32 v242, s42, v242
mm v,132,v,196,a,212,132
buffer_load_dwordx4 v252, s[4:7], s51 offen lds
v_add_u32 v243, s42, v243
mm v,180,v,192,a,216,188
s_add_u32 s51, s34, 50176
v_fma_f32 v219, v219, v235, v239
v_fma_f32 v220, v220, v232, v236
v_fma_f32 v221, v221, v233, v237
mm v,180,v,196,a,220,180
buffer_load_dwordx4 v252, s[4:7], s51 offen offset:1024 lds
mm v,40,v,200,a,192,188
s_waitcnt vmcnt(23) lgkmcnt(0)
s_barrier
s_add_u32 s51, s34, 59392
mm v,40,v,204,a,196,40
tr 192,242,0
s_mov_b32 s43, s28
mm v,88,v,200,a,200,188
tr 194,242,3072
s_mov_b32 s28, s29
mm v,88,v,204,a,204,88
tr 196,242,6144
s_mov_b32 s29, s30
mm v,136,v,200,a,208,188
tr 198,242,9216
mm v,136,v,204,a,212,136
s_mov_b32 s30, s43
buffer_load_dwordx4 v252, s[4:7], s51 offen offset:2048 lds
mm v,184,v,200,a,216,188
s_add_u32 s51, s34, 68608
v_fma_f32 v222, v222, v234, v238
v_fma_f32 v223, v223, v235, v239
mm v,184,v,204,a,220,184
v_cvt_pk_bf16_f32 v216, v216, v217
v_cvt_pk_bf16_f32 v217, v218, v219
mm v,44,v,208,a,192,188
tr 200,242,8
v_cvt_pk_bf16_f32 v218, v220, v221
v_cvt_pk_bf16_f32 v219, v222, v223
mm v,44,v,212,a,196,44
tr 202,242,3080
buffer_load_dwordx4 v252, s[4:7], s51 offen offset:3072 lds
mz v,224,v,216,a,26
mz v,228,v,216,a,24
mm v,92,v,208,a,200,188
tr 204,242,6152
s_add_u32 s34, s34, 128
mm v,92,v,212,a,204,92
tr 206,242,9224
mm v,140,v,208,a,208,188
s_cmp_eq_u32 s34, s95
s_cselect_b32 s55, 1280, 0
s_sub_u32 s34, s34, s55
mm v,140,v,212,a,212,140
v_accvgpr_read_b32 v216, a140
v_accvgpr_read_b32 v217, a141
mm v,188,v,208,a,216,188
v_accvgpr_read_b32 v218, a142
v_accvgpr_read_b32 v219, a143
mm v,188,v,212,a,220,188
s_waitcnt lgkmcnt(4)
v_accvgpr_read_b32 v220, a156
v_accvgpr_read_b32 v221, a157
mm v,0,v,192,a,224,0
tr 208,243,0
s_add_u32 m0, s30, s40
mm v,0,v,196,a,228,0
tr 210,243,3072
v_accvgpr_read_b32 v222, a158
mm v,48,v,192,a,232,48
tr 212,243,6144
v_accvgpr_read_b32 v223, a159
mm v,48,v,196,a,236,48
tr 214,243,9216
mm v,96,v,192,a,240,96
buffer_load_dwordx4 v249, s[8:11], s33 offen lds
mm v,96,v,196,a,244,96
v_cvt_pk_bf16_f32 v224, v224, v225
v_cvt_pk_bf16_f32 v225, v226, v227
mm v,144,v,192,a,248,144
v_cvt_pk_bf16_f32 v226, v228, v229
v_cvt_pk_bf16_f32 v227, v230, v231
mm v,144,v,196,a,252,144
s_add_u32 s50, s46, 18432
s_waitcnt lgkmcnt(6)
mm v,4,v,200,a,224,4
tr 192,243,8
s_waitcnt lgkmcnt(5)
mm v,4,v,204,a,228,4
tr 194,243,3080
mm v,52,v,200,a,232,52
tr 196,243,6152
mm v,52,v,204,a,236,52
tr 198,243,9224
mm v,100,v,200,a,240,100
buffer_load_dwordx4 v250, s[8:11], s33 offen offset:1024 lds
mm v,100,v,204,a,244,100
buffer_store_dwordx4 v[224:227], v253, s[20:23], s50 offen offset:3072 sc1
mm v,148,v,200,a,248,148
v_fma_f32 v216, v216, v232, v236
v_fma_f32 v217, v217, v233, v237
mm v,148,v,204,a,252,148
s_waitcnt lgkmcnt(4)
v_fma_f32 v218, v218, v234, v238
v_fma_f32 v219, v219, v235, v239
mm v,8,v,208,a,224,8
tr 200,242,128
v_fma_f32 v220, v220, v232, v236
mm v,8,v,212,a,228,8
tr 202,242,3200
v_fma_f32 v221, v221, v233, v237
mm v,56,v,208,a,232,56
tr 204,242,6272
buffer_load_dwordx4 v251, s[8:11], s33 offen offset:2048 lds
mm v,56,v,212,a,236,56
tr 206,242,9344
mm v,104,v,208,a,240,104
s_add_u32 s33, s33, 786432
s_cmp_eq_u32 s33, s94
s_cselect_b32 s55, 7864320, 0
mm v,104,v,212,a,244,104
s_sub_u32 s33, s33, s55
v_fma_f32 v222, v222, v234, v238
v_fma_f32 v223, v223, v235, v239
mm v,152,v,208,a,248,152
v_cvt_pk_bf16_f32 v216, v216, v217
v_cvt_pk_bf16_f32 v217, v218, v219
mm v,152,v,212,a,252,152
s_waitcnt lgkmcnt(6)
v_cvt_pk_bf16_f32 v218, v220, v221
v_cvt_pk_bf16_f32 v219, v222, v223
mm v,12,v,192,a,224,12
tr 208,242,136
s_waitcnt lgkmcnt(5)
mm v,12,v,196,a,228,12
tr 210,242,3208
mz v,224,v,216,a,26
mz v,228,v,216,a,24
mm v,60,v,192,a,232,60
tr 212,242,6280
v_accvgpr_read_b32 v216, a172
mm v,60,v,196,a,236,60
tr 214,242,9352
mm v,108,v,192,a,240,108
v_accvgpr_read_b32 v217, a173
v_accvgpr_read_b32 v218, a174
mm v,108,v,196,a,244,108
v_accvgpr_read_b32 v219, a175
v_accvgpr_read_b32 v220, a188
mm v,156,v,192,a,248,156
v_accvgpr_read_b32 v221, a189
v_accvgpr_read_b32 v222, a190
mm v,156,v,196,a,252,156
s_waitcnt lgkmcnt(4)
v_accvgpr_read_b32 v223, a191
v_cvt_pk_bf16_f32 v224, v224, v225
mm v,16,v,200,a,224,16
tr 192,243,128
s_waitcnt vmcnt(18)
mm v,16,v,204,a,228,16
tr 194,243,3200
v_cvt_pk_bf16_f32 v225, v226, v227
mm v,64,v,200,a,232,64
tr 196,243,6272
v_cvt_pk_bf16_f32 v226, v228, v229
mm v,64,v,204,a,236,64
tr 198,243,9344
s_waitcnt lgkmcnt(4)
mm v,112,v,200,a,240,112
ds_read_b128 a[192:195], v244
v_cvt_pk_bf16_f32 v227, v230, v231
mm v,112,v,204,a,244,112
ds_read_b128 a[196:199], v245
s_add_u32 s50, s46, 22528
mm v,160,v,200,a,248,160
ds_read_b128 a[200:203], v244 offset:2048
buffer_store_dwordx4 v[224:227], v253, s[20:23], s50 offen sc1
mm v,160,v,204,a,252,160
ds_read_b128 a[204:207], v245 offset:2048
v_fma_f32 v216, v216, v232, v236
mm v,20,v,208,a,224,20
tr 200,243,136
v_fma_f32 v217, v217, v233, v237
mm v,20,v,212,a,228,20
tr 202,243,3208
v_fma_f32 v218, v218, v234, v238
mm v,68,v,208,a,232,68
tr 204,243,6280
v_fma_f32 v219, v219, v235, v239
mm v,68,v,212,a,236,68
tr 206,243,9352
s_waitcnt lgkmcnt(8)
mm v,116,v,208,a,240,116
ds_read_b128 a[208:211], v244 offset:4096
v_fma_f32 v220, v220, v232, v236
mm v,116,v,212,a,244,116
ds_read_b128 a[212:215], v245 offset:4096
v_fma_f32 v221, v221, v233, v237
mm v,164,v,208,a,248,164
ds_read_b128 a[216:219], v244 offset:6144
v_fma_f32 v222, v222, v234, v238
mm v,164,v,212,a,252,164
ds_read_b128 a[220:223], v245 offset:6144
v_fma_f32 v223, v223, v235, v239
mm v,24,v,192,a,224,24
tr 208,242,256
v_cvt_pk_bf16_f32 v216, v216, v217
mm v,24,v,196,a,228,24
tr 210,242,3328
v_cvt_pk_bf16_f32 v217, v218, v219
mm v,72,v,192,a,232,72
tr 212,242,6400
v_cvt_pk_bf16_f32 v218, v220, v221
mm v,72,v,196,a,236,72
tr 214,242,9472
mm v,120,v,192,a,240,120
s_waitcnt lgkmcnt(4)
v_cvt_pk_bf16_f32 v219, v222, v223
mm v,120,v,196,a,244,120
s_add_u32 m0, s44, 0
s_add_u32 s51, s34, 0
mz v,224,v,216,a,26
mz v,228,v,216,a,24
mm v,168,v,192,a,248,168
buffer_load_dwordx4 v252, s[4:7], s51 offen lds
mm v,168,v,196,a,252,168
s_add_u32 s51, s34, 9216
ds_read_b128 v[232:235], v246 offset:128
mm v,28,v,200,a,224,28
tr 192,242,264
v_accvgpr_read_b32 v216, a40
mm v,28,v,204,a,228,28
tr 194,242,3336
v_accvgpr_read_b32 v217, a41
mm v,76,v,200,a,232,76
tr 196,242,6408
v_accvgpr_read_b32 v218, a42
mm v,76,v,204,a,236,76
tr 198,242,9480
mm v,124,v,200,a,240,124
buffer_load_dwordx4 v252, s[4:7], s51 offen offset:1024 lds
mm v,124,v,204,a,244,124
s_add_u32 s51, s34, 18432
v_accvgpr_read_b32 v219, a43
v_accvgpr_read_b32 v220, a56
mm v,172,v,200,a,248,172
s_waitcnt lgkmcnt(5)
v_accvgpr_read_b32 v221, a57
v_accvgpr_read_b32 v222, a58
mm v,172,v,204,a,252,172
buffer_load_dwordx4 v252, s[4:7], s51 offen offset:2048 lds
mm v,32,v,208,a,224,32
tr 200,243,256
s_add_u32 s51, s34, 27648
mm v,32,v,212,a,228,32
tr 202,243,3328
v_accvgpr_read_b32 v223, a59
mm v,80,v,208,a,232,80
tr 204,243,6400
v_cvt_pk_bf16_f32 v224, v224, v225
mm v,80,v,212,a,236,80
tr 206,243,9472
mm v,128,v,208,a,240,128
s_waitcnt lgkmcnt(6)
v_cvt_pk_bf16_f32 v225, v226, v227
v_cvt_pk_bf16_f32 v226, v228, v229
mm v,128,v,212,a,244,128
buffer_load_dwordx4 v252, s[4:7], s51 offen offset:3072 lds
mm v,176,v,208,a,248,176
s_add_u32 m0, s44, 4096
s_add_u32 s51, s34, 40960
v_cvt_pk_bf16_f32 v227, v230, v231
mm v,176,v,212,a,252,176
s_add_u32 s50, s46, 22528
buffer_store_dwordx4 v[224:227], v253, s[20:23], s50 offen offset:1024 sc1
mm v,36,v,192,a,224,36
tr 208,243,264
s_waitcnt lgkmcnt(5)
mm v,36,v,196,a,228,36
tr 210,243,3336
v_mul_f32_e64 v236, -v248, v232
mm v,84,v,192,a,232,84
tr 212,243,6408
v_mul_f32_e64 v237, -v248, v233
mm v,84,v,196,a,236,84
tr 214,243,9480
s_waitcnt lgkmcnt(6)
mm v,132,v,192,a,240,132
s_sub_u32 s42, s29, s48
s_mov_b32 s48, s29
v_add_u32 v242, s42, v242
mm v,132,v,196,a,244,132
buffer_load_dwordx4 v252, s[4:7], s51 offen lds
v_add_u32 v243, s42, v243
mm v,180,v,192,a,248,180
s_add_u32 s51, s34, 50176
v_mul_f32_e64 v238, -v248, v234
v_mul_f32_e64 v239, -v248, v235
v_fma_f32 v216, v216, v232, v236
mm v,180,v,196,a,252,180
buffer_load_dwordx4 v252, s[4:7], s51 offen offset:1024 lds
v_fma_f32 v217, v217, v233, v237
mm v,40,v,200,a,224,40
s_waitcnt vmcnt(22) lgkmcnt(0)
s_barrier
s_add_u32 s51, s34, 59392
mm v,40,v,204,a,228,40
L_pg46:
s_cbranch_execz L_ir44
tr 192,242,0
s_mov_b32 s43, s28
mm v,88,v,200,a,232,88
tr 194,242,3072
s_mov_b32 s28, s29
mm v,88,v,204,a,236,88
tr 196,242,6144
s_mov_b32 s29, s30
mm v,136,v,200,a,240,136
tr 198,242,9216
mm v,136,v,204,a,244,136
s_mov_b32 s30, s43
buffer_load_dwordx4 v252, s[4:7], s51 offen offset:2048 lds
mm v,184,v,200,a,248,184
s_add_u32 s51, s34, 68608
v_fma_f32 v218, v218, v234, v238
v_fma_f32 v219, v219, v235, v239
mm v,184,v,204,a,252,184
v_fma_f32 v220, v220, v232, v236
v_fma_f32 v221, v221, v233, v237
mm v,44,v,208,a,224,44
tr 200,242,8
v_fma_f32 v222, v222, v234, v238
v_fma_f32 v223, v223, v235, v239
mm v,44,v,212,a,228,44
tr 202,242,3080
buffer_load_dwordx4 v252, s[4:7], s51 offen offset:3072 lds
mm v,92,v,208,a,232,92
tr 204,242,6152
s_add_u32 s34, s34, 128
mm v,92,v,212,a,236,92
tr 206,242,9224
mm v,140,v,208,a,240,140
s_cmp_eq_u32 s34, s95
s_cselect_b32 s55, 1280, 0
s_sub_u32 s34, s34, s55
mm v,140,v,212,a,244,140
v_cvt_pk_bf16_f32 v216, v216, v217
v_cvt_pk_bf16_f32 v217, v218, v219
mm v,188,v,208,a,248,188
v_cvt_pk_bf16_f32 v218, v220, v221
v_cvt_pk_bf16_f32 v219, v222, v223
mm v,188,v,212,a,252,188
s_waitcnt lgkmcnt(4)
mm v,0,v,192,a,192,0
tr 208,243,0
s_add_u32 m0, s30, s40
mm v,0,v,196,a,196,0
tr 210,243,3072
mz v,224,v,216,a,26
mz v,228,v,216,a,24
mm v,48,v,192,a,200,48
tr 212,243,6144
v_accvgpr_read_b32 v216, a72
v_accvgpr_read_b32 v217, a73
mm v,48,v,196,a,204,48
tr 214,243,9216
mm v,96,v,192,a,208,96
buffer_load_dwordx4 v249, s[8:11], s33 offen lds
mm v,96,v,196,a,212,96
v_accvgpr_read_b32 v218, a74
v_accvgpr_read_b32 v219, a75
mm v,144,v,192,a,216,144
v_accvgpr_read_b32 v220, a88
v_accvgpr_read_b32 v221, a89
mm v,144,v,196,a,220,144
s_waitcnt lgkmcnt(4)
v_accvgpr_read_b32 v222, a90
v_accvgpr_read_b32 v223, a91
mm v,4,v,200,a,192,4
tr 192,243,8
v_cvt_pk_bf16_f32 v224, v224, v225
mm v,4,v,204,a,196,4
tr 194,243,3080
v_cvt_pk_bf16_f32 v225, v226, v227
mm v,52,v,200,a,200,52
tr 196,243,6152
v_cvt_pk_bf16_f32 v226, v228, v229
mm v,52,v,204,a,204,52
tr 198,243,9224
mm v,100,v,200,a,208,100
buffer_load_dwordx4 v250, s[8:11], s33 offen offset:1024 lds
mm v,100,v,204,a,212,100
v_cvt_pk_bf16_f32 v227, v230, v231
mm v,148,v,200,a,216,148
s_add_u32 s50, s46, 12288
s_waitcnt lgkmcnt(4)
mm v,148,v,204,a,220,148
buffer_store_dwordx4 v[224:227], v253, s[20:23], s50 offen offset:1024 sc1
mm v,8,v,208,a,192,8
tr 200,242,128
v_fma_f32 v216, v216, v232, v236
mm v,8,v,212,a,196,8
tr 202,242,3200
v_fma_f32 v217, v217, v233, v237
mm v,56,v,208,a,200,56
tr 204,242,6272
buffer_load_dwordx4 v251, s[8:11], s33 offen offset:2048 lds
mm v,56,v,212,a,204,56
tr 206,242,9344
mm v,104,v,208,a,208,104
s_add_u32 s33, s33, 786432
s_cmp_eq_u32 s33, s94
s_cselect_b32 s55, 7864320, 0
mm v,104,v,212,a,212,104
s_sub_u32 s33, s33, s55
v_fma_f32 v218, v218, v234, v238
v_fma_f32 v219, v219, v235, v239
mm v,152,v,208,a,216,152
v_fma_f32 v220, v220, v232, v236
v_fma_f32 v221, v221, v233, v237
mm v,152,v,212,a,220,152
s_waitcnt lgkmcnt(4)
v_fma_f32 v222, v222, v234, v238
v_fma_f32 v223, v223, v235, v239
mm v,12,v,192,a,192,12
tr 208,242,136
v_cvt_pk_bf16_f32 v216, v216, v217
mm v,12,v,196,a,196,12
tr 210,242,3208
v_cvt_pk_bf16_f32 v217, v218, v219
mm v,60,v,192,a,200,60
tr 212,242,6280
v_cvt_pk_bf16_f32 v218, v220, v221
mm v,60,v,196,a,204,60
tr 214,242,9352
mm v,108,v,192,a,208,108
v_cvt_pk_bf16_f32 v219, v222, v223
mm v,108,v,196,a,212,108
mm v,156,v,192,a,216,156
s_waitcnt lgkmcnt(4)
mm v,156,v,196,a,220,156
mz v,224,v,216,a,26
mz v,228,v,216,a,24
mm v,16,v,200,a,192,16
tr 192,243,128
s_waitcnt vmcnt(18)
mm v,16,v,204,a,196,16
tr 194,243,3200
v_accvgpr_read_b32 v216, a104
mm v,64,v,200,a,200,64
tr 196,243,6272
v_accvgpr_read_b32 v217, a105
mm v,64,v,204,a,204,64
tr 198,243,9344
s_waitcnt lgkmcnt(4)
mm v,112,v,200,a,208,112
ds_read_b128 a[224:227], v244 offset:24832
v_accvgpr_read_b32 v218, a106
mm v,112,v,204,a,212,112
ds_read_b128 a[228:231], v245 offset:24832
v_accvgpr_read_b32 v219, a107
mm v,160,v,200,a,216,160
ds_read_b128 a[232:235], v244 offset:26880
v_accvgpr_read_b32 v220, a120
mm v,160,v,204,a,220,160
ds_read_b128 a[236:239], v245 offset:26880
v_accvgpr_read_b32 v221, a121
mm v,20,v,208,a,192,20
tr 200,243,136
v_accvgpr_read_b32 v222, a122
mm v,20,v,212,a,196,20
tr 202,243,3208
v_accvgpr_read_b32 v223, a123
mm v,68,v,208,a,200,68
tr 204,243,6280
v_cvt_pk_bf16_f32 v224, v224, v225
mm v,68,v,212,a,204,68
tr 206,243,9352
s_waitcnt lgkmcnt(8)
mm v,116,v,208,a,208,116
ds_read_b128 a[240:243], v244 offset:28928
v_cvt_pk_bf16_f32 v225, v226, v227
mm v,116,v,212,a,212,116
ds_read_b128 a[244:247], v245 offset:28928
v_cvt_pk_bf16_f32 v226, v228, v229
mm v,164,v,208,a,216,164
ds_read_b128 a[248:251], v244 offset:30976
v_cvt_pk_bf16_f32 v227, v230, v231
mm v,164,v,212,a,220,164
ds_read_b128 a[252:255], v245 offset:30976
s_add_u32 s50, s46, 12288
mm v,24,v,192,a,192,24
tr 208,242,256
buffer_store_dwordx4 v[224:227], v253, s[20:23], s50 offen offset:2048 sc1
mm v,24,v,196,a,196,24
tr 210,242,3328
v_fma_f32 v216, v216, v232, v236
mm v,72,v,192,a,200,72
tr 212,242,6400
v_fma_f32 v217, v217, v233, v237
mm v,72,v,196,a,204,72
tr 214,242,9472
mm v,120,v,192,a,208,120
s_waitcnt lgkmcnt(4)
v_fma_f32 v218, v218, v234, v238
v_fma_f32 v219, v219, v235, v239
mm v,120,v,196,a,212,120
s_add_u32 m0, s45, 0
s_add_u32 s51, s34, 0
v_fma_f32 v220, v220, v232, v236
mm v,168,v,192,a,216,168
buffer_load_dwordx4 v252, s[4:7], s51 offen lds
mm v,168,v,196,a,220,168
s_add_u32 s51, s34, 9216
v_fma_f32 v221, v221, v233, v237
v_fma_f32 v222, v222, v234, v238
mm v,28,v,200,a,192,28
tr 192,242,264
v_fma_f32 v223, v223, v235, v239
mm v,28,v,204,a,196,28
tr 194,242,3336
v_cvt_pk_bf16_f32 v216, v216, v217
mm v,76,v,200,a,200,76
tr 196,242,6408
v_cvt_pk_bf16_f32 v217, v218, v219
mm v,76,v,204,a,204,76
tr 198,242,9480
mm v,124,v,200,a,208,124
buffer_load_dwordx4 v252, s[4:7], s51 offen offset:1024 lds
mm v,124,v,204,a,212,124
s_add_u32 s51, s34, 18432
v_cvt_pk_bf16_f32 v218, v220, v221
v_cvt_pk_bf16_f32 v219, v222, v223
mm v,172,v,200,a,216,172
s_waitcnt lgkmcnt(4)
mm v,172,v,204,a,220,172
buffer_load_dwordx4 v252, s[4:7], s51 offen offset:2048 lds
mz v,224,v,216,a,26
mz v,228,v,216,a,24
mm v,32,v,208,a,192,32
tr 200,243,256
s_add_u32 s51, s34, 27648
mm v,32,v,212,a,196,32
tr 202,243,3328
v_accvgpr_read_b32 v216, a136
mm v,80,v,208,a,200,80
tr 204,243,6400
v_accvgpr_read_b32 v217, a137
v_accvgpr_read_b32 v218, a138
mm v,80,v,212,a,204,80
tr 206,243,9472
mm v,128,v,208,a,208,128
v_accvgpr_read_b32 v219, a139
v_accvgpr_read_b32 v220, a152
mm v,128,v,212,a,212,128
buffer_load_dwordx4 v252, s[4:7], s51 offen offset:3072 lds
mm v,176,v,208,a,216,176
s_add_u32 m0, s45, 4096
s_add_u32 s51, s34, 40960
v_accvgpr_read_b32 v221, a153
mm v,176,v,212,a,220,176
s_waitcnt lgkmcnt(4)
v_accvgpr_read_b32 v222, a154
v_accvgpr_read_b32 v223, a155
mm v,36,v,192,a,192,36
tr 208,243,264
v_cvt_pk_bf16_f32 v224, v224, v225
mm v,36,v,196,a,196,36
tr 210,243,3336
v_cvt_pk_bf16_f32 v225, v226, v227
mm v,84,v,192,a,200,84
tr 212,243,6408
v_cvt_pk_bf16_f32 v226, v228, v229
mm v,84,v,196,a,204,84
tr 214,243,9480
mm v,132,v,192,a,208,132
s_sub_u32 s42, s29, s48
s_mov_b32 s48, s29
v_add_u32 v242, s42, v242
mm v,132,v,196,a,212,132
buffer_load_dwordx4 v252, s[4:7], s51 offen lds
v_add_u32 v243, s42, v243
mm v,180,v,192,a,216,180
s_add_u32 s51, s34, 50176
s_waitcnt lgkmcnt(6)
v_cvt_pk_bf16_f32 v227, v230, v231
mm v,180,v,196,a,220,180
buffer_load_dwordx4 v252, s[4:7], s51 offen offset:1024 lds
s_add_u32 s50, s46, 12288
mm v,40,v,200,a,192,40
s_waitcnt vmcnt(21) lgkmcnt(0)
s_barrier
s_add_u32 s51, s34, 59392
buffer_store_dwordx4 v[224:227], v253, s[20:23], s50 offen offset:3072 sc1
mm v,40,v,204,a,196,40
tr 192,242,0
s_mov_b32 s43, s28
v_fma_f32 v216, v216, v232, v236
mm v,88,v,200,a,200,88
tr 194,242,3072
s_mov_b32 s28, s29
v_fma_f32 v217, v217, v233, v237
mm v,88,v,204,a,204,88
tr 196,242,6144
s_mov_b32 s29, s30
v_fma_f32 v218, v218, v234, v238
mm v,136,v,200,a,208,136
tr 198,242,9216
v_fma_f32 v219, v219, v235, v239
mm v,136,v,204,a,212,136
s_mov_b32 s30, s43
buffer_load_dwordx4 v252, s[4:7], s51 offen offset:2048 lds
mm v,184,v,200,a,216,184
s_add_u32 s51, s34, 68608
v_fma_f32 v220, v220, v232, v236
v_fma_f32 v221, v221, v233, v237
mm v,184,v,204,a,220,184
v_fma_f32 v222, v222, v234, v238
v_fma_f32 v223, v223, v235, v239
mm v,44,v,208,a,192,44
tr 200,242,8
v_cvt_pk_bf16_f32 v216, v216, v217
v_cvt_pk_bf16_f32 v217, v218, v219
mm v,44,v,212,a,196,44
tr 202,242,3080
buffer_load_dwordx4 v252, s[4:7], s51 offen offset:3072 lds
mm v,92,v,208,a,200,92
tr 204,242,6152
s_add_u32 s34, s34, 128
mm v,92,v,212,a,204,92
tr 206,242,9224
mm v,140,v,208,a,208,140
s_cmp_eq_u32 s34, s95
s_cselect_b32 s55, 1280, 0
s_sub_u32 s34, s34, s55
mm v,140,v,212,a,212,140
v_cvt_pk_bf16_f32 v218, v220, v221
v_cvt_pk_bf16_f32 v219, v222, v223
mm v,188,v,208,a,216,188
s_waitcnt lgkmcnt(4)
mm v,188,v,212,a,220,188
mz v,224,v,216,a,26
mz v,228,v,216,a,24
mm v,0,v,192,a,224,0
tr 208,243,0
s_add_u32 m0, s30, s40
v_accvgpr_read_b32 v216, a168
mm v,0,v,196,a,228,0
tr 210,243,3072
v_accvgpr_read_b32 v217, a169
mm v,48,v,192,a,232,48
tr 212,243,6144
v_accvgpr_read_b32 v218, a170
v_accvgpr_read_b32 v219, a171
mm v,48,v,196,a,236,48
tr 214,243,9216
mm v,96,v,192,a,240,96
buffer_load_dwordx4 v249, s[8:11], s33 offen lds
mm v,96,v,196,a,244,96
v_accvgpr_read_b32 v220, a184
v_accvgpr_read_b32 v221, a185
mm v,144,v,192,a,248,144
v_accvgpr_read_b32 v222, a186
v_accvgpr_read_b32 v223, a187
mm v,144,v,196,a,252,144
s_waitcnt lgkmcnt(4)
v_cvt_pk_bf16_f32 v224, v224, v225
v_cvt_pk_bf16_f32 v225, v226, v227
mm v,4,v,200,a,224,4
tr 192,243,8
v_cvt_pk_bf16_f32 v226, v228, v229
mm v,4,v,204,a,228,4
tr 194,243,3080
v_cvt_pk_bf16_f32 v227, v230, v231
mm v,52,v,200,a,232,52
tr 196,243,6152
s_add_u32 s50, s46, 16384
mm v,52,v,204,a,236,52
tr 198,243,9224
mm v,100,v,200,a,240,100
buffer_load_dwordx4 v250, s[8:11], s33 offen offset:1024 lds
mm v,100,v,204,a,244,100
buffer_store_dwordx4 v[224:227], v253, s[20:23], s50 offen sc1
mm v,148,v,200,a,248,148
v_fma_f32 v216, v216, v232, v236
v_fma_f32 v217, v217, v233, v237
mm v,148,v,204,a,252,148
s_waitcnt lgkmcnt(4)
v_fma_f32 v218, v218, v234, v238
v_fma_f32 v219, v219, v235, v239
mm v,8,v,208,a,224,8
tr 200,242,128
v_fma_f32 v220, v220, v232, v236
mm v,8,v,212,a,228,8
tr 202,242,3200
v_fma_f32 v221, v221, v233, v237
mm v,56,v,208,a,232,56
tr 204,242,6272
buffer_load_dwordx4 v251, s[8:11], s33 offen offset:2048 lds
mm v,56,v,212,a,236,56
tr 206,242,9344
mm v,104,v,208,a,240,104
s_add_u32 s33, s33, 786432
s_cmp_eq_u32 s33, s94
s_cselect_b32 s55, 7864320, 0
mm v,104,v,212,a,244,104
s_sub_u32 s33, s33, s55
v_fma_f32 v222, v222, v234, v238
v_fma_f32 v223, v223, v235, v239
mm v,152,v,208,a,248,152
v_cvt_pk_bf16_f32 v216, v216, v217
v_cvt_pk_bf16_f32 v217, v218, v219
mm v,152,v,212,a,252,152
s_waitcnt lgkmcnt(6)
v_cvt_pk_bf16_f32 v218, v220, v221
v_cvt_pk_bf16_f32 v219, v222, v223
mm v,12,v,192,a,224,12
tr 208,242,136
s_waitcnt lgkmcnt(5)
mm v,12,v,196,a,228,12
tr 210,242,3208
mz v,224,v,216,a,26
mz v,228,v,216,a,24
mm v,60,v,192,a,232,60
tr 212,242,6280
mm v,60,v,196,a,236,60
tr 214,242,9352
mm v,108,v,192,a,240,108
ds_read_b128 v[232:235], v246 offset:64
v_accvgpr_read_b32 v216, a36
mm v,108,v,196,a,244,108
v_accvgpr_read_b32 v217, a37
v_accvgpr_read_b32 v218, a38
mm v,156,v,192,a,248,156
v_accvgpr_read_b32 v219, a39
v_accvgpr_read_b32 v220, a52
mm v,156,v,196,a,252,156
s_waitcnt lgkmcnt(5)
v_accvgpr_read_b32 v221, a53
v_accvgpr_read_b32 v222, a54
mm v,16,v,200,a,224,16
tr 192,243,128
s_waitcnt vmcnt(18)
mm v,16,v,204,a,228,16
tr 194,243,3200
v_accvgpr_read_b32 v223, a55
mm v,64,v,200,a,232,64
tr 196,243,6272
v_cvt_pk_bf16_f32 v224, v224, v225
mm v,64,v,204,a,236,64
tr 198,243,9344
s_waitcnt lgkmcnt(5)
mm v,112,v,200,a,240,112
ds_read_b128 a[192:195], v244
v_cvt_pk_bf16_f32 v225, v226, v227
mm v,112,v,204,a,244,112
ds_read_b128 a[196:199], v245
v_cvt_pk_bf16_f32 v226, v228, v229
mm v,160,v,200,a,248,160
ds_read_b128 a[200:203], v244 offset:2048
v_cvt_pk_bf16_f32 v227, v230, v231
mm v,160,v,204,a,252,160
ds_read_b128 a[204:207], v245 offset:2048
s_add_u32 s50, s46, 16384
mm v,20,v,208,a,224,20
tr 200,243,136
buffer_store_dwordx4 v[224:227], v253, s[20:23], s50 offen offset:1024 sc1
mm v,20,v,212,a,228,20
tr 202,243,3208
s_waitcnt lgkmcnt(10)
mm v,68,v,208,a,232,68
tr 204,243,6280
v_mul_f32_e64 v236, -v248, v232
mm v,68,v,212,a,236,68
tr 206,243,9352
s_waitcnt lgkmcnt(8)
mm v,116,v,208,a,240,116
ds_read_b128 a[208:211], v244 offset:4096
v_mul_f32_e64 v237, -v248, v233
mm v,116,v,212,a,244,116
ds_read_b128 a[212:215], v245 offset:4096
v_mul_f32_e64 v238, -v248, v234
mm v,164,v,208,a,248,164
ds_read_b128 a[216:219], v244 offset:6144
v_mul_f32_e64 v239, -v248, v235
mm v,164,v,212,a,252,164
ds_read_b128 a[220:223], v245 offset:6144
v_fma_f32 v216, v216, v232, v236
mm v,24,v,192,a,224,24
tr 208,242,256
v_fma_f32 v217, v217, v233, v237
mm v,24,v,196,a,228,24
tr 210,242,3328
v_fma_f32 v218, v218, v234, v238
mm v,72,v,192,a,232,72
tr 212,242,6400
v_fma_f32 v219, v219, v235, v239
mm v,72,v,196,a,236,72
tr 214,242,9472
mm v,120,v,192,a,240,120
s_waitcnt lgkmcnt(4)
v_fma_f32 v220, v220, v232, v236
v_fma_f32 v221, v221, v233, v237
mm v,120,v,196,a,244,120
s_add_u32 m0, s44, 0
s_add_u32 s51, s34, 0
v_fma_f32 v222, v222, v234, v238
mm v,168,v,192,a,248,168
buffer_load_dwordx4 v252, s[4:7], s51 offen lds
mm v,168,v,196,a,252,168
s_add_u32 s51, s34, 9216
v_fma_f32 v223, v223, v235, v239
v_cvt_pk_bf16_f32 v216, v216, v217
mm v,28,v,200,a,224,28
tr 192,242,264
v_cvt_pk_bf16_f32 v217, v218, v219
mm v,28,v,204,a,228,28
tr 194,242,3336
v_cvt_pk_bf16_f32 v218, v220, v221
mm v,76,v,200,a,232,76
tr 196,242,6408
v_cvt_pk_bf16_f32 v219, v222, v223
mm v,76,v,204,a,236,76
tr 198,242,9480
mz v,224,v,216,a,26
mz v,228,v,216,a,24
mm v,124,v,200,a,240,124
buffer_load_dwordx4 v252, s[4:7], s51 offen offset:1024 lds
mm v,124,v,204,a,244,124
s_add_u32 s51, s34, 18432
v_accvgpr_read_b32 v216, a68
v_accvgpr_read_b32 v217, a69
mm v,172,v,200,a,248,172
s_waitcnt lgkmcnt(4)
v_accvgpr_read_b32 v218, a70
v_accvgpr_read_b32 v219, a71
mm v,172,v,204,a,252,172
buffer_load_dwordx4 v252, s[4:7], s51 offen offset:2048 lds
mm v,32,v,208,a,224,32
tr 200,243,256
s_add_u32 s51, s34, 27648
mm v,32,v,212,a,228,32
tr 202,243,3328
v_accvgpr_read_b32 v220, a84
mm v,80,v,208,a,232,80
L_pg52:
s_cbranch_execz L_ir51
tr 204,243,6400
v_accvgpr_read_b32 v221, a85
mm v,80,v,212,a,236,80
tr 206,243,9472
mm v,128,v,208,a,240,128
v_accvgpr_read_b32 v222, a86
v_accvgpr_read_b32 v223, a87
mm v,128,v,212,a,244,128
buffer_load_dwordx4 v252, s[4:7], s51 offen offset:3072 lds
mm v,176,v,208,a,248,176
s_add_u32 m0, s44, 4096
s_add_u32 s51, s34, 40960
v_cvt_pk_bf16_f32 v224, v224, v225
mm v,176,v,212,a,252,176
s_waitcnt lgkmcnt(4)
v_cvt_pk_bf16_f32 v225, v226, v227
v_cvt_pk_bf16_f32 v226, v228, v229
mm v,36,v,192,a,224,36
tr 208,243,264
v_cvt_pk_bf16_f32 v227, v230, v231
mm v,36,v,196,a,228,36
tr 210,243,3336
s_add_u32 s50, s46, 6144
mm v,84,v,192,a,232,84
tr 212,243,6408
mm v,84,v,196,a,236,84
tr 214,243,9480
s_waitcnt lgkmcnt(6)
mm v,132,v,192,a,240,132
s_sub_u32 s42, s29, s48
s_mov_b32 s48, s29
v_add_u32 v242, s42, v242
mm v,132,v,196,a,244,132
buffer_load_dwordx4 v252, s[4:7], s51 offen lds
v_add_u32 v243, s42, v243
mm v,180,v,192,a,248,180
s_add_u32 s51, s34, 50176
buffer_store_dwordx4 v[224:227], v253, s[20:23], s50 offen offset:1024 sc1
mm v,180,v,196,a,252,180
buffer_load_dwordx4 v252, s[4:7], s51 offen offset:1024 lds
mm v,40,v,200,a,224,40
s_waitcnt vmcnt(22) lgkmcnt(0)
s_barrier
s_add_u32 s51, s34, 59392
mm v,40,v,204,a,228,40
tr 192,242,0
s_mov_b32 s43, s28
mm v,88,v,200,a,232,88
tr 194,242,3072
s_mov_b32 s28, s29
mm v,88,v,204,a,236,88
tr 196,242,6144
s_mov_b32 s29, s30
mm v,136,v,200,a,240,136
tr 198,242,9216
mm v,136,v,204,a,244,136
s_mov_b32 s30, s43
buffer_load_dwordx4 v252, s[4:7], s51 offen offset:2048 lds
mm v,184,v,200,a,248,184
s_add_u32 s51, s34, 68608
v_fma_f32 v216, v216, v232, v236
v_fma_f32 v217, v217, v233, v237
mm v,184,v,204,a,252,184
v_fma_f32 v218, v218, v234, v238
v_fma_f32 v219, v219, v235, v239
mm v,44,v,208,a,224,44
tr 200,242,8
v_fma_f32 v220, v220, v232, v236
v_fma_f32 v221, v221, v233, v237
mm v,44,v,212,a,228,44
tr 202,242,3080
buffer_load_dwordx4 v252, s[4:7], s51 offen offset:3072 lds
mm v,92,v,208,a,232,92
tr 204,242,6152
s_add_u32 s34, s34, 128
mm v,92,v,212,a,236,92
tr 206,242,9224
mm v,140,v,208,a,240,140
s_cmp_eq_u32 s34, s95
s_cselect_b32 s55, 1280, 0
s_sub_u32 s34, s34, s55
mm v,140,v,212,a,244,140
v_fma_f32 v222, v222, v234, v238
v_fma_f32 v223, v223, v235, v239
mm v,188,v,208,a,248,188
v_cvt_pk_bf16_f32 v216, v216, v217
v_cvt_pk_bf16_f32 v217, v218, v219
mm v,188,v,212,a,252,188
s_waitcnt lgkmcnt(4)
v_cvt_pk_bf16_f32 v218, v220, v221
v_cvt_pk_bf16_f32 v219, v222, v223
mm v,0,v,192,a,192,0
tr 208,243,0
s_add_u32 m0, s30, s40
mm v,0,v,196,a,196,0
tr 210,243,3072
mz v,224,v,216,a,26
mz v,228,v,216,a,24
mm v,48,v,192,a,200,48
tr 212,243,6144
v_accvgpr_read_b32 v216, a100
mm v,48,v,196,a,204,48
tr 214,243,9216
mm v,96,v,192,a,208,96
buffer_load_dwordx4 v249, s[8:11], s33 offen lds
mm v,96,v,196,a,212,96
v_accvgpr_read_b32 v217, a101
v_accvgpr_read_b32 v218, a102
mm v,144,v,192,a,216,144
v_accvgpr_read_b32 v219, a103
v_accvgpr_read_b32 v220, a116
mm v,144,v,196,a,220,144
s_waitcnt lgkmcnt(4)
v_accvgpr_read_b32 v221, a117
v_accvgpr_read_b32 v222, a118
mm v,4,v,200,a,192,4
tr 192,243,8
v_accvgpr_read_b32 v223, a119
mm v,4,v,204,a,196,4
tr 194,243,3080
v_cvt_pk_bf16_f32 v224, v224, v225
mm v,52,v,200,a,200,52
tr 196,243,6152
v_cvt_pk_bf16_f32 v225, v226, v227
mm v,52,v,204,a,204,52
tr 198,243,9224
mm v,100,v,200,a,208,100
buffer_load_dwordx4 v250, s[8:11], s33 offen offset:1024 lds
mm v,100,v,204,a,212,100
v_cvt_pk_bf16_f32 v226, v228, v229
v_cvt_pk_bf16_f32 v227, v230, v231
mm v,148,v,200,a,216,148
s_add_u32 s50, s46, 6144
s_waitcnt lgkmcnt(4)
mm v,148,v,204,a,220,148
buffer_store_dwordx4 v[224:227], v253, s[20:23], s50 offen offset:2048 sc1
mm v,8,v,208,a,192,8
tr 200,242,128
v_fma_f32 v216, v216, v232, v236
mm v,8,v,212,a,196,8
tr 202,242,3200
v_fma_f32 v217, v217, v233, v237
mm v,56,v,208,a,200,56
tr 204,242,6272
buffer_load_dwordx4 v251, s[8:11], s33 offen offset:2048 lds
mm v,56,v,212,a,204,56
tr 206,242,9344
mm v,104,v,208,a,208,104
s_add_u32 s33, s33, 786432
s_cmp_eq_u32 s33, s94
s_cselect_b32 s55, 7864320, 0
mm v,104,v,212,a,212,104
s_sub_u32 s33, s33, s55
v_fma_f32 v218, v218, v234, v238
v_fma_f32 v219, v219, v235, v239
mm v,152,v,208,a,216,152
v_fma_f32 v220, v220, v232, v236
v_fma_f32 v221, v221, v233, v237
mm v,152,v,212,a,220,152
s_waitcnt lgkmcnt(4)
v_fma_f32 v222, v222, v234, v238
v_fma_f32 v223, v223, v235, v239
mm v,12,v,192,a,192,12
tr 208,242,136
v_cvt_pk_bf16_f32 v216, v216, v217
mm v,12,v,196,a,196,12
tr 210,242,3208
v_cvt_pk_bf16_f32 v217, v218, v219
mm v,60,v,192,a,200,60
tr 212,242,6280
v_cvt_pk_bf16_f32 v218, v220, v221
mm v,60,v,196,a,204,60
tr 214,242,9352
mm v,108,v,192,a,208,108
v_cvt_pk_bf16_f32 v219, v222, v223
mm v,108,v,196,a,212,108
mm v,156,v,192,a,216,156
s_waitcnt lgkmcnt(4)
mm v,156,v,196,a,220,156
mz v,224,v,216,a,26
mz v,228,v,216,a,24
mm v,16,v,200,a,192,16
tr 192,243,128
s_waitcnt vmcnt(18)
mm v,16,v,204,a,196,16
tr 194,243,3200
v_accvgpr_read_b32 v216, a132
mm v,64,v,200,a,200,64
tr 196,243,6272
v_accvgpr_read_b32 v217, a133
mm v,64,v,204,a,204,64
tr 198,243,9344
s_waitcnt lgkmcnt(4)
mm v,112,v,200,a,208,112
ds_read_b128 a[224:227], v244 offset:24832
v_accvgpr_read_b32 v218, a134
mm v,112,v,204,a,212,112
ds_read_b128 a[228:231], v245 offset:24832
v_accvgpr_read_b32 v219, a135
mm v,160,v,200,a,216,160
ds_read_b128 a[232:235], v244 offset:26880
v_accvgpr_read_b32 v220, a148
mm v,160,v,204,a,220,160
ds_read_b128 a[236:239], v245 offset:26880
v_accvgpr_read_b32 v221, a149
mm v,20,v,208,a,192,20
tr 200,243,136
v_accvgpr_read_b32 v222, a150
mm v,20,v,212,a,196,20
tr 202,243,3208
v_accvgpr_read_b32 v223, a151
mm v,68,v,208,a,200,68
tr 204,243,6280
v_cvt_pk_bf16_f32 v224, v224, v225
mm v,68,v,212,a,204,68
tr 206,243,9352
s_waitcnt lgkmcnt(8)
mm v,116,v,208,a,208,116
ds_read_b128 a[240:243], v244 offset:28928
v_cvt_pk_bf16_f32 v225, v226, v227
mm v,116,v,212,a,212,116
ds_read_b128 a[244:247], v245 offset:28928
v_cvt_pk_bf16_f32 v226, v228, v229
mm v,164,v,208,a,216,164
ds_read_b128 a[248:251], v244 offset:30976
v_cvt_pk_bf16_f32 v227, v230, v231
mm v,164,v,212,a,220,164
ds_read_b128 a[252:255], v245 offset:30976
s_add_u32 s50, s46, 6144
mm v,24,v,192,a,192,24
tr 208,242,256
buffer_store_dwordx4 v[224:227], v253, s[20:23], s50 offen offset:3072 sc1
mm v,24,v,196,a,196,24
tr 210,242,3328
v_fma_f32 v216, v216, v232, v236
mm v,72,v,192,a,200,72
tr 212,242,6400
v_fma_f32 v217, v217, v233, v237
mm v,72,v,196,a,204,72
tr 214,242,9472
mm v,120,v,192,a,208,120
s_waitcnt lgkmcnt(4)
v_fma_f32 v218, v218, v234, v238
v_fma_f32 v219, v219, v235, v239
mm v,120,v,196,a,212,120
s_add_u32 m0, s45, 0
s_add_u32 s51, s34, 0
v_fma_f32 v220, v220, v232, v236
mm v,168,v,192,a,216,168
buffer_load_dwordx4 v252, s[4:7], s51 offen lds
mm v,168,v,196,a,220,168
s_add_u32 s51, s34, 9216
v_fma_f32 v221, v221, v233, v237
v_fma_f32 v222, v222, v234, v238
mm v,28,v,200,a,192,28
tr 192,242,264
v_fma_f32 v223, v223, v235, v239
mm v,28,v,204,a,196,28
tr 194,242,3336
v_cvt_pk_bf16_f32 v216, v216, v217
mm v,76,v,200,a,200,76
tr 196,242,6408
v_cvt_pk_bf16_f32 v217, v218, v219
mm v,76,v,204,a,204,76
tr 198,242,9480
mm v,124,v,200,a,208,124
buffer_load_dwordx4 v252, s[4:7], s51 offen offset:1024 lds
mm v,124,v,204,a,212,124
s_add_u32 s51, s34, 18432
v_cvt_pk_bf16_f32 v218, v220, v221
v_cvt_pk_bf16_f32 v219, v222, v223
mm v,172,v,200,a,216,172
s_waitcnt lgkmcnt(4)
mm v,172,v,204,a,220,172
buffer_load_dwordx4 v252, s[4:7], s51 offen offset:2048 lds
mz v,224,v,216,a,26
mz v,228,v,216,a,24
mm v,32,v,208,a,192,32
tr 200,243,256
s_add_u32 s51, s34, 27648
mm v,32,v,212,a,196,32
tr 202,243,3328
v_accvgpr_read_b32 v216, a164
mm v,80,v,208,a,200,80
tr 204,243,6400
v_accvgpr_read_b32 v217, a165
mm v,80,v,212,a,204,80
tr 206,243,9472
mm v,128,v,208,a,208,128
v_accvgpr_read_b32 v218, a166
v_accvgpr_read_b32 v219, a167
mm v,128,v,212,a,212,128
buffer_load_dwordx4 v252, s[4:7], s51 offen offset:3072 lds
mm v,176,v,208,a,216,176
s_add_u32 m0, s45, 4096
s_add_u32 s51, s34, 40960
v_accvgpr_read_b32 v220, a180
mm v,176,v,212,a,220,176
s_waitcnt lgkmcnt(4)
v_accvgpr_read_b32 v221, a181
v_accvgpr_read_b32 v222, a182
mm v,36,v,192,a,192,36
tr 208,243,264
v_accvgpr_read_b32 v223, a183
mm v,36,v,196,a,196,36
tr 210,243,3336
v_cvt_pk_bf16_f32 v224, v224, v225
mm v,84,v,192,a,200,84
tr 212,243,6408
v_cvt_pk_bf16_f32 v225, v226, v227
mm v,84,v,196,a,204,84
tr 214,243,9480
s_waitcnt lgkmcnt(6)
mm v,132,v,192,a,208,132
s_sub_u32 s42, s29, s48
s_mov_b32 s48, s29
v_add_u32 v242, s42, v242
mm v,132,v,196,a,212,132
buffer_load_dwordx4 v252, s[4:7], s51 offen lds
v_add_u32 v243, s42, v243
mm v,180,v,192,a,216,180
s_add_u32 s51, s34, 50176
v_cvt_pk_bf16_f32 v226, v228, v229
v_cvt_pk_bf16_f32 v227, v230, v231
mm v,180,v,196,a,220,180
buffer_load_dwordx4 v252, s[4:7], s51 offen offset:1024 lds
s_add_u32 s50, s46, 10240
mm v,40,v,200,a,192,40
s_waitcnt vmcnt(21) lgkmcnt(0)
s_barrier
s_add_u32 s51, s34, 59392
buffer_store_dwordx4 v[224:227], v253, s[20:23], s50 offen sc1
mm v,40,v,204,a,196,40
tr 192,242,0
s_mov_b32 s43, s28
v_fma_f32 v216, v216, v232, v236
mm v,88,v,200,a,200,88
tr 194,242,3072
s_mov_b32 s28, s29
v_fma_f32 v217, v217, v233, v237
mm v,88,v,204,a,204,88
tr 196,242,6144
s_mov_b32 s29, s30
mm v,136,v,200,a,208,136
tr 198,242,9216
mm v,136,v,204,a,212,136
s_mov_b32 s30, s43
buffer_load_dwordx4 v252, s[4:7], s51 offen offset:2048 lds
mm v,184,v,200,a,216,184
s_add_u32 s51, s34, 68608
v_fma_f32 v218, v218, v234, v238
v_fma_f32 v219, v219, v235, v239
mm v,184,v,204,a,220,184
v_fma_f32 v220, v220, v232, v236
v_fma_f32 v221, v221, v233, v237
mm v,44,v,208,a,192,44
tr 200,242,8
v_fma_f32 v222, v222, v234, v238
v_fma_f32 v223, v223, v235, v239
mm v,44,v,212,a,196,44
tr 202,242,3080
buffer_load_dwordx4 v252, s[4:7], s51 offen offset:3072 lds
mm v,92,v,208,a,200,92
tr 204,242,6152
s_add_u32 s34, s34, 128
mm v,92,v,212,a,204,92
tr 206,242,9224
mm v,140,v,208,a,208,140
s_cmp_eq_u32 s34, s95
s_cselect_b32 s55, 1280, 0
s_sub_u32 s34, s34, s55
mm v,140,v,212,a,212,140
v_cvt_pk_bf16_f32 v216, v216, v217
v_cvt_pk_bf16_f32 v217, v218, v219
mm v,188,v,208,a,216,188
v_cvt_pk_bf16_f32 v218, v220, v221
v_cvt_pk_bf16_f32 v219, v222, v223
mm v,188,v,212,a,220,188
s_waitcnt lgkmcnt(4)
mm v,0,v,192,a,224,0
tr 208,243,0
s_add_u32 m0, s30, s40
mm v,0,v,196,a,228,0
tr 210,243,3072
mz v,224,v,216,a,26
mz v,228,v,216,a,24
mm v,48,v,192,a,232,48
tr 212,243,6144
ds_read_b128 v[232:235], v246
mm v,48,v,196,a,236,48
tr 214,243,9216
v_accvgpr_read_b32 v216, a32
mm v,96,v,192,a,240,96
buffer_load_dwordx4 v249, s[8:11], s33 offen lds
mm v,96,v,196,a,244,96
v_accvgpr_read_b32 v217, a33
v_accvgpr_read_b32 v218, a34
mm v,144,v,192,a,248,144
v_accvgpr_read_b32 v219, a35
v_accvgpr_read_b32 v220, a48
mm v,144,v,196,a,252,144
s_waitcnt lgkmcnt(5)
v_accvgpr_read_b32 v221, a49
v_accvgpr_read_b32 v222, a50
mm v,4,v,200,a,224,4
tr 192,243,8
v_accvgpr_read_b32 v223, a51
mm v,4,v,204,a,228,4
tr 194,243,3080
v_cvt_pk_bf16_f32 v224, v224, v225
mm v,52,v,200,a,232,52
tr 196,243,6152
v_cvt_pk_bf16_f32 v225, v226, v227
mm v,52,v,204,a,236,52
tr 198,243,9224
mm v,100,v,200,a,240,100
buffer_load_dwordx4 v250, s[8:11], s33 offen offset:1024 lds
mm v,100,v,204,a,244,100
v_cvt_pk_bf16_f32 v226, v228, v229
v_cvt_pk_bf16_f32 v227, v230, v231
mm v,148,v,200,a,248,148
s_add_u32 s50, s46, 10240
s_waitcnt lgkmcnt(7)
mm v,148,v,204,a,252,148
buffer_store_dwordx4 v[224:227], v253, s[20:23], s50 offen offset:1024 sc1
mm v,8,v,208,a,224,8
tr 200,242,128
s_waitcnt lgkmcnt(5)
mm v,8,v,212,a,228,8
tr 202,242,3200
v_mul_f32_e64 v236, -v248, v232
mm v,56,v,208,a,232,56
tr 204,242,6272
buffer_load_dwordx4 v251, s[8:11], s33 offen offset:2048 lds
mm v,56,v,212,a,236,56
tr 206,242,9344
mm v,104,v,208,a,240,104
s_add_u32 s33, s33, 786432
s_cmp_eq_u32 s33, s94
s_cselect_b32 s55, 7864320, 0
mm v,104,v,212,a,244,104
s_sub_u32 s33, s33, s55
v_mul_f32_e64 v237, -v248, v233
v_mul_f32_e64 v238, -v248, v234
mm v,152,v,208,a,248,152
v_mul_f32_e64 v239, -v248, v235
v_fma_f32 v216, v216, v232, v236
mm v,152,v,212,a,252,152
s_waitcnt lgkmcnt(4)
v_fma_f32 v217, v217, v233, v237
v_fma_f32 v218, v218, v234, v238
mm v,12,v,192,a,224,12
tr 208,242,136
v_fma_f32 v219, v219, v235, v239
mm v,12,v,196,a,228,12
tr 210,242,3208
v_fma_f32 v220, v220, v232, v236
mm v,60,v,192,a,232,60
tr 212,242,6280
v_fma_f32 v221, v221, v233, v237
mm v,60,v,196,a,236,60
tr 214,242,9352
mm v,108,v,192,a,240,108
v_fma_f32 v222, v222, v234, v238
v_fma_f32 v223, v223, v235, v239
mm v,108,v,196,a,244,108
v_cvt_pk_bf16_f32 v216, v216, v217
v_cvt_pk_bf16_f32 v217, v218, v219
mm v,156,v,192,a,248,156
v_cvt_pk_bf16_f32 v218, v220, v221
v_cvt_pk_bf16_f32 v219, v222, v223
mm v,156,v,196,a,252,156
s_waitcnt lgkmcnt(4)
mm v,16,v,200,a,224,16
tr 192,243,128
s_waitcnt vmcnt(18)
mm v,16,v,204,a,228,16
tr 194,243,3200
mz v,224,v,216,a,26
mz v,228,v,216,a,24
mm v,64,v,200,a,232,64
tr 196,243,6272
v_accvgpr_read_b32 v216, a64
mm v,64,v,204,a,236,64
tr 198,243,9344
s_waitcnt lgkmcnt(4)
mm v,112,v,200,a,240,112
ds_read_b128 a[192:195], v244
v_accvgpr_read_b32 v217, a65
mm v,112,v,204,a,244,112
ds_read_b128 a[196:199], v245
v_accvgpr_read_b32 v218, a66
mm v,160,v,200,a,248,160
ds_read_b128 a[200:203], v244 offset:2048
v_accvgpr_read_b32 v219, a67
mm v,160,v,204,a,252,160
ds_read_b128 a[204:207], v245 offset:2048
v_accvgpr_read_b32 v220, a80
mm v,20,v,208,a,224,20
tr 200,243,136
v_accvgpr_read_b32 v221, a81
mm v,20,v,212,a,228,20
tr 202,243,3208
v_accvgpr_read_b32 v222, a82
mm v,68,v,208,a,232,68
tr 204,243,6280
v_accvgpr_read_b32 v223, a83
mm v,68,v,212,a,236,68
tr 206,243,9352
s_waitcnt lgkmcnt(8)
mm v,116,v,208,a,240,116
ds_read_b128 a[208:211], v244 offset:4096
v_cvt_pk_bf16_f32 v224, v224, v225
mm v,116,v,212,a,244,116
ds_read_b128 a[212:215], v245 offset:4096
v_cvt_pk_bf16_f32 v225, v226, v227
mm v,164,v,208,a,248,164
ds_read_b128 a[216:219], v244 offset:6144
v_cvt_pk_bf16_f32 v226, v228, v229
mm v,164,v,212,a,252,164
ds_read_b128 a[220:223], v245 offset:6144
v_cvt_pk_bf16_f32 v227, v230, v231
mm v,24,v,192,a,224,24
tr 208,242,256
s_add_u32 s50, s46, 0
mm v,24,v,196,a,228,24
tr 210,242,3328
mm v,72,v,192,a,232,72
tr 212,242,6400
mm v,72,v,196,a,236,72
tr 214,242,9472
mm v,120,v,192,a,240,120
s_waitcnt lgkmcnt(4)
buffer_store_dwordx4 v[224:227], v253, s[20:23], s50 offen offset:1024 sc1
mm v,120,v,196,a,244,120
s_add_u32 m0, s44, 0
s_add_u32 s51, s34, 0
v_fma_f32 v216, v216, v232, v236
mm v,168,v,192,a,248,168
buffer_load_dwordx4 v252, s[4:7], s51 offen lds
mm v,168,v,196,a,252,168
L_pg56:
s_cbranch_execz L_ir55
s_add_u32 s51, s34, 9216
v_fma_f32 v217, v217, v233, v237
v_fma_f32 v218, v218, v234, v238
mm v,28,v,200,a,224,28
tr 192,242,264
v_fma_f32 v219, v219, v235, v239
mm v,28,v,204,a,228,28
tr 194,242,3336
v_fma_f32 v220, v220, v232, v236
mm v,76,v,200,a,232,76
tr 196,242,6408
v_fma_f32 v221, v221, v233, v237
mm v,76,v,204,a,236,76
tr 198,242,9480
mm v,124,v,200,a,240,124
buffer_load_dwordx4 v252, s[4:7], s51 offen offset:1024 lds
mm v,124,v,204,a,244,124
s_add_u32 s51, s34, 18432
v_fma_f32 v222, v222, v234, v238
v_fma_f32 v223, v223, v235, v239
mm v,172,v,200,a,248,172
s_waitcnt lgkmcnt(4)
v_cvt_pk_bf16_f32 v216, v216, v217
v_cvt_pk_bf16_f32 v217, v218, v219
mm v,172,v,204,a,252,172
buffer_load_dwordx4 v252, s[4:7], s51 offen offset:2048 lds
mm v,32,v,208,a,224,32
tr 200,243,256
s_add_u32 s51, s34, 27648
mm v,32,v,212,a,228,32
tr 202,243,3328
v_cvt_pk_bf16_f32 v218, v220, v221
mm v,80,v,208,a,232,80
tr 204,243,6400
v_cvt_pk_bf16_f32 v219, v222, v223
mm v,80,v,212,a,236,80
tr 206,243,9472
mz v,224,v,216,a,26
mz v,228,v,216,a,24
mm v,128,v,208,a,240,128
v_accvgpr_read_b32 v216, a96
v_accvgpr_read_b32 v217, a97
mm v,128,v,212,a,244,128
buffer_load_dwordx4 v252, s[4:7], s51 offen offset:3072 lds
mm v,176,v,208,a,248,176
s_add_u32 m0, s44, 4096
s_add_u32 s51, s34, 40960
v_accvgpr_read_b32 v218, a98
mm v,176,v,212,a,252,176
s_waitcnt lgkmcnt(4)
v_accvgpr_read_b32 v219, a99
v_accvgpr_read_b32 v220, a112
mm v,36,v,192,a,224,36
tr 208,243,264
v_accvgpr_read_b32 v221, a113
mm v,36,v,196,a,228,36
tr 210,243,3336
v_accvgpr_read_b32 v222, a114
mm v,84,v,192,a,232,84
tr 212,243,6408
v_accvgpr_read_b32 v223, a115
mm v,84,v,196,a,236,84
tr 214,243,9480
s_waitcnt lgkmcnt(6)
mm v,132,v,192,a,240,132
s_sub_u32 s42, s29, s48
s_mov_b32 s48, s29
v_add_u32 v242, s42, v242
mm v,132,v,196,a,244,132
buffer_load_dwordx4 v252, s[4:7], s51 offen lds
v_add_u32 v243, s42, v243
mm v,180,v,192,a,248,180
s_add_u32 s51, s34, 50176
v_cvt_pk_bf16_f32 v224, v224, v225
v_cvt_pk_bf16_f32 v225, v226, v227
v_cvt_pk_bf16_f32 v226, v228, v229
mm v,180,v,196,a,252,180
buffer_load_dwordx4 v252, s[4:7], s51 offen offset:1024 lds
v_cvt_pk_bf16_f32 v227, v230, v231
mm v,40,v,200,a,224,40
s_waitcnt vmcnt(21) lgkmcnt(0)
s_barrier
s_add_u32 s51, s34, 59392
mm v,40,v,204,a,228,40
tr 192,242,0
s_mov_b32 s43, s28
mm v,88,v,200,a,232,88
tr 194,242,3072
s_mov_b32 s28, s29
mm v,88,v,204,a,236,88
tr 196,242,6144
s_mov_b32 s29, s30
mm v,136,v,200,a,240,136
tr 198,242,9216
mm v,136,v,204,a,244,136
s_mov_b32 s30, s43
buffer_load_dwordx4 v252, s[4:7], s51 offen offset:2048 lds
mm v,184,v,200,a,248,184
s_add_u32 s51, s34, 68608
s_add_u32 s50, s46, 0
mm v,184,v,204,a,252,184
buffer_store_dwordx4 v[224:227], v253, s[20:23], s50 offen offset:2048 sc1
mm v,44,v,208,a,224,44
tr 200,242,8
v_fma_f32 v216, v216, v232, v236
v_fma_f32 v217, v217, v233, v237
mm v,44,v,212,a,228,44
tr 202,242,3080
buffer_load_dwordx4 v252, s[4:7], s51 offen offset:3072 lds
mm v,92,v,208,a,232,92
tr 204,242,6152
s_add_u32 s34, s34, 128
v_fma_f32 v218, v218, v234, v238
mm v,92,v,212,a,236,92
tr 206,242,9224
v_fma_f32 v219, v219, v235, v239
mm v,140,v,208,a,240,140
s_cmp_eq_u32 s34, s95
s_cselect_b32 s55, 1280, 0
s_sub_u32 s34, s34, s55
mm v,140,v,212,a,244,140
v_fma_f32 v220, v220, v232, v236
v_fma_f32 v221, v221, v233, v237
mm v,188,v,208,a,248,188
v_fma_f32 v222, v222, v234, v238
v_fma_f32 v223, v223, v235, v239
mm v,188,v,212,a,252,188
s_waitcnt lgkmcnt(4)
v_cvt_pk_bf16_f32 v216, v216, v217
v_cvt_pk_bf16_f32 v217, v218, v219
mm v,0,v,192,a,192,0
tr 208,243,0
s_add_u32 m0, s30, s40
mm v,0,v,196,a,196,0
tr 210,243,3072
v_cvt_pk_bf16_f32 v218, v220, v221
mm v,48,v,192,a,200,48
tr 212,243,6144
v_cvt_pk_bf16_f32 v219, v222, v223
mm v,48,v,196,a,204,48
tr 214,243,9216
mz v,224,v,216,a,26
mz v,228,v,216,a,24
mm v,96,v,192,a,208,96
buffer_load_dwordx4 v249, s[8:11], s33 offen lds
mm v,96,v,196,a,212,96
v_accvgpr_read_b32 v216, a128
v_accvgpr_read_b32 v217, a129
mm v,144,v,192,a,216,144
v_accvgpr_read_b32 v218, a130
v_accvgpr_read_b32 v219, a131
mm v,144,v,196,a,220,144
s_waitcnt lgkmcnt(4)
v_accvgpr_read_b32 v220, a144
v_accvgpr_read_b32 v221, a145
mm v,4,v,200,a,192,4
tr 192,243,8
v_accvgpr_read_b32 v222, a146
mm v,4,v,204,a,196,4
tr 194,243,3080
v_accvgpr_read_b32 v223, a147
mm v,52,v,200,a,200,52
tr 196,243,6152
v_cvt_pk_bf16_f32 v224, v224, v225
mm v,52,v,204,a,204,52
tr 198,243,9224
mm v,100,v,200,a,208,100
buffer_load_dwordx4 v250, s[8:11], s33 offen offset:1024 lds
mm v,100,v,204,a,212,100
v_cvt_pk_bf16_f32 v225, v226, v227
v_cvt_pk_bf16_f32 v226, v228, v229
mm v,148,v,200,a,216,148
v_cvt_pk_bf16_f32 v227, v230, v231
mm v,148,v,204,a,220,148
s_add_u32 s50, s46, 0
s_waitcnt lgkmcnt(6)
mm v,8,v,208,a,192,8
tr 200,242,128
s_waitcnt lgkmcnt(5)
mm v,8,v,212,a,196,8
tr 202,242,3200
mm v,56,v,208,a,200,56
tr 204,242,6272
buffer_load_dwordx4 v251, s[8:11], s33 offen offset:2048 lds
mm v,56,v,212,a,204,56
tr 206,242,9344
mm v,104,v,208,a,208,104
s_add_u32 s33, s33, 786432
s_cmp_eq_u32 s33, s94
s_cselect_b32 s55, 7864320, 0
mm v,104,v,212,a,212,104
s_sub_u32 s33, s33, s55
mm v,152,v,208,a,216,152
buffer_store_dwordx4 v[224:227], v253, s[20:23], s50 offen offset:3072 sc1
mm v,152,v,212,a,220,152
s_waitcnt lgkmcnt(4)
v_fma_f32 v216, v216, v232, v236
v_fma_f32 v217, v217, v233, v237
mm v,12,v,192,a,192,12
tr 208,242,136
v_fma_f32 v218, v218, v234, v238
mm v,12,v,196,a,196,12
tr 210,242,3208
v_fma_f32 v219, v219, v235, v239
mm v,60,v,192,a,200,60
tr 212,242,6280
v_fma_f32 v220, v220, v232, v236
mm v,60,v,196,a,204,60
tr 214,242,9352
mm v,108,v,192,a,208,108
v_fma_f32 v221, v221, v233, v237
v_fma_f32 v222, v222, v234, v238
mm v,108,v,196,a,212,108
v_fma_f32 v223, v223, v235, v239
v_cvt_pk_bf16_f32 v216, v216, v217
mm v,156,v,192,a,216,156
v_cvt_pk_bf16_f32 v217, v218, v219
v_cvt_pk_bf16_f32 v218, v220, v221
mm v,156,v,196,a,220,156
s_waitcnt lgkmcnt(4)
v_cvt_pk_bf16_f32 v219, v222, v223
mm v,16,v,200,a,192,16
tr 192,243,128
s_waitcnt vmcnt(18)
mm v,16,v,204,a,196,16
tr 194,243,3200
mz v,224,v,216,a,26
mz v,228,v,216,a,24
mm v,64,v,200,a,200,64
tr 196,243,6272
v_accvgpr_read_b32 v216, a160
mm v,64,v,204,a,204,64
tr 198,243,9344
s_waitcnt lgkmcnt(4)
mm v,112,v,200,a,208,112
ds_read_b128 a[224:227], v244 offset:24832
v_accvgpr_read_b32 v217, a161
mm v,112,v,204,a,212,112
ds_read_b128 a[228:231], v245 offset:24832
v_accvgpr_read_b32 v218, a162
mm v,160,v,200,a,216,160
ds_read_b128 a[232:235], v244 offset:26880
v_accvgpr_read_b32 v219, a163
mm v,160,v,204,a,220,160
ds_read_b128 a[236:239], v245 offset:26880
v_accvgpr_read_b32 v220, a176
mm v,20,v,208,a,192,20
tr 200,243,136
v_accvgpr_read_b32 v221, a177
mm v,20,v,212,a,196,20
tr 202,243,3208
v_accvgpr_read_b32 v222, a178
mm v,68,v,208,a,200,68
tr 204,243,6280
v_accvgpr_read_b32 v223, a179
mm v,68,v,212,a,204,68
tr 206,243,9352
s_waitcnt lgkmcnt(8)
mm v,116,v,208,a,208,116
ds_read_b128 a[240:243], v244 offset:28928
v_cvt_pk_bf16_f32 v224, v224, v225
mm v,116,v,212,a,212,116
ds_read_b128 a[244:247], v245 offset:28928
v_cvt_pk_bf16_f32 v225, v226, v227
mm v,164,v,208,a,216,164
ds_read_b128 a[248:251], v244 offset:30976
v_cvt_pk_bf16_f32 v226, v228, v229
mm v,164,v,212,a,220,164
ds_read_b128 a[252:255], v245 offset:30976
v_cvt_pk_bf16_f32 v227, v230, v231
mm v,24,v,192,a,192,24
tr 208,242,256
s_add_u32 s50, s46, 4096
mm v,24,v,196,a,196,24
tr 210,242,3328
mm v,72,v,192,a,200,72
tr 212,242,6400
mm v,72,v,196,a,204,72
tr 214,242,9472
mm v,120,v,192,a,208,120
s_waitcnt lgkmcnt(4)
buffer_store_dwordx4 v[224:227], v253, s[20:23], s50 offen sc1
mm v,120,v,196,a,212,120
s_add_u32 m0, s45, 0
s_add_u32 s51, s34, 0
v_fma_f32 v216, v216, v232, v236
mm v,168,v,192,a,216,168
buffer_load_dwordx4 v252, s[4:7], s51 offen lds
mm v,168,v,196,a,220,168
s_add_u32 s51, s34, 9216
v_fma_f32 v217, v217, v233, v237
v_fma_f32 v218, v218, v234, v238
mm v,28,v,200,a,192,28
tr 192,242,264
v_fma_f32 v219, v219, v235, v239
mm v,28,v,204,a,196,28
tr 194,242,3336
v_fma_f32 v220, v220, v232, v236
mm v,76,v,200,a,200,76
tr 196,242,6408
v_fma_f32 v221, v221, v233, v237
mm v,76,v,204,a,204,76
tr 198,242,9480
mm v,124,v,200,a,208,124
buffer_load_dwordx4 v252, s[4:7], s51 offen offset:1024 lds
mm v,124,v,204,a,212,124
s_add_u32 s51, s34, 18432
v_fma_f32 v222, v222, v234, v238
v_fma_f32 v223, v223, v235, v239
mm v,172,v,200,a,216,172
s_waitcnt lgkmcnt(4)
v_cvt_pk_bf16_f32 v216, v216, v217
v_cvt_pk_bf16_f32 v217, v218, v219
mm v,172,v,204,a,220,172
buffer_load_dwordx4 v252, s[4:7], s51 offen offset:2048 lds
mm v,32,v,208,a,192,32
tr 200,243,256
s_add_u32 s51, s34, 27648
mm v,32,v,212,a,196,32
tr 202,243,3328
v_cvt_pk_bf16_f32 v218, v220, v221
mm v,80,v,208,a,200,80
tr 204,243,6400
v_cvt_pk_bf16_f32 v219, v222, v223
mm v,80,v,212,a,204,80
tr 206,243,9472
mz v,224,v,216,a,26
mz v,228,v,216,a,24
mm v,128,v,208,a,208,128
mm v,128,v,212,a,212,128
buffer_load_dwordx4 v252, s[4:7], s51 offen offset:3072 lds
mm v,176,v,208,a,216,176
s_add_u32 m0, s45, 4096
s_add_u32 s51, s34, 40960
mm v,176,v,212,a,220,176
s_waitcnt lgkmcnt(6)
mm v,36,v,192,a,192,36
tr 208,243,264
s_waitcnt lgkmcnt(5)
mm v,36,v,196,a,196,36
tr 210,243,3336
mm v,84,v,192,a,200,84
tr 212,243,6408
v_cvt_pk_bf16_f32 v224, v224, v225
mm v,84,v,196,a,204,84
tr 214,243,9480
s_waitcnt lgkmcnt(6)
mm v,132,v,192,a,208,132
s_sub_u32 s42, s29, s48
s_mov_b32 s48, s29
v_add_u32 v242, s42, v242
mm v,132,v,196,a,212,132
buffer_load_dwordx4 v252, s[4:7], s51 offen lds
v_add_u32 v243, s42, v243
mm v,180,v,192,a,216,180
s_add_u32 s51, s34, 50176
v_cvt_pk_bf16_f32 v225, v226, v227
v_cvt_pk_bf16_f32 v226, v228, v229
v_cvt_pk_bf16_f32 v227, v230, v231
mm v,180,v,196,a,220,180
buffer_load_dwordx4 v252, s[4:7], s51 offen offset:1024 lds
s_add_u32 s50, s46, 4096
mm v,40,v,200,a,192,40
s_waitcnt vmcnt(21) lgkmcnt(0)
s_barrier
s_add_u32 s51, s34, 59392
buffer_store_dwordx4 v[224:227], v253, s[20:23], s50 offen offset:1024 sc1
mm v,40,v,204,a,196,40
tr 192,242,0
s_mov_b32 s43, s28
mm v,88,v,200,a,200,88
tr 194,242,3072
s_mov_b32 s28, s29
mm v,88,v,204,a,204,88
tr 196,242,6144
s_mov_b32 s29, s30
mm v,136,v,200,a,208,136
tr 198,242,9216
mm v,136,v,204,a,212,136
s_mov_b32 s30, s43
buffer_load_dwordx4 v252, s[4:7], s51 offen offset:2048 lds
mm v,184,v,200,a,216,184
s_add_u32 s51, s34, 68608
mm v,184,v,204,a,220,184
mm v,44,v,208,a,192,44
tr 200,242,8
mm v,44,v,212,a,196,44
tr 202,242,3080
buffer_load_dwordx4 v252, s[4:7], s51 offen offset:3072 lds
mm v,92,v,208,a,200,92
tr 204,242,6152
s_add_u32 s34, s34, 128
mm v,92,v,212,a,204,92
tr 206,242,9224
mm v,140,v,208,a,208,140
s_cmp_eq_u32 s34, s95
s_cselect_b32 s55, 1280, 0
s_sub_u32 s34, s34, s55
mm v,140,v,212,a,212,140
mm v,188,v,208,a,216,188
mm v,188,v,212,a,220,188
s_waitcnt lgkmcnt(4)
mm v,0,v,192,a,224,0
tr 208,243,0
s_add_u32 m0, s30, s40
mm v,0,v,196,a,228,0
tr 210,243,3072
mm v,48,v,192,a,232,48
tr 212,243,6144
mm v,48,v,196,a,236,48
tr 214,243,9216
mm v,96,v,192,a,240,96
buffer_load_dwordx4 v249, s[8:11], s33 offen lds
mm v,96,v,196,a,244,96
mm v,144,v,192,a,248,144
mm v,144,v,196,a,252,144
s_waitcnt lgkmcnt(6)
mm v,4,v,200,a,224,4
tr 192,243,8
s_waitcnt lgkmcnt(5)
mm v,4,v,204,a,228,4
tr 194,243,3080
mm v,52,v,200,a,232,52
tr 196,243,6152
mm v,52,v,204,a,236,52
tr 198,243,9224
mm v,100,v,200,a,240,100
buffer_load_dwordx4 v250, s[8:11], s33 offen offset:1024 lds
mm v,100,v,204,a,244,100
mm v,148,v,200,a,248,148
mm v,148,v,204,a,252,148
s_waitcnt lgkmcnt(6)
mm v,8,v,208,a,224,8
tr 200,242,128
s_waitcnt lgkmcnt(5)
mm v,8,v,212,a,228,8
tr 202,242,3200
mm v,56,v,208,a,232,56
tr 204,242,6272
buffer_load_dwordx4 v251, s[8:11], s33 offen offset:2048 lds
mm v,56,v,212,a,236,56
tr 206,242,9344
mm v,104,v,208,a,240,104
s_add_u32 s33, s33, 786432
s_cmp_eq_u32 s33, s94
s_cselect_b32 s55, 7864320, 0
mm v,104,v,212,a,244,104
s_sub_u32 s33, s33, s55
mm v,152,v,208,a,248,152
mm v,152,v,212,a,252,152
s_waitcnt lgkmcnt(6)
mm v,12,v,192,a,224,12
tr 208,242,136
s_waitcnt lgkmcnt(5)
mm v,12,v,196,a,228,12
tr 210,242,3208
mm v,60,v,192,a,232,60
tr 212,242,6280
mm v,60,v,196,a,236,60
tr 214,242,9352
mm v,108,v,192,a,240,108
mm v,108,v,196,a,244,108
mm v,156,v,192,a,248,156
mm v,156,v,196,a,252,156
s_waitcnt lgkmcnt(4)
mm v,16,v,200,a,224,16
tr 192,243,128
s_waitcnt vmcnt(17)
mm v,16,v,204,a,228,16
tr 194,243,3200
mm v,64,v,200,a,232,64
tr 196,243,6272
mm v,64,v,204,a,236,64
tr 198,243,9344
mm v,112,v,200,a,240,112
ds_read_b128 a[192:195], v244
mm v,112,v,204,a,244,112
ds_read_b128 a[196:199], v245
mm v,160,v,200,a,248,160
ds_read_b128 a[200:203], v244 offset:2048
mm v,160,v,204,a,252,160
ds_read_b128 a[204:207], v245 offset:2048
s_waitcnt lgkmcnt(10)
mm v,20,v,208,a,224,20
tr 200,243,136
s_waitcnt lgkmcnt(9)
mm v,20,v,212,a,228,20
tr 202,243,3208
mm v,68,v,208,a,232,68
tr 204,243,6280
mm v,68,v,212,a,236,68
tr 206,243,9352
mm v,116,v,208,a,240,116
ds_read_b128 a[208:211], v244 offset:4096
mm v,116,v,212,a,244,116
ds_read_b128 a[212:215], v245 offset:4096
mm v,164,v,208,a,248,164
ds_read_b128 a[216:219], v244 offset:6144
mm v,164,v,212,a,252,164
ds_read_b128 a[220:223], v245 offset:6144
s_waitcnt lgkmcnt(14)
mm v,24,v,192,a,224,24
tr 208,242,256
s_waitcnt lgkmcnt(13)
mm v,24,v,196,a,228,24
tr 210,242,3328
mm v,72,v,192,a,232,72
tr 212,242,6400
mm v,72,v,196,a,236,72
tr 214,242,9472
mm v,120,v,192,a,240,120
mm v,120,v,196,a,244,120
mm v,168,v,192,a,248,168
mm v,168,v,196,a,252,168
s_waitcnt lgkmcnt(10)
mm v,28,v,200,a,224,28
tr 192,242,264
s_waitcnt lgkmcnt(9)
mm v,28,v,204,a,228,28
tr 194,242,3336
mm v,76,v,200,a,232,76
tr 196,242,6408
mm v,76,v,204,a,236,76
tr 198,242,9480
mm v,124,v,200,a,240,124
mm v,124,v,204,a,244,124
mm v,172,v,200,a,248,172
mm v,172,v,204,a,252,172
s_waitcnt lgkmcnt(6)
mm v,32,v,208,a,224,32
tr 200,243,256
s_waitcnt lgkmcnt(5)
mm v,32,v,212,a,228,32
tr 202,243,3328
mm v,80,v,208,a,232,80
tr 204,243,6400
mm v,80,v,212,a,236,80
tr 206,243,9472
mm v,128,v,208,a,240,128
mm v,128,v,212,a,244,128
mm v,176,v,208,a,248,176
mm v,176,v,212,a,252,176
s_waitcnt lgkmcnt(6)
mm v,36,v,192,a,224,36
tr 208,243,264
s_waitcnt lgkmcnt(5)
mm v,36,v,196,a,228,36
tr 210,243,3336
mm v,84,v,192,a,232,84
tr 212,243,6408
mm v,84,v,196,a,236,84
tr 214,243,9480
mm v,132,v,192,a,240,132
s_sub_u32 s42, s29, s48
s_mov_b32 s48, s29
v_add_u32 v242, s42, v242
mm v,132,v,196,a,244,132
v_add_u32 v243, s42, v243
mm v,180,v,192,a,248,180
mm v,180,v,196,a,252,180
s_waitcnt lgkmcnt(6)
mm v,40,v,200,a,224,40
s_waitcnt vmcnt(14) lgkmcnt(0)
s_barrier
mm v,40,v,204,a,228,40
tr 192,242,0
s_mov_b32 s43, s28
mm v,88,v,200,a,232,88
tr 194,242,3072
s_mov_b32 s28, s29
mm v,88,v,204,a,236,88
tr 196,242,6144
s_mov_b32 s29, s30
mm v,136,v,200,a,240,136
tr 198,242,9216
mm v,136,v,204,a,244,136
s_mov_b32 s30, s43
mm v,184,v,200,a,248,184
mm v,184,v,204,a,252,184
mm v,44,v,208,a,224,44
tr 200,242,8
mm v,44,v,212,a,228,44
tr 202,242,3080
mm v,92,v,208,a,232,92
tr 204,242,6152
mm v,92,v,212,a,236,92
tr 206,242,9224
mm v,140,v,208,a,240,140
mm v,140,v,212,a,244,140
mm v,188,v,208,a,248,188
mm v,188,v,212,a,252,188
s_waitcnt lgkmcnt(6)
mm v,0,v,192,a,192,0
tr 208,243,0
s_waitcnt lgkmcnt(5)
mm v,0,v,196,a,196,0
tr 210,243,3072
mm v,48,v,192,a,200,48
tr 212,243,6144
mm v,48,v,196,a,204,48
tr 214,243,9216
mm v,96,v,192,a,208,96
mm v,96,v,196,a,212,96
mm v,144,v,192,a,216,144
mm v,144,v,196,a,220,144
s_waitcnt lgkmcnt(6)
mm v,4,v,200,a,192,4
tr 192,243,8
s_waitcnt lgkmcnt(5)
mm v,4,v,204,a,196,4
tr 194,243,3080
mm v,52,v,200,a,200,52
tr 196,243,6152
mm v,52,v,204,a,204,52
tr 198,243,9224
mm v,100,v,200,a,208,100
mm v,100,v,204,a,212,100
mm v,148,v,200,a,216,148
mm v,148,v,204,a,220,148
s_waitcnt lgkmcnt(6)
mm v,8,v,208,a,192,8
tr 200,242,128
s_waitcnt lgkmcnt(5)
mm v,8,v,212,a,196,8
tr 202,242,3200
mm v,56,v,208,a,200,56
tr 204,242,6272
mm v,56,v,212,a,204,56
tr 206,242,9344
mm v,104,v,208,a,208,104
mm v,104,v,212,a,212,104
mm v,152,v,208,a,216,152
mm v,152,v,212,a,220,152
s_waitcnt lgkmcnt(6)
mm v,12,v,192,a,192,12
tr 208,242,136
s_waitcnt lgkmcnt(5)
mm v,12,v,196,a,196,12
tr 210,242,3208
mm v,60,v,192,a,200,60
tr 212,242,6280
mm v,60,v,196,a,204,60
tr 214,242,9352
mm v,108,v,192,a,208,108
mm v,108,v,196,a,212,108
mm v,156,v,192,a,216,156
mm v,156,v,196,a,220,156
s_waitcnt lgkmcnt(4)
mm v,16,v,200,a,192,16
tr 192,243,128
s_waitcnt vmcnt(3)
mm v,16,v,204,a,196,16
tr 194,243,3200
mm v,64,v,200,a,200,64
tr 196,243,6272
mm v,64,v,204,a,204,64
tr 198,243,9344
mm v,112,v,200,a,208,112
ds_read_b128 a[224:227], v244 offset:24832
mm v,112,v,204,a,212,112
ds_read_b128 a[228:231], v245 offset:24832
mm v,160,v,200,a,216,160
ds_read_b128 a[232:235], v244 offset:26880
mm v,160,v,204,a,220,160
ds_read_b128 a[236:239], v245 offset:26880
s_waitcnt lgkmcnt(8)
mm v,20,v,208,a,192,20
tr 200,243,136
v_accvgpr_read_b32 v236, a0
mm v,20,v,212,a,196,20
tr 202,243,3208
v_accvgpr_read_b32 v237, a1
mm v,68,v,208,a,200,68
tr 204,243,6280
v_accvgpr_read_b32 v238, a2
mm v,68,v,212,a,204,68
tr 206,243,9352
mm v,116,v,208,a,208,116
ds_read_b128 a[240:243], v244 offset:28928
v_accvgpr_read_b32 v239, a3
mm v,116,v,212,a,212,116
ds_read_b128 a[244:247], v245 offset:28928
mm v,164,v,208,a,216,164
ds_read_b128 a[248:251], v244 offset:30976
mm v,164,v,212,a,220,164
ds_read_b128 a[252:255], v245 offset:30976
s_waitcnt lgkmcnt(14)
mm v,24,v,192,a,192,24
tr 208,242,256
s_waitcnt lgkmcnt(13)
mm v,24,v,196,a,196,24
tr 210,242,3328
mm v,72,v,192,a,200,72
tr 212,242,6400
mm v,72,v,196,a,204,72
tr 214,242,9472
mm v,120,v,192,a,208,120
mm v,120,v,196,a,212,120
mm v,168,v,192,a,216,168
mm v,168,v,196,a,220,168
s_waitcnt lgkmcnt(10)
mm v,28,v,200,a,192,28
tr 192,242,264
s_waitcnt lgkmcnt(9)
mm v,28,v,204,a,196,28
tr 194,242,3336
mm v,76,v,200,a,200,76
tr 196,242,6408
mm v,76,v,204,a,204,76
tr 198,242,9480
mm v,124,v,200,a,208,124
mm v,124,v,204,a,212,124
mm v,172,v,200,a,216,172
mm v,172,v,204,a,220,172
s_waitcnt lgkmcnt(6)
mm v,32,v,208,a,192,32
tr 200,243,256
s_waitcnt lgkmcnt(5)
mm v,32,v,212,a,196,32
tr 202,243,3328
mm v,80,v,208,a,200,80
tr 204,243,6400
mm v,80,v,212,a,204,80
tr 206,243,9472
mm v,128,v,208,a,208,128
mm v,128,v,212,a,212,128
mm v,176,v,208,a,216,176
mm v,176,v,212,a,220,176
s_waitcnt lgkmcnt(6)
mm v,36,v,192,a,192,36
tr 208,243,264
s_waitcnt lgkmcnt(5)
mm v,36,v,196,a,196,36
tr 210,243,3336
mm v,84,v,192,a,200,84
tr 212,243,6408
mm v,84,v,196,a,204,84
tr 214,243,9480
mm v,132,v,192,a,208,132
s_sub_u32 s42, s29, s48
s_mov_b32 s48, s29
v_add_u32 v242, s42, v242
mm v,132,v,196,a,212,132
v_add_u32 v243, s42, v243
mm v,180,v,192,a,216,180
mm v,180,v,196,a,220,180
s_waitcnt lgkmcnt(6)
mm v,40,v,200,a,192,40
s_waitcnt vmcnt(0) lgkmcnt(0)
s_barrier
mm v,40,v,204,a,196,40
tr 192,242,0
s_mov_b32 s43, s28
mm v,88,v,200,a,200,88
tr 194,242,3072
s_mov_b32 s28, s29
mm v,88,v,204,a,204,88
tr 196,242,6144
s_mov_b32 s29, s30
mm v,136,v,200,a,208,136
tr 198,242,9216
mm v,136,v,204,a,212,136
s_mov_b32 s30, s43
mm v,184,v,200,a,216,184
mm v,184,v,204,a,220,184
mm v,44,v,208,a,192,44
tr 200,242,8
mm v,44,v,212,a,196,44
tr 202,242,3080
mm v,92,v,208,a,200,92
tr 204,242,6152
mm v,92,v,212,a,204,92
tr 206,242,9224
mm v,140,v,208,a,208,140
mm v,140,v,212,a,212,140
mm v,188,v,208,a,216,188
mm v,188,v,212,a,220,188
s_waitcnt lgkmcnt(6)
mm v,0,v,192,a,224,0
tr 208,243,0
s_waitcnt lgkmcnt(5)
mm v,0,v,196,a,228,0
tr 210,243,3072
mm v,48,v,192,a,232,48
tr 212,243,6144
mm v,48,v,196,a,236,48
tr 214,243,9216
mm v,96,v,192,a,240,96
mm v,96,v,196,a,244,96
mm v,144,v,192,a,248,144
mm v,144,v,196,a,252,144
s_waitcnt lgkmcnt(6)
mm v,4,v,200,a,224,4
tr 192,243,8
s_waitcnt lgkmcnt(5)
mm v,4,v,204,a,228,4
tr 194,243,3080
mm v,52,v,200,a,232,52
tr 196,243,6152
mm v,52,v,204,a,236,52
tr 198,243,9224
mm v,100,v,200,a,240,100
mm v,100,v,204,a,244,100
mm v,148,v,200,a,248,148
mm v,148,v,204,a,252,148
s_waitcnt lgkmcnt(6)
mm v,8,v,208,a,224,8
tr 200,242,128
s_waitcnt lgkmcnt(5)
mm v,8,v,212,a,228,8
tr 202,242,3200
mm v,56,v,208,a,232,56
tr 204,242,6272
mm v,56,v,212,a,236,56
tr 206,242,9344
mm v,104,v,208,a,240,104
mm v,104,v,212,a,244,104
mm v,152,v,208,a,248,152
mm v,152,v,212,a,252,152
s_waitcnt lgkmcnt(6)
mm v,12,v,192,a,224,12
tr 208,242,136
s_waitcnt lgkmcnt(5)
mm v,12,v,196,a,228,12
tr 210,242,3208
mm v,60,v,192,a,232,60
tr 212,242,6280
mm v,60,v,196,a,236,60
tr 214,242,9352
mm v,108,v,192,a,240,108
mm v,108,v,196,a,244,108
mm v,156,v,192,a,248,156
mm v,156,v,196,a,252,156
s_waitcnt lgkmcnt(6)
mm v,16,v,200,a,224,16
tr 192,243,128
s_waitcnt lgkmcnt(5)
mm v,16,v,204,a,228,16
tr 194,243,3200
mm v,64,v,200,a,232,64
tr 196,243,6272
mm v,64,v,204,a,236,64
tr 198,243,9344
mm v,112,v,200,a,240,112
mm v,112,v,204,a,244,112
mm v,160,v,200,a,248,160
mm v,160,v,204,a,252,160
s_waitcnt lgkmcnt(6)
mm v,20,v,208,a,224,20
tr 200,243,136
s_waitcnt lgkmcnt(5)
mm v,20,v,212,a,228,20
tr 202,243,3208
mm v,68,v,208,a,232,68
tr 204,243,6280
mm v,68,v,212,a,236,68
tr 206,243,9352
mm v,116,v,208,a,240,116
mm v,116,v,212,a,244,116
mm v,164,v,208,a,248,164
mm v,164,v,212,a,252,164
s_waitcnt lgkmcnt(6)
mm v,24,v,192,a,224,24
tr 208,242,256
s_waitcnt lgkmcnt(5)
mm v,24,v,196,a,228,24
tr 210,242,3328
mm v,72,v,192,a,232,72
tr 212,242,6400
mm v,72,v,196,a,236,72
tr 214,242,9472
mm v,120,v,192,a,240,120
mm v,120,v,196,a,244,120
mm v,168,v,192,a,248,168
mm v,168,v,196,a,252,168
s_waitcnt lgkmcnt(6)
mm v,28,v,200,a,224,28
tr 192,242,264
s_waitcnt lgkmcnt(5)
mm v,28,v,204,a,228,28
tr 194,242,3336
mm v,76,v,200,a,232,76
tr 196,242,6408
mm v,76,v,204,a,236,76
tr 198,242,9480
mm v,124,v,200,a,240,124
mm v,124,v,204,a,244,124
mm v,172,v,200,a,248,172
mm v,172,v,204,a,252,172
s_waitcnt lgkmcnt(6)
mm v,32,v,208,a,224,32
tr 200,243,256
s_waitcnt lgkmcnt(5)
mm v,32,v,212,a,228,32
tr 202,243,3328
mm v,80,v,208,a,232,80
tr 204,243,6400
mm v,80,v,212,a,236,80
tr 206,243,9472
mm v,128,v,208,a,240,128
mm v,128,v,212,a,244,128
mm v,176,v,208,a,248,176
mm v,176,v,212,a,252,176
s_waitcnt lgkmcnt(6)
mm v,36,v,192,a,224,36
tr 208,243,264
s_waitcnt lgkmcnt(5)
mm v,36,v,196,a,228,36
tr 210,243,3336
mm v,84,v,192,a,232,84
tr 212,243,6408
mm v,84,v,196,a,236,84
tr 214,243,9480
mm v,132,v,192,a,240,132
s_sub_u32 s42, s29, s49
s_mov_b32 s49, s29
v_add_u32 v238, s42, v238
mm v,132,v,196,a,244,132
s_add_u32 s46, s46, 1474560
v_add_u32 v239, s42, v239
v_add_u32 v240, s42, v240
mm v,180,v,192,a,248,180
v_add_u32 v241, s42, v241
mm v,180,v,196,a,252,180
s_waitcnt lgkmcnt(6)
mm v,40,v,200,a,224,40
s_waitcnt lgkmcnt(0)
s_barrier
mm v,40,v,204,a,228,40
ds_read_b128 a[192:195], v236
s_mov_b32 s43, s28
mm v,88,v,200,a,232,88
ds_read_b128 a[196:199], v237
s_mov_b32 s28, s29
mm v,88,v,204,a,236,88
ds_read_b128 a[200:203], v236 offset:128
s_mov_b32 s29, s30
mm v,136,v,200,a,240,136
ds_read_b128 a[204:207], v237 offset:128
s_mov_b32 s30, s43
mm v,136,v,204,a,244,136
ds_read_b128 a[208:211], v236 offset:256
mm v,184,v,200,a,248,184
ds_read_b128 a[212:215], v237 offset:256
mm v,184,v,204,a,252,184
mm v,44,v,208,a,224,44
mm v,44,v,212,a,228,44
mm v,92,v,208,a,232,92
mm v,92,v,212,a,236,92
mm v,140,v,208,a,240,140
mm v,140,v,212,a,244,140
mm v,188,v,208,a,248,188
mm v,188,v,212,a,252,188
s_mov_b32 s36, 1
s_branch L_head_4
L_slow_4:
s_waitcnt vmcnt(0) lgkmcnt(0)
s_barrier
s_mov_b32 s87, -1
s_cmp_eq_u32 s36, 0
s_cselect_b32 s41, 6291456, 0
s_cselect_b32 s42, 6144, 0
s_cselect_b32 s43, 0, 6291456
s_mov_b32 s28, 74496
s_mov_b32 s29, 99328
s_mov_b32 s30, 124160
s_cselect_b32 s28, 99328, s28
s_cselect_b32 s29, 124160, s29
s_cselect_b32 s30, 74496, s30
s_sub_u32 s94, s94, s42
s_sub_u32 s89, s89, s41
s_sub_u32 s31, s31, s41
s_sub_u32 s32, s32, s41
s_mov_b32 s100, s89
s_mov_b32 s33, s90
s_mov_b32 s34, s91
s_sub_u32 s42, s28, s49
s_mov_b32 s49, s28
v_add_u32 v238, s42, v238
v_add_u32 v239, s42, v239
v_add_u32 v240, s42, v240
v_add_u32 v241, s42, v241
v_mov_b32 v164, 0xff800000
v_mov_b32 v172, 0xff800000
v_mov_b32 v180, 0xff800000
v_mov_b32 v188, 0xff800000
s_mov_b32 s35, 16
L_slowl_4:
s_waitcnt vmcnt(0)
s_barrier
ds_read_b128 a[192:195], v236
ds_read_b128 a[196:199], v237
ds_read_b128 a[200:203], v236 offset:128
ds_read_b128 a[204:207], v237 offset:128
ds_read_b128 a[208:211], v236 offset:256
ds_read_b128 a[212:215], v237 offset:256
s_waitcnt lgkmcnt(0)
mz v,132,a,192,v,0
mm v,132,a,196,v,8,132
mm v,132,a,200,v,16,132
mm v,132,a,204,v,24,132
mm v,132,a,208,v,32,132
mm v,132,a,212,v,40,132
mz v,140,a,192,v,48
mm v,140,a,196,v,56,140
mm v,140,a,200,v,64,140
mm v,140,a,204,v,72,140
mm v,140,a,208,v,80,140
mm v,140,a,212,v,88,140
mz v,148,a,192,v,96
mm v,148,a,196,v,104,148
mm v,148,a,200,v,112,148
mm v,148,a,204,v,120,148
mm v,148,a,208,v,128,148
mm v,148,a,212,v,136,148
mz v,156,a,192,v,144
mm v,156,a,196,v,152,156
mm v,156,a,200,v,160,156
mm v,156,a,204,v,168,156
mm v,156,a,208,v,176,156
mm v,156,a,212,v,184,156
s_nop 7
v_max3_f32 v164, v164, v132, v133
v_max3_f32 v164, v164, v134, v135
v_max3_f32 v172, v172, v140, v141
v_max3_f32 v172, v172, v142, v143
v_max3_f32 v180, v180, v148, v149
v_max3_f32 v180, v180, v150, v151
v_max3_f32 v188, v188, v156, v157
v_max3_f32 v188, v188, v158, v159
ds_read_b128 a[216:219], v236 offset:6144
ds_read_b128 a[220:223], v237 offset:6144
ds_read_b128 a[224:227], v236 offset:6272
ds_read_b128 a[228:231], v237 offset:6272
ds_read_b128 a[232:235], v236 offset:6400
ds_read_b128 a[236:239], v237 offset:6400
s_waitcnt lgkmcnt(0)
mz v,132,a,216,v,0
mm v,132,a,220,v,8,132
mm v,132,a,224,v,16,132
mm v,132,a,228,v,24,132
mm v,132,a,232,v,32,132
mm v,132,a,236,v,40,132
mz v,140,a,216,v,48
mm v,140,a,220,v,56,140
mm v,140,a,224,v,64,140
mm v,140,a,228,v,72,140
mm v,140,a,232,v,80,140
mm v,140,a,236,v,88,140
mz v,148,a,216,v,96
mm v,148,a,220,v,104,148
mm v,148,a,224,v,112,148
mm v,148,a,228,v,120,148
mm v,148,a,232,v,128,148
mm v,148,a,236,v,136,148
mz v,156,a,216,v,144
mm v,156,a,220,v,152,156
mm v,156,a,224,v,160,156
mm v,156,a,228,v,168,156
mm v,156,a,232,v,176,156
mm v,156,a,236,v,184,156
s_nop 7
v_max3_f32 v164, v164, v132, v133
v_max3_f32 v164, v164, v134, v135
v_max3_f32 v172, v172, v140, v141
v_max3_f32 v172, v172, v142, v143
v_max3_f32 v180, v180, v148, v149
v_max3_f32 v180, v180, v150, v151
v_max3_f32 v188, v188, v156, v157
v_max3_f32 v188, v188, v158, v159
ds_read_b128 a[192:195], v236 offset:12288
ds_read_b128 a[196:199], v237 offset:12288
ds_read_b128 a[200:203], v236 offset:12416
ds_read_b128 a[204:207], v237 offset:12416
ds_read_b128 a[208:211], v236 offset:12544
ds_read_b128 a[212:215], v237 offset:12544
s_waitcnt lgkmcnt(0)
mz v,132,a,192,v,0
mm v,132,a,196,v,8,132
mm v,132,a,200,v,16,132
mm v,132,a,204,v,24,132
mm v,132,a,208,v,32,132
mm v,132,a,212,v,40,132
mz v,140,a,192,v,48
mm v,140,a,196,v,56,140
mm v,140,a,200,v,64,140
mm v,140,a,204,v,72,140
mm v,140,a,208,v,80,140
mm v,140,a,212,v,88,140
mz v,148,a,192,v,96
mm v,148,a,196,v,104,148
mm v,148,a,200,v,112,148
mm v,148,a,204,v,120,148
mm v,148,a,208,v,128,148
mm v,148,a,212,v,136,148
mz v,156,a,192,v,144
mm v,156,a,196,v,152,156
mm v,156,a,200,v,160,156
mm v,156,a,204,v,168,156
mm v,156,a,208,v,176,156
mm v,156,a,212,v,184,156
s_nop 7
v_max3_f32 v164, v164, v132, v133
v_max3_f32 v164, v164, v134, v135
v_max3_f32 v172, v172, v140, v141
v_max3_f32 v172, v172, v142, v143
v_max3_f32 v180, v180, v148, v149
v_max3_f32 v180, v180, v150, v151
v_max3_f32 v188, v188, v156, v157
v_max3_f32 v188, v188, v158, v159
ds_read_b128 a[216:219], v236 offset:18432
ds_read_b128 a[220:223], v237 offset:18432
ds_read_b128 a[224:227], v236 offset:18560
ds_read_b128 a[228:231], v237 offset:18560
ds_read_b128 a[232:235], v236 offset:18688
ds_read_b128 a[236:239], v237 offset:18688
s_waitcnt lgkmcnt(0)
mz v,132,a,216,v,0
mm v,132,a,220,v,8,132
mm v,132,a,224,v,16,132
mm v,132,a,228,v,24,132
mm v,132,a,232,v,32,132
mm v,132,a,236,v,40,132
mz v,140,a,216,v,48
mm v,140,a,220,v,56,140
mm v,140,a,224,v,64,140
mm v,140,a,228,v,72,140
mm v,140,a,232,v,80,140
mm v,140,a,236,v,88,140
mz v,148,a,216,v,96
mm v,148,a,220,v,104,148
mm v,148,a,224,v,112,148
mm v,148,a,228,v,120,148
mm v,148,a,232,v,128,148
mm v,148,a,236,v,136,148
mz v,156,a,216,v,144
mm v,156,a,220,v,152,156
mm v,156,a,224,v,160,156
mm v,156,a,228,v,168,156
mm v,156,a,232,v,176,156
mm v,156,a,236,v,184,156
s_nop 7
v_max3_f32 v164, v164, v132, v133
v_max3_f32 v164, v164, v134, v135
v_max3_f32 v172, v172, v140, v141
v_max3_f32 v172, v172, v142, v143
v_max3_f32 v180, v180, v148, v149
v_max3_f32 v180, v180, v150, v151
v_max3_f32 v188, v188, v156, v157
v_max3_f32 v188, v188, v158, v159
s_barrier
s_sub_u32 s35, s35, 1
s_cmp_lg_u32 s35, 0
s_cbranch_scc1 L_slowl_4
s_waitcnt vmcnt(0)
s_waitcnt vmcnt(0)
s_barrier
ds_read_b128 a[192:195], v236
ds_read_b128 a[196:199], v237
ds_read_b128 a[200:203], v236 offset:128
ds_read_b128 a[204:207], v237 offset:128
ds_read_b128 a[208:211], v236 offset:256
ds_read_b128 a[212:215], v237 offset:256
s_waitcnt lgkmcnt(0)
s_branch L_prol_4
L_idle_4:
v_accvgpr_read_b32 v216, a44
v_accvgpr_read_b32 v217, a45
v_accvgpr_read_b32 v218, a46
v_accvgpr_read_b32 v219, a47
v_accvgpr_read_b32 v220, a60
v_accvgpr_read_b32 v221, a61
v_accvgpr_read_b32 v222, a62
v_accvgpr_read_b32 v223, a63
v_mul_f32_e64 v236, -v248, v232
v_mul_f32_e64 v237, -v248, v233
v_mul_f32_e64 v238, -v248, v234
v_mul_f32_e64 v239, -v248, v235
v_fma_f32 v216, v216, v232, v236
v_fma_f32 v217, v217, v233, v237
v_fma_f32 v218, v218, v234, v238
v_fma_f32 v219, v219, v235, v239
v_fma_f32 v220, v220, v232, v236
v_fma_f32 v221, v221, v233, v237
v_fma_f32 v222, v222, v234, v238
v_fma_f32 v223, v223, v235, v239
v_cvt_pk_bf16_f32 v216, v216, v217
v_cvt_pk_bf16_f32 v217, v218, v219
v_cvt_pk_bf16_f32 v218, v220, v221
v_cvt_pk_bf16_f32 v219, v222, v223
s_nop 1
mz v,224,v,216,a,26
mz v,228,v,216,a,24
v_accvgpr_read_b32 v216, a76
v_accvgpr_read_b32 v217, a77
v_accvgpr_read_b32 v218, a78
v_accvgpr_read_b32 v219, a79
v_accvgpr_read_b32 v220, a92
v_accvgpr_read_b32 v221, a93
v_accvgpr_read_b32 v222, a94
v_accvgpr_read_b32 v223, a95
v_cvt_pk_bf16_f32 v224, v224, v225
v_cvt_pk_bf16_f32 v225, v226, v227
v_cvt_pk_bf16_f32 v226, v228, v229
v_cvt_pk_bf16_f32 v227, v230, v231
s_add_u32 s50, s46, 18432
buffer_store_dwordx4 v[224:227], v253, s[20:23], s50 offen offset:1024
v_fma_f32 v216, v216, v232, v236
v_fma_f32 v217, v217, v233, v237
v_fma_f32 v218, v218, v234, v238
v_fma_f32 v219, v219, v235, v239
v_fma_f32 v220, v220, v232, v236
v_fma_f32 v221, v221, v233, v237
v_fma_f32 v222, v222, v234, v238
v_fma_f32 v223, v223, v235, v239
v_cvt_pk_bf16_f32 v216, v216, v217
v_cvt_pk_bf16_f32 v217, v218, v219
v_cvt_pk_bf16_f32 v218, v220, v221
v_cvt_pk_bf16_f32 v219, v222, v223
s_nop 1
mz v,224,v,216,a,26
mz v,228,v,216,a,24
v_accvgpr_read_b32 v216, a108
v_accvgpr_read_b32 v217, a109
v_accvgpr_read_b32 v218, a110
v_accvgpr_read_b32 v219, a111
v_accvgpr_read_b32 v220, a124
v_accvgpr_read_b32 v221, a125
v_accvgpr_read_b32 v222, a126
v_accvgpr_read_b32 v223, a127
v_cvt_pk_bf16_f32 v224, v224, v225
v_cvt_pk_bf16_f32 v225, v226, v227
v_cvt_pk_bf16_f32 v226, v228, v229
v_cvt_pk_bf16_f32 v227, v230, v231
s_add_u32 s50, s46, 18432
buffer_store_dwordx4 v[224:227], v253, s[20:23], s50 offen offset:2048
v_fma_f32 v216, v216, v232, v236
v_fma_f32 v217, v217, v233, v237
v_fma_f32 v218, v218, v234, v238
v_fma_f32 v219, v219, v235, v239
v_fma_f32 v220, v220, v232, v236
v_fma_f32 v221, v221, v233, v237
v_fma_f32 v222, v222, v234, v238
v_fma_f32 v223, v223, v235, v239
v_cvt_pk_bf16_f32 v216, v216, v217
v_cvt_pk_bf16_f32 v217, v218, v219
v_cvt_pk_bf16_f32 v218, v220, v221
v_cvt_pk_bf16_f32 v219, v222, v223
s_nop 1
mz v,224,v,216,a,26
mz v,228,v,216,a,24
v_accvgpr_read_b32 v216, a140
v_accvgpr_read_b32 v217, a141
v_accvgpr_read_b32 v218, a142
v_accvgpr_read_b32 v219, a143
v_accvgpr_read_b32 v220, a156
v_accvgpr_read_b32 v221, a157
v_accvgpr_read_b32 v222, a158
v_accvgpr_read_b32 v223, a159
v_cvt_pk_bf16_f32 v224, v224, v225
v_cvt_pk_bf16_f32 v225, v226, v227
v_cvt_pk_bf16_f32 v226, v228, v229
v_cvt_pk_bf16_f32 v227, v230, v231
s_add_u32 s50, s46, 18432
buffer_store_dwordx4 v[224:227], v253, s[20:23], s50 offen offset:3072
v_fma_f32 v216, v216, v232, v236
v_fma_f32 v217, v217, v233, v237
v_fma_f32 v218, v218, v234, v238
v_fma_f32 v219, v219, v235, v239
v_fma_f32 v220, v220, v232, v236
v_fma_f32 v221, v221, v233, v237
v_fma_f32 v222, v222, v234, v238
v_fma_f32 v223, v223, v235, v239
v_cvt_pk_bf16_f32 v216, v216, v217
v_cvt_pk_bf16_f32 v217, v218, v219
v_cvt_pk_bf16_f32 v218, v220, v221
v_cvt_pk_bf16_f32 v219, v222, v223
s_nop 1
mz v,224,v,216,a,26
mz v,228,v,216,a,24
v_accvgpr_read_b32 v216, a172
v_accvgpr_read_b32 v217, a173
v_accvgpr_read_b32 v218, a174
v_accvgpr_read_b32 v219, a175
v_accvgpr_read_b32 v220, a188
v_accvgpr_read_b32 v221, a189
v_accvgpr_read_b32 v222, a190
v_accvgpr_read_b32 v223, a191
v_cvt_pk_bf16_f32 v224, v224, v225
v_cvt_pk_bf16_f32 v225, v226, v227
v_cvt_pk_bf16_f32 v226, v228, v229
v_cvt_pk_bf16_f32 v227, v230, v231
s_add_u32 s50, s46, 22528
buffer_store_dwordx4 v[224:227], v253, s[20:23], s50 offen
v_fma_f32 v216, v216, v232, v236
v_fma_f32 v217, v217, v233, v237
v_fma_f32 v218, v218, v234, v238
v_fma_f32 v219, v219, v235, v239
v_fma_f32 v220, v220, v232, v236
v_fma_f32 v221, v221, v233, v237
v_fma_f32 v222, v222, v234, v238
v_fma_f32 v223, v223, v235, v239
v_cvt_pk_bf16_f32 v216, v216, v217
v_cvt_pk_bf16_f32 v217, v218, v219
v_cvt_pk_bf16_f32 v218, v220, v221
v_cvt_pk_bf16_f32 v219, v222, v223
s_nop 1
mz v,224,v,216,a,26
mz v,228,v,216,a,24
ds_read_b128 v[232:235], v246 offset:128
v_accvgpr_read_b32 v216, a40
v_accvgpr_read_b32 v217, a41
v_accvgpr_read_b32 v218, a42
v_accvgpr_read_b32 v219, a43
v_accvgpr_read_b32 v220, a56
v_accvgpr_read_b32 v221, a57
v_accvgpr_read_b32 v222, a58
v_accvgpr_read_b32 v223, a59
v_cvt_pk_bf16_f32 v224, v224, v225
v_cvt_pk_bf16_f32 v225, v226, v227
v_cvt_pk_bf16_f32 v226, v228, v229
v_cvt_pk_bf16_f32 v227, v230, v231
s_add_u32 s50, s46, 22528
buffer_store_dwordx4 v[224:227], v253, s[20:23], s50 offen offset:1024
s_waitcnt lgkmcnt(0)
v_mul_f32_e64 v236, -v248, v232
v_mul_f32_e64 v237, -v248, v233
v_mul_f32_e64 v238, -v248, v234
v_mul_f32_e64 v239, -v248, v235
v_fma_f32 v216, v216, v232, v236
v_fma_f32 v217, v217, v233, v237
v_fma_f32 v218, v218, v234, v238
v_fma_f32 v219, v219, v235, v239
v_fma_f32 v220, v220, v232, v236
v_fma_f32 v221, v221, v233, v237
v_fma_f32 v222, v222, v234, v238
v_fma_f32 v223, v223, v235, v239
v_cvt_pk_bf16_f32 v216, v216, v217
v_cvt_pk_bf16_f32 v217, v218, v219
v_cvt_pk_bf16_f32 v218, v220, v221
v_cvt_pk_bf16_f32 v219, v222, v223
s_nop 1
mz v,224,v,216,a,26
mz v,228,v,216,a,24
v_accvgpr_read_b32 v216, a72
v_accvgpr_read_b32 v217, a73
v_accvgpr_read_b32 v218, a74
v_accvgpr_read_b32 v219, a75
v_accvgpr_read_b32 v220, a88
v_accvgpr_read_b32 v221, a89
v_accvgpr_read_b32 v222, a90
v_accvgpr_read_b32 v223, a91
v_cvt_pk_bf16_f32 v224, v224, v225
v_cvt_pk_bf16_f32 v225, v226, v227
v_cvt_pk_bf16_f32 v226, v228, v229
v_cvt_pk_bf16_f32 v227, v230, v231
s_add_u32 s50, s46, 12288
buffer_store_dwordx4 v[224:227], v253, s[20:23], s50 offen offset:1024
v_fma_f32 v216, v216, v232, v236
v_fma_f32 v217, v217, v233, v237
v_fma_f32 v218, v218, v234, v238
v_fma_f32 v219, v219, v235, v239
v_fma_f32 v220, v220, v232, v236
v_fma_f32 v221, v221, v233, v237
v_fma_f32 v222, v222, v234, v238
v_fma_f32 v223, v223, v235, v239
v_cvt_pk_bf16_f32 v216, v216, v217
v_cvt_pk_bf16_f32 v217, v218, v219
v_cvt_pk_bf16_f32 v218, v220, v221
v_cvt_pk_bf16_f32 v219, v222, v223
s_nop 1
mz v,224,v,216,a,26
mz v,228,v,216,a,24
v_accvgpr_read_b32 v216, a104
v_accvgpr_read_b32 v217, a105
v_accvgpr_read_b32 v218, a106
v_accvgpr_read_b32 v219, a107
v_accvgpr_read_b32 v220, a120
v_accvgpr_read_b32 v221, a121
v_accvgpr_read_b32 v222, a122
v_accvgpr_read_b32 v223, a123
v_cvt_pk_bf16_f32 v224, v224, v225
v_cvt_pk_bf16_f32 v225, v226, v227
v_cvt_pk_bf16_f32 v226, v228, v229
v_cvt_pk_bf16_f32 v227, v230, v231
s_add_u32 s50, s46, 12288
buffer_store_dwordx4 v[224:227], v253, s[20:23], s50 offen offset:2048
v_fma_f32 v216, v216, v232, v236
v_fma_f32 v217, v217, v233, v237
v_fma_f32 v218, v218, v234, v238
v_fma_f32 v219, v219, v235, v239
v_fma_f32 v220, v220, v232, v236
v_fma_f32 v221, v221, v233, v237
v_fma_f32 v222, v222, v234, v238
v_fma_f32 v223, v223, v235, v239
v_cvt_pk_bf16_f32 v216, v216, v217
v_cvt_pk_bf16_f32 v217, v218, v219
v_cvt_pk_bf16_f32 v218, v220, v221
v_cvt_pk_bf16_f32 v219, v222, v223
s_nop 1
mz v,224,v,216,a,26
mz v,228,v,216,a,24
v_accvgpr_read_b32 v216, a136
v_accvgpr_read_b32 v217, a137
v_accvgpr_read_b32 v218, a138
v_accvgpr_read_b32 v219, a139
v_accvgpr_read_b32 v220, a152
v_accvgpr_read_b32 v221, a153
v_accvgpr_read_b32 v222, a154
v_accvgpr_read_b32 v223, a155
v_cvt_pk_bf16_f32 v224, v224, v225
v_cvt_pk_bf16_f32 v225, v226, v227
v_cvt_pk_bf16_f32 v226, v228, v229
v_cvt_pk_bf16_f32 v227, v230, v231
s_add_u32 s50, s46, 12288
buffer_store_dwordx4 v[224:227], v253, s[20:23], s50 offen offset:3072
v_fma_f32 v216, v216, v232, v236
v_fma_f32 v217, v217, v233, v237
v_fma_f32 v218, v218, v234, v238
v_fma_f32 v219, v219, v235, v239
v_fma_f32 v220, v220, v232, v236
v_fma_f32 v221, v221, v233, v237
v_fma_f32 v222, v222, v234, v238
v_fma_f32 v223, v223, v235, v239
v_cvt_pk_bf16_f32 v216, v216, v217
v_cvt_pk_bf16_f32 v217, v218, v219
v_cvt_pk_bf16_f32 v218, v220, v221
v_cvt_pk_bf16_f32 v219, v222, v223
s_nop 1
mz v,224,v,216,a,26
mz v,228,v,216,a,24
v_accvgpr_read_b32 v216, a168
v_accvgpr_read_b32 v217, a169
v_accvgpr_read_b32 v218, a170
v_accvgpr_read_b32 v219, a171
v_accvgpr_read_b32 v220, a184
v_accvgpr_read_b32 v221, a185
v_accvgpr_read_b32 v222, a186
v_accvgpr_read_b32 v223, a187
v_cvt_pk_bf16_f32 v224, v224, v225
v_cvt_pk_bf16_f32 v225, v226, v227
v_cvt_pk_bf16_f32 v226, v228, v229
v_cvt_pk_bf16_f32 v227, v230, v231
s_add_u32 s50, s46, 16384
buffer_store_dwordx4 v[224:227], v253, s[20:23], s50 offen
v_fma_f32 v216, v216, v232, v236
v_fma_f32 v217, v217, v233, v237
v_fma_f32 v218, v218, v234, v238
v_fma_f32 v219, v219, v235, v239
v_fma_f32 v220, v220, v232, v236
v_fma_f32 v221, v221, v233, v237
v_fma_f32 v222, v222, v234, v238
v_fma_f32 v223, v223, v235, v239
v_cvt_pk_bf16_f32 v216, v216, v217
v_cvt_pk_bf16_f32 v217, v218, v219
v_cvt_pk_bf16_f32 v218, v220, v221
v_cvt_pk_bf16_f32 v219, v222, v223
s_nop 1
mz v,224,v,216,a,26
mz v,228,v,216,a,24
ds_read_b128 v[232:235], v246 offset:64
v_accvgpr_read_b32 v216, a36
v_accvgpr_read_b32 v217, a37
v_accvgpr_read_b32 v218, a38
v_accvgpr_read_b32 v219, a39
v_accvgpr_read_b32 v220, a52
v_accvgpr_read_b32 v221, a53
v_accvgpr_read_b32 v222, a54
v_accvgpr_read_b32 v223, a55
v_cvt_pk_bf16_f32 v224, v224, v225
v_cvt_pk_bf16_f32 v225, v226, v227
v_cvt_pk_bf16_f32 v226, v228, v229
v_cvt_pk_bf16_f32 v227, v230, v231
s_add_u32 s50, s46, 16384
buffer_store_dwordx4 v[224:227], v253, s[20:23], s50 offen offset:1024
s_waitcnt lgkmcnt(0)
v_mul_f32_e64 v236, -v248, v232
v_mul_f32_e64 v237, -v248, v233
v_mul_f32_e64 v238, -v248, v234
v_mul_f32_e64 v239, -v248, v235
v_fma_f32 v216, v216, v232, v236
v_fma_f32 v217, v217, v233, v237
v_fma_f32 v218, v218, v234, v238
v_fma_f32 v219, v219, v235, v239
v_fma_f32 v220, v220, v232, v236
v_fma_f32 v221, v221, v233, v237
v_fma_f32 v222, v222, v234, v238
v_fma_f32 v223, v223, v235, v239
v_cvt_pk_bf16_f32 v216, v216, v217
v_cvt_pk_bf16_f32 v217, v218, v219
v_cvt_pk_bf16_f32 v218, v220, v221
v_cvt_pk_bf16_f32 v219, v222, v223
s_nop 1
mz v,224,v,216,a,26
mz v,228,v,216,a,24
v_accvgpr_read_b32 v216, a68
v_accvgpr_read_b32 v217, a69
v_accvgpr_read_b32 v218, a70
v_accvgpr_read_b32 v219, a71
v_accvgpr_read_b32 v220, a84
v_accvgpr_read_b32 v221, a85
v_accvgpr_read_b32 v222, a86
v_accvgpr_read_b32 v223, a87
v_cvt_pk_bf16_f32 v224, v224, v225
v_cvt_pk_bf16_f32 v225, v226, v227
v_cvt_pk_bf16_f32 v226, v228, v229
v_cvt_pk_bf16_f32 v227, v230, v231
s_add_u32 s50, s46, 6144
buffer_store_dwordx4 v[224:227], v253, s[20:23], s50 offen offset:1024
v_fma_f32 v216, v216, v232, v236
v_fma_f32 v217, v217, v233, v237
v_fma_f32 v218, v218, v234, v238
v_fma_f32 v219, v219, v235, v239
v_fma_f32 v220, v220, v232, v236
v_fma_f32 v221, v221, v233, v237
v_fma_f32 v222, v222, v234, v238
v_fma_f32 v223, v223, v235, v239
v_cvt_pk_bf16_f32 v216, v216, v217
v_cvt_pk_bf16_f32 v217, v218, v219
v_cvt_pk_bf16_f32 v218, v220, v221
v_cvt_pk_bf16_f32 v219, v222, v223
s_nop 1
mz v,224,v,216,a,26
mz v,228,v,216,a,24
v_accvgpr_read_b32 v216, a100
v_accvgpr_read_b32 v217, a101
v_accvgpr_read_b32 v218, a102
v_accvgpr_read_b32 v219, a103
v_accvgpr_read_b32 v220, a116
v_accvgpr_read_b32 v221, a117
v_accvgpr_read_b32 v222, a118
v_accvgpr_read_b32 v223, a119
v_cvt_pk_bf16_f32 v224, v224, v225
v_cvt_pk_bf16_f32 v225, v226, v227
v_cvt_pk_bf16_f32 v226, v228, v229
v_cvt_pk_bf16_f32 v227, v230, v231
s_add_u32 s50, s46, 6144
buffer_store_dwordx4 v[224:227], v253, s[20:23], s50 offen offset:2048
v_fma_f32 v216, v216, v232, v236
v_fma_f32 v217, v217, v233, v237
v_fma_f32 v218, v218, v234, v238
v_fma_f32 v219, v219, v235, v239
v_fma_f32 v220, v220, v232, v236
v_fma_f32 v221, v221, v233, v237
v_fma_f32 v222, v222, v234, v238
v_fma_f32 v223, v223, v235, v239
v_cvt_pk_bf16_f32 v216, v216, v217
v_cvt_pk_bf16_f32 v217, v218, v219
v_cvt_pk_bf16_f32 v218, v220, v221
v_cvt_pk_bf16_f32 v219, v222, v223
s_nop 1
mz v,224,v,216,a,26
mz v,228,v,216,a,24
v_accvgpr_read_b32 v216, a132
v_accvgpr_read_b32 v217, a133
v_accvgpr_read_b32 v218, a134
v_accvgpr_read_b32 v219, a135
v_accvgpr_read_b32 v220, a148
v_accvgpr_read_b32 v221, a149
v_accvgpr_read_b32 v222, a150
v_accvgpr_read_b32 v223, a151
v_cvt_pk_bf16_f32 v224, v224, v225
v_cvt_pk_bf16_f32 v225, v226, v227
v_cvt_pk_bf16_f32 v226, v228, v229
v_cvt_pk_bf16_f32 v227, v230, v231
s_add_u32 s50, s46, 6144
buffer_store_dwordx4 v[224:227], v253, s[20:23], s50 offen offset:3072
v_fma_f32 v216, v216, v232, v236
v_fma_f32 v217, v217, v233, v237
v_fma_f32 v218, v218, v234, v238
v_fma_f32 v219, v219, v235, v239
v_fma_f32 v220, v220, v232, v236
v_fma_f32 v221, v221, v233, v237
v_fma_f32 v222, v222, v234, v238
v_fma_f32 v223, v223, v235, v239
v_cvt_pk_bf16_f32 v216, v216, v217
v_cvt_pk_bf16_f32 v217, v218, v219
v_cvt_pk_bf16_f32 v218, v220, v221
v_cvt_pk_bf16_f32 v219, v222, v223
s_nop 1
mz v,224,v,216,a,26
mz v,228,v,216,a,24
v_accvgpr_read_b32 v216, a164
v_accvgpr_read_b32 v217, a165
v_accvgpr_read_b32 v218, a166
v_accvgpr_read_b32 v219, a167
v_accvgpr_read_b32 v220, a180
v_accvgpr_read_b32 v221, a181
v_accvgpr_read_b32 v222, a182
v_accvgpr_read_b32 v223, a183
v_cvt_pk_bf16_f32 v224, v224, v225
v_cvt_pk_bf16_f32 v225, v226, v227
v_cvt_pk_bf16_f32 v226, v228, v229
v_cvt_pk_bf16_f32 v227, v230, v231
s_add_u32 s50, s46, 10240
buffer_store_dwordx4 v[224:227], v253, s[20:23], s50 offen
v_fma_f32 v216, v216, v232, v236
v_fma_f32 v217, v217, v233, v237
v_fma_f32 v218, v218, v234, v238
v_fma_f32 v219, v219, v235, v239
v_fma_f32 v220, v220, v232, v236
v_fma_f32 v221, v221, v233, v237
v_fma_f32 v222, v222, v234, v238
v_fma_f32 v223, v223, v235, v239
v_cvt_pk_bf16_f32 v216, v216, v217
v_cvt_pk_bf16_f32 v217, v218, v219
v_cvt_pk_bf16_f32 v218, v220, v221
v_cvt_pk_bf16_f32 v219, v222, v223
s_nop 1
mz v,224,v,216,a,26
mz v,228,v,216,a,24
ds_read_b128 v[232:235], v246
v_accvgpr_read_b32 v216, a32
v_accvgpr_read_b32 v217, a33
v_accvgpr_read_b32 v218, a34
v_accvgpr_read_b32 v219, a35
v_accvgpr_read_b32 v220, a48
v_accvgpr_read_b32 v221, a49
v_accvgpr_read_b32 v222, a50
v_accvgpr_read_b32 v223, a51
v_cvt_pk_bf16_f32 v224, v224, v225
v_cvt_pk_bf16_f32 v225, v226, v227
v_cvt_pk_bf16_f32 v226, v228, v229
v_cvt_pk_bf16_f32 v227, v230, v231
s_add_u32 s50, s46, 10240
buffer_store_dwordx4 v[224:227], v253, s[20:23], s50 offen offset:1024
s_waitcnt lgkmcnt(0)
v_mul_f32_e64 v236, -v248, v232
v_mul_f32_e64 v237, -v248, v233
v_mul_f32_e64 v238, -v248, v234
v_mul_f32_e64 v239, -v248, v235
v_fma_f32 v216, v216, v232, v236
v_fma_f32 v217, v217, v233, v237
v_fma_f32 v218, v218, v234, v238
v_fma_f32 v219, v219, v235, v239
v_fma_f32 v220, v220, v232, v236
v_fma_f32 v221, v221, v233, v237
v_fma_f32 v222, v222, v234, v238
v_fma_f32 v223, v223, v235, v239
v_cvt_pk_bf16_f32 v216, v216, v217
v_cvt_pk_bf16_f32 v217, v218, v219
v_cvt_pk_bf16_f32 v218, v220, v221
v_cvt_pk_bf16_f32 v219, v222, v223
s_nop 1
mz v,224,v,216,a,26
mz v,228,v,216,a,24
v_accvgpr_read_b32 v216, a64
v_accvgpr_read_b32 v217, a65
v_accvgpr_read_b32 v218, a66
v_accvgpr_read_b32 v219, a67
v_accvgpr_read_b32 v220, a80
v_accvgpr_read_b32 v221, a81
v_accvgpr_read_b32 v222, a82
v_accvgpr_read_b32 v223, a83
v_cvt_pk_bf16_f32 v224, v224, v225
v_cvt_pk_bf16_f32 v225, v226, v227
v_cvt_pk_bf16_f32 v226, v228, v229
v_cvt_pk_bf16_f32 v227, v230, v231
s_add_u32 s50, s46, 0
buffer_store_dwordx4 v[224:227], v253, s[20:23], s50 offen offset:1024
v_fma_f32 v216, v216, v232, v236
v_fma_f32 v217, v217, v233, v237
v_fma_f32 v218, v218, v234, v238
v_fma_f32 v219, v219, v235, v239
v_fma_f32 v220, v220, v232, v236
v_fma_f32 v221, v221, v233, v237
v_fma_f32 v222, v222, v234, v238
v_fma_f32 v223, v223, v235, v239
v_cvt_pk_bf16_f32 v216, v216, v217
v_cvt_pk_bf16_f32 v217, v218, v219
v_cvt_pk_bf16_f32 v218, v220, v221
v_cvt_pk_bf16_f32 v219, v222, v223
s_nop 1
mz v,224,v,216,a,26
mz v,228,v,216,a,24
v_accvgpr_read_b32 v216, a96
v_accvgpr_read_b32 v217, a97
v_accvgpr_read_b32 v218, a98
v_accvgpr_read_b32 v219, a99
v_accvgpr_read_b32 v220, a112
v_accvgpr_read_b32 v221, a113
v_accvgpr_read_b32 v222, a114
v_accvgpr_read_b32 v223, a115
v_cvt_pk_bf16_f32 v224, v224, v225
v_cvt_pk_bf16_f32 v225, v226, v227
v_cvt_pk_bf16_f32 v226, v228, v229
v_cvt_pk_bf16_f32 v227, v230, v231
s_add_u32 s50, s46, 0
buffer_store_dwordx4 v[224:227], v253, s[20:23], s50 offen offset:2048
v_fma_f32 v216, v216, v232, v236
v_fma_f32 v217, v217, v233, v237
v_fma_f32 v218, v218, v234, v238
v_fma_f32 v219, v219, v235, v239
v_fma_f32 v220, v220, v232, v236
v_fma_f32 v221, v221, v233, v237
v_fma_f32 v222, v222, v234, v238
v_fma_f32 v223, v223, v235, v239
v_cvt_pk_bf16_f32 v216, v216, v217
v_cvt_pk_bf16_f32 v217, v218, v219
v_cvt_pk_bf16_f32 v218, v220, v221
v_cvt_pk_bf16_f32 v219, v222, v223
s_nop 1
mz v,224,v,216,a,26
mz v,228,v,216,a,24
v_accvgpr_read_b32 v216, a128
v_accvgpr_read_b32 v217, a129
v_accvgpr_read_b32 v218, a130
v_accvgpr_read_b32 v219, a131
v_accvgpr_read_b32 v220, a144
v_accvgpr_read_b32 v221, a145
v_accvgpr_read_b32 v222, a146
v_accvgpr_read_b32 v223, a147
v_cvt_pk_bf16_f32 v224, v224, v225
v_cvt_pk_bf16_f32 v225, v226, v227
v_cvt_pk_bf16_f32 v226, v228, v229
v_cvt_pk_bf16_f32 v227, v230, v231
s_add_u32 s50, s46, 0
buffer_store_dwordx4 v[224:227], v253, s[20:23], s50 offen offset:3072
v_fma_f32 v216, v216, v232, v236
v_fma_f32 v217, v217, v233, v237
v_fma_f32 v218, v218, v234, v238
v_fma_f32 v219, v219, v235, v239
v_fma_f32 v220, v220, v232, v236
v_fma_f32 v221, v221, v233, v237
v_fma_f32 v222, v222, v234, v238
v_fma_f32 v223, v223, v235, v239
v_cvt_pk_bf16_f32 v216, v216, v217
v_cvt_pk_bf16_f32 v217, v218, v219
v_cvt_pk_bf16_f32 v218, v220, v221
v_cvt_pk_bf16_f32 v219, v222, v223
s_nop 1
mz v,224,v,216,a,26
mz v,228,v,216,a,24
v_accvgpr_read_b32 v216, a160
v_accvgpr_read_b32 v217, a161
v_accvgpr_read_b32 v218, a162
v_accvgpr_read_b32 v219, a163
v_accvgpr_read_b32 v220, a176
v_accvgpr_read_b32 v221, a177
v_accvgpr_read_b32 v222, a178
v_accvgpr_read_b32 v223, a179
v_cvt_pk_bf16_f32 v224, v224, v225
v_cvt_pk_bf16_f32 v225, v226, v227
v_cvt_pk_bf16_f32 v226, v228, v229
v_cvt_pk_bf16_f32 v227, v230, v231
s_add_u32 s50, s46, 4096
buffer_store_dwordx4 v[224:227], v253, s[20:23], s50 offen
v_fma_f32 v216, v216, v232, v236
v_fma_f32 v217, v217, v233, v237
v_fma_f32 v218, v218, v234, v238
v_fma_f32 v219, v219, v235, v239
v_fma_f32 v220, v220, v232, v236
v_fma_f32 v221, v221, v233, v237
v_fma_f32 v222, v222, v234, v238
v_fma_f32 v223, v223, v235, v239
v_cvt_pk_bf16_f32 v216, v216, v217
v_cvt_pk_bf16_f32 v217, v218, v219
v_cvt_pk_bf16_f32 v218, v220, v221
v_cvt_pk_bf16_f32 v219, v222, v223
s_nop 1
mz v,224,v,216,a,26
mz v,228,v,216,a,24
s_nop 7
v_cvt_pk_bf16_f32 v224, v224, v225
v_cvt_pk_bf16_f32 v225, v226, v227
v_cvt_pk_bf16_f32 v226, v228, v229
v_cvt_pk_bf16_f32 v227, v230, v231
s_add_u32 s50, s46, 4096
buffer_store_dwordx4 v[224:227], v253, s[20:23], s50 offen offset:1024
s_waitcnt vmcnt(0)
s_barrier
s_endpgm
.p2align 12
L_v3:
L_pg9:
s_cbranch_execz L_pg8
s_getreg_b32 s41, hwreg(HW_REG_XCC_ID)
s_and_b32 s41, s41, 7
s_mul_i32 s42, s41, s41
s_lshl_b32 s42, s42, 8
s_add_u32 s41, s41, s42
s_lshl_b32 s41, s41, 8
s_add_u32 s40, s41, 1
v_mov_b32 v1, 0
v_lshlrev_b32 v2, 2, v0
s_mov_b64 exec, 15
buffer_store_dword v1, v2, s[68:71], s82 offen sc1
s_mov_b64 exec, -1
s_add_u32 s94, s33, 7864320
s_mul_i32 s41, s2, 5
s_lshr_b32 s42, s2, 4
s_add_u32 s41, s41, s42
s_and_b32 s41, s41, 15
s_min_u32 s92, s41, 14
s_mov_b32 s93, s92
s_mov_b32 s89, s31
s_mul_i32 s55, s92, 13
s_lshr_b32 s55, s55, 6
s_mul_i32 s55, s55, 101376
s_mul_i32 s31, s92, 6144
s_add_u32 s31, s31, s55
s_add_u32 s31, s31, s89
v_add_u32 v152, 33792, v144
v_add_u32 v153, 33792, v145
v_add_u32 v154, 33792, v146
v_add_u32 v160, 64512, v144
v_add_u32 v161, 64512, v145
v_add_u32 v162, 64512, v146
v_add_u32 v168, 98304, v144
v_add_u32 v169, 98304, v145
v_add_u32 v170, 98304, v146
s_lshr_b32 s41, s101, 3
s_lshl_b32 s41, s41, 1
s_and_b32 s42, s101, 7
s_add_u32 s41, s41, s42
s_mul_i32 s41, s41, 5
s_lshr_b32 s41, s41, 2
s_cmp_ge_u32 s41, 10
s_cselect_b32 s42, 10, 0
s_sub_u32 s41, s41, s42
s_mul_i32 s0, s41, 786432
s_lshl_b32 s1, s41, 7
s_mov_b32 s32, s31
s_mov_b32 s90, s33
s_add_u32 s33, s33, 1572864
s_waitcnt vmcnt(12)
s_barrier
tr 192,242,0
tr 194,242,3072
tr 196,242,6144
tr 198,242,9216
ds_read_b128 v[224:227], v244
ds_read_b128 v[228:231], v245
ds_read_b128 a[192:195], v244
ds_read_b128 a[196:199], v245
ds_read_b128 a[200:203], v244 offset:2048
ds_read_b128 a[204:207], v245 offset:2048
ds_read_b128 a[208:211], v244 offset:4096
ds_read_b128 a[212:215], v245 offset:4096
tr 200,242,8
tr 202,242,3080
tr 204,242,6152
tr 206,242,9224
s_waitcnt lgkmcnt(10)
v_max3_f32 v216, |v224|, |v225|, |v226|
v_max3_f32 v216, v216, |v227|, |v228|
v_max3_f32 v216, v216, |v229|, |v230|
v_max3_f32 v216, v216, |v231|, |v231|
v_max3_f32 v247, |v192|, |v193|, |v194|
v_max3_f32 v247, v247, |v195|, |v196|
v_max3_f32 v247, v247, |v197|, |v198|
v_max3_f32 v247, v247, |v199|, |v199|
v_mul_f32 v247, v247, v216
v_and_b32 v247, 0x7f800000, v247
v_mul_f32 v247, 0x43c00000, v247
v_min_f32 v247, 0x71800000, v247
s_nop 0
v_readlane_b32 s57, v247, 0
v_readlane_b32 s58, v247, 21
v_readlane_b32 s59, v247, 42
s_nop 3
s_min_u32 s57, s57, s58
s_min_u32 s57, s57, s59
v_mov_b32 v247, s57
v_mov_b32 v140, v247
v_mov_b32 v141, v247
v_mov_b32 v142, v247
v_mov_b32 v143, v247
s_nop 1
s_waitcnt lgkmcnt(9)
mm v,0,v,192,a,192,140
tr 208,243,0
s_waitcnt lgkmcnt(9)
mm v,0,v,196,a,196,0
tr 210,243,3072
s_waitcnt lgkmcnt(9)
mm v,48,v,192,a,200,140
tr 212,243,6144
s_waitcnt lgkmcnt(9)
mm v,48,v,196,a,204,48
tr 214,243,9216
s_waitcnt lgkmcnt(9)
mm v,96,v,192,a,208,140
s_waitcnt lgkmcnt(8)
mm v,96,v,196,a,212,96
s_waitcnt lgkmcnt(4)
mm v,4,v,200,a,192,140
tr 192,243,8
s_add_u32 m0, s44, 0
mm v,4,v,204,a,196,4
tr 194,243,3080
s_add_u32 s51, s34, 0
mm v,52,v,200,a,200,140
tr 196,243,6152
buffer_load_dwordx4 v252, s[4:7], s51 offen lds
mm v,52,v,204,a,204,52
tr 198,243,9224
mm v,100,v,200,a,208,140
s_add_u32 s51, s34, 9216
s_waitcnt lgkmcnt(4)
mm v,100,v,204,a,212,100
buffer_load_dwordx4 v252, s[4:7], s51 offen offset:1024 lds
mm v,8,v,208,a,192,140
tr 200,242,128
s_add_u32 s51, s34, 18432
mm v,8,v,212,a,196,8
tr 202,242,3200
buffer_load_dwordx4 v252, s[4:7], s51 offen offset:2048 lds
mm v,56,v,208,a,200,140
tr 204,242,6272
s_add_u32 s51, s34, 27648
mm v,56,v,212,a,204,56
tr 206,242,9344
s_waitcnt lgkmcnt(4)
mm v,104,v,208,a,208,140
buffer_load_dwordx4 v252, s[4:7], s51 offen offset:3072 lds
mm v,104,v,212,a,212,104
s_add_u32 m0, s44, 4096
s_add_u32 s51, s34, 40960
buffer_load_dwordx4 v252, s[4:7], s51 offen lds
mm v,12,v,192,a,192,140
tr 208,242,136
s_add_u32 s51, s34, 50176
mm v,12,v,196,a,196,12
tr 210,242,3208
mm v,60,v,192,a,200,140
tr 212,242,6280
mm v,60,v,196,a,204,60
tr 214,242,9352
s_waitcnt lgkmcnt(4)
mm v,108,v,192,a,208,140
buffer_load_dwordx4 v252, s[4:7], s51 offen offset:1024 lds
mm v,108,v,196,a,212,108
s_add_u32 s34, s34, 128
s_cmp_eq_u32 s34, s95
s_cselect_b32 s55, 1280, 0
mm v,16,v,200,a,192,140
tr 192,243,128
s_waitcnt vmcnt(12)
mm v,16,v,204,a,196,16
tr 194,243,3200
s_sub_u32 s34, s34, s55
mm v,64,v,200,a,200,140
tr 196,243,6272
s_add_u32 m0, s30, 9216
mm v,64,v,204,a,204,64
tr 198,243,9344
s_waitcnt lgkmcnt(4)
mm v,112,v,200,a,208,140
ds_read_b128 a[224:227], v244 offset:6144
s_add_u32 s41, s33, 442368
mm v,112,v,204,a,212,112
ds_read_b128 a[228:231], v245 offset:6144
buffer_load_dwordx4 v249, s[8:11], s41 offen lds
mm v,20,v,208,a,192,140
tr 200,243,136
buffer_load_dwordx4 v250, s[8:11], s41 offen offset:1024 lds
mm v,20,v,212,a,196,20
tr 202,243,3208
buffer_load_dwordx4 v251, s[8:11], s41 offen offset:2048 lds
mm v,68,v,208,a,200,140
tr 204,243,6280
s_add_u32 m0, s30, 12296
mm v,68,v,212,a,204,68
tr 206,243,9352
s_waitcnt lgkmcnt(6)
mm v,116,v,208,a,208,140
ds_read_b128 a[232:235], v244 offset:8192
s_add_u32 s41, s33, 98304
mm v,116,v,212,a,212,116
ds_read_b128 a[236:239], v245 offset:8192
buffer_load_dwordx4 v249, s[8:11], s41 offen lds
mm v,24,v,192,a,192,140
tr 208,242,256
buffer_load_dwordx4 v250, s[8:11], s41 offen offset:1024 lds
mm v,24,v,196,a,196,24
tr 210,242,3328
buffer_load_dwordx4 v251, s[8:11], s41 offen offset:2048 lds
mm v,72,v,192,a,200,140
tr 212,242,6400
s_add_u32 m0, s30, 15368
mm v,72,v,196,a,204,72
tr 214,242,9472
s_waitcnt lgkmcnt(6)
mm v,120,v,192,a,208,140
ds_read_b128 a[240:243], v244 offset:10240
s_add_u32 s41, s33, 147456
mm v,120,v,196,a,212,120
ds_read_b128 a[244:247], v245 offset:10240
buffer_load_dwordx4 v249, s[8:11], s41 offen lds
mm v,28,v,200,a,192,140
tr 192,242,264
buffer_load_dwordx4 v250, s[8:11], s41 offen offset:1024 lds
mm v,28,v,204,a,196,28
tr 194,242,3336
buffer_load_dwordx4 v251, s[8:11], s41 offen offset:2048 lds
mm v,76,v,200,a,200,140
tr 196,242,6408
s_add_u32 m0, s30, 18440
mm v,76,v,204,a,204,76
tr 198,242,9480
mm v,124,v,200,a,208,140
s_add_u32 s41, s33, 491520
s_waitcnt lgkmcnt(6)
mm v,124,v,204,a,212,124
buffer_load_dwordx4 v249, s[8:11], s41 offen lds
mm v,32,v,208,a,192,140
tr 200,243,256
buffer_load_dwordx4 v250, s[8:11], s41 offen offset:1024 lds
mm v,32,v,212,a,196,32
tr 202,243,3328
buffer_load_dwordx4 v251, s[8:11], s41 offen offset:2048 lds
mm v,80,v,208,a,200,140
tr 204,243,6400
s_add_u32 m0, s30, 21512
s_add_u32 s41, s33, 540672
mm v,80,v,212,a,204,80
tr 206,243,9472
s_waitcnt lgkmcnt(6)
mm v,128,v,208,a,208,140
buffer_load_dwordx4 v249, s[8:11], s41 offen lds
mm v,128,v,212,a,212,128
buffer_load_dwordx4 v250, s[8:11], s41 offen offset:1024 lds
mm v,36,v,192,a,192,140
tr 208,243,264
s_waitcnt lgkmcnt(5)
mm v,36,v,196,a,196,36
tr 210,243,3336
buffer_load_dwordx4 v251, s[8:11], s41 offen offset:2048 lds
mm v,84,v,192,a,200,140
tr 212,243,6408
s_add_u32 s33, s33, 786432
s_cmp_eq_u32 s33, s94
s_cselect_b32 s55, 7864320, 0
mm v,84,v,196,a,204,84
tr 214,243,9480
s_sub_u32 s33, s33, s55
mm v,132,v,192,a,208,140
s_sub_u32 s42, s29, s48
s_mov_b32 s48, s29
v_add_u32 v242, s42, v242
mm v,132,v,196,a,212,132
s_waitcnt lgkmcnt(6)
v_add_u32 v243, s42, v243
mm v,40,v,200,a,192,140
s_waitcnt vmcnt(21) lgkmcnt(0)
s_barrier
mm v,40,v,204,a,196,40
tr 192,242,0
s_mov_b32 s43, s28
mm v,88,v,200,a,200,140
tr 194,242,3072
s_mov_b32 s28, s29
mm v,88,v,204,a,204,88
tr 196,242,6144
s_mov_b32 s29, s30
mm v,136,v,200,a,208,140
tr 198,242,9216
mm v,136,v,204,a,212,136
s_mov_b32 s30, s43
mm v,44,v,208,a,192,140
tr 200,242,8
mm v,44,v,212,a,196,44
tr 202,242,3080
mm v,92,v,208,a,200,140
tr 204,242,6152
mm v,92,v,212,a,204,92
tr 206,242,9224
mm v,140,v,208,a,208,140
mm v,140,v,212,a,212,140
s_waitcnt lgkmcnt(4)
mm v,0,v,192,a,224,0
tr 208,243,0
s_add_u32 m0, s45, 0
mm v,0,v,196,a,228,0
tr 210,243,3072
s_add_u32 s51, s34, 0
mm v,48,v,192,a,232,48
tr 212,243,6144
buffer_load_dwordx4 v252, s[4:7], s51 offen lds
mm v,48,v,196,a,236,48
tr 214,243,9216
mm v,96,v,192,a,240,96
s_add_u32 s51, s34, 9216
s_waitcnt lgkmcnt(4)
mm v,96,v,196,a,244,96
buffer_load_dwordx4 v252, s[4:7], s51 offen offset:1024 lds
mm v,4,v,200,a,224,4
tr 192,243,8
s_add_u32 s51, s34, 18432
mm v,4,v,204,a,228,4
tr 194,243,3080
buffer_load_dwordx4 v252, s[4:7], s51 offen offset:2048 lds
mm v,52,v,200,a,232,52
tr 196,243,6152
s_add_u32 s51, s34, 27648
mm v,52,v,204,a,236,52
tr 198,243,9224
s_waitcnt lgkmcnt(4)
mm v,100,v,200,a,240,100
buffer_load_dwordx4 v252, s[4:7], s51 offen offset:3072 lds
mm v,100,v,204,a,244,100
s_add_u32 m0, s45, 4096
s_add_u32 s51, s34, 40960
buffer_load_dwordx4 v252, s[4:7], s51 offen lds
mm v,8,v,208,a,224,8
tr 200,242,128
s_add_u32 s51, s34, 50176
mm v,8,v,212,a,228,8
tr 202,242,3200
mm v,56,v,208,a,232,56
tr 204,242,6272
mm v,56,v,212,a,236,56
tr 206,242,9344
s_waitcnt lgkmcnt(4)
mm v,104,v,208,a,240,104
buffer_load_dwordx4 v252, s[4:7], s51 offen offset:1024 lds
mm v,104,v,212,a,244,104
s_add_u32 s34, s34, 128
s_cmp_eq_u32 s34, s95
s_cselect_b32 s55, 1280, 0
mm v,12,v,192,a,224,12
tr 208,242,136
s_sub_u32 s34, s34, s55
mm v,12,v,196,a,228,12
tr 210,242,3208
s_add_u32 m0, s30, 9216
mm v,60,v,192,a,232,60
tr 212,242,6280
s_add_u32 s41, s33, 442368
mm v,60,v,196,a,236,60
tr 214,242,9352
s_waitcnt lgkmcnt(4)
mm v,108,v,192,a,240,108
buffer_load_dwordx4 v249, s[8:11], s41 offen lds
mm v,108,v,196,a,244,108
buffer_load_dwordx4 v250, s[8:11], s41 offen offset:1024 lds
mm v,16,v,200,a,224,16
tr 192,243,128
s_waitcnt vmcnt(23)
mm v,16,v,204,a,228,16
tr 194,243,3200
buffer_load_dwordx4 v251, s[8:11], s41 offen offset:2048 lds
mm v,64,v,200,a,232,64
tr 196,243,6272
s_add_u32 m0, s30, 12296
mm v,64,v,204,a,236,64
tr 198,243,9344
s_waitcnt lgkmcnt(4)
mm v,112,v,200,a,240,112
ds_read_b128 a[192:195], v244
s_add_u32 s41, s33, 98304
mm v,112,v,204,a,244,112
ds_read_b128 a[196:199], v245
buffer_load_dwordx4 v249, s[8:11], s41 offen lds
mm v,20,v,208,a,224,20
tr 200,243,136
buffer_load_dwordx4 v250, s[8:11], s41 offen offset:1024 lds
mm v,20,v,212,a,228,20
tr 202,243,3208
buffer_load_dwordx4 v251, s[8:11], s41 offen offset:2048 lds
mm v,68,v,208,a,232,68
tr 204,243,6280
s_add_u32 m0, s30, 15368
mm v,68,v,212,a,236,68
tr 206,243,9352
s_waitcnt lgkmcnt(6)
mm v,116,v,208,a,240,116
ds_read_b128 a[200:203], v244 offset:2048
s_add_u32 s41, s33, 147456
mm v,116,v,212,a,244,116
ds_read_b128 a[204:207], v245 offset:2048
buffer_load_dwordx4 v249, s[8:11], s41 offen lds
mm v,24,v,192,a,224,24
tr 208,242,256
buffer_load_dwordx4 v250, s[8:11], s41 offen offset:1024 lds
mm v,24,v,196,a,228,24
tr 210,242,3328
mm v,72,v,192,a,232,72
tr 212,242,6400
mm v,72,v,196,a,236,72
tr 214,242,9472
s_waitcnt lgkmcnt(6)
mm v,120,v,192,a,240,120
ds_read_b128 a[208:211], v244 offset:4096
buffer_load_dwordx4 v251, s[8:11], s41 offen offset:2048 lds
mm v,120,v,196,a,244,120
ds_read_b128 a[212:215], v245 offset:4096
s_add_u32 m0, s30, 18440
mm v,28,v,200,a,224,28
tr 192,242,264
s_add_u32 s41, s33, 491520
mm v,28,v,204,a,228,28
tr 194,242,3336
buffer_load_dwordx4 v249, s[8:11], s41 offen lds
mm v,76,v,200,a,232,76
tr 196,242,6408
mm v,76,v,204,a,236,76
tr 198,242,9480
s_waitcnt lgkmcnt(6)
mm v,124,v,200,a,240,124
buffer_load_dwordx4 v250, s[8:11], s41 offen offset:1024 lds
mm v,124,v,204,a,244,124
buffer_load_dwordx4 v251, s[8:11], s41 offen offset:2048 lds
mm v,32,v,208,a,224,32
tr 200,243,256
s_add_u32 m0, s30, 21512
mm v,32,v,212,a,228,32
tr 202,243,3328
s_add_u32 s41, s33, 540672
mm v,80,v,208,a,232,80
tr 204,243,6400
mm v,80,v,212,a,236,80
tr 206,243,9472
s_waitcnt lgkmcnt(6)
mm v,128,v,208,a,240,128
buffer_load_dwordx4 v249, s[8:11], s41 offen lds
mm v,128,v,212,a,244,128
buffer_load_dwordx4 v250, s[8:11], s41 offen offset:1024 lds
mm v,36,v,192,a,224,36
tr 208,243,264
s_waitcnt lgkmcnt(5)
mm v,36,v,196,a,228,36
tr 210,243,3336
buffer_load_dwordx4 v251, s[8:11], s41 offen offset:2048 lds
mm v,84,v,192,a,232,84
tr 212,243,6408
s_add_u32 s33, s33, 786432
s_cmp_eq_u32 s33, s94
s_cselect_b32 s55, 7864320, 0
mm v,84,v,196,a,236,84
tr 214,243,9480
s_sub_u32 s33, s33, s55
mm v,132,v,192,a,240,132
s_sub_u32 s42, s29, s48
s_mov_b32 s48, s29
v_add_u32 v242, s42, v242
mm v,132,v,196,a,244,132
s_waitcnt lgkmcnt(6)
v_add_u32 v243, s42, v243
mm v,40,v,200,a,224,40
s_waitcnt vmcnt(21) lgkmcnt(0)
s_barrier
mm v,40,v,204,a,228,40
tr 192,242,0
s_mov_b32 s43, s28
mm v,88,v,200,a,232,88
tr 194,242,3072
s_mov_b32 s28, s29
mm v,88,v,204,a,236,88
tr 196,242,6144
s_mov_b32 s29, s30
mm v,136,v,200,a,240,136
tr 198,242,9216
s_mov_b64 exec, 0
s_branch L_pg21
L_ir20:
s_mov_b64 exec, -1
L_ir20x:
mm v,136,v,204,a,244,136
s_mov_b32 s30, s43
mm v,44,v,208,a,224,44
tr 200,242,8
mm v,44,v,212,a,228,44
tr 202,242,3080
mm v,92,v,208,a,232,92
tr 204,242,6152
mm v,92,v,212,a,236,92
tr 206,242,9224
mm v,140,v,208,a,240,140
mm v,140,v,212,a,244,140
s_waitcnt lgkmcnt(4)
mm v,0,v,192,a,192,0
tr 208,243,0
s_add_u32 m0, s44, 0
mm v,0,v,196,a,196,0
tr 210,243,3072
s_add_u32 s51, s34, 0
mm v,48,v,192,a,200,48
tr 212,243,6144
buffer_load_dwordx4 v252, s[4:7], s51 offen lds
mm v,48,v,196,a,204,48
tr 214,243,9216
mm v,96,v,192,a,208,96
s_add_u32 s51, s34, 9216
s_waitcnt lgkmcnt(4)
mm v,96,v,196,a,212,96
buffer_load_dwordx4 v252, s[4:7], s51 offen offset:1024 lds
mm v,4,v,200,a,192,4
tr 192,243,8
s_add_u32 s51, s34, 18432
mm v,4,v,204,a,196,4
tr 194,243,3080
buffer_load_dwordx4 v252, s[4:7], s51 offen offset:2048 lds
mm v,52,v,200,a,200,52
tr 196,243,6152
s_add_u32 s51, s34, 27648
mm v,52,v,204,a,204,52
tr 198,243,9224
s_waitcnt lgkmcnt(4)
mm v,100,v,200,a,208,100
buffer_load_dwordx4 v252, s[4:7], s51 offen offset:3072 lds
mm v,100,v,204,a,212,100
s_add_u32 m0, s44, 4096
s_add_u32 s51, s34, 40960
buffer_load_dwordx4 v252, s[4:7], s51 offen lds
mm v,8,v,208,a,192,8
tr 200,242,128
s_add_u32 s51, s34, 50176
mm v,8,v,212,a,196,8
tr 202,242,3200
mm v,56,v,208,a,200,56
tr 204,242,6272
mm v,56,v,212,a,204,56
tr 206,242,9344
s_waitcnt lgkmcnt(4)
mm v,104,v,208,a,208,104
buffer_load_dwordx4 v252, s[4:7], s51 offen offset:1024 lds
mm v,104,v,212,a,212,104
s_add_u32 s34, s34, 128
s_cmp_eq_u32 s34, s95
s_cselect_b32 s55, 1280, 0
mm v,12,v,192,a,192,12
tr 208,242,136
s_sub_u32 s34, s34, s55
mm v,12,v,196,a,196,12
tr 210,242,3208
s_add_u32 m0, s30, 9216
mm v,60,v,192,a,200,60
tr 212,242,6280
s_add_u32 s41, s33, 442368
mm v,60,v,196,a,204,60
tr 214,242,9352
s_waitcnt lgkmcnt(4)
mm v,108,v,192,a,208,108
buffer_load_dwordx4 v249, s[8:11], s41 offen lds
mm v,108,v,196,a,212,108
buffer_load_dwordx4 v250, s[8:11], s41 offen offset:1024 lds
mm v,16,v,200,a,192,16
tr 192,243,128
s_waitcnt vmcnt(23)
mm v,16,v,204,a,196,16
tr 194,243,3200
buffer_load_dwordx4 v251, s[8:11], s41 offen offset:2048 lds
mm v,64,v,200,a,200,64
tr 196,243,6272
s_add_u32 m0, s30, 12296
mm v,64,v,204,a,204,64
tr 198,243,9344
s_waitcnt lgkmcnt(4)
mm v,112,v,200,a,208,112
ds_read_b128 a[224:227], v244 offset:6144
s_add_u32 s41, s33, 98304
mm v,112,v,204,a,212,112
L_pg7:
s_cbranch_execz L_pg6
ds_read_b128 a[228:231], v245 offset:6144
buffer_load_dwordx4 v249, s[8:11], s41 offen lds
mm v,20,v,208,a,192,20
tr 200,243,136
buffer_load_dwordx4 v250, s[8:11], s41 offen offset:1024 lds
mm v,20,v,212,a,196,20
tr 202,243,3208
buffer_load_dwordx4 v251, s[8:11], s41 offen offset:2048 lds
mm v,68,v,208,a,200,68
tr 204,243,6280
s_add_u32 m0, s30, 15368
mm v,68,v,212,a,204,68
tr 206,243,9352
s_waitcnt lgkmcnt(6)
mm v,116,v,208,a,208,116
ds_read_b128 a[232:235], v244 offset:8192
s_add_u32 s41, s33, 147456
mm v,116,v,212,a,212,116
ds_read_b128 a[236:239], v245 offset:8192
buffer_load_dwordx4 v249, s[8:11], s41 offen lds
mm v,24,v,192,a,192,24
tr 208,242,256
buffer_load_dwordx4 v250, s[8:11], s41 offen offset:1024 lds
mm v,24,v,196,a,196,24
tr 210,242,3328
mm v,72,v,192,a,200,72
tr 212,242,6400
mm v,72,v,196,a,204,72
tr 214,242,9472
s_waitcnt lgkmcnt(6)
mm v,120,v,192,a,208,120
ds_read_b128 a[240:243], v244 offset:10240
buffer_load_dwordx4 v251, s[8:11], s41 offen offset:2048 lds
mm v,120,v,196,a,212,120
ds_read_b128 a[244:247], v245 offset:10240
s_add_u32 m0, s30, 18440
mm v,28,v,200,a,192,28
tr 192,242,264
s_add_u32 s41, s33, 491520
mm v,28,v,204,a,196,28
tr 194,242,3336
buffer_load_dwordx4 v249, s[8:11], s41 offen lds
mm v,76,v,200,a,200,76
tr 196,242,6408
mm v,76,v,204,a,204,76
tr 198,242,9480
s_waitcnt lgkmcnt(6)
mm v,124,v,200,a,208,124
buffer_load_dwordx4 v250, s[8:11], s41 offen offset:1024 lds
mm v,124,v,204,a,212,124
buffer_load_dwordx4 v251, s[8:11], s41 offen offset:2048 lds
mm v,32,v,208,a,192,32
tr 200,243,256
s_add_u32 m0, s30, 21512
mm v,32,v,212,a,196,32
tr 202,243,3328
s_add_u32 s41, s33, 540672
mm v,80,v,208,a,200,80
tr 204,243,6400
mm v,80,v,212,a,204,80
tr 206,243,9472
s_waitcnt lgkmcnt(6)
mm v,128,v,208,a,208,128
buffer_load_dwordx4 v249, s[8:11], s41 offen lds
mm v,128,v,212,a,212,128
buffer_load_dwordx4 v250, s[8:11], s41 offen offset:1024 lds
mm v,36,v,192,a,192,36
tr 208,243,264
s_waitcnt lgkmcnt(5)
mm v,36,v,196,a,196,36
tr 210,243,3336
buffer_load_dwordx4 v251, s[8:11], s41 offen offset:2048 lds
mm v,84,v,192,a,200,84
tr 212,243,6408
s_add_u32 s33, s33, 786432
s_cmp_eq_u32 s33, s94
s_cselect_b32 s55, 7864320, 0
mm v,84,v,196,a,204,84
tr 214,243,9480
s_sub_u32 s33, s33, s55
mm v,132,v,192,a,208,132
s_sub_u32 s42, s29, s48
s_mov_b32 s48, s29
v_add_u32 v242, s42, v242
mm v,132,v,196,a,212,132
s_waitcnt lgkmcnt(6)
v_add_u32 v243, s42, v243
mm v,40,v,200,a,192,40
s_waitcnt vmcnt(21) lgkmcnt(0)
s_barrier
mm v,40,v,204,a,196,40
tr 192,242,0
s_mov_b32 s43, s28
mm v,88,v,200,a,200,88
tr 194,242,3072
s_mov_b32 s28, s29
mm v,88,v,204,a,204,88
tr 196,242,6144
s_mov_b32 s29, s30
mm v,136,v,200,a,208,136
tr 198,242,9216
s_mov_b64 exec, 0
s_branch L_pg23
L_ir22:
s_mov_b64 exec, -1
L_ir22x:
mm v,136,v,204,a,212,136
s_mov_b32 s30, s43
mm v,44,v,208,a,192,44
tr 200,242,8
mm v,44,v,212,a,196,44
tr 202,242,3080
mm v,92,v,208,a,200,92
tr 204,242,6152
mm v,92,v,212,a,204,92
tr 206,242,9224
mm v,140,v,208,a,208,140
mm v,140,v,212,a,212,140
s_waitcnt lgkmcnt(4)
mm v,0,v,192,a,224,0
tr 208,243,0
s_add_u32 m0, s45, 0
mm v,0,v,196,a,228,0
tr 210,243,3072
s_add_u32 s51, s34, 0
mm v,48,v,192,a,232,48
tr 212,243,6144
buffer_load_dwordx4 v252, s[4:7], s51 offen lds
mm v,48,v,196,a,236,48
tr 214,243,9216
mm v,96,v,192,a,240,96
s_add_u32 s51, s34, 9216
s_waitcnt lgkmcnt(4)
mm v,96,v,196,a,244,96
buffer_load_dwordx4 v252, s[4:7], s51 offen offset:1024 lds
mm v,4,v,200,a,224,4
tr 192,243,8
s_add_u32 s51, s34, 18432
mm v,4,v,204,a,228,4
tr 194,243,3080
buffer_load_dwordx4 v252, s[4:7], s51 offen offset:2048 lds
mm v,52,v,200,a,232,52
tr 196,243,6152
s_add_u32 s51, s34, 27648
mm v,52,v,204,a,236,52
tr 198,243,9224
s_waitcnt lgkmcnt(4)
mm v,100,v,200,a,240,100
buffer_load_dwordx4 v252, s[4:7], s51 offen offset:3072 lds
mm v,100,v,204,a,244,100
s_add_u32 m0, s45, 4096
s_add_u32 s51, s34, 40960
buffer_load_dwordx4 v252, s[4:7], s51 offen lds
mm v,8,v,208,a,224,8
tr 200,242,128
s_add_u32 s51, s34, 50176
mm v,8,v,212,a,228,8
tr 202,242,3200
mm v,56,v,208,a,232,56
tr 204,242,6272
mm v,56,v,212,a,236,56
tr 206,242,9344
s_waitcnt lgkmcnt(4)
mm v,104,v,208,a,240,104
buffer_load_dwordx4 v252, s[4:7], s51 offen offset:1024 lds
mm v,104,v,212,a,244,104
s_add_u32 s34, s34, 128
s_cmp_eq_u32 s34, s95
s_cselect_b32 s55, 1280, 0
mm v,12,v,192,a,224,12
tr 208,242,136
s_sub_u32 s34, s34, s55
mm v,12,v,196,a,228,12
tr 210,242,3208
s_add_u32 m0, s30, 9216
mm v,60,v,192,a,232,60
tr 212,242,6280
s_add_u32 s41, s33, 442368
mm v,60,v,196,a,236,60
tr 214,242,9352
s_waitcnt lgkmcnt(4)
mm v,108,v,192,a,240,108
buffer_load_dwordx4 v249, s[8:11], s41 offen lds
mm v,108,v,196,a,244,108
buffer_load_dwordx4 v250, s[8:11], s41 offen offset:1024 lds
mm v,16,v,200,a,224,16
tr 192,243,128
s_waitcnt vmcnt(23)
mm v,16,v,204,a,228,16
tr 194,243,3200
buffer_load_dwordx4 v251, s[8:11], s41 offen offset:2048 lds
mm v,64,v,200,a,232,64
tr 196,243,6272
s_add_u32 m0, s30, 12296
mm v,64,v,204,a,236,64
tr 198,243,9344
s_waitcnt lgkmcnt(4)
mm v,112,v,200,a,240,112
ds_read_b128 a[192:195], v244
s_add_u32 s41, s33, 98304
mm v,112,v,204,a,244,112
ds_read_b128 a[196:199], v245
buffer_load_dwordx4 v249, s[8:11], s41 offen lds
mm v,20,v,208,a,224,20
tr 200,243,136
buffer_load_dwordx4 v250, s[8:11], s41 offen offset:1024 lds
mm v,20,v,212,a,228,20
tr 202,243,3208
buffer_load_dwordx4 v251, s[8:11], s41 offen offset:2048 lds
mm v,68,v,208,a,232,68
tr 204,243,6280
s_add_u32 m0, s30, 15368
mm v,68,v,212,a,236,68
tr 206,243,9352
s_waitcnt lgkmcnt(6)
mm v,116,v,208,a,240,116
ds_read_b128 a[200:203], v244 offset:2048
s_add_u32 s41, s33, 147456
mm v,116,v,212,a,244,116
ds_read_b128 a[204:207], v245 offset:2048
buffer_load_dwordx4 v249, s[8:11], s41 offen lds
mm v,24,v,192,a,224,24
tr 208,242,256
buffer_load_dwordx4 v250, s[8:11], s41 offen offset:1024 lds
mm v,24,v,196,a,228,24
tr 210,242,3328
mm v,72,v,192,a,232,72
tr 212,242,6400
mm v,72,v,196,a,236,72
tr 214,242,9472
s_waitcnt lgkmcnt(6)
mm v,120,v,192,a,240,120
ds_read_b128 a[208:211], v244 offset:4096
buffer_load_dwordx4 v251, s[8:11], s41 offen offset:2048 lds
mm v,120,v,196,a,244,120
ds_read_b128 a[212:215], v245 offset:4096
s_add_u32 m0, s30, 18440
mm v,28,v,200,a,224,28
tr 192,242,264
s_add_u32 s41, s33, 491520
mm v,28,v,204,a,228,28
tr 194,242,3336
buffer_load_dwordx4 v249, s[8:11], s41 offen lds
mm v,76,v,200,a,232,76
tr 196,242,6408
mm v,76,v,204,a,236,76
tr 198,242,9480
s_waitcnt lgkmcnt(6)
mm v,124,v,200,a,240,124
buffer_load_dwordx4 v250, s[8:11], s41 offen offset:1024 lds
mm v,124,v,204,a,244,124
buffer_load_dwordx4 v251, s[8:11], s41 offen offset:2048 lds
mm v,32,v,208,a,224,32
tr 200,243,256
s_add_u32 m0, s30, 21512
mm v,32,v,212,a,228,32
tr 202,243,3328
s_add_u32 s41, s33, 540672
mm v,80,v,208,a,232,80
tr 204,243,6400
mm v,80,v,212,a,236,80
tr 206,243,9472
s_waitcnt lgkmcnt(6)
mm v,128,v,208,a,240,128
buffer_load_dwordx4 v249, s[8:11], s41 offen lds
mm v,128,v,212,a,244,128
buffer_load_dwordx4 v250, s[8:11], s41 offen offset:1024 lds
mm v,36,v,192,a,224,36
tr 208,243,264
s_waitcnt lgkmcnt(5)
mm v,36,v,196,a,228,36
tr 210,243,3336
buffer_load_dwordx4 v251, s[8:11], s41 offen offset:2048 lds
mm v,84,v,192,a,232,84
tr 212,243,6408
s_add_u32 s33, s33, 786432
s_cmp_eq_u32 s33, s94
s_cselect_b32 s55, 7864320, 0
mm v,84,v,196,a,236,84
tr 214,243,9480
s_sub_u32 s33, s33, s55
mm v,132,v,192,a,240,132
s_sub_u32 s42, s29, s48
s_mov_b32 s48, s29
v_add_u32 v242, s42, v242
mm v,132,v,196,a,244,132
s_waitcnt lgkmcnt(6)
v_add_u32 v243, s42, v243
mm v,40,v,200,a,224,40
s_waitcnt vmcnt(21) lgkmcnt(0)
s_barrier
mm v,40,v,204,a,228,40
tr 192,242,0
s_mov_b32 s43, s28
mm v,88,v,200,a,232,88
tr 194,242,3072
s_mov_b32 s28, s29
mm v,88,v,204,a,236,88
tr 196,242,6144
s_mov_b32 s29, s30
mm v,136,v,200,a,240,136
tr 198,242,9216
s_mov_b64 exec, 0
s_branch L_pg25
L_ir24:
s_mov_b64 exec, -1
L_ir24x:
mm v,136,v,204,a,244,136
s_mov_b32 s30, s43
mm v,44,v,208,a,224,44
tr 200,242,8
mm v,44,v,212,a,228,44
tr 202,242,3080
mm v,92,v,208,a,232,92
tr 204,242,6152
mm v,92,v,212,a,236,92
tr 206,242,9224
mm v,140,v,208,a,240,140
mm v,140,v,212,a,244,140
s_waitcnt lgkmcnt(4)
mm v,0,v,192,a,192,0
tr 208,243,0
s_add_u32 m0, s44, 0
mm v,0,v,196,a,196,0
tr 210,243,3072
s_add_u32 s51, s34, 0
mm v,48,v,192,a,200,48
tr 212,243,6144
buffer_load_dwordx4 v252, s[4:7], s51 offen lds
mm v,48,v,196,a,204,48
tr 214,243,9216
mm v,96,v,192,a,208,96
s_add_u32 s51, s34, 9216
s_waitcnt lgkmcnt(4)
mm v,96,v,196,a,212,96
buffer_load_dwordx4 v252, s[4:7], s51 offen offset:1024 lds
mm v,4,v,200,a,192,4
tr 192,243,8
s_add_u32 s51, s34, 18432
mm v,4,v,204,a,196,4
tr 194,243,3080
buffer_load_dwordx4 v252, s[4:7], s51 offen offset:2048 lds
mm v,52,v,200,a,200,52
tr 196,243,6152
s_add_u32 s51, s34, 27648
mm v,52,v,204,a,204,52
tr 198,243,9224
s_waitcnt lgkmcnt(4)
mm v,100,v,200,a,208,100
buffer_load_dwordx4 v252, s[4:7], s51 offen offset:3072 lds
mm v,100,v,204,a,212,100
s_add_u32 m0, s44, 4096
s_add_u32 s51, s34, 40960
buffer_load_dwordx4 v252, s[4:7], s51 offen lds
mm v,8,v,208,a,192,8
tr 200,242,128
s_add_u32 s51, s34, 50176
mm v,8,v,212,a,196,8
tr 202,242,3200
mm v,56,v,208,a,200,56
tr 204,242,6272
mm v,56,v,212,a,204,56
tr 206,242,9344
s_waitcnt lgkmcnt(4)
mm v,104,v,208,a,208,104
buffer_load_dwordx4 v252, s[4:7], s51 offen offset:1024 lds
mm v,104,v,212,a,212,104
s_add_u32 s34, s34, 128
s_cmp_eq_u32 s34, s95
s_cselect_b32 s55, 1280, 0
mm v,12,v,192,a,192,12
tr 208,242,136
s_sub_u32 s34, s34, s55
mm v,12,v,196,a,196,12
tr 210,242,3208
s_add_u32 m0, s30, 9216
mm v,60,v,192,a,200,60
tr 212,242,6280
s_add_u32 s41, s33, 442368
mm v,60,v,196,a,204,60
tr 214,242,9352
s_waitcnt lgkmcnt(4)
mm v,108,v,192,a,208,108
buffer_load_dwordx4 v249, s[8:11], s41 offen lds
mm v,108,v,196,a,212,108
buffer_load_dwordx4 v250, s[8:11], s41 offen offset:1024 lds
mm v,16,v,200,a,192,16
tr 192,243,128
s_waitcnt vmcnt(23)
mm v,16,v,204,a,196,16
tr 194,243,3200
buffer_load_dwordx4 v251, s[8:11], s41 offen offset:2048 lds
mm v,64,v,200,a,200,64
tr 196,243,6272
s_add_u32 m0, s30, 12296
mm v,64,v,204,a,204,64
tr 198,243,9344
s_waitcnt lgkmcnt(4)
mm v,112,v,200,a,208,112
ds_read_b128 a[224:227], v244 offset:6144
s_add_u32 s41, s33, 98304
mm v,112,v,204,a,212,112
ds_read_b128 a[228:231], v245 offset:6144
buffer_load_dwordx4 v249, s[8:11], s41 offen lds
mm v,20,v,208,a,192,20
tr 200,243,136
buffer_load_dwordx4 v250, s[8:11], s41 offen offset:1024 lds
mm v,20,v,212,a,196,20
tr 202,243,3208
buffer_load_dwordx4 v251, s[8:11], s41 offen offset:2048 lds
mm v,68,v,208,a,200,68
tr 204,243,6280
s_add_u32 m0, s30, 15368
mm v,68,v,212,a,204,68
tr 206,243,9352
s_waitcnt lgkmcnt(6)
mm v,116,v,208,a,208,116
ds_read_b128 a[232:235], v244 offset:8192
s_add_u32 s41, s33, 147456
mm v,116,v,212,a,212,116
ds_read_b128 a[236:239], v245 offset:8192
buffer_load_dwordx4 v249, s[8:11], s41 offen lds
mm v,24,v,192,a,192,24
tr 208,242,256
buffer_load_dwordx4 v250, s[8:11], s41 offen offset:1024 lds
mm v,24,v,196,a,196,24
tr 210,242,3328
mm v,72,v,192,a,200,72
tr 212,242,6400
mm v,72,v,196,a,204,72
tr 214,242,9472
s_waitcnt lgkmcnt(6)
mm v,120,v,192,a,208,120
ds_read_b128 a[240:243], v244 offset:10240
buffer_load_dwordx4 v251, s[8:11], s41 offen offset:2048 lds
mm v,120,v,196,a,212,120
ds_read_b128 a[244:247], v245 offset:10240
s_add_u32 m0, s30, 18440
mm v,28,v,200,a,192,28
tr 192,242,264
s_add_u32 s41, s33, 491520
mm v,28,v,204,a,196,28
tr 194,242,3336
buffer_load_dwordx4 v249, s[8:11], s41 offen lds
mm v,76,v,200,a,200,76
tr 196,242,6408
mm v,76,v,204,a,204,76
tr 198,242,9480
s_waitcnt lgkmcnt(6)
mm v,124,v,200,a,208,124
buffer_load_dwordx4 v250, s[8:11], s41 offen offset:1024 lds
mm v,124,v,204,a,212,124
buffer_load_dwordx4 v251, s[8:11], s41 offen offset:2048 lds
mm v,32,v,208,a,192,32
tr 200,243,256
s_add_u32 m0, s30, 21512
mm v,32,v,212,a,196,32
tr 202,243,3328
s_add_u32 s41, s33, 540672
mm v,80,v,208,a,200,80
tr 204,243,6400
mm v,80,v,212,a,204,80
tr 206,243,9472
s_waitcnt lgkmcnt(6)
mm v,128,v,208,a,208,128
buffer_load_dwordx4 v249, s[8:11], s41 offen lds
mm v,128,v,212,a,212,128
buffer_load_dwordx4 v250, s[8:11], s41 offen offset:1024 lds
mm v,36,v,192,a,192,36
tr 208,243,264
s_waitcnt lgkmcnt(5)
mm v,36,v,196,a,196,36
tr 210,243,3336
buffer_load_dwordx4 v251, s[8:11], s41 offen offset:2048 lds
mm v,84,v,192,a,200,84
tr 212,243,6408
s_add_u32 s33, s33, 786432
s_cmp_eq_u32 s33, s94
s_cselect_b32 s55, 7864320, 0
mm v,84,v,196,a,204,84
tr 214,243,9480
s_sub_u32 s33, s33, s55
mm v,132,v,192,a,208,132
s_sub_u32 s42, s29, s48
s_mov_b32 s48, s29
v_add_u32 v242, s42, v242
mm v,132,v,196,a,212,132
s_waitcnt lgkmcnt(6)
v_add_u32 v243, s42, v243
mm v,40,v,200,a,192,40
s_waitcnt vmcnt(21) lgkmcnt(0)
s_barrier
mm v,40,v,204,a,196,40
tr 192,242,0
s_mov_b32 s43, s28
mm v,88,v,200,a,200,88
tr 194,242,3072
s_mov_b32 s28, s29
mm v,88,v,204,a,204,88
tr 196,242,6144
s_mov_b32 s29, s30
mm v,136,v,200,a,208,136
tr 198,242,9216
s_mov_b64 exec, 0
s_branch L_pg27
L_ir26:
s_mov_b64 exec, -1
L_ir26x:
mm v,136,v,204,a,212,136
s_mov_b32 s30, s43
mm v,44,v,208,a,192,44
tr 200,242,8
mm v,44,v,212,a,196,44
tr 202,242,3080
mm v,92,v,208,a,200,92
tr 204,242,6152
mm v,92,v,212,a,204,92
tr 206,242,9224
mm v,140,v,208,a,208,140
mm v,140,v,212,a,212,140
s_waitcnt lgkmcnt(4)
mm v,0,v,192,a,224,0
tr 208,243,0
s_add_u32 m0, s45, 0
mm v,0,v,196,a,228,0
tr 210,243,3072
s_add_u32 s51, s34, 0
mm v,48,v,192,a,232,48
tr 212,243,6144
buffer_load_dwordx4 v252, s[4:7], s51 offen lds
mm v,48,v,196,a,236,48
tr 214,243,9216
mm v,96,v,192,a,240,96
s_add_u32 s51, s34, 9216
s_waitcnt lgkmcnt(4)
mm v,96,v,196,a,244,96
buffer_load_dwordx4 v252, s[4:7], s51 offen offset:1024 lds
mm v,4,v,200,a,224,4
tr 192,243,8
s_add_u32 s51, s34, 18432
mm v,4,v,204,a,228,4
tr 194,243,3080
buffer_load_dwordx4 v252, s[4:7], s51 offen offset:2048 lds
mm v,52,v,200,a,232,52
tr 196,243,6152
s_add_u32 s51, s34, 27648
mm v,52,v,204,a,236,52
tr 198,243,9224
s_waitcnt lgkmcnt(4)
mm v,100,v,200,a,240,100
buffer_load_dwordx4 v252, s[4:7], s51 offen offset:3072 lds
mm v,100,v,204,a,244,100
s_add_u32 m0, s45, 4096
s_add_u32 s51, s34, 40960
buffer_load_dwordx4 v252, s[4:7], s51 offen lds
mm v,8,v,208,a,224,8
tr 200,242,128
s_add_u32 s51, s34, 50176
mm v,8,v,212,a,228,8
tr 202,242,3200
mm v,56,v,208,a,232,56
L_pg8:
s_cbranch_execz L_ir1
tr 204,242,6272
mm v,56,v,212,a,236,56
tr 206,242,9344
s_waitcnt lgkmcnt(4)
mm v,104,v,208,a,240,104
buffer_load_dwordx4 v252, s[4:7], s51 offen offset:1024 lds
mm v,104,v,212,a,244,104
s_add_u32 s34, s34, 128
s_cmp_eq_u32 s34, s95
s_cselect_b32 s55, 1280, 0
mm v,12,v,192,a,224,12
tr 208,242,136
s_sub_u32 s34, s34, s55
mm v,12,v,196,a,228,12
tr 210,242,3208
s_add_u32 m0, s30, 9216
mm v,60,v,192,a,232,60
tr 212,242,6280
s_add_u32 s41, s33, 442368
mm v,60,v,196,a,236,60
tr 214,242,9352
s_waitcnt lgkmcnt(4)
mm v,108,v,192,a,240,108
buffer_load_dwordx4 v249, s[8:11], s41 offen lds
mm v,108,v,196,a,244,108
buffer_load_dwordx4 v250, s[8:11], s41 offen offset:1024 lds
mm v,16,v,200,a,224,16
tr 192,243,128
s_waitcnt vmcnt(23)
mm v,16,v,204,a,228,16
tr 194,243,3200
buffer_load_dwordx4 v251, s[8:11], s41 offen offset:2048 lds
mm v,64,v,200,a,232,64
tr 196,243,6272
s_add_u32 m0, s30, 12296
mm v,64,v,204,a,236,64
tr 198,243,9344
s_waitcnt lgkmcnt(4)
mm v,112,v,200,a,240,112
ds_read_b128 a[192:195], v244
s_add_u32 s41, s33, 98304
mm v,112,v,204,a,244,112
ds_read_b128 a[196:199], v245
buffer_load_dwordx4 v249, s[8:11], s41 offen lds
mm v,20,v,208,a,224,20
tr 200,243,136
buffer_load_dwordx4 v250, s[8:11], s41 offen offset:1024 lds
mm v,20,v,212,a,228,20
tr 202,243,3208
buffer_load_dwordx4 v251, s[8:11], s41 offen offset:2048 lds
mm v,68,v,208,a,232,68
tr 204,243,6280
s_add_u32 m0, s30, 15368
mm v,68,v,212,a,236,68
tr 206,243,9352
s_waitcnt lgkmcnt(6)
mm v,116,v,208,a,240,116
ds_read_b128 a[200:203], v244 offset:2048
s_add_u32 s41, s33, 147456
mm v,116,v,212,a,244,116
ds_read_b128 a[204:207], v245 offset:2048
buffer_load_dwordx4 v249, s[8:11], s41 offen lds
mm v,24,v,192,a,224,24
tr 208,242,256
buffer_load_dwordx4 v250, s[8:11], s41 offen offset:1024 lds
mm v,24,v,196,a,228,24
tr 210,242,3328
mm v,72,v,192,a,232,72
tr 212,242,6400
mm v,72,v,196,a,236,72
tr 214,242,9472
s_waitcnt lgkmcnt(6)
mm v,120,v,192,a,240,120
ds_read_b128 a[208:211], v244 offset:4096
buffer_load_dwordx4 v251, s[8:11], s41 offen offset:2048 lds
mm v,120,v,196,a,244,120
ds_read_b128 a[212:215], v245 offset:4096
s_add_u32 m0, s30, 18440
mm v,28,v,200,a,224,28
tr 192,242,264
s_add_u32 s41, s33, 491520
mm v,28,v,204,a,228,28
tr 194,242,3336
buffer_load_dwordx4 v249, s[8:11], s41 offen lds
mm v,76,v,200,a,232,76
tr 196,242,6408
mm v,76,v,204,a,236,76
tr 198,242,9480
s_waitcnt lgkmcnt(6)
mm v,124,v,200,a,240,124
buffer_load_dwordx4 v250, s[8:11], s41 offen offset:1024 lds
mm v,124,v,204,a,244,124
buffer_load_dwordx4 v251, s[8:11], s41 offen offset:2048 lds
mm v,32,v,208,a,224,32
tr 200,243,256
s_add_u32 m0, s30, 21512
mm v,32,v,212,a,228,32
tr 202,243,3328
s_add_u32 s41, s33, 540672
mm v,80,v,208,a,232,80
tr 204,243,6400
mm v,80,v,212,a,236,80
tr 206,243,9472
s_waitcnt lgkmcnt(6)
mm v,128,v,208,a,240,128
buffer_load_dwordx4 v249, s[8:11], s41 offen lds
mm v,128,v,212,a,244,128
buffer_load_dwordx4 v250, s[8:11], s41 offen offset:1024 lds
mm v,36,v,192,a,224,36
tr 208,243,264
s_waitcnt lgkmcnt(5)
mm v,36,v,196,a,228,36
tr 210,243,3336
buffer_load_dwordx4 v251, s[8:11], s41 offen offset:2048 lds
mm v,84,v,192,a,232,84
tr 212,243,6408
s_add_u32 s33, s33, 786432
s_cmp_eq_u32 s33, s94
s_cselect_b32 s55, 7864320, 0
mm v,84,v,196,a,236,84
tr 214,243,9480
s_sub_u32 s33, s33, s55
mm v,132,v,192,a,240,132
s_sub_u32 s42, s29, s48
s_mov_b32 s48, s29
v_add_u32 v242, s42, v242
mm v,132,v,196,a,244,132
s_waitcnt lgkmcnt(6)
v_add_u32 v243, s42, v243
mm v,40,v,200,a,224,40
s_waitcnt vmcnt(21) lgkmcnt(0)
s_barrier
mm v,40,v,204,a,228,40
tr 192,242,0
s_mov_b32 s43, s28
mm v,88,v,200,a,232,88
tr 194,242,3072
s_mov_b32 s28, s29
mm v,88,v,204,a,236,88
tr 196,242,6144
s_mov_b32 s29, s30
mm v,136,v,200,a,240,136
tr 198,242,9216
s_mov_b64 exec, 0
s_branch L_pg29
L_ir28:
s_mov_b64 exec, -1
L_ir28x:
mm v,136,v,204,a,244,136
s_mov_b32 s30, s43
mm v,44,v,208,a,224,44
tr 200,242,8
mm v,44,v,212,a,228,44
tr 202,242,3080
mm v,92,v,208,a,232,92
tr 204,242,6152
mm v,92,v,212,a,236,92
tr 206,242,9224
mm v,140,v,208,a,240,140
mm v,140,v,212,a,244,140
s_waitcnt lgkmcnt(4)
mm v,0,v,192,a,192,0
tr 208,243,0
s_add_u32 m0, s44, 0
mm v,0,v,196,a,196,0
tr 210,243,3072
s_add_u32 s51, s34, 0
mm v,48,v,192,a,200,48
tr 212,243,6144
buffer_load_dwordx4 v252, s[4:7], s51 offen lds
mm v,48,v,196,a,204,48
tr 214,243,9216
s_waitcnt lgkmcnt(4)
s_add_u32 s51, s34, 9216
mm v,96,v,192,a,208,96
buffer_load_dwordx4 v252, s[4:7], s51 offen offset:1024 lds
mm v,96,v,196,a,212,96
s_add_u32 s51, s34, 18432
buffer_load_dwordx4 v252, s[4:7], s51 offen offset:2048 lds
mm v,4,v,200,a,192,4
tr 192,243,8
s_add_u32 s51, s34, 27648
mm v,4,v,204,a,196,4
tr 194,243,3080
buffer_load_dwordx4 v252, s[4:7], s51 offen offset:3072 lds
mm v,52,v,200,a,200,52
tr 196,243,6152
s_add_u32 m0, s44, 4096
s_add_u32 s51, s34, 40960
mm v,52,v,204,a,204,52
tr 198,243,9224
s_waitcnt lgkmcnt(4)
mm v,100,v,200,a,208,100
buffer_load_dwordx4 v252, s[4:7], s51 offen lds
mm v,100,v,204,a,212,100
s_add_u32 s51, s34, 50176
buffer_load_dwordx4 v252, s[4:7], s51 offen offset:1024 lds
mm v,8,v,208,a,192,8
tr 200,242,128
s_add_u32 s34, s34, 128
mm v,8,v,212,a,196,8
tr 202,242,3200
s_cmp_eq_u32 s34, s95
s_cselect_b32 s55, 1280, 0
mm v,56,v,208,a,200,56
tr 204,242,6272
s_sub_u32 s34, s34, s55
mm v,56,v,212,a,204,56
tr 206,242,9344
mm v,104,v,208,a,208,104
s_add_u32 m0, s30, 9216
s_add_u32 s41, s33, 442368
s_waitcnt lgkmcnt(4)
mm v,104,v,212,a,212,104
buffer_load_dwordx4 v249, s[8:11], s41 offen lds
mm v,12,v,192,a,192,12
tr 208,242,136
buffer_load_dwordx4 v250, s[8:11], s41 offen offset:1024 lds
mm v,12,v,196,a,196,12
tr 210,242,3208
buffer_load_dwordx4 v251, s[8:11], s41 offen offset:2048 lds
mm v,60,v,192,a,200,60
tr 212,242,6280
s_add_u32 m0, s30, 12296
s_add_u32 s41, s33, 98304
mm v,60,v,196,a,204,60
tr 214,242,9352
s_waitcnt lgkmcnt(4)
mm v,108,v,192,a,208,108
buffer_load_dwordx4 v249, s[8:11], s41 offen lds
mm v,108,v,196,a,212,108
buffer_load_dwordx4 v250, s[8:11], s41 offen offset:1024 lds
buffer_load_dwordx4 v251, s[8:11], s41 offen offset:2048 lds
mm v,16,v,200,a,192,16
tr 192,243,128
s_waitcnt vmcnt(27)
mm v,16,v,204,a,196,16
tr 194,243,3200
s_add_u32 m0, s30, 15368
mm v,64,v,200,a,200,64
tr 196,243,6272
s_add_u32 s41, s33, 147456
buffer_load_dwordx4 v249, s[8:11], s41 offen lds
mm v,64,v,204,a,204,64
tr 198,243,9344
s_waitcnt lgkmcnt(4)
mm v,112,v,200,a,208,112
ds_read_b128 a[224:227], v244 offset:6144
buffer_load_dwordx4 v250, s[8:11], s41 offen offset:1024 lds
mm v,112,v,204,a,212,112
ds_read_b128 a[228:231], v245 offset:6144
buffer_load_dwordx4 v251, s[8:11], s41 offen offset:2048 lds
s_add_u32 m0, s30, 18440
mm v,20,v,208,a,192,20
tr 200,243,136
s_add_u32 s41, s33, 491520
mm v,20,v,212,a,196,20
tr 202,243,3208
buffer_load_dwordx4 v249, s[8:11], s41 offen lds
mm v,68,v,208,a,200,68
tr 204,243,6280
buffer_load_dwordx4 v250, s[8:11], s41 offen offset:1024 lds
mm v,68,v,212,a,204,68
tr 206,243,9352
s_waitcnt lgkmcnt(6)
buffer_load_dwordx4 v251, s[8:11], s41 offen offset:2048 lds
mm v,116,v,208,a,208,116
ds_read_b128 a[232:235], v244 offset:8192
s_add_u32 m0, s30, 21512
mm v,116,v,212,a,212,116
ds_read_b128 a[236:239], v245 offset:8192
s_add_u32 s41, s33, 540672
mm v,24,v,192,a,192,24
tr 208,242,256
buffer_load_dwordx4 v249, s[8:11], s41 offen lds
mm v,24,v,196,a,196,24
tr 210,242,3328
buffer_load_dwordx4 v250, s[8:11], s41 offen offset:1024 lds
mm v,72,v,192,a,200,72
tr 212,242,6400
buffer_load_dwordx4 v251, s[8:11], s41 offen offset:2048 lds
mm v,72,v,196,a,204,72
tr 214,242,9472
s_waitcnt lgkmcnt(6)
s_add_u32 s33, s33, 786432
s_cmp_eq_u32 s33, s94
s_cselect_b32 s55, 7864320, 0
mm v,120,v,192,a,208,120
ds_read_b128 a[240:243], v244 offset:10240
s_sub_u32 s33, s33, s55
mm v,120,v,196,a,212,120
ds_read_b128 a[244:247], v245 offset:10240
s_add_u32 m0, s25, 0
mm v,28,v,200,a,192,28
tr 192,242,264
s_add_u32 s41, s89, 30720
mm v,28,v,204,a,196,28
tr 194,242,3336
buffer_load_dwordx4 v144, s[12:15], s41 offen nt lds
mm v,76,v,200,a,200,76
tr 196,242,6408
buffer_load_dwordx4 v145, s[12:15], s41 offen offset:1024 nt lds
mm v,76,v,204,a,204,76
tr 198,242,9480
buffer_load_dwordx4 v146, s[12:15], s41 offen offset:2048 nt lds
mm v,124,v,200,a,208,124
s_add_u32 m0, s25, 3072
s_add_u32 s41, s89, 95232
s_waitcnt lgkmcnt(6)
mm v,124,v,204,a,212,124
buffer_load_dwordx4 v144, s[12:15], s41 offen nt lds
mm v,32,v,208,a,192,32
tr 200,243,256
buffer_load_dwordx4 v145, s[12:15], s41 offen offset:1024 nt lds
mm v,32,v,212,a,196,32
tr 202,243,3328
buffer_load_dwordx4 v146, s[12:15], s41 offen offset:2048 nt lds
mm v,80,v,208,a,200,80
tr 204,243,6400
s_add_u32 m0, s25, 6144
s_add_u32 s41, s89, 129024
mm v,80,v,212,a,204,80
tr 206,243,9472
s_waitcnt lgkmcnt(4)
mm v,128,v,208,a,208,128
buffer_load_dwordx4 v144, s[12:15], s41 offen nt lds
mm v,128,v,212,a,212,128
buffer_load_dwordx4 v145, s[12:15], s41 offen offset:1024 nt lds
mm v,36,v,192,a,192,36
tr 208,243,264
buffer_load_dwordx4 v146, s[12:15], s41 offen offset:2048 nt lds
mm v,36,v,196,a,196,36
tr 210,243,3336
s_add_u32 m0, s25, 9216
mm v,84,v,192,a,200,84
tr 212,243,6408
s_add_u32 s41, s89, 162816
buffer_load_dwordx4 v144, s[12:15], s41 offen nt lds
mm v,84,v,196,a,204,84
tr 214,243,9480
buffer_load_dwordx4 v145, s[12:15], s41 offen offset:1024 nt lds
mm v,132,v,192,a,208,132
s_sub_u32 s42, s29, s48
s_mov_b32 s48, s29
buffer_load_dwordx4 v146, s[12:15], s41 offen offset:2048 nt lds
v_add_u32 v242, s42, v242
mm v,132,v,196,a,212,132
s_waitcnt lgkmcnt(6)
v_add_u32 v243, s42, v243
mm v,40,v,200,a,192,40
s_waitcnt vmcnt(33) lgkmcnt(0)
s_barrier
mm v,40,v,204,a,196,40
tr 192,242,0
s_mov_b32 s43, s28
mm v,88,v,200,a,200,88
tr 194,242,3072
s_mov_b32 s28, s29
mm v,88,v,204,a,204,88
tr 196,242,6144
s_mov_b32 s29, s30
mm v,136,v,200,a,208,136
tr 198,242,9216
mm v,136,v,204,a,212,136
s_mov_b32 s30, s43
mm v,44,v,208,a,192,44
tr 200,242,8
mm v,44,v,212,a,196,44
tr 202,242,3080
mm v,92,v,208,a,200,92
tr 204,242,6152
mm v,92,v,212,a,204,92
tr 206,242,9224
mm v,140,v,208,a,208,140
mm v,140,v,212,a,212,140
s_waitcnt lgkmcnt(4)
mm v,0,v,192,a,224,0
tr 208,243,0
s_add_u32 m0, s45, 0
mm v,0,v,196,a,228,0
tr 210,243,3072
s_add_u32 s51, s34, 0
mm v,48,v,192,a,232,48
tr 212,243,6144
buffer_load_dwordx4 v252, s[4:7], s51 offen lds
mm v,48,v,196,a,236,48
tr 214,243,9216
s_waitcnt lgkmcnt(4)
s_add_u32 s51, s34, 9216
mm v,96,v,192,a,240,96
buffer_load_dwordx4 v252, s[4:7], s51 offen offset:1024 lds
mm v,96,v,196,a,244,96
s_add_u32 s51, s34, 18432
buffer_load_dwordx4 v252, s[4:7], s51 offen offset:2048 lds
mm v,4,v,200,a,224,4
tr 192,243,8
s_add_u32 s51, s34, 27648
mm v,4,v,204,a,228,4
tr 194,243,3080
buffer_load_dwordx4 v252, s[4:7], s51 offen offset:3072 lds
mm v,52,v,200,a,232,52
tr 196,243,6152
s_add_u32 m0, s45, 4096
s_add_u32 s51, s34, 40960
mm v,52,v,204,a,236,52
tr 198,243,9224
s_waitcnt lgkmcnt(4)
mm v,100,v,200,a,240,100
buffer_load_dwordx4 v252, s[4:7], s51 offen lds
mm v,100,v,204,a,244,100
s_add_u32 s51, s34, 50176
buffer_load_dwordx4 v252, s[4:7], s51 offen offset:1024 lds
mm v,8,v,208,a,224,8
tr 200,242,128
s_add_u32 s34, s34, 128
mm v,8,v,212,a,228,8
tr 202,242,3200
s_cmp_eq_u32 s34, s95
s_cselect_b32 s55, 1280, 0
mm v,56,v,208,a,232,56
tr 204,242,6272
s_sub_u32 s34, s34, s55
mm v,56,v,212,a,236,56
tr 206,242,9344
mm v,104,v,208,a,240,104
s_add_u32 m0, s30, 9216
s_add_u32 s41, s33, 442368
s_waitcnt lgkmcnt(4)
mm v,104,v,212,a,244,104
buffer_load_dwordx4 v249, s[8:11], s41 offen lds
mm v,12,v,192,a,224,12
tr 208,242,136
buffer_load_dwordx4 v250, s[8:11], s41 offen offset:1024 lds
mm v,12,v,196,a,228,12
tr 210,242,3208
buffer_load_dwordx4 v251, s[8:11], s41 offen offset:2048 lds
mm v,60,v,192,a,232,60
tr 212,242,6280
s_add_u32 m0, s30, 12296
s_add_u32 s41, s33, 98304
mm v,60,v,196,a,236,60
tr 214,242,9352
s_waitcnt lgkmcnt(4)
mm v,108,v,192,a,240,108
buffer_load_dwordx4 v249, s[8:11], s41 offen lds
mm v,108,v,196,a,244,108
buffer_load_dwordx4 v250, s[8:11], s41 offen offset:1024 lds
buffer_load_dwordx4 v251, s[8:11], s41 offen offset:2048 lds
mm v,16,v,200,a,224,16
tr 192,243,128
s_waitcnt vmcnt(39)
mm v,16,v,204,a,228,16
tr 194,243,3200
s_add_u32 m0, s30, 15368
mm v,64,v,200,a,232,64
tr 196,243,6272
s_add_u32 s41, s33, 147456
buffer_load_dwordx4 v249, s[8:11], s41 offen lds
mm v,64,v,204,a,236,64
tr 198,243,9344
s_waitcnt lgkmcnt(4)
mm v,112,v,200,a,240,112
ds_read_b128 a[192:195], v244
buffer_load_dwordx4 v250, s[8:11], s41 offen offset:1024 lds
mm v,112,v,204,a,244,112
ds_read_b128 a[196:199], v245
buffer_load_dwordx4 v251, s[8:11], s41 offen offset:2048 lds
s_add_u32 m0, s30, 18440
mm v,20,v,208,a,224,20
tr 200,243,136
s_add_u32 s41, s33, 491520
mm v,20,v,212,a,228,20
tr 202,243,3208
buffer_load_dwordx4 v249, s[8:11], s41 offen lds
mm v,68,v,208,a,232,68
tr 204,243,6280
buffer_load_dwordx4 v250, s[8:11], s41 offen offset:1024 lds
mm v,68,v,212,a,236,68
tr 206,243,9352
s_waitcnt lgkmcnt(6)
buffer_load_dwordx4 v251, s[8:11], s41 offen offset:2048 lds
mm v,116,v,208,a,240,116
ds_read_b128 a[200:203], v244 offset:2048
s_add_u32 m0, s30, 21512
mm v,116,v,212,a,244,116
ds_read_b128 a[204:207], v245 offset:2048
s_add_u32 s41, s33, 540672
mm v,24,v,192,a,224,24
tr 208,242,256
buffer_load_dwordx4 v249, s[8:11], s41 offen lds
mm v,24,v,196,a,228,24
tr 210,242,3328
buffer_load_dwordx4 v250, s[8:11], s41 offen offset:1024 lds
mm v,72,v,192,a,232,72
tr 212,242,6400
buffer_load_dwordx4 v251, s[8:11], s41 offen offset:2048 lds
mm v,72,v,196,a,236,72
tr 214,242,9472
s_waitcnt lgkmcnt(6)
s_add_u32 s33, s33, 786432
s_cmp_eq_u32 s33, s94
s_cselect_b32 s55, 7864320, 0
mm v,120,v,192,a,240,120
ds_read_b128 a[208:211], v244 offset:4096
s_sub_u32 s33, s33, s55
mm v,120,v,196,a,244,120
ds_read_b128 a[212:215], v245 offset:4096
s_add_u32 m0, s25, 12288
mm v,28,v,200,a,224,28
tr 192,242,264
s_add_u32 s41, s89, 227328
mm v,28,v,204,a,228,28
tr 194,242,3336
buffer_load_dwordx4 v144, s[12:15], s41 offen nt lds
mm v,76,v,200,a,232,76
tr 196,242,6408
buffer_load_dwordx4 v145, s[12:15], s41 offen offset:1024 nt lds
mm v,76,v,204,a,236,76
tr 198,242,9480
buffer_load_dwordx4 v146, s[12:15], s41 offen offset:2048 nt lds
mm v,124,v,200,a,240,124
s_add_u32 m0, s25, 15360
s_add_u32 s41, s89, 261120
s_waitcnt lgkmcnt(6)
mm v,124,v,204,a,244,124
buffer_load_dwordx4 v144, s[12:15], s41 offen nt lds
mm v,32,v,208,a,224,32
tr 200,243,256
buffer_load_dwordx4 v145, s[12:15], s41 offen offset:1024 nt lds
mm v,32,v,212,a,228,32
tr 202,243,3328
buffer_load_dwordx4 v146, s[12:15], s41 offen offset:2048 nt lds
mm v,80,v,208,a,232,80
tr 204,243,6400
s_add_u32 m0, s25, 18432
s_add_u32 s41, s89, 294912
mm v,80,v,212,a,236,80
tr 206,243,9472
s_waitcnt lgkmcnt(4)
mm v,128,v,208,a,240,128
buffer_load_dwordx4 v144, s[12:15], s41 offen nt lds
mm v,128,v,212,a,244,128
buffer_load_dwordx4 v145, s[12:15], s41 offen offset:1024 nt lds
mm v,36,v,192,a,224,36
tr 208,243,264
buffer_load_dwordx4 v146, s[12:15], s41 offen offset:2048 nt lds
mm v,36,v,196,a,228,36
tr 210,243,3336
s_add_u32 m0, s25, 21504
mm v,84,v,192,a,232,84
L_pg6:
s_cbranch_execz L_ir1
tr 212,243,6408
s_add_u32 s41, s89, 359424
buffer_load_dwordx4 v144, s[12:15], s41 offen nt lds
mm v,84,v,196,a,236,84
tr 214,243,9480
buffer_load_dwordx4 v145, s[12:15], s41 offen offset:1024 nt lds
mm v,132,v,192,a,240,132
s_sub_u32 s42, s29, s48
s_mov_b32 s48, s29
buffer_load_dwordx4 v146, s[12:15], s41 offen offset:2048 nt lds
v_add_u32 v242, s42, v242
mm v,132,v,196,a,244,132
s_waitcnt lgkmcnt(6)
v_add_u32 v243, s42, v243
mm v,40,v,200,a,224,40
s_waitcnt vmcnt(45) lgkmcnt(0)
s_barrier
mm v,40,v,204,a,228,40
tr 192,242,0
s_mov_b32 s43, s28
mm v,88,v,200,a,232,88
tr 194,242,3072
s_mov_b32 s28, s29
mm v,88,v,204,a,236,88
tr 196,242,6144
s_mov_b32 s29, s30
mm v,136,v,200,a,240,136
tr 198,242,9216
s_mov_b64 exec, 0
s_branch L_pg31
L_ir30:
s_mov_b64 exec, -1
L_ir30x:
mm v,136,v,204,a,244,136
s_mov_b32 s30, s43
mm v,44,v,208,a,224,44
tr 200,242,8
mm v,44,v,212,a,228,44
tr 202,242,3080
mm v,92,v,208,a,232,92
tr 204,242,6152
mm v,92,v,212,a,236,92
tr 206,242,9224
mm v,140,v,208,a,240,140
mm v,140,v,212,a,244,140
s_waitcnt lgkmcnt(4)
mm v,0,v,192,a,192,0
tr 208,243,0
s_add_u32 m0, s30, 0
mm v,0,v,196,a,196,0
tr 210,243,3072
s_add_u32 s41, s89, 30720
mm v,48,v,192,a,200,48
tr 212,243,6144
mm v,48,v,196,a,204,48
tr 214,243,9216
s_waitcnt lgkmcnt(4)
mm v,96,v,192,a,208,96
buffer_load_dwordx4 v144, s[16:19], s41 offen nt lds
mm v,96,v,196,a,212,96
buffer_load_dwordx4 v145, s[16:19], s41 offen offset:1024 nt lds
mm v,4,v,200,a,192,4
tr 192,243,8
buffer_load_dwordx4 v146, s[16:19], s41 offen offset:2048 nt lds
mm v,4,v,204,a,196,4
tr 194,243,3080
s_add_u32 m0, s30, 3072
mm v,52,v,200,a,200,52
tr 196,243,6152
s_add_u32 s41, s89, 95232
mm v,52,v,204,a,204,52
tr 198,243,9224
s_waitcnt lgkmcnt(4)
mm v,100,v,200,a,208,100
buffer_load_dwordx4 v144, s[16:19], s41 offen nt lds
mm v,100,v,204,a,212,100
buffer_load_dwordx4 v145, s[16:19], s41 offen offset:1024 nt lds
mm v,8,v,208,a,192,8
tr 200,242,128
buffer_load_dwordx4 v146, s[16:19], s41 offen offset:2048 nt lds
mm v,8,v,212,a,196,8
tr 202,242,3200
s_add_u32 m0, s30, 6144
mm v,56,v,208,a,200,56
tr 204,242,6272
s_add_u32 s41, s89, 129024
mm v,56,v,212,a,204,56
tr 206,242,9344
s_waitcnt lgkmcnt(6)
mm v,104,v,208,a,208,104
buffer_load_dwordx4 v144, s[16:19], s41 offen nt lds
mm v,104,v,212,a,212,104
buffer_load_dwordx4 v145, s[16:19], s41 offen offset:1024 nt lds
mm v,12,v,192,a,192,12
tr 208,242,136
s_waitcnt lgkmcnt(5)
mm v,12,v,196,a,196,12
tr 210,242,3208
mm v,60,v,192,a,200,60
tr 212,242,6280
mm v,60,v,196,a,204,60
tr 214,242,9352
s_waitcnt lgkmcnt(4)
mm v,108,v,192,a,208,108
buffer_load_dwordx4 v146, s[16:19], s41 offen offset:2048 nt lds
mm v,108,v,196,a,212,108
s_add_u32 m0, s30, 9216
s_add_u32 s41, s89, 162816
buffer_load_dwordx4 v144, s[16:19], s41 offen nt lds
mm v,16,v,200,a,192,16
tr 192,243,128
s_waitcnt vmcnt(37)
mm v,16,v,204,a,196,16
tr 194,243,3200
buffer_load_dwordx4 v145, s[16:19], s41 offen offset:1024 nt lds
mm v,64,v,200,a,200,64
tr 196,243,6272
mm v,64,v,204,a,204,64
tr 198,243,9344
s_waitcnt lgkmcnt(4)
mm v,112,v,200,a,208,112
ds_read_b128 a[224:227], v244 offset:6144
buffer_load_dwordx4 v146, s[16:19], s41 offen offset:2048 nt lds
mm v,112,v,204,a,212,112
ds_read_b128 a[228:231], v245 offset:6144
s_add_u32 m0, s30, 12288
mm v,20,v,208,a,192,20
tr 200,243,136
s_add_u32 s41, s89, 227328
mm v,20,v,212,a,196,20
tr 202,243,3208
buffer_load_dwordx4 v144, s[16:19], s41 offen nt lds
mm v,68,v,208,a,200,68
tr 204,243,6280
buffer_load_dwordx4 v145, s[16:19], s41 offen offset:1024 nt lds
mm v,68,v,212,a,204,68
tr 206,243,9352
s_waitcnt lgkmcnt(6)
mm v,116,v,208,a,208,116
ds_read_b128 a[232:235], v244 offset:8192
buffer_load_dwordx4 v146, s[16:19], s41 offen offset:2048 nt lds
mm v,116,v,212,a,212,116
ds_read_b128 a[236:239], v245 offset:8192
s_add_u32 m0, s30, 15360
mm v,24,v,192,a,192,24
tr 208,242,256
s_add_u32 s41, s89, 261120
mm v,24,v,196,a,196,24
tr 210,242,3328
buffer_load_dwordx4 v144, s[16:19], s41 offen nt lds
mm v,72,v,192,a,200,72
tr 212,242,6400
mm v,72,v,196,a,204,72
tr 214,242,9472
s_waitcnt lgkmcnt(6)
mm v,120,v,192,a,208,120
ds_read_b128 a[240:243], v244 offset:10240
buffer_load_dwordx4 v145, s[16:19], s41 offen offset:1024 nt lds
mm v,120,v,196,a,212,120
ds_read_b128 a[244:247], v245 offset:10240
buffer_load_dwordx4 v146, s[16:19], s41 offen offset:2048 nt lds
mm v,28,v,200,a,192,28
tr 192,242,264
s_add_u32 m0, s30, 18432
mm v,28,v,204,a,196,28
tr 194,242,3336
s_add_u32 s41, s89, 294912
mm v,76,v,200,a,200,76
tr 196,242,6408
mm v,76,v,204,a,204,76
tr 198,242,9480
s_waitcnt lgkmcnt(8)
mm v,124,v,200,a,208,124
buffer_load_dwordx4 v144, s[16:19], s41 offen nt lds
mm v,124,v,204,a,212,124
buffer_load_dwordx4 v145, s[16:19], s41 offen offset:1024 nt lds
mm v,32,v,208,a,192,32
tr 200,243,256
s_waitcnt lgkmcnt(7)
mm v,32,v,212,a,196,32
tr 202,243,3328
buffer_load_dwordx4 v146, s[16:19], s41 offen offset:2048 nt lds
mm v,80,v,208,a,200,80
tr 204,243,6400
s_add_u32 m0, s30, 21504
mm v,80,v,212,a,204,80
tr 206,243,9472
mm v,128,v,208,a,208,128
s_add_u32 s41, s89, 359424
s_waitcnt lgkmcnt(4)
mm v,128,v,212,a,212,128
buffer_load_dwordx4 v144, s[16:19], s41 offen nt lds
mm v,36,v,192,a,192,36
tr 208,243,264
buffer_load_dwordx4 v145, s[16:19], s41 offen offset:1024 nt lds
mm v,36,v,196,a,196,36
tr 210,243,3336
mm v,84,v,192,a,200,84
tr 212,243,6408
buffer_load_dwordx4 v146, s[16:19], s41 offen offset:2048 nt lds
mm v,84,v,196,a,204,84
tr 214,243,9480
mm v,132,v,192,a,208,132
s_sub_u32 s42, s29, s48
s_mov_b32 s48, s29
v_add_u32 v242, s42, v242
mm v,132,v,196,a,212,132
s_waitcnt lgkmcnt(6)
v_add_u32 v243, s42, v243
mm v,40,v,200,a,192,40
s_waitcnt vmcnt(36) lgkmcnt(0)
s_barrier
mm v,40,v,204,a,196,40
tr 192,242,0
s_mov_b32 s43, s28
mm v,88,v,200,a,200,88
tr 194,242,3072
s_mov_b32 s28, s29
mm v,88,v,204,a,204,88
tr 196,242,6144
s_mov_b32 s29, s30
mm v,136,v,200,a,208,136
tr 198,242,9216
s_mov_b64 exec, 0
s_branch L_pg33
L_ir32:
s_mov_b64 exec, -1
L_ir32x:
mm v,136,v,204,a,212,136
s_mov_b32 s30, s43
mm v,44,v,208,a,192,44
tr 200,242,8
mm v,44,v,212,a,196,44
tr 202,242,3080
mm v,92,v,208,a,200,92
tr 204,242,6152
mm v,92,v,212,a,204,92
tr 206,242,9224
mm v,140,v,208,a,208,140
mm v,140,v,212,a,212,140
s_waitcnt lgkmcnt(4)
mm v,0,v,192,a,224,0
tr 208,243,0
s_add_u32 m0, s26, 12288
mm v,0,v,196,a,228,0
tr 210,243,3072
mm v,48,v,192,a,232,48
tr 212,243,6144
mm v,48,v,196,a,236,48
tr 214,243,9216
s_waitcnt lgkmcnt(4)
mm v,96,v,192,a,240,96
buffer_load_dwordx4 v160, s[12:15], s31 offen nt lds
s_add_u32 m0, s26, 0
mm v,96,v,196,a,244,96
buffer_load_dwordx4 v144, s[12:15], s31 offen nt lds
s_add_u32 m0, s26, 12288
mm v,4,v,200,a,224,4
tr 192,243,8
buffer_load_dwordx4 v161, s[12:15], s31 offen offset:1024 nt lds
s_add_u32 m0, s26, 18432
mm v,4,v,204,a,228,4
tr 194,243,3080
buffer_load_dwordx4 v168, s[12:15], s31 offen nt lds
mm v,52,v,200,a,232,52
tr 196,243,6152
s_add_u32 m0, s26, 0
mm v,52,v,204,a,236,52
tr 198,243,9224
s_waitcnt lgkmcnt(4)
mm v,100,v,200,a,240,100
buffer_load_dwordx4 v145, s[12:15], s31 offen offset:1024 nt lds
s_add_u32 m0, s26, 6144
mm v,100,v,204,a,244,100
buffer_load_dwordx4 v152, s[12:15], s31 offen nt lds
s_add_u32 m0, s26, 12288
mm v,8,v,208,a,224,8
tr 200,242,128
buffer_load_dwordx4 v162, s[12:15], s31 offen offset:2048 nt lds
s_add_u32 m0, s26, 18432
mm v,8,v,212,a,228,8
tr 202,242,3200
buffer_load_dwordx4 v169, s[12:15], s31 offen offset:1024 nt lds
mm v,56,v,208,a,232,56
tr 204,242,6272
s_add_u32 m0, s26, 0
mm v,56,v,212,a,236,56
tr 206,242,9344
s_waitcnt lgkmcnt(4)
mm v,104,v,208,a,240,104
buffer_load_dwordx4 v146, s[12:15], s31 offen offset:2048 nt lds
s_add_u32 m0, s26, 6144
mm v,104,v,212,a,244,104
buffer_load_dwordx4 v153, s[12:15], s31 offen offset:1024 nt lds
s_add_u32 s41, s31, 3072
s_add_u32 m0, s26, 15360
mm v,12,v,192,a,224,12
tr 208,242,136
buffer_load_dwordx4 v160, s[12:15], s41 offen nt lds
s_add_u32 m0, s26, 18432
mm v,12,v,196,a,228,12
tr 210,242,3208
buffer_load_dwordx4 v170, s[12:15], s31 offen offset:2048 nt lds
mm v,60,v,192,a,232,60
tr 212,242,6280
s_add_u32 m0, s26, 3072
mm v,60,v,196,a,236,60
tr 214,242,9352
s_waitcnt lgkmcnt(4)
mm v,108,v,192,a,240,108
buffer_load_dwordx4 v144, s[12:15], s41 offen nt lds
s_add_u32 m0, s26, 6144
mm v,108,v,196,a,244,108
buffer_load_dwordx4 v154, s[12:15], s31 offen offset:2048 nt lds
s_add_u32 m0, s26, 15360
mm v,16,v,200,a,224,16
tr 192,243,128
buffer_load_dwordx4 v161, s[12:15], s41 offen offset:1024 nt lds
s_add_u32 m0, s26, 21504
mm v,16,v,204,a,228,16
tr 194,243,3200
buffer_load_dwordx4 v168, s[12:15], s41 offen nt lds
mm v,64,v,200,a,232,64
tr 196,243,6272
s_add_u32 m0, s26, 3072
mm v,64,v,204,a,236,64
tr 198,243,9344
s_waitcnt lgkmcnt(4)
mm v,112,v,200,a,240,112
buffer_load_dwordx4 v145, s[12:15], s41 offen offset:1024 nt lds
s_add_u32 m0, s26, 9216
mm v,112,v,204,a,244,112
buffer_load_dwordx4 v152, s[12:15], s41 offen nt lds
s_add_u32 m0, s26, 15360
mm v,20,v,208,a,224,20
tr 200,243,136
buffer_load_dwordx4 v162, s[12:15], s41 offen offset:2048 nt lds
s_add_u32 m0, s26, 21504
mm v,20,v,212,a,228,20
tr 202,243,3208
buffer_load_dwordx4 v169, s[12:15], s41 offen offset:1024 nt lds
mm v,68,v,208,a,232,68
tr 204,243,6280
s_add_u32 m0, s26, 3072
mm v,68,v,212,a,236,68
tr 206,243,9352
mm v,116,v,208,a,240,116
mm v,116,v,212,a,244,116
s_waitcnt lgkmcnt(6)
mm v,24,v,192,a,224,24
tr 208,242,256
s_waitcnt lgkmcnt(5)
mm v,24,v,196,a,228,24
tr 210,242,3328
mm v,72,v,192,a,232,72
tr 212,242,6400
mm v,72,v,196,a,236,72
tr 214,242,9472
s_waitcnt lgkmcnt(4)
mm v,120,v,192,a,240,120
buffer_load_dwordx4 v146, s[12:15], s41 offen offset:2048 nt lds
s_add_u32 m0, s26, 9216
mm v,120,v,196,a,244,120
buffer_load_dwordx4 v153, s[12:15], s41 offen offset:1024 nt lds
s_add_u32 m0, s26, 21504
mm v,28,v,200,a,224,28
tr 192,242,264
buffer_load_dwordx4 v170, s[12:15], s41 offen offset:2048 nt lds
mm v,28,v,204,a,228,28
tr 194,242,3336
s_add_u32 m0, s26, 9216
mm v,76,v,200,a,232,76
tr 196,242,6408
mm v,76,v,204,a,236,76
tr 198,242,9480
s_waitcnt lgkmcnt(4)
mm v,124,v,200,a,240,124
buffer_load_dwordx4 v154, s[12:15], s41 offen offset:2048 nt lds
s_add_u32 s92, s92, 1
s_cmp_eq_u32 s92, 15
s_cselect_b32 s92, 0, s92
s_mul_i32 s55, s92, 13
s_lshr_b32 s55, s55, 6
s_mul_i32 s55, s55, 101376
s_mul_i32 s31, s92, 6144
s_add_u32 s31, s31, s55
s_add_u32 s31, s31, s89
s_add_u32 m0, s30, 12288
mm v,124,v,204,a,244,124
buffer_load_dwordx4 v160, s[16:19], s32 offen nt lds
mm v,32,v,208,a,224,32
tr 200,243,256
s_add_u32 m0, s30, 0
mm v,32,v,212,a,228,32
tr 202,243,3328
mm v,80,v,208,a,232,80
tr 204,243,6400
mm v,80,v,212,a,236,80
tr 206,243,9472
s_waitcnt lgkmcnt(4)
mm v,128,v,208,a,240,128
buffer_load_dwordx4 v144, s[16:19], s32 offen nt lds
s_add_u32 m0, s30, 12288
mm v,128,v,212,a,244,128
buffer_load_dwordx4 v161, s[16:19], s32 offen offset:1024 nt lds
s_add_u32 m0, s30, 18432
mm v,36,v,192,a,224,36
tr 208,243,264
buffer_load_dwordx4 v168, s[16:19], s32 offen nt lds
s_add_u32 m0, s30, 0
mm v,36,v,196,a,228,36
tr 210,243,3336
buffer_load_dwordx4 v145, s[16:19], s32 offen offset:1024 nt lds
s_add_u32 m0, s30, 6144
mm v,84,v,192,a,232,84
tr 212,243,6408
buffer_load_dwordx4 v152, s[16:19], s32 offen nt lds
mm v,84,v,196,a,236,84
tr 214,243,9480
mm v,132,v,192,a,240,132
s_sub_u32 s42, s29, s49
s_mov_b32 s49, s29
v_add_u32 v238, s42, v238
mm v,132,v,196,a,244,132
s_waitcnt lgkmcnt(6)
v_add_u32 v239, s42, v239
v_add_u32 v240, s42, v240
mm v,40,v,200,a,224,40
s_waitcnt vmcnt(54) lgkmcnt(0)
s_barrier
v_add_u32 v241, s42, v241
mm v,40,v,204,a,228,40
ds_read_b128 a[192:195], v236
s_mov_b32 s43, s28
mm v,88,v,200,a,232,88
ds_read_b128 a[196:199], v237
s_mov_b32 s28, s29
mm v,88,v,204,a,236,88
ds_read_b128 a[200:203], v236 offset:128
s_mov_b32 s29, s30
mm v,136,v,200,a,240,136
ds_read_b128 a[204:207], v237 offset:128
s_mov_b32 s30, s43
mm v,136,v,204,a,244,136
ds_read_b128 a[208:211], v236 offset:256
mm v,44,v,208,a,224,44
ds_read_b128 a[212:215], v237 offset:256
mm v,44,v,212,a,228,44
mm v,92,v,208,a,232,92
mm v,92,v,212,a,236,92
mm v,140,v,208,a,240,140
mm v,140,v,212,a,244,140
L_head_3:
L_pg77:
s_cbranch_execz L_ir76
v_mul_f32 v224, 0xbdd53b95, v247
v_mul_f32 v225, 0xbdd53b95, v247
v_pk_fma_f32 v[0:1], v[0:1], s[38:39], v[224:225]
s_add_u32 m0, s29, 12288
v_pk_fma_f32 v[2:3], v[2:3], s[38:39], v[224:225]
v_pk_fma_f32 v[4:5], v[4:5], s[38:39], v[224:225]
v_pk_fma_f32 v[6:7], v[6:7], s[38:39], v[224:225]
v_cvt_pk_bf16_f32 v0, v0, v1
buffer_load_dwordx4 v162, s[16:19], s32 offen offset:2048 nt lds
v_cvt_pk_bf16_f32 v1, v2, v3
v_cvt_pk_bf16_f32 v2, v4, v5
v_cvt_pk_bf16_f32 v3, v6, v7
v_pk_fma_f32 v[48:49], v[48:49], s[38:39], v[224:225]
s_add_u32 m0, s29, 18432
v_pk_fma_f32 v[50:51], v[50:51], s[38:39], v[224:225]
v_pk_fma_f32 v[52:53], v[52:53], s[38:39], v[224:225]
v_pk_fma_f32 v[54:55], v[54:55], s[38:39], v[224:225]
v_cvt_pk_bf16_f32 v48, v48, v49
buffer_load_dwordx4 v169, s[16:19], s32 offen offset:1024 nt lds
v_cvt_pk_bf16_f32 v49, v50, v51
v_cvt_pk_bf16_f32 v50, v52, v53
v_cvt_pk_bf16_f32 v51, v54, v55
v_pk_fma_f32 v[96:97], v[96:97], s[38:39], v[224:225]
s_add_u32 m0, s29, 0
v_pk_fma_f32 v[98:99], v[98:99], s[38:39], v[224:225]
v_pk_fma_f32 v[100:101], v[100:101], s[38:39], v[224:225]
v_pk_fma_f32 v[102:103], v[102:103], s[38:39], v[224:225]
v_cvt_pk_bf16_f32 v96, v96, v97
buffer_load_dwordx4 v146, s[16:19], s32 offen offset:2048 nt lds
v_cvt_pk_bf16_f32 v97, v98, v99
v_cvt_pk_bf16_f32 v98, v100, v101
v_cvt_pk_bf16_f32 v99, v102, v103
v_pk_fma_f32 v[8:9], v[8:9], s[38:39], v[224:225]
s_add_u32 m0, s29, 6144
v_pk_fma_f32 v[10:11], v[10:11], s[38:39], v[224:225]
v_pk_fma_f32 v[12:13], v[12:13], s[38:39], v[224:225]
v_pk_fma_f32 v[14:15], v[14:15], s[38:39], v[224:225]
v_cvt_pk_bf16_f32 v8, v8, v9
buffer_load_dwordx4 v153, s[16:19], s32 offen offset:1024 nt lds
v_cvt_pk_bf16_f32 v9, v10, v11
v_cvt_pk_bf16_f32 v10, v12, v13
v_cvt_pk_bf16_f32 v11, v14, v15
v_pk_fma_f32 v[56:57], v[56:57], s[38:39], v[224:225]
s_add_u32 s41, s32, 3072
v_pk_fma_f32 v[58:59], v[58:59], s[38:39], v[224:225]
v_pk_fma_f32 v[60:61], v[60:61], s[38:39], v[224:225]
v_pk_fma_f32 v[62:63], v[62:63], s[38:39], v[224:225]
v_cvt_pk_bf16_f32 v56, v56, v57
s_add_u32 m0, s29, 15360
v_cvt_pk_bf16_f32 v57, v58, v59
v_cvt_pk_bf16_f32 v58, v60, v61
v_cvt_pk_bf16_f32 v59, v62, v63
v_pk_fma_f32 v[104:105], v[104:105], s[38:39], v[224:225]
buffer_load_dwordx4 v160, s[16:19], s41 offen nt lds
v_pk_fma_f32 v[106:107], v[106:107], s[38:39], v[224:225]
v_pk_fma_f32 v[108:109], v[108:109], s[38:39], v[224:225]
v_pk_fma_f32 v[110:111], v[110:111], s[38:39], v[224:225]
v_cvt_pk_bf16_f32 v104, v104, v105
s_add_u32 m0, s29, 18432
v_cvt_pk_bf16_f32 v105, v106, v107
v_cvt_pk_bf16_f32 v106, v108, v109
v_cvt_pk_bf16_f32 v107, v110, v111
v_pk_fma_f32 v[16:17], v[16:17], s[38:39], v[224:225]
buffer_load_dwordx4 v170, s[16:19], s32 offen offset:2048 nt lds
v_pk_fma_f32 v[18:19], v[18:19], s[38:39], v[224:225]
v_pk_fma_f32 v[20:21], v[20:21], s[38:39], v[224:225]
v_pk_fma_f32 v[22:23], v[22:23], s[38:39], v[224:225]
v_cvt_pk_bf16_f32 v16, v16, v17
s_add_u32 m0, s29, 3072
v_cvt_pk_bf16_f32 v17, v18, v19
v_cvt_pk_bf16_f32 v18, v20, v21
v_cvt_pk_bf16_f32 v19, v22, v23
v_pk_fma_f32 v[64:65], v[64:65], s[38:39], v[224:225]
buffer_load_dwordx4 v144, s[16:19], s41 offen nt lds
v_pk_fma_f32 v[66:67], v[66:67], s[38:39], v[224:225]
v_pk_fma_f32 v[68:69], v[68:69], s[38:39], v[224:225]
v_pk_fma_f32 v[70:71], v[70:71], s[38:39], v[224:225]
v_cvt_pk_bf16_f32 v64, v64, v65
s_add_u32 m0, s29, 6144
v_cvt_pk_bf16_f32 v65, v66, v67
v_cvt_pk_bf16_f32 v66, v68, v69
v_cvt_pk_bf16_f32 v67, v70, v71
v_pk_fma_f32 v[112:113], v[112:113], s[38:39], v[224:225]
buffer_load_dwordx4 v154, s[16:19], s32 offen offset:2048 nt lds
v_pk_fma_f32 v[114:115], v[114:115], s[38:39], v[224:225]
v_pk_fma_f32 v[116:117], v[116:117], s[38:39], v[224:225]
v_pk_fma_f32 v[118:119], v[118:119], s[38:39], v[224:225]
v_cvt_pk_bf16_f32 v112, v112, v113
s_add_u32 m0, s29, 15360
v_cvt_pk_bf16_f32 v113, v114, v115
v_cvt_pk_bf16_f32 v114, v116, v117
v_cvt_pk_bf16_f32 v115, v118, v119
v_pk_fma_f32 v[24:25], v[24:25], s[38:39], v[224:225]
buffer_load_dwordx4 v161, s[16:19], s41 offen offset:1024 nt lds
v_pk_fma_f32 v[26:27], v[26:27], s[38:39], v[224:225]
v_pk_fma_f32 v[28:29], v[28:29], s[38:39], v[224:225]
v_pk_fma_f32 v[30:31], v[30:31], s[38:39], v[224:225]
v_cvt_pk_bf16_f32 v24, v24, v25
v_cvt_pk_bf16_f32 v25, v26, v27
v_cvt_pk_bf16_f32 v26, v28, v29
v_cvt_pk_bf16_f32 v27, v30, v31
v_pk_fma_f32 v[72:73], v[72:73], s[38:39], v[224:225]
v_pk_fma_f32 v[74:75], v[74:75], s[38:39], v[224:225]
v_pk_fma_f32 v[76:77], v[76:77], s[38:39], v[224:225]
v_pk_fma_f32 v[78:79], v[78:79], s[38:39], v[224:225]
v_cvt_pk_bf16_f32 v72, v72, v73
v_cvt_pk_bf16_f32 v73, v74, v75
v_cvt_pk_bf16_f32 v74, v76, v77
v_cvt_pk_bf16_f32 v75, v78, v79
v_pk_fma_f32 v[120:121], v[120:121], s[38:39], v[224:225]
v_pk_fma_f32 v[122:123], v[122:123], s[38:39], v[224:225]
v_pk_fma_f32 v[124:125], v[124:125], s[38:39], v[224:225]
v_pk_fma_f32 v[126:127], v[126:127], s[38:39], v[224:225]
v_cvt_pk_bf16_f32 v120, v120, v121
v_cvt_pk_bf16_f32 v121, v122, v123
v_cvt_pk_bf16_f32 v122, v124, v125
v_cvt_pk_bf16_f32 v123, v126, v127
v_pk_fma_f32 v[32:33], v[32:33], s[38:39], v[224:225]
v_pk_fma_f32 v[34:35], v[34:35], s[38:39], v[224:225]
v_pk_fma_f32 v[36:37], v[36:37], s[38:39], v[224:225]
v_pk_fma_f32 v[38:39], v[38:39], s[38:39], v[224:225]
v_cvt_pk_bf16_f32 v32, v32, v33
v_cvt_pk_bf16_f32 v33, v34, v35
v_cvt_pk_bf16_f32 v34, v36, v37
v_cvt_pk_bf16_f32 v35, v38, v39
v_pk_fma_f32 v[80:81], v[80:81], s[38:39], v[224:225]
v_pk_fma_f32 v[82:83], v[82:83], s[38:39], v[224:225]
v_pk_fma_f32 v[84:85], v[84:85], s[38:39], v[224:225]
v_pk_fma_f32 v[86:87], v[86:87], s[38:39], v[224:225]
v_cvt_pk_bf16_f32 v80, v80, v81
v_cvt_pk_bf16_f32 v81, v82, v83
v_cvt_pk_bf16_f32 v82, v84, v85
v_cvt_pk_bf16_f32 v83, v86, v87
v_pk_fma_f32 v[128:129], v[128:129], s[38:39], v[224:225]
v_pk_fma_f32 v[130:131], v[130:131], s[38:39], v[224:225]
v_pk_fma_f32 v[132:133], v[132:133], s[38:39], v[224:225]
v_pk_fma_f32 v[134:135], v[134:135], s[38:39], v[224:225]
v_cvt_pk_bf16_f32 v128, v128, v129
v_cvt_pk_bf16_f32 v129, v130, v131
v_cvt_pk_bf16_f32 v130, v132, v133
v_cvt_pk_bf16_f32 v131, v134, v135
v_pk_fma_f32 v[40:41], v[40:41], s[38:39], v[224:225]
v_pk_fma_f32 v[42:43], v[42:43], s[38:39], v[224:225]
v_pk_fma_f32 v[44:45], v[44:45], s[38:39], v[224:225]
v_pk_fma_f32 v[46:47], v[46:47], s[38:39], v[224:225]
v_cvt_pk_bf16_f32 v40, v40, v41
v_cvt_pk_bf16_f32 v41, v42, v43
v_cvt_pk_bf16_f32 v42, v44, v45
v_cvt_pk_bf16_f32 v43, v46, v47
v_pk_fma_f32 v[88:89], v[88:89], s[38:39], v[224:225]
v_pk_fma_f32 v[90:91], v[90:91], s[38:39], v[224:225]
v_pk_fma_f32 v[92:93], v[92:93], s[38:39], v[224:225]
v_pk_fma_f32 v[94:95], v[94:95], s[38:39], v[224:225]
v_cvt_pk_bf16_f32 v88, v88, v89
v_cvt_pk_bf16_f32 v89, v90, v91
v_cvt_pk_bf16_f32 v90, v92, v93
v_cvt_pk_bf16_f32 v91, v94, v95
v_pk_fma_f32 v[136:137], v[136:137], s[38:39], v[224:225]
v_pk_fma_f32 v[138:139], v[138:139], s[38:39], v[224:225]
v_pk_fma_f32 v[140:141], v[140:141], s[38:39], v[224:225]
v_pk_fma_f32 v[142:143], v[142:143], s[38:39], v[224:225]
v_cvt_pk_bf16_f32 v136, v136, v137
v_cvt_pk_bf16_f32 v137, v138, v139
v_cvt_pk_bf16_f32 v138, v140, v141
v_cvt_pk_bf16_f32 v139, v142, v143
v_mov_b32 v164, 0xff800000
v_mov_b32 v172, 0xff800000
v_mov_b32 v180, 0xff800000
L_prol_3:
v_and_b32 v224, 48, v253
v_mov_b32 v225, 0x3f803f80
v_cmp_eq_u32 vcc, 0, v224
s_nop 1
v_cndmask_b32 v232, 0, v225, vcc
v_cndmask_b32 v233, 0, v225, vcc
v_cndmask_b32 v234, 0, v225, vcc
v_cndmask_b32 v235, 0, v225, vcc
s_waitcnt lgkmcnt(2)
mz v,132,a,192,v,0
L_pg23:
s_cbranch_execz L_ir22
ds_read_b128 a[216:219], v236 offset:6144
s_add_u32 s41, s32, 3072
s_add_u32 m0, s29, 21504
mm v,132,a,196,v,8,132
buffer_load_dwordx4 v168, s[16:19], s41 offen nt lds
mm v,132,a,200,v,16,132
ds_read_b128 a[220:223], v237 offset:6144
s_add_u32 m0, s29, 3072
mm v,132,a,204,v,24,132
s_waitcnt lgkmcnt(3)
mm v,132,a,208,v,32,132
ds_read_b128 a[224:227], v236 offset:6272
s_waitcnt lgkmcnt(3)
mm v,132,a,212,v,40,132
mz v,140,a,192,v,48
ds_read_b128 a[228:231], v237 offset:6272
mm v,140,a,196,v,56,140
mm v,140,a,200,v,64,140
ds_read_b128 a[232:235], v236 offset:6400
mm v,140,a,204,v,72,140
buffer_load_dwordx4 v145, s[16:19], s41 offen offset:1024 nt lds
s_add_u32 m0, s29, 9216
mm v,140,a,208,v,80,140
ds_read_b128 a[236:239], v237 offset:6400
buffer_load_dwordx4 v152, s[16:19], s41 offen nt lds
s_add_u32 m0, s29, 15360
mm v,140,a,212,v,88,140
buffer_load_dwordx4 v162, s[16:19], s41 offen offset:2048 nt lds
s_add_u32 m0, s29, 21504
mz v,148,a,192,v,96
buffer_load_dwordx4 v169, s[16:19], s41 offen offset:1024 nt lds
s_add_u32 m0, s29, 3072
v_max3_f32 v225, v132, v133, v134
v_max3_f32 v225, v225, v135, v164
v_mov_b32 v224, v225
s_nop 1
v_permlane32_swap_b32 v224, v225
mm v,148,a,196,v,104,148
buffer_load_dwordx4 v146, s[16:19], s41 offen offset:2048 nt lds
s_add_u32 m0, s29, 9216
v_max_f32 v225, v225, v224
v_mov_b32 v224, v225
s_nop 1
v_permlane16_swap_b32 v224, v225
mm v,148,a,200,v,112,148
buffer_load_dwordx4 v153, s[16:19], s41 offen offset:1024 nt lds
s_add_u32 m0, s29, 21504
v_max_f32 v225, v225, v224
v_add_f32 v225, 0x40900000, v225
v_sub_f32 v164, 0, v225
v_sub_f32 v165, 0, v225
mm v,148,a,204,v,120,148
buffer_load_dwordx4 v170, s[16:19], s41 offen offset:2048 nt lds
v_sub_f32 v166, 0, v225
v_sub_f32 v167, 0, v225
v_sub_f32 v132, v132, v225
v_sub_f32 v133, v133, v225
mm v,148,a,208,v,128,148
s_add_u32 m0, s29, 9216
v_sub_f32 v134, v134, v225
v_sub_f32 v135, v135, v225
v_exp_f32 v132, v132
v_exp_f32 v133, v133
mm v,148,a,212,v,136,148
buffer_load_dwordx4 v154, s[16:19], s41 offen offset:2048 nt lds
v_exp_f32 v134, v134
v_exp_f32 v135, v135
v_cvt_pk_bf16_f32 v4, v132, v133
v_cvt_pk_bf16_f32 v5, v134, v135
s_waitcnt lgkmcnt(0)
mm v,156,a,216,v,0,164
ds_read_b128 a[192:195], v236 offset:12288
s_add_u32 s93, s93, 1
s_cmp_eq_u32 s93, 15
s_cselect_b32 s93, 0, s93
s_mul_i32 s55, s93, 13
s_lshr_b32 s55, s55, 6
s_mul_i32 s55, s55, 101376
s_mul_i32 s32, s93, 6144
s_add_u32 s32, s32, s55
s_add_u32 s32, s32, s89
s_add_u32 m0, s27, 12288
v_max3_f32 v225, v140, v141, v142
v_max3_f32 v225, v225, v143, v172
v_mov_b32 v224, v225
s_nop 1
v_permlane32_swap_b32 v224, v225
mm v,156,a,220,v,8,156
buffer_load_dwordx4 v160, s[12:15], s31 offen nt lds
v_max_f32 v225, v225, v224
v_mov_b32 v224, v225
s_nop 1
v_permlane16_swap_b32 v224, v225
mm v,156,a,224,v,16,156
ds_read_b128 a[196:199], v237 offset:12288
s_add_u32 m0, s27, 0
v_max_f32 v225, v225, v224
v_add_f32 v225, 0x40900000, v225
v_sub_f32 v172, 0, v225
v_sub_f32 v173, 0, v225
mm v,156,a,228,v,24,156
buffer_load_dwordx4 v144, s[12:15], s31 offen nt lds
s_add_u32 m0, s27, 12288
v_sub_f32 v174, 0, v225
v_sub_f32 v175, 0, v225
v_sub_f32 v140, v140, v225
v_sub_f32 v141, v141, v225
mm v,156,a,232,v,32,156
ds_read_b128 a[200:203], v236 offset:12416
buffer_load_dwordx4 v161, s[12:15], s31 offen offset:1024 nt lds
s_add_u32 m0, s27, 18432
v_sub_f32 v142, v142, v225
v_sub_f32 v143, v143, v225
v_exp_f32 v140, v140
v_exp_f32 v141, v141
mm v,156,a,236,v,40,156
buffer_load_dwordx4 v168, s[12:15], s31 offen nt lds
v_exp_f32 v142, v142
v_exp_f32 v143, v143
v_cvt_pk_bf16_f32 v20, v140, v141
v_cvt_pk_bf16_f32 v21, v142, v143
mm v,132,a,216,v,48,172
ds_read_b128 a[204:207], v237 offset:12416
s_add_u32 m0, s27, 0
v_max3_f32 v225, v148, v149, v150
v_max3_f32 v225, v225, v151, v180
v_mov_b32 v224, v225
s_nop 1
v_permlane32_swap_b32 v224, v225
mm v,132,a,220,v,56,132
v_max_f32 v225, v225, v224
v_mov_b32 v224, v225
s_nop 1
v_permlane16_swap_b32 v224, v225
mm v,132,a,224,v,64,132
ds_read_b128 a[208:211], v236 offset:12544
v_max_f32 v225, v225, v224
v_add_f32 v225, 0x40900000, v225
v_sub_f32 v180, 0, v225
v_sub_f32 v181, 0, v225
mm v,132,a,228,v,72,132
v_sub_f32 v182, 0, v225
v_sub_f32 v183, 0, v225
v_sub_f32 v148, v148, v225
v_sub_f32 v149, v149, v225
mm v,132,a,232,v,80,132
ds_read_b128 a[212:215], v237 offset:12544
v_sub_f32 v150, v150, v225
v_sub_f32 v151, v151, v225
v_exp_f32 v148, v148
v_exp_f32 v149, v149
mm v,132,a,236,v,88,132
buffer_load_dwordx4 v145, s[12:15], s31 offen offset:1024 nt lds
s_add_u32 m0, s27, 6144
v_exp_f32 v150, v150
v_exp_f32 v151, v151
v_cvt_pk_bf16_f32 v36, v148, v149
v_cvt_pk_bf16_f32 v37, v150, v151
mm v,140,a,216,v,96,180
buffer_load_dwordx4 v152, s[12:15], s31 offen nt lds
s_add_u32 m0, s27, 12288
v_exp_f32 v156, v156
mm v,140,a,220,v,104,140
buffer_load_dwordx4 v162, s[12:15], s31 offen offset:2048 nt lds
s_add_u32 m0, s27, 18432
v_exp_f32 v157, v157
mm v,140,a,224,v,112,140
buffer_load_dwordx4 v169, s[12:15], s31 offen offset:1024 nt lds
v_exp_f32 v158, v158
mm v,140,a,228,v,120,140
s_add_u32 m0, s27, 0
v_exp_f32 v159, v159
mm v,140,a,232,v,128,140
buffer_load_dwordx4 v146, s[12:15], s31 offen offset:2048 nt lds
s_add_u32 m0, s27, 6144
v_cvt_pk_bf16_f32 v6, v156, v157
mm v,140,a,236,v,136,140
buffer_load_dwordx4 v153, s[12:15], s31 offen offset:1024 nt lds
s_add_u32 s41, s31, 3072
s_add_u32 m0, s27, 15360
v_cvt_pk_bf16_f32 v7, v158, v159
s_waitcnt lgkmcnt(2)
mm v,148,a,192,v,0,164
ds_read_b128 a[216:219], v236 offset:18432
buffer_load_dwordx4 v160, s[12:15], s41 offen nt lds
s_add_u32 m0, s27, 18432
v_exp_f32 v132, v132
mm v,148,a,196,v,8,148
buffer_load_dwordx4 v170, s[12:15], s31 offen offset:2048 nt lds
v_exp_f32 v133, v133
mm v,148,a,200,v,16,148
ds_read_b128 a[220:223], v237 offset:18432
s_add_u32 m0, s27, 3072
v_exp_f32 v134, v134
mm v,148,a,204,v,24,148
s_waitcnt lgkmcnt(2)
v_exp_f32 v135, v135
mm v,148,a,208,v,32,148
ds_read_b128 a[224:227], v236 offset:18560
v_cvt_pk_bf16_f32 v22, v132, v133
mm v,148,a,212,v,40,148
v_cvt_pk_bf16_f32 v23, v134, v135
mm v,156,a,192,v,48,172
ds_read_b128 a[228:231], v237 offset:18560
v_exp_f32 v140, v140
mm v,156,a,196,v,56,156
v_exp_f32 v141, v141
mm v,156,a,200,v,64,156
ds_read_b128 a[232:235], v236 offset:18688
v_exp_f32 v142, v142
mm v,156,a,204,v,72,156
v_exp_f32 v143, v143
mm v,156,a,208,v,80,156
ds_read_b128 a[236:239], v237 offset:18688
v_cvt_pk_bf16_f32 v38, v140, v141
mm v,156,a,212,v,88,156
s_sub_u32 s47, s26, s25
v_add_u32 v236, s47, v236
v_add_u32 v237, s47, v237
v_cvt_pk_bf16_f32 v39, v142, v143
mm v,132,a,192,v,96,180
buffer_load_dwordx4 v144, s[12:15], s41 offen nt lds
s_add_u32 m0, s27, 6144
v_exp_f32 v148, v148
mm v,132,a,196,v,104,132
buffer_load_dwordx4 v154, s[12:15], s31 offen offset:2048 nt lds
s_add_u32 m0, s27, 15360
v_exp_f32 v149, v149
mm v,132,a,200,v,112,132
buffer_load_dwordx4 v161, s[12:15], s41 offen offset:1024 nt lds
v_exp_f32 v150, v150
mm v,132,a,204,v,120,132
v_exp_f32 v151, v151
mm v,132,a,208,v,128,132
v_cvt_pk_bf16_f32 v12, v148, v149
mm v,132,a,212,v,136,132
s_waitcnt vmcnt(39) lgkmcnt(0)
s_barrier
v_cvt_pk_bf16_f32 v13, v150, v151
mm v,140,a,216,v,0,164
ds_read_b128 a[192:195], v236
s_mov_b32 s43, s25
v_exp_f32 v156, v156
mm v,140,a,220,v,8,140
ds_read_b128 a[196:199], v237
s_mov_b32 s25, s26
v_exp_f32 v157, v157
mm v,140,a,224,v,16,140
ds_read_b128 a[200:203], v236 offset:128
s_mov_b32 s26, s27
v_exp_f32 v158, v158
mm v,140,a,228,v,24,140
ds_read_b128 a[204:207], v237 offset:128
s_mov_b32 s27, s43
v_exp_f32 v159, v159
mm v,140,a,232,v,32,140
ds_read_b128 a[208:211], v236 offset:256
s_add_u32 s41, s31, 3072
s_add_u32 m0, s26, 21504
v_cvt_pk_bf16_f32 v28, v156, v157
mm v,140,a,236,v,40,140
ds_read_b128 a[212:215], v237 offset:256
buffer_load_dwordx4 v168, s[12:15], s41 offen nt lds
s_add_u32 m0, s26, 3072
v_cvt_pk_bf16_f32 v29, v158, v159
mm v,148,a,216,v,48,172
tr 192,238,0
buffer_load_dwordx4 v145, s[12:15], s41 offen offset:1024 nt lds
s_add_u32 m0, s26, 9216
v_exp_f32 v132, v132
mm v,148,a,220,v,56,148
tr 194,238,6144
buffer_load_dwordx4 v152, s[12:15], s41 offen nt lds
s_add_u32 m0, s26, 15360
v_exp_f32 v133, v133
mm v,148,a,224,v,64,148
tr 196,238,12288
buffer_load_dwordx4 v162, s[12:15], s41 offen offset:2048 nt lds
s_add_u32 m0, s26, 21504
v_exp_f32 v134, v134
mm v,148,a,228,v,72,148
tr 198,238,18432
buffer_load_dwordx4 v169, s[12:15], s41 offen offset:1024 nt lds
v_exp_f32 v135, v135
mm v,148,a,232,v,80,148
tr 200,239,0
s_add_u32 m0, s26, 3072
v_cvt_pk_bf16_f32 v44, v132, v133
mm v,148,a,236,v,88,148
tr 202,239,6144
v_cvt_pk_bf16_f32 v45, v134, v135
mm v,156,a,216,v,96,180
tr 204,239,12288
buffer_load_dwordx4 v146, s[12:15], s41 offen offset:2048 nt lds
s_add_u32 m0, s26, 9216
v_exp_f32 v140, v140
mm v,156,a,220,v,104,156
tr 206,239,18432
buffer_load_dwordx4 v153, s[12:15], s41 offen offset:1024 nt lds
s_add_u32 m0, s26, 21504
v_exp_f32 v141, v141
mm v,156,a,224,v,112,156
tr 208,240,0
buffer_load_dwordx4 v170, s[12:15], s41 offen offset:2048 nt lds
v_exp_f32 v142, v142
mm v,156,a,228,v,120,156
tr 210,240,6144
s_add_u32 m0, s26, 9216
v_exp_f32 v143, v143
mm v,156,a,232,v,128,156
tr 212,240,12288
buffer_load_dwordx4 v154, s[12:15], s41 offen offset:2048 nt lds
v_cvt_pk_bf16_f32 v14, v140, v141
mm v,156,a,236,v,136,156
tr 214,240,18432
s_add_u32 s92, s92, 1
s_cmp_eq_u32 s92, 15
s_cselect_b32 s92, 0, s92
s_mul_i32 s55, s92, 13
s_lshr_b32 s55, s55, 6
s_mul_i32 s55, s55, 101376
s_mul_i32 s31, s92, 6144
s_add_u32 s31, s31, s55
s_add_u32 s31, s31, s89
v_cvt_pk_bf16_f32 v15, v142, v143
v_exp_f32 v148, v148
v_exp_f32 v149, v149
v_exp_f32 v150, v150
v_exp_f32 v151, v151
v_cvt_pk_bf16_f32 v30, v148, v149
v_cvt_pk_bf16_f32 v31, v150, v151
s_waitcnt lgkmcnt(4)
v_max3_f32 v248, |v192|, |v193|, |v194|
v_max3_f32 v248, v248, |v195|, |v196|
v_max3_f32 v248, v248, |v197|, |v198|
v_max3_f32 v248, v248, |v199|, |v200|
v_max3_f32 v248, v248, |v201|, |v202|
v_max3_f32 v248, v248, |v203|, |v204|
v_max3_f32 v248, v248, |v205|, |v206|
v_max3_f32 v248, v248, |v207|, |v207|
v_and_b32 v248, 0x7f800000, v248
v_mul_f32 v248, 0x41400000, v248
v_min_f32 v248, 0x71800000, v248
s_nop 0
v_readlane_b32 s57, v248, 0
v_readlane_b32 s58, v248, 21
v_readlane_b32 s59, v248, 42
s_nop 3
s_min_u32 s57, s57, s58
s_min_u32 s57, s57, s59
v_mov_b32 v248, s57
v_accvgpr_write_b32 a252, v248
v_accvgpr_write_b32 a253, v248
v_accvgpr_write_b32 a254, v248
v_accvgpr_write_b32 a255, v248
mm v,132,a,192,v,0,164
s_add_u32 m0, s30, 12288
v_exp_f32 v156, v156
mm v,132,a,196,v,8,132
tr 216,241,0
buffer_load_dwordx4 v160, s[16:19], s32 offen nt lds
mm v,132,a,200,v,16,132
s_add_u32 m0, s30, 0
v_exp_f32 v157, v157
mm v,132,a,204,v,24,132
tr 218,241,6144
v_cvt_pk_bf16_f32 v46, v156, v157
mm v,132,a,208,v,32,132
v_exp_f32 v158, v158
mm v,132,a,212,v,40,132
tr 220,241,12288
mm a,0,v,4,v,192,252
v_exp_f32 v159, v159
mm a,0,v,12,v,196,0
tr 222,241,18432
v_cvt_pk_bf16_f32 v47, v158, v159
mm a,4,v,20,v,192,252
ds_read_b128 a[216:219], v236 offset:6144
buffer_load_dwordx4 v144, s[16:19], s32 offen nt lds
s_add_u32 m0, s30, 12288
mm a,4,v,28,v,196,4
ds_read_b128 a[220:223], v237 offset:6144
buffer_load_dwordx4 v161, s[16:19], s32 offen offset:1024 nt lds
s_add_u32 m0, s30, 18432
mm a,8,v,36,v,192,252
ds_read_b128 a[224:227], v236 offset:6272
buffer_load_dwordx4 v168, s[16:19], s32 offen nt lds
mm a,8,v,44,v,196,8
ds_read_b128 a[228:231], v237 offset:6272
s_add_u32 m0, s30, 0
mm v,140,a,192,v,48,172
buffer_load_dwordx4 v145, s[16:19], s32 offen offset:1024 nt lds
s_add_u32 m0, s30, 6144
v_exp_f32 v132, v132
mm v,140,a,196,v,56,140
ds_read_b128 a[232:235], v236 offset:6400
buffer_load_dwordx4 v152, s[16:19], s32 offen nt lds
s_add_u32 m0, s30, 12288
mm v,140,a,200,v,64,140
buffer_load_dwordx4 v162, s[16:19], s32 offen offset:2048 nt lds
s_add_u32 m0, s30, 18432
v_exp_f32 v133, v133
mm v,140,a,204,v,72,140
ds_read_b128 a[236:239], v237 offset:6400
buffer_load_dwordx4 v169, s[16:19], s32 offen offset:1024 nt lds
mm v,140,a,208,v,80,140
v_exp_f32 v134, v134
mm v,140,a,212,v,88,140
tr 192,238,128
v_cvt_pk_bf16_f32 v68, v132, v133
mm a,16,v,4,v,200,252
s_add_u32 m0, s30, 0
v_exp_f32 v135, v135
mm a,16,v,12,v,204,16
tr 194,238,6272
mm a,20,v,20,v,200,252
tr 196,238,12416
s_mov_b32 s35, 6
mm a,20,v,28,v,204,20
tr 198,238,18560
v_cvt_pk_bf16_f32 v69, v134, v135
mm a,24,v,36,v,200,252
buffer_load_dwordx4 v146, s[16:19], s32 offen offset:2048 nt lds
s_add_u32 m0, s30, 6144
mm a,24,v,44,v,204,24
buffer_load_dwordx4 v153, s[16:19], s32 offen offset:1024 nt lds
s_add_u32 s41, s32, 3072
s_add_u32 m0, s30, 15360
mm v,148,a,192,v,96,180
buffer_load_dwordx4 v160, s[16:19], s41 offen nt lds
s_add_u32 m0, s30, 18432
v_exp_f32 v140, v140
mm v,148,a,196,v,104,148
tr 200,239,128
buffer_load_dwordx4 v170, s[16:19], s32 offen offset:2048 nt lds
mm v,148,a,200,v,112,148
s_add_u32 m0, s30, 3072
v_exp_f32 v141, v141
mm v,148,a,204,v,120,148
tr 202,239,6272
mm v,148,a,208,v,128,148
s_waitcnt lgkmcnt(15)
v_exp_f32 v142, v142
mm v,148,a,212,v,136,148
tr 204,239,12416
v_cvt_pk_bf16_f32 v84, v140, v141
mm a,32,v,4,v,208,252
v_exp_f32 v143, v143
mm a,32,v,12,v,212,32
tr 206,239,18560
mm a,36,v,20,v,208,252
buffer_load_dwordx4 v144, s[16:19], s41 offen nt lds
s_add_u32 m0, s30, 6144
mm a,36,v,28,v,212,36
buffer_load_dwordx4 v154, s[16:19], s32 offen offset:2048 nt lds
s_add_u32 m0, s30, 15360
v_cvt_pk_bf16_f32 v85, v142, v143
mm a,40,v,36,v,208,252
buffer_load_dwordx4 v161, s[16:19], s41 offen offset:1024 nt lds
s_add_u32 m0, s30, 21504
mm a,40,v,44,v,212,40
s_waitcnt lgkmcnt(12)
buffer_load_dwordx4 v168, s[16:19], s41 offen nt lds
mz a,240,v,232,v,4
mm a,240,v,232,v,12,240
mm v,156,a,216,v,0,164
s_add_u32 m0, s30, 3072
v_exp_f32 v148, v148
mm v,156,a,220,v,8,156
tr 208,240,128
s_waitcnt lgkmcnt(12)
mm v,156,a,224,v,16,156
s_waitcnt lgkmcnt(11)
v_exp_f32 v149, v149
mm v,156,a,228,v,24,156
tr 210,240,6272
s_waitcnt lgkmcnt(11)
mm v,156,a,232,v,32,156
s_waitcnt lgkmcnt(10)
v_exp_f32 v150, v150
mm v,156,a,236,v,40,156
tr 212,240,12416
v_cvt_pk_bf16_f32 v100, v148, v149
mm a,48,v,4,v,216,252
v_exp_f32 v151, v151
mm a,48,v,12,v,220,48
tr 214,240,18560
mm a,52,v,20,v,216,252
ds_read_b128 a[192:195], v236 offset:12288
mm a,52,v,28,v,220,52
ds_read_b128 a[196:199], v237 offset:12288
v_cvt_pk_bf16_f32 v101, v150, v151
mm a,56,v,36,v,216,252
ds_read_b128 a[200:203], v236 offset:12416
buffer_load_dwordx4 v145, s[16:19], s41 offen offset:1024 nt lds
s_add_u32 m0, s30, 9216
mm a,56,v,44,v,220,56
ds_read_b128 a[204:207], v237 offset:12416
buffer_load_dwordx4 v152, s[16:19], s41 offen nt lds
s_add_u32 m0, s30, 15360
mm v,132,a,216,v,48,172
buffer_load_dwordx4 v162, s[16:19], s41 offen offset:2048 nt lds
s_add_u32 m0, s30, 21504
v_exp_f32 v156, v156
mm v,132,a,220,v,56,132
ds_read_b128 a[208:211], v236 offset:12544
buffer_load_dwordx4 v169, s[16:19], s41 offen offset:1024 nt lds
mm v,132,a,224,v,64,132
s_add_u32 m0, s30, 3072
v_exp_f32 v157, v157
mm v,132,a,228,v,72,132
ds_read_b128 a[212:215], v237 offset:12544
mm v,132,a,232,v,80,132
s_waitcnt lgkmcnt(15)
v_exp_f32 v158, v158
mm v,132,a,236,v,88,132
tr 216,241,128
v_cvt_pk_bf16_f32 v70, v156, v157
mm a,64,v,4,v,192,252
L_pg27:
s_cbranch_execz L_ir26
s_waitcnt lgkmcnt(15)
v_exp_f32 v159, v159
mm a,64,v,12,v,196,64
tr 218,241,6272
mm a,68,v,20,v,192,252
tr 220,241,12416
mm a,68,v,28,v,196,68
tr 222,241,18560
v_cvt_pk_bf16_f32 v71, v158, v159
mm a,72,v,36,v,192,252
buffer_load_dwordx4 v146, s[16:19], s41 offen offset:2048 nt lds
s_add_u32 m0, s30, 9216
mm a,72,v,44,v,196,72
buffer_load_dwordx4 v153, s[16:19], s41 offen offset:1024 nt lds
s_add_u32 m0, s30, 21504
mm v,140,a,216,v,96,180
buffer_load_dwordx4 v170, s[16:19], s41 offen offset:2048 nt lds
v_exp_f32 v132, v132
mm v,140,a,220,v,104,140
tr 192,238,256
s_add_u32 m0, s30, 9216
mm v,140,a,224,v,112,140
v_exp_f32 v133, v133
mm v,140,a,228,v,120,140
tr 194,238,6400
mm v,140,a,232,v,128,140
s_waitcnt lgkmcnt(15)
v_exp_f32 v134, v134
mm v,140,a,236,v,136,140
tr 196,238,12544
v_cvt_pk_bf16_f32 v86, v132, v133
mm a,80,v,4,v,200,252
v_exp_f32 v135, v135
mm a,80,v,12,v,204,80
tr 198,238,18688
mm a,84,v,20,v,200,252
buffer_load_dwordx4 v154, s[16:19], s41 offen offset:2048 nt lds
mm a,84,v,28,v,204,84
s_add_u32 s93, s93, 1
s_cmp_eq_u32 s93, 15
s_cselect_b32 s93, 0, s93
s_mul_i32 s55, s93, 13
s_lshr_b32 s55, s55, 6
s_mul_i32 s55, s55, 101376
s_mul_i32 s32, s93, 6144
s_add_u32 s32, s32, s55
s_add_u32 s32, s32, s89
s_add_u32 m0, s27, 12288
v_cvt_pk_bf16_f32 v87, v134, v135
mm a,88,v,36,v,200,252
buffer_load_dwordx4 v160, s[12:15], s31 offen nt lds
s_add_u32 m0, s27, 0
mm a,88,v,44,v,204,88
s_waitcnt lgkmcnt(10)
buffer_load_dwordx4 v144, s[12:15], s31 offen nt lds
s_add_u32 m0, s27, 12288
mm v,148,a,192,v,0,164
buffer_load_dwordx4 v161, s[12:15], s31 offen offset:1024 nt lds
s_add_u32 m0, s27, 18432
v_exp_f32 v140, v140
mm v,148,a,196,v,8,148
tr 200,239,256
buffer_load_dwordx4 v168, s[12:15], s31 offen nt lds
mm v,148,a,200,v,16,148
s_add_u32 m0, s27, 0
v_exp_f32 v141, v141
mm v,148,a,204,v,24,148
tr 202,239,6400
s_waitcnt lgkmcnt(11)
mm v,148,a,208,v,32,148
s_waitcnt lgkmcnt(10)
v_exp_f32 v142, v142
mm v,148,a,212,v,40,148
tr 204,239,12544
v_cvt_pk_bf16_f32 v102, v140, v141
mm a,96,v,4,v,208,252
v_exp_f32 v143, v143
mm a,96,v,12,v,212,96
tr 206,239,18688
mm a,100,v,20,v,208,252
ds_read_b128 a[216:219], v236 offset:18432
mm a,100,v,28,v,212,100
ds_read_b128 a[220:223], v237 offset:18432
v_cvt_pk_bf16_f32 v103, v142, v143
mm a,104,v,36,v,208,252
ds_read_b128 a[224:227], v236 offset:18560
buffer_load_dwordx4 v145, s[12:15], s31 offen offset:1024 nt lds
s_add_u32 m0, s27, 6144
mm a,104,v,44,v,212,104
ds_read_b128 a[228:231], v237 offset:18560
buffer_load_dwordx4 v152, s[12:15], s31 offen nt lds
s_add_u32 m0, s27, 12288
mz a,244,v,232,v,20
mm a,244,v,232,v,28,244
mm v,156,a,192,v,48,172
buffer_load_dwordx4 v162, s[12:15], s31 offen offset:2048 nt lds
s_add_u32 m0, s27, 18432
v_exp_f32 v148, v148
mm v,156,a,196,v,56,156
ds_read_b128 a[232:235], v236 offset:18688
buffer_load_dwordx4 v169, s[12:15], s31 offen offset:1024 nt lds
mm v,156,a,200,v,64,156
s_add_u32 m0, s27, 0
v_exp_f32 v149, v149
mm v,156,a,204,v,72,156
ds_read_b128 a[236:239], v237 offset:18688
mm v,156,a,208,v,80,156
s_waitcnt lgkmcnt(15)
v_exp_f32 v150, v150
mm v,156,a,212,v,88,156
tr 208,240,256
v_cvt_pk_bf16_f32 v76, v148, v149
mm a,112,v,4,v,216,252
s_waitcnt lgkmcnt(15)
v_exp_f32 v151, v151
mm a,112,v,12,v,220,112
tr 210,240,6400
mm a,116,v,20,v,216,252
tr 212,240,12544
mm a,116,v,28,v,220,116
tr 214,240,18688
v_cvt_pk_bf16_f32 v77, v150, v151
mm a,120,v,36,v,216,252
buffer_load_dwordx4 v146, s[12:15], s31 offen offset:2048 nt lds
s_add_u32 m0, s27, 6144
mm a,120,v,44,v,220,120
buffer_load_dwordx4 v153, s[12:15], s31 offen offset:1024 nt lds
s_add_u32 s41, s31, 3072
s_add_u32 m0, s27, 15360
mm v,132,a,192,v,96,180
buffer_load_dwordx4 v160, s[12:15], s41 offen nt lds
s_add_u32 m0, s27, 18432
v_exp_f32 v156, v156
mm v,132,a,196,v,104,132
tr 216,241,256
buffer_load_dwordx4 v170, s[12:15], s31 offen offset:2048 nt lds
mm v,132,a,200,v,112,132
v_exp_f32 v157, v157
mm v,132,a,204,v,120,132
tr 218,241,6400
mm v,132,a,208,v,128,132
s_waitcnt lgkmcnt(15)
v_exp_f32 v158, v158
mm v,132,a,212,v,136,132
tr 220,241,12544
v_cvt_pk_bf16_f32 v92, v156, v157
mm a,128,v,4,v,192,252
v_exp_f32 v159, v159
mm a,128,v,12,v,196,128
tr 222,241,18688
s_sub_u32 s42, s29, s49
mm a,132,v,20,v,192,252
s_mov_b32 s49, s29
v_add_u32 v238, s42, v238
v_add_u32 v239, s42, v239
mm a,132,v,28,v,196,132
v_cvt_pk_bf16_f32 v93, v158, v159
v_add_u32 v240, s42, v240
mm a,136,v,36,v,192,252
v_add_u32 v241, s42, v241
mm a,136,v,44,v,196,136
s_waitcnt lgkmcnt(13)
s_sub_u32 s47, s26, s25
v_add_u32 v236, s47, v236
mm v,140,a,216,v,0,164
s_waitcnt vmcnt(36) lgkmcnt(0)
v_exp_f32 v132, v132
mm v,140,a,220,v,8,140
v_add_u32 v237, s47, v237
mm v,140,a,224,v,16,140
s_barrier
v_exp_f32 v133, v133
mm v,140,a,228,v,24,140
tr 192,238,0
s_mov_b32 s43, s28
s_mov_b32 s28, s29
mm v,140,a,232,v,32,140
s_mov_b32 s29, s30
s_mov_b32 s30, s43
v_exp_f32 v134, v134
mm v,140,a,236,v,40,140
tr 194,238,6144
s_mov_b32 s43, s25
s_mov_b32 s25, s26
v_cvt_pk_bf16_f32 v108, v132, v133
mm a,144,v,4,v,200,252
s_mov_b32 s26, s27
s_mov_b32 s27, s43
v_exp_f32 v135, v135
mm a,144,v,12,v,204,144
tr 196,238,12288
s_add_u32 s41, s31, 3072
s_add_u32 m0, s26, 3072
mm a,148,v,20,v,200,252
tr 198,238,18432
buffer_load_dwordx4 v144, s[12:15], s41 offen nt lds
s_add_u32 m0, s26, 6144
mm a,148,v,28,v,204,148
ds_read_b128 a[192:195], v236
buffer_load_dwordx4 v154, s[12:15], s31 offen offset:2048 nt lds
s_add_u32 m0, s26, 15360
v_cvt_pk_bf16_f32 v109, v134, v135
mm a,152,v,36,v,200,252
ds_read_b128 a[196:199], v237
buffer_load_dwordx4 v161, s[12:15], s41 offen offset:1024 nt lds
s_add_u32 m0, s26, 21504
mm a,152,v,44,v,204,152
ds_read_b128 a[200:203], v236 offset:128
buffer_load_dwordx4 v168, s[12:15], s41 offen nt lds
mm v,148,a,216,v,48,172
s_add_u32 m0, s26, 3072
v_exp_f32 v140, v140
mm v,148,a,220,v,56,148
ds_read_b128 a[204:207], v237 offset:128
mm v,148,a,224,v,64,148
v_exp_f32 v141, v141
mm v,148,a,228,v,72,148
ds_read_b128 a[208:211], v236 offset:256
mm v,148,a,232,v,80,148
v_exp_f32 v142, v142
mm v,148,a,236,v,88,148
ds_read_b128 a[212:215], v237 offset:256
v_cvt_pk_bf16_f32 v78, v140, v141
mm a,160,v,4,v,208,252
v_exp_f32 v143, v143
mm a,160,v,12,v,212,160
tr 200,239,0
mm a,164,v,20,v,208,252
tr 202,239,6144
buffer_load_dwordx4 v145, s[12:15], s41 offen offset:1024 nt lds
s_add_u32 m0, s26, 9216
mm a,164,v,28,v,212,164
tr 204,239,12288
buffer_load_dwordx4 v152, s[12:15], s41 offen nt lds
s_add_u32 m0, s26, 15360
v_cvt_pk_bf16_f32 v79, v142, v143
mm a,168,v,36,v,208,252
tr 206,239,18432
buffer_load_dwordx4 v162, s[12:15], s41 offen offset:2048 nt lds
s_add_u32 m0, s26, 21504
mm a,168,v,44,v,212,168
buffer_load_dwordx4 v169, s[12:15], s41 offen offset:1024 nt lds
mz a,248,v,232,v,36
mm a,248,v,232,v,44,248
mm v,156,a,216,v,96,180
s_add_u32 m0, s26, 3072
v_exp_f32 v148, v148
mm v,156,a,220,v,104,156
tr 208,240,0
mm v,156,a,224,v,112,156
v_exp_f32 v149, v149
mm v,156,a,228,v,120,156
tr 210,240,6144
mm v,156,a,232,v,128,156
v_exp_f32 v150, v150
mm v,156,a,236,v,136,156
tr 212,240,12288
v_cvt_pk_bf16_f32 v94, v148, v149
mm a,176,v,4,v,216,252
v_exp_f32 v151, v151
mm a,176,v,12,v,220,176
tr 214,240,18432
buffer_load_dwordx4 v146, s[12:15], s41 offen offset:2048 nt lds
s_add_u32 m0, s26, 9216
mm a,180,v,20,v,216,252
buffer_load_dwordx4 v153, s[12:15], s41 offen offset:1024 nt lds
s_add_u32 m0, s26, 21504
mm a,180,v,28,v,220,180
buffer_load_dwordx4 v170, s[12:15], s41 offen offset:2048 nt lds
s_add_u32 m0, s26, 9216
v_cvt_pk_bf16_f32 v95, v150, v151
mm a,184,v,36,v,216,252
buffer_load_dwordx4 v154, s[12:15], s41 offen offset:2048 nt lds
s_add_u32 s92, s92, 1
s_cmp_eq_u32 s92, 15
s_cselect_b32 s92, 0, s92
s_mul_i32 s55, s92, 13
s_lshr_b32 s55, s55, 6
s_mul_i32 s55, s55, 101376
s_mul_i32 s31, s92, 6144
s_add_u32 s31, s31, s55
s_add_u32 s31, s31, s89
mm a,184,v,44,v,220,184
s_waitcnt lgkmcnt(9)
.p2align 3
L_loop_3:
mm v,132,a,192,v,0,164
s_add_u32 m0, s30, 12288
v_exp_f32 v156, v156
mm v,132,a,196,v,8,132
tr 216,241,0
buffer_load_dwordx4 v160, s[16:19], s32 offen nt lds
mm v,132,a,200,v,16,132
s_add_u32 m0, s30, 0
v_exp_f32 v157, v157
mm v,132,a,204,v,24,132
tr 218,241,6144
v_cvt_pk_bf16_f32 v110, v156, v157
mm v,132,a,208,v,32,132
s_waitcnt lgkmcnt(10)
v_exp_f32 v158, v158
mm v,132,a,212,v,40,132
tr 220,241,12288
mm a,0,v,68,v,192,0
v_exp_f32 v159, v159
mm a,0,v,76,v,196,0
tr 222,241,18432
v_cvt_pk_bf16_f32 v111, v158, v159
mm a,4,v,84,v,192,4
ds_read_b128 a[216:219], v236 offset:6144
buffer_load_dwordx4 v144, s[16:19], s32 offen nt lds
s_add_u32 m0, s30, 12288
mm a,4,v,92,v,196,4
ds_read_b128 a[220:223], v237 offset:6144
buffer_load_dwordx4 v161, s[16:19], s32 offen offset:1024 nt lds
s_add_u32 m0, s30, 18432
mm a,8,v,100,v,192,8
ds_read_b128 a[224:227], v236 offset:6272
buffer_load_dwordx4 v168, s[16:19], s32 offen nt lds
s_cmp_lg_u32 s35, 3
s_cbranch_scc1 L_cts34
s_cmp_lg_u32 s36, 0
s_cbranch_scc1 L_cta34
s_getpc_b64 s[58:59]
L_ct35:
s_add_u32 s58, s58, L_tail1_4-L_ct35
s_addc_u32 s59, s59, 0-((L_tail1_4-L_ct35)>>63)
s_and_b32 s57, s58, 0xf80
s_and_b32 s58, s58, 0xfffff000
v_lshrrev_b32 v176, 7, v253
v_lshlrev_b32 v176, 12, v176
v_max_u32 v176, s57, v176
v_and_b32 v177, 0x70, v253
v_lshl_add_u32 v176, v177, 3, v176
v_min_u32 v176, L_code_end-(L_tail1_4)-4, v176
v_mov_b32 v177, s59
v_add_co_u32 v176, vcc, s58, v176
s_nop 1
v_addc_co_u32 v177, vcc, 0, v177, vcc
global_load_dword v178, v[176:177], off
s_getpc_b64 s[58:59]
L_ct36:
s_add_u32 s58, s58, L_tail1_3-L_ct36
s_addc_u32 s59, s59, 0-((L_tail1_3-L_ct36)>>63)
s_and_b32 s57, s58, 0xf80
s_and_b32 s58, s58, 0xfffff000
v_lshrrev_b32 v176, 7, v253
v_lshlrev_b32 v176, 12, v176
v_max_u32 v176, s57, v176
v_and_b32 v177, 0x70, v253
v_lshl_add_u32 v176, v177, 3, v176
v_min_u32 v176, L_code_end-(L_tail1_3)-4, v176
v_mov_b32 v177, s59
v_add_co_u32 v176, vcc, s58, v176
s_nop 1
v_addc_co_u32 v177, vcc, 0, v177, vcc
global_load_dword v178, v[176:177], off
s_branch L_cts34
L_cta34:
s_getpc_b64 s[58:59]
L_ct37:
s_add_u32 s58, s58, L_b13_4-L_ct37
s_addc_u32 s59, s59, 0-((L_b13_4-L_ct37)>>63)
s_and_b32 s57, s58, 0xf80
s_and_b32 s58, s58, 0xfffff000
v_lshrrev_b32 v176, 7, v253
v_lshlrev_b32 v176, 12, v176
v_max_u32 v176, s57, v176
v_and_b32 v177, 0x70, v253
v_lshl_add_u32 v176, v177, 3, v176
v_min_u32 v176, L_code_end-(L_b13_4)-4, v176
v_mov_b32 v177, s59
v_add_co_u32 v176, vcc, s58, v176
s_nop 1
v_addc_co_u32 v177, vcc, 0, v177, vcc
global_load_dword v178, v[176:177], off
s_getpc_b64 s[58:59]
L_ct38:
s_add_u32 s58, s58, L_b13_3-L_ct38
s_addc_u32 s59, s59, 0-((L_b13_3-L_ct38)>>63)
s_and_b32 s57, s58, 0xf80
s_and_b32 s58, s58, 0xfffff000
v_lshrrev_b32 v176, 7, v253
v_lshlrev_b32 v176, 12, v176
v_max_u32 v176, s57, v176
v_and_b32 v177, 0x70, v253
v_lshl_add_u32 v176, v177, 3, v176
v_min_u32 v176, L_code_end-(L_b13_3)-4, v176
v_mov_b32 v177, s59
v_add_co_u32 v176, vcc, s58, v176
s_nop 1
v_addc_co_u32 v177, vcc, 0, v177, vcc
global_load_dword v178, v[176:177], off
L_cts34:
mm a,8,v,108,v,196,8
ds_read_b128 a[228:231], v237 offset:6272
s_add_u32 m0, s30, 0
mm v,140,a,192,v,48,172
buffer_load_dwordx4 v145, s[16:19], s32 offen offset:1024 nt lds
s_add_u32 m0, s30, 6144
v_exp_f32 v132, v132
mm v,140,a,196,v,56,140
ds_read_b128 a[232:235], v236 offset:6400
buffer_load_dwordx4 v152, s[16:19], s32 offen nt lds
s_add_u32 m0, s30, 12288
mm v,140,a,200,v,64,140
buffer_load_dwordx4 v162, s[16:19], s32 offen offset:2048 nt lds
s_add_u32 m0, s30, 18432
v_exp_f32 v133, v133
mm v,140,a,204,v,72,140
ds_read_b128 a[236:239], v237 offset:6400
buffer_load_dwordx4 v169, s[16:19], s32 offen offset:1024 nt lds
mm v,140,a,208,v,80,140
s_waitcnt lgkmcnt(14)
v_exp_f32 v134, v134
mm v,140,a,212,v,88,140
tr 192,238,128
v_cvt_pk_bf16_f32 v4, v132, v133
mm a,16,v,68,v,200,16
s_add_u32 m0, s30, 0
v_exp_f32 v135, v135
mm a,16,v,76,v,204,16
tr 194,238,6272
mm a,20,v,84,v,200,20
tr 196,238,12416
mm a,20,v,92,v,204,20
tr 198,238,18560
v_cvt_pk_bf16_f32 v5, v134, v135
mm a,24,v,100,v,200,24
buffer_load_dwordx4 v146, s[16:19], s32 offen offset:2048 nt lds
s_add_u32 m0, s30, 6144
mm a,24,v,108,v,204,24
buffer_load_dwordx4 v153, s[16:19], s32 offen offset:1024 nt lds
s_add_u32 s41, s32, 3072
s_add_u32 m0, s30, 15360
mm v,148,a,192,v,96,180
buffer_load_dwordx4 v160, s[16:19], s41 offen nt lds
s_add_u32 m0, s30, 18432
v_exp_f32 v140, v140
mm v,148,a,196,v,104,148
tr 200,239,128
buffer_load_dwordx4 v170, s[16:19], s32 offen offset:2048 nt lds
mm v,148,a,200,v,112,148
s_add_u32 m0, s30, 3072
v_exp_f32 v141, v141
mm v,148,a,204,v,120,148
tr 202,239,6272
mm v,148,a,208,v,128,148
s_waitcnt lgkmcnt(15)
v_exp_f32 v142, v142
mm v,148,a,212,v,136,148
tr 204,239,12416
v_cvt_pk_bf16_f32 v20, v140, v141
mm a,32,v,68,v,208,32
v_exp_f32 v143, v143
mm a,32,v,76,v,212,32
tr 206,239,18560
mm a,36,v,84,v,208,36
buffer_load_dwordx4 v144, s[16:19], s41 offen nt lds
s_add_u32 m0, s30, 6144
mm a,36,v,92,v,212,36
buffer_load_dwordx4 v154, s[16:19], s32 offen offset:2048 nt lds
s_add_u32 m0, s30, 15360
v_cvt_pk_bf16_f32 v21, v142, v143
mm a,40,v,100,v,208,40
buffer_load_dwordx4 v161, s[16:19], s41 offen offset:1024 nt lds
s_add_u32 m0, s30, 21504
mm a,40,v,108,v,212,40
s_waitcnt lgkmcnt(12)
buffer_load_dwordx4 v168, s[16:19], s41 offen nt lds
mm a,240,v,232,v,68,240
mm a,240,v,232,v,76,240
mm v,156,a,216,v,0,164
s_add_u32 m0, s30, 3072
v_exp_f32 v148, v148
mm v,156,a,220,v,8,156
tr 208,240,128
s_waitcnt lgkmcnt(12)
mm v,156,a,224,v,16,156
s_waitcnt lgkmcnt(11)
v_exp_f32 v149, v149
mm v,156,a,228,v,24,156
tr 210,240,6272
s_waitcnt lgkmcnt(11)
mm v,156,a,232,v,32,156
s_waitcnt lgkmcnt(10)
v_exp_f32 v150, v150
mm v,156,a,236,v,40,156
tr 212,240,12416
v_cvt_pk_bf16_f32 v36, v148, v149
mm a,48,v,68,v,216,48
v_exp_f32 v151, v151
mm a,48,v,76,v,220,48
tr 214,240,18560
mm a,52,v,84,v,216,52
ds_read_b128 a[192:195], v236 offset:12288
mm a,52,v,92,v,220,52
ds_read_b128 a[196:199], v237 offset:12288
v_cvt_pk_bf16_f32 v37, v150, v151
mm a,56,v,100,v,216,56
ds_read_b128 a[200:203], v236 offset:12416
buffer_load_dwordx4 v145, s[16:19], s41 offen offset:1024 nt lds
s_add_u32 m0, s30, 9216
mm a,56,v,108,v,220,56
ds_read_b128 a[204:207], v237 offset:12416
buffer_load_dwordx4 v152, s[16:19], s41 offen nt lds
s_add_u32 m0, s30, 15360
mm v,132,a,216,v,48,172
buffer_load_dwordx4 v162, s[16:19], s41 offen offset:2048 nt lds
s_add_u32 m0, s30, 21504
v_exp_f32 v156, v156
mm v,132,a,220,v,56,132
ds_read_b128 a[208:211], v236 offset:12544
buffer_load_dwordx4 v169, s[16:19], s41 offen offset:1024 nt lds
mm v,132,a,224,v,64,132
s_add_u32 m0, s30, 3072
v_exp_f32 v157, v157
mm v,132,a,228,v,72,132
ds_read_b128 a[212:215], v237 offset:12544
mm v,132,a,232,v,80,132
s_waitcnt lgkmcnt(15)
v_exp_f32 v158, v158
mm v,132,a,236,v,88,132
tr 216,241,128
v_cvt_pk_bf16_f32 v6, v156, v157
mm a,64,v,68,v,192,64
s_waitcnt lgkmcnt(15)
v_exp_f32 v159, v159
mm a,64,v,76,v,196,64
tr 218,241,6272
mm a,68,v,84,v,192,68
tr 220,241,12416
mm a,68,v,92,v,196,68
tr 222,241,18560
v_cvt_pk_bf16_f32 v7, v158, v159
mm a,72,v,100,v,192,72
buffer_load_dwordx4 v146, s[16:19], s41 offen offset:2048 nt lds
s_add_u32 m0, s30, 9216
mm a,72,v,108,v,196,72
buffer_load_dwordx4 v153, s[16:19], s41 offen offset:1024 nt lds
s_add_u32 m0, s30, 21504
mm v,140,a,216,v,96,180
buffer_load_dwordx4 v170, s[16:19], s41 offen offset:2048 nt lds
v_exp_f32 v132, v132
mm v,140,a,220,v,104,140
tr 192,238,256
s_add_u32 m0, s30, 9216
mm v,140,a,224,v,112,140
v_exp_f32 v133, v133
mm v,140,a,228,v,120,140
tr 194,238,6400
mm v,140,a,232,v,128,140
s_waitcnt lgkmcnt(15)
v_exp_f32 v134, v134
mm v,140,a,236,v,136,140
tr 196,238,12544
v_cvt_pk_bf16_f32 v22, v132, v133
mm a,80,v,68,v,200,80
v_exp_f32 v135, v135
mm a,80,v,76,v,204,80
tr 198,238,18688
mm a,84,v,84,v,200,84
buffer_load_dwordx4 v154, s[16:19], s41 offen offset:2048 nt lds
mm a,84,v,92,v,204,84
s_add_u32 s93, s93, 1
s_cmp_eq_u32 s93, 15
s_cselect_b32 s93, 0, s93
s_mul_i32 s55, s93, 13
s_lshr_b32 s55, s55, 6
s_mul_i32 s55, s55, 101376
s_mul_i32 s32, s93, 6144
s_add_u32 s32, s32, s55
s_add_u32 s32, s32, s89
s_add_u32 m0, s27, 12288
v_cvt_pk_bf16_f32 v23, v134, v135
mm a,88,v,100,v,200,88
buffer_load_dwordx4 v160, s[12:15], s31 offen nt lds
s_add_u32 m0, s27, 0
mm a,88,v,108,v,204,88
s_waitcnt lgkmcnt(10)
buffer_load_dwordx4 v144, s[12:15], s31 offen nt lds
s_add_u32 m0, s27, 12288
mm v,148,a,192,v,0,164
buffer_load_dwordx4 v161, s[12:15], s31 offen offset:1024 nt lds
s_add_u32 m0, s27, 18432
v_exp_f32 v140, v140
mm v,148,a,196,v,8,148
tr 200,239,256
buffer_load_dwordx4 v168, s[12:15], s31 offen nt lds
mm v,148,a,200,v,16,148
s_add_u32 m0, s27, 0
v_exp_f32 v141, v141
mm v,148,a,204,v,24,148
tr 202,239,6400
s_waitcnt lgkmcnt(11)
mm v,148,a,208,v,32,148
s_waitcnt lgkmcnt(10)
v_exp_f32 v142, v142
mm v,148,a,212,v,40,148
tr 204,239,12544
v_cvt_pk_bf16_f32 v38, v140, v141
mm a,96,v,68,v,208,96
L_pg31:
s_cbranch_execz L_ir30
v_exp_f32 v143, v143
mm a,96,v,76,v,212,96
tr 206,239,18688
mm a,100,v,84,v,208,100
ds_read_b128 a[216:219], v236 offset:18432
mm a,100,v,92,v,212,100
ds_read_b128 a[220:223], v237 offset:18432
v_cvt_pk_bf16_f32 v39, v142, v143
mm a,104,v,100,v,208,104
ds_read_b128 a[224:227], v236 offset:18560
buffer_load_dwordx4 v145, s[12:15], s31 offen offset:1024 nt lds
s_add_u32 m0, s27, 6144
mm a,104,v,108,v,212,104
ds_read_b128 a[228:231], v237 offset:18560
buffer_load_dwordx4 v152, s[12:15], s31 offen nt lds
s_add_u32 m0, s27, 12288
mm a,244,v,232,v,84,244
mm a,244,v,232,v,92,244
mm v,156,a,192,v,48,172
buffer_load_dwordx4 v162, s[12:15], s31 offen offset:2048 nt lds
s_add_u32 m0, s27, 18432
v_exp_f32 v148, v148
mm v,156,a,196,v,56,156
ds_read_b128 a[232:235], v236 offset:18688
buffer_load_dwordx4 v169, s[12:15], s31 offen offset:1024 nt lds
mm v,156,a,200,v,64,156
s_add_u32 m0, s27, 0
v_exp_f32 v149, v149
mm v,156,a,204,v,72,156
ds_read_b128 a[236:239], v237 offset:18688
mm v,156,a,208,v,80,156
s_waitcnt lgkmcnt(15)
v_exp_f32 v150, v150
mm v,156,a,212,v,88,156
tr 208,240,256
v_cvt_pk_bf16_f32 v12, v148, v149
mm a,112,v,68,v,216,112
s_waitcnt lgkmcnt(15)
v_exp_f32 v151, v151
mm a,112,v,76,v,220,112
tr 210,240,6400
mm a,116,v,84,v,216,116
tr 212,240,12544
mm a,116,v,92,v,220,116
tr 214,240,18688
v_cvt_pk_bf16_f32 v13, v150, v151
mm a,120,v,100,v,216,120
buffer_load_dwordx4 v146, s[12:15], s31 offen offset:2048 nt lds
s_add_u32 m0, s27, 6144
mm a,120,v,108,v,220,120
buffer_load_dwordx4 v153, s[12:15], s31 offen offset:1024 nt lds
s_add_u32 s41, s31, 3072
s_add_u32 m0, s27, 15360
mm v,132,a,192,v,96,180
buffer_load_dwordx4 v160, s[12:15], s41 offen nt lds
s_add_u32 m0, s27, 18432
v_exp_f32 v156, v156
mm v,132,a,196,v,104,132
tr 216,241,256
buffer_load_dwordx4 v170, s[12:15], s31 offen offset:2048 nt lds
mm v,132,a,200,v,112,132
v_exp_f32 v157, v157
mm v,132,a,204,v,120,132
tr 218,241,6400
mm v,132,a,208,v,128,132
s_waitcnt lgkmcnt(15)
v_exp_f32 v158, v158
mm v,132,a,212,v,136,132
tr 220,241,12544
v_cvt_pk_bf16_f32 v28, v156, v157
mm a,128,v,68,v,192,128
v_exp_f32 v159, v159
mm a,128,v,76,v,196,128
tr 222,241,18688
s_sub_u32 s42, s29, s49
mm a,132,v,84,v,192,132
s_mov_b32 s49, s29
v_add_u32 v238, s42, v238
v_add_u32 v239, s42, v239
mm a,132,v,92,v,196,132
v_cvt_pk_bf16_f32 v29, v158, v159
v_add_u32 v240, s42, v240
mm a,136,v,100,v,192,136
v_add_u32 v241, s42, v241
mm a,136,v,108,v,196,136
s_waitcnt lgkmcnt(13)
s_sub_u32 s47, s26, s25
v_add_u32 v236, s47, v236
mm v,140,a,216,v,0,164
s_waitcnt vmcnt(36) lgkmcnt(0)
v_exp_f32 v132, v132
mm v,140,a,220,v,8,140
v_add_u32 v237, s47, v237
mm v,140,a,224,v,16,140
s_barrier
v_exp_f32 v133, v133
mm v,140,a,228,v,24,140
tr 192,238,0
s_mov_b32 s43, s28
s_mov_b32 s28, s29
mm v,140,a,232,v,32,140
s_mov_b32 s29, s30
s_mov_b32 s30, s43
v_exp_f32 v134, v134
s_cmp_gt_u32 s35, 2
s_cbranch_scc1 L_ir39x
s_lshl_b32 s58, s36, 3
s_add_u32 s58, s58, s35
s_mov_b64 exec, 0
s_cmp_eq_u32 s58, 2
s_cbranch_scc1 L_pg40
s_cmp_eq_u32 s58, 1
s_cbranch_scc1 L_pg41
s_cmp_eq_u32 s58, 10
s_cbranch_scc1 L_pg42
s_cmp_eq_u32 s58, 9
s_cbranch_scc1 L_pg43
L_ir39:
s_mov_b64 exec, -1
L_ir39x:
mm v,140,a,236,v,40,140
tr 194,238,6144
s_mov_b32 s43, s25
s_mov_b32 s25, s26
v_cvt_pk_bf16_f32 v44, v132, v133
mm a,144,v,68,v,200,144
s_mov_b32 s26, s27
s_mov_b32 s27, s43
v_exp_f32 v135, v135
mm a,144,v,76,v,204,144
tr 196,238,12288
s_add_u32 s41, s31, 3072
s_add_u32 m0, s26, 3072
mm a,148,v,84,v,200,148
tr 198,238,18432
buffer_load_dwordx4 v144, s[12:15], s41 offen nt lds
s_add_u32 m0, s26, 6144
mm a,148,v,92,v,204,148
ds_read_b128 a[192:195], v236
buffer_load_dwordx4 v154, s[12:15], s31 offen offset:2048 nt lds
s_add_u32 m0, s26, 15360
v_cvt_pk_bf16_f32 v45, v134, v135
mm a,152,v,100,v,200,152
ds_read_b128 a[196:199], v237
buffer_load_dwordx4 v161, s[12:15], s41 offen offset:1024 nt lds
s_add_u32 m0, s26, 21504
mm a,152,v,108,v,204,152
ds_read_b128 a[200:203], v236 offset:128
buffer_load_dwordx4 v168, s[12:15], s41 offen nt lds
mm v,148,a,216,v,48,172
s_add_u32 m0, s26, 3072
v_exp_f32 v140, v140
mm v,148,a,220,v,56,148
ds_read_b128 a[204:207], v237 offset:128
mm v,148,a,224,v,64,148
v_exp_f32 v141, v141
mm v,148,a,228,v,72,148
ds_read_b128 a[208:211], v236 offset:256
mm v,148,a,232,v,80,148
v_exp_f32 v142, v142
mm v,148,a,236,v,88,148
ds_read_b128 a[212:215], v237 offset:256
v_cvt_pk_bf16_f32 v14, v140, v141
mm a,160,v,68,v,208,160
v_exp_f32 v143, v143
mm a,160,v,76,v,212,160
tr 200,239,0
mm a,164,v,84,v,208,164
tr 202,239,6144
buffer_load_dwordx4 v145, s[12:15], s41 offen offset:1024 nt lds
s_add_u32 m0, s26, 9216
mm a,164,v,92,v,212,164
tr 204,239,12288
buffer_load_dwordx4 v152, s[12:15], s41 offen nt lds
s_add_u32 m0, s26, 15360
v_cvt_pk_bf16_f32 v15, v142, v143
mm a,168,v,100,v,208,168
tr 206,239,18432
buffer_load_dwordx4 v162, s[12:15], s41 offen offset:2048 nt lds
s_add_u32 m0, s26, 21504
mm a,168,v,108,v,212,168
buffer_load_dwordx4 v169, s[12:15], s41 offen offset:1024 nt lds
mm a,248,v,232,v,100,248
mm a,248,v,232,v,108,248
mm v,156,a,216,v,96,180
s_add_u32 m0, s26, 3072
v_exp_f32 v148, v148
mm v,156,a,220,v,104,156
tr 208,240,0
mm v,156,a,224,v,112,156
v_exp_f32 v149, v149
mm v,156,a,228,v,120,156
tr 210,240,6144
mm v,156,a,232,v,128,156
v_exp_f32 v150, v150
mm v,156,a,236,v,136,156
tr 212,240,12288
v_cvt_pk_bf16_f32 v30, v148, v149
mm a,176,v,68,v,216,176
v_exp_f32 v151, v151
mm a,176,v,76,v,220,176
tr 214,240,18432
buffer_load_dwordx4 v146, s[12:15], s41 offen offset:2048 nt lds
s_add_u32 m0, s26, 9216
mm a,180,v,84,v,216,180
buffer_load_dwordx4 v153, s[12:15], s41 offen offset:1024 nt lds
s_add_u32 m0, s26, 21504
mm a,180,v,92,v,220,180
buffer_load_dwordx4 v170, s[12:15], s41 offen offset:2048 nt lds
s_add_u32 m0, s26, 9216
v_cvt_pk_bf16_f32 v31, v150, v151
mm a,184,v,100,v,216,184
buffer_load_dwordx4 v154, s[12:15], s41 offen offset:2048 nt lds
s_add_u32 s92, s92, 1
s_cmp_eq_u32 s92, 15
s_cselect_b32 s92, 0, s92
s_mul_i32 s55, s92, 13
s_lshr_b32 s55, s55, 6
s_mul_i32 s55, s55, 101376
s_mul_i32 s31, s92, 6144
s_add_u32 s31, s31, s55
s_add_u32 s31, s31, s89
mm a,184,v,108,v,220,184
s_waitcnt lgkmcnt(9)
mm v,132,a,192,v,0,164
s_add_u32 m0, s30, 12288
v_exp_f32 v156, v156
mm v,132,a,196,v,8,132
tr 216,241,0
buffer_load_dwordx4 v160, s[16:19], s32 offen nt lds
mm v,132,a,200,v,16,132
s_add_u32 m0, s30, 0
v_exp_f32 v157, v157
mm v,132,a,204,v,24,132
tr 218,241,6144
v_cvt_pk_bf16_f32 v46, v156, v157
mm v,132,a,208,v,32,132
s_waitcnt lgkmcnt(10)
v_exp_f32 v158, v158
mm v,132,a,212,v,40,132
tr 220,241,12288
mm a,0,v,4,v,192,0
v_exp_f32 v159, v159
mm a,0,v,12,v,196,0
tr 222,241,18432
v_cvt_pk_bf16_f32 v47, v158, v159
mm a,4,v,20,v,192,4
ds_read_b128 a[216:219], v236 offset:6144
buffer_load_dwordx4 v144, s[16:19], s32 offen nt lds
s_add_u32 m0, s30, 12288
mm a,4,v,28,v,196,4
ds_read_b128 a[220:223], v237 offset:6144
buffer_load_dwordx4 v161, s[16:19], s32 offen offset:1024 nt lds
s_add_u32 m0, s30, 18432
mm a,8,v,36,v,192,8
ds_read_b128 a[224:227], v236 offset:6272
buffer_load_dwordx4 v168, s[16:19], s32 offen nt lds
mm a,8,v,44,v,196,8
ds_read_b128 a[228:231], v237 offset:6272
s_add_u32 m0, s30, 0
mm v,140,a,192,v,48,172
buffer_load_dwordx4 v145, s[16:19], s32 offen offset:1024 nt lds
s_add_u32 m0, s30, 6144
v_exp_f32 v132, v132
mm v,140,a,196,v,56,140
ds_read_b128 a[232:235], v236 offset:6400
buffer_load_dwordx4 v152, s[16:19], s32 offen nt lds
s_add_u32 m0, s30, 12288
mm v,140,a,200,v,64,140
buffer_load_dwordx4 v162, s[16:19], s32 offen offset:2048 nt lds
s_add_u32 m0, s30, 18432
v_exp_f32 v133, v133
mm v,140,a,204,v,72,140
ds_read_b128 a[236:239], v237 offset:6400
buffer_load_dwordx4 v169, s[16:19], s32 offen offset:1024 nt lds
mm v,140,a,208,v,80,140
s_waitcnt lgkmcnt(14)
v_exp_f32 v134, v134
mm v,140,a,212,v,88,140
tr 192,238,128
v_cvt_pk_bf16_f32 v68, v132, v133
mm a,16,v,4,v,200,16
s_add_u32 m0, s30, 0
v_exp_f32 v135, v135
mm a,16,v,12,v,204,16
tr 194,238,6272
mm a,20,v,20,v,200,20
tr 196,238,12416
s_sub_u32 s35, s35, 1
mm a,20,v,28,v,204,20
tr 198,238,18560
v_cvt_pk_bf16_f32 v69, v134, v135
mm a,24,v,36,v,200,24
buffer_load_dwordx4 v146, s[16:19], s32 offen offset:2048 nt lds
s_add_u32 m0, s30, 6144
mm a,24,v,44,v,204,24
buffer_load_dwordx4 v153, s[16:19], s32 offen offset:1024 nt lds
s_add_u32 s41, s32, 3072
s_add_u32 m0, s30, 15360
mm v,148,a,192,v,96,180
buffer_load_dwordx4 v160, s[16:19], s41 offen nt lds
s_add_u32 m0, s30, 18432
v_exp_f32 v140, v140
mm v,148,a,196,v,104,148
tr 200,239,128
buffer_load_dwordx4 v170, s[16:19], s32 offen offset:2048 nt lds
mm v,148,a,200,v,112,148
s_add_u32 m0, s30, 3072
v_exp_f32 v141, v141
mm v,148,a,204,v,120,148
tr 202,239,6272
mm v,148,a,208,v,128,148
s_waitcnt lgkmcnt(15)
v_exp_f32 v142, v142
mm v,148,a,212,v,136,148
tr 204,239,12416
v_cvt_pk_bf16_f32 v84, v140, v141
mm a,32,v,4,v,208,32
v_exp_f32 v143, v143
mm a,32,v,12,v,212,32
tr 206,239,18560
mm a,36,v,20,v,208,36
buffer_load_dwordx4 v144, s[16:19], s41 offen nt lds
s_add_u32 m0, s30, 6144
mm a,36,v,28,v,212,36
buffer_load_dwordx4 v154, s[16:19], s32 offen offset:2048 nt lds
s_add_u32 m0, s30, 15360
v_cvt_pk_bf16_f32 v85, v142, v143
mm a,40,v,36,v,208,40
buffer_load_dwordx4 v161, s[16:19], s41 offen offset:1024 nt lds
s_add_u32 m0, s30, 21504
mm a,40,v,44,v,212,40
s_waitcnt lgkmcnt(12)
buffer_load_dwordx4 v168, s[16:19], s41 offen nt lds
mm a,240,v,232,v,4,240
mm a,240,v,232,v,12,240
mm v,156,a,216,v,0,164
s_add_u32 m0, s30, 3072
v_exp_f32 v148, v148
mm v,156,a,220,v,8,156
tr 208,240,128
s_waitcnt lgkmcnt(12)
mm v,156,a,224,v,16,156
s_waitcnt lgkmcnt(11)
v_exp_f32 v149, v149
mm v,156,a,228,v,24,156
tr 210,240,6272
s_waitcnt lgkmcnt(11)
mm v,156,a,232,v,32,156
s_waitcnt lgkmcnt(10)
v_exp_f32 v150, v150
mm v,156,a,236,v,40,156
tr 212,240,12416
v_cvt_pk_bf16_f32 v100, v148, v149
mm a,48,v,4,v,216,48
v_exp_f32 v151, v151
mm a,48,v,12,v,220,48
tr 214,240,18560
mm a,52,v,20,v,216,52
ds_read_b128 a[192:195], v236 offset:12288
mm a,52,v,28,v,220,52
ds_read_b128 a[196:199], v237 offset:12288
v_cvt_pk_bf16_f32 v101, v150, v151
mm a,56,v,36,v,216,56
ds_read_b128 a[200:203], v236 offset:12416
buffer_load_dwordx4 v145, s[16:19], s41 offen offset:1024 nt lds
s_add_u32 m0, s30, 9216
mm a,56,v,44,v,220,56
ds_read_b128 a[204:207], v237 offset:12416
buffer_load_dwordx4 v152, s[16:19], s41 offen nt lds
s_add_u32 m0, s30, 15360
mm v,132,a,216,v,48,172
buffer_load_dwordx4 v162, s[16:19], s41 offen offset:2048 nt lds
s_add_u32 m0, s30, 21504
v_exp_f32 v156, v156
mm v,132,a,220,v,56,132
ds_read_b128 a[208:211], v236 offset:12544
buffer_load_dwordx4 v169, s[16:19], s41 offen offset:1024 nt lds
mm v,132,a,224,v,64,132
s_add_u32 m0, s30, 3072
v_exp_f32 v157, v157
mm v,132,a,228,v,72,132
ds_read_b128 a[212:215], v237 offset:12544
mm v,132,a,232,v,80,132
s_waitcnt lgkmcnt(15)
v_exp_f32 v158, v158
mm v,132,a,236,v,88,132
tr 216,241,128
v_cvt_pk_bf16_f32 v70, v156, v157
mm a,64,v,4,v,192,64
s_waitcnt lgkmcnt(15)
v_exp_f32 v159, v159
mm a,64,v,12,v,196,64
tr 218,241,6272
mm a,68,v,20,v,192,68
tr 220,241,12416
mm a,68,v,28,v,196,68
tr 222,241,18560
v_cvt_pk_bf16_f32 v71, v158, v159
mm a,72,v,36,v,192,72
buffer_load_dwordx4 v146, s[16:19], s41 offen offset:2048 nt lds
s_add_u32 m0, s30, 9216
mm a,72,v,44,v,196,72
buffer_load_dwordx4 v153, s[16:19], s41 offen offset:1024 nt lds
s_add_u32 m0, s30, 21504
mm v,140,a,216,v,96,180
buffer_load_dwordx4 v170, s[16:19], s41 offen offset:2048 nt lds
v_exp_f32 v132, v132
mm v,140,a,220,v,104,140
tr 192,238,256
s_add_u32 m0, s30, 9216
mm v,140,a,224,v,112,140
v_exp_f32 v133, v133
mm v,140,a,228,v,120,140
tr 194,238,6400
mm v,140,a,232,v,128,140
s_waitcnt lgkmcnt(15)
v_exp_f32 v134, v134
mm v,140,a,236,v,136,140
tr 196,238,12544
v_cvt_pk_bf16_f32 v86, v132, v133
mm a,80,v,4,v,200,80
v_exp_f32 v135, v135
mm a,80,v,12,v,204,80
tr 198,238,18688
mm a,84,v,20,v,200,84
buffer_load_dwordx4 v154, s[16:19], s41 offen offset:2048 nt lds
mm a,84,v,28,v,204,84
s_add_u32 s93, s93, 1
s_cmp_eq_u32 s93, 15
s_cselect_b32 s93, 0, s93
s_mul_i32 s55, s93, 13
s_lshr_b32 s55, s55, 6
s_mul_i32 s55, s55, 101376
s_mul_i32 s32, s93, 6144
s_add_u32 s32, s32, s55
s_add_u32 s32, s32, s89
s_add_u32 m0, s27, 12288
v_cvt_pk_bf16_f32 v87, v134, v135
mm a,88,v,36,v,200,88
buffer_load_dwordx4 v160, s[12:15], s31 offen nt lds
s_add_u32 m0, s27, 0
mm a,88,v,44,v,204,88
s_waitcnt lgkmcnt(10)
buffer_load_dwordx4 v144, s[12:15], s31 offen nt lds
s_add_u32 m0, s27, 12288
mm v,148,a,192,v,0,164
buffer_load_dwordx4 v161, s[12:15], s31 offen offset:1024 nt lds
s_add_u32 m0, s27, 18432
v_exp_f32 v140, v140
mm v,148,a,196,v,8,148
tr 200,239,256
buffer_load_dwordx4 v168, s[12:15], s31 offen nt lds
mm v,148,a,200,v,16,148
s_add_u32 m0, s27, 0
v_exp_f32 v141, v141
mm v,148,a,204,v,24,148
tr 202,239,6400
s_waitcnt lgkmcnt(11)
mm v,148,a,208,v,32,148
s_waitcnt lgkmcnt(10)
v_exp_f32 v142, v142
mm v,148,a,212,v,40,148
tr 204,239,12544
v_cvt_pk_bf16_f32 v102, v140, v141
mm a,96,v,4,v,208,96
v_exp_f32 v143, v143
mm a,96,v,12,v,212,96
tr 206,239,18688
mm a,100,v,20,v,208,100
ds_read_b128 a[216:219], v236 offset:18432
mm a,100,v,28,v,212,100
ds_read_b128 a[220:223], v237 offset:18432
v_cvt_pk_bf16_f32 v103, v142, v143
mm a,104,v,36,v,208,104
ds_read_b128 a[224:227], v236 offset:18560
buffer_load_dwordx4 v145, s[12:15], s31 offen offset:1024 nt lds
s_add_u32 m0, s27, 6144
mm a,104,v,44,v,212,104
ds_read_b128 a[228:231], v237 offset:18560
buffer_load_dwordx4 v152, s[12:15], s31 offen nt lds
s_add_u32 m0, s27, 12288
mm a,244,v,232,v,20,244
mm a,244,v,232,v,28,244
mm v,156,a,192,v,48,172
buffer_load_dwordx4 v162, s[12:15], s31 offen offset:2048 nt lds
s_add_u32 m0, s27, 18432
v_exp_f32 v148, v148
mm v,156,a,196,v,56,156
ds_read_b128 a[232:235], v236 offset:18688
buffer_load_dwordx4 v169, s[12:15], s31 offen offset:1024 nt lds
mm v,156,a,200,v,64,156
s_add_u32 m0, s27, 0
v_exp_f32 v149, v149
mm v,156,a,204,v,72,156
ds_read_b128 a[236:239], v237 offset:18688
mm v,156,a,208,v,80,156
s_waitcnt lgkmcnt(15)
v_exp_f32 v150, v150
mm v,156,a,212,v,88,156
tr 208,240,256
v_cvt_pk_bf16_f32 v76, v148, v149
mm a,112,v,4,v,216,112
s_waitcnt lgkmcnt(15)
v_exp_f32 v151, v151
mm a,112,v,12,v,220,112
tr 210,240,6400
mm a,116,v,20,v,216,116
tr 212,240,12544
mm a,116,v,28,v,220,116
tr 214,240,18688
v_cvt_pk_bf16_f32 v77, v150, v151
mm a,120,v,36,v,216,120
buffer_load_dwordx4 v146, s[12:15], s31 offen offset:2048 nt lds
s_add_u32 m0, s27, 6144
mm a,120,v,44,v,220,120
buffer_load_dwordx4 v153, s[12:15], s31 offen offset:1024 nt lds
s_add_u32 s41, s31, 3072
s_add_u32 m0, s27, 15360
mm v,132,a,192,v,96,180
buffer_load_dwordx4 v160, s[12:15], s41 offen nt lds
s_add_u32 m0, s27, 18432
v_exp_f32 v156, v156
mm v,132,a,196,v,104,132
tr 216,241,256
buffer_load_dwordx4 v170, s[12:15], s31 offen offset:2048 nt lds
mm v,132,a,200,v,112,132
v_exp_f32 v157, v157
mm v,132,a,204,v,120,132
tr 218,241,6400
mm v,132,a,208,v,128,132
s_waitcnt lgkmcnt(15)
v_exp_f32 v158, v158
mm v,132,a,212,v,136,132
tr 220,241,12544
v_cvt_pk_bf16_f32 v92, v156, v157
mm a,128,v,4,v,192,128
v_exp_f32 v159, v159
mm a,128,v,12,v,196,128
tr 222,241,18688
s_sub_u32 s42, s29, s49
mm a,132,v,20,v,192,132
s_mov_b32 s49, s29
v_add_u32 v238, s42, v238
v_add_u32 v239, s42, v239
mm a,132,v,28,v,196,132
v_cvt_pk_bf16_f32 v93, v158, v159
v_add_u32 v240, s42, v240
mm a,136,v,36,v,192,136
v_add_u32 v241, s42, v241
mm a,136,v,44,v,196,136
s_waitcnt lgkmcnt(13)
s_sub_u32 s47, s26, s25
v_add_u32 v236, s47, v236
mm v,140,a,216,v,0,164
s_waitcnt vmcnt(36) lgkmcnt(0)
v_exp_f32 v132, v132
mm v,140,a,220,v,8,140
v_add_u32 v237, s47, v237
mm v,140,a,224,v,16,140
s_barrier
v_exp_f32 v133, v133
mm v,140,a,228,v,24,140
tr 192,238,0
s_mov_b32 s43, s28
s_mov_b32 s28, s29
mm v,140,a,232,v,32,140
s_mov_b32 s29, s30
s_mov_b32 s30, s43
v_exp_f32 v134, v134
s_cmp_gt_u32 s35, 1
s_cbranch_scc1 L_ir44x
s_lshl_b32 s58, s36, 3
s_add_u32 s58, s58, s35
s_mov_b64 exec, 0
s_cmp_eq_u32 s58, 1
s_cbranch_scc1 L_pg45
s_cmp_eq_u32 s58, 0
s_cbranch_scc1 L_pg46
s_cmp_eq_u32 s58, 9
s_cbranch_scc1 L_pg47
s_cmp_eq_u32 s58, 8
s_cbranch_scc1 L_pg48
L_ir44:
s_mov_b64 exec, -1
L_ir44x:
mm v,140,a,236,v,40,140
tr 194,238,6144
s_mov_b32 s43, s25
s_mov_b32 s25, s26
v_cvt_pk_bf16_f32 v108, v132, v133
mm a,144,v,4,v,200,144
s_mov_b32 s26, s27
s_mov_b32 s27, s43
v_exp_f32 v135, v135
mm a,144,v,12,v,204,144
tr 196,238,12288
s_add_u32 s41, s31, 3072
s_add_u32 m0, s26, 3072
mm a,148,v,20,v,200,148
tr 198,238,18432
buffer_load_dwordx4 v144, s[12:15], s41 offen nt lds
s_add_u32 m0, s26, 6144
mm a,148,v,28,v,204,148
L_pg33:
s_cbranch_execz L_ir32
ds_read_b128 a[192:195], v236
buffer_load_dwordx4 v154, s[12:15], s31 offen offset:2048 nt lds
s_add_u32 m0, s26, 15360
v_cvt_pk_bf16_f32 v109, v134, v135
mm a,152,v,36,v,200,152
ds_read_b128 a[196:199], v237
buffer_load_dwordx4 v161, s[12:15], s41 offen offset:1024 nt lds
s_add_u32 m0, s26, 21504
mm a,152,v,44,v,204,152
ds_read_b128 a[200:203], v236 offset:128
buffer_load_dwordx4 v168, s[12:15], s41 offen nt lds
mm v,148,a,216,v,48,172
s_add_u32 m0, s26, 3072
v_exp_f32 v140, v140
mm v,148,a,220,v,56,148
ds_read_b128 a[204:207], v237 offset:128
mm v,148,a,224,v,64,148
v_exp_f32 v141, v141
mm v,148,a,228,v,72,148
ds_read_b128 a[208:211], v236 offset:256
mm v,148,a,232,v,80,148
v_exp_f32 v142, v142
mm v,148,a,236,v,88,148
ds_read_b128 a[212:215], v237 offset:256
v_cvt_pk_bf16_f32 v78, v140, v141
mm a,160,v,4,v,208,160
v_exp_f32 v143, v143
mm a,160,v,12,v,212,160
tr 200,239,0
mm a,164,v,20,v,208,164
tr 202,239,6144
buffer_load_dwordx4 v145, s[12:15], s41 offen offset:1024 nt lds
s_add_u32 m0, s26, 9216
mm a,164,v,28,v,212,164
tr 204,239,12288
buffer_load_dwordx4 v152, s[12:15], s41 offen nt lds
s_add_u32 m0, s26, 15360
v_cvt_pk_bf16_f32 v79, v142, v143
mm a,168,v,36,v,208,168
tr 206,239,18432
buffer_load_dwordx4 v162, s[12:15], s41 offen offset:2048 nt lds
s_add_u32 m0, s26, 21504
mm a,168,v,44,v,212,168
buffer_load_dwordx4 v169, s[12:15], s41 offen offset:1024 nt lds
mm a,248,v,232,v,36,248
mm a,248,v,232,v,44,248
mm v,156,a,216,v,96,180
s_add_u32 m0, s26, 3072
v_exp_f32 v148, v148
mm v,156,a,220,v,104,156
tr 208,240,0
mm v,156,a,224,v,112,156
v_exp_f32 v149, v149
mm v,156,a,228,v,120,156
tr 210,240,6144
mm v,156,a,232,v,128,156
v_exp_f32 v150, v150
mm v,156,a,236,v,136,156
tr 212,240,12288
v_cvt_pk_bf16_f32 v94, v148, v149
mm a,176,v,4,v,216,176
v_exp_f32 v151, v151
mm a,176,v,12,v,220,176
tr 214,240,18432
buffer_load_dwordx4 v146, s[12:15], s41 offen offset:2048 nt lds
s_add_u32 m0, s26, 9216
mm a,180,v,20,v,216,180
buffer_load_dwordx4 v153, s[12:15], s41 offen offset:1024 nt lds
s_add_u32 m0, s26, 21504
mm a,180,v,28,v,220,180
buffer_load_dwordx4 v170, s[12:15], s41 offen offset:2048 nt lds
s_add_u32 m0, s26, 9216
v_cvt_pk_bf16_f32 v95, v150, v151
mm a,184,v,36,v,216,184
buffer_load_dwordx4 v154, s[12:15], s41 offen offset:2048 nt lds
s_add_u32 s92, s92, 1
s_cmp_eq_u32 s92, 15
s_cselect_b32 s92, 0, s92
s_mul_i32 s55, s92, 13
s_lshr_b32 s55, s55, 6
s_mul_i32 s55, s55, 101376
s_mul_i32 s31, s92, 6144
s_add_u32 s31, s31, s55
s_add_u32 s31, s31, s89
mm a,184,v,44,v,220,184
s_waitcnt lgkmcnt(9)
s_cmp_lg_u32 s35, 0
s_cbranch_scc1 L_loop_3
s_cmp_lg_u32 s36, 0
s_cbranch_scc1 L_tail2_3
L_tail1_3:
mm v,132,a,192,v,0,164
s_add_u32 m0, s30, 12288
v_exp_f32 v156, v156
mm v,132,a,196,v,8,132
tr 216,241,0
buffer_load_dwordx4 v160, s[16:19], s32 offen nt lds
mm v,132,a,200,v,16,132
s_add_u32 m0, s30, 0
v_exp_f32 v157, v157
mm v,132,a,204,v,24,132
tr 218,241,6144
v_cvt_pk_bf16_f32 v110, v156, v157
mm v,132,a,208,v,32,132
s_waitcnt lgkmcnt(10)
v_exp_f32 v158, v158
mm v,132,a,212,v,40,132
tr 220,241,12288
mm a,0,v,68,v,192,0
v_exp_f32 v159, v159
mm a,0,v,76,v,196,0
tr 222,241,18432
v_cvt_pk_bf16_f32 v111, v158, v159
mm a,4,v,84,v,192,4
ds_read_b128 a[216:219], v236 offset:6144
buffer_load_dwordx4 v144, s[16:19], s32 offen nt lds
s_add_u32 m0, s30, 12288
mm a,4,v,92,v,196,4
ds_read_b128 a[220:223], v237 offset:6144
buffer_load_dwordx4 v161, s[16:19], s32 offen offset:1024 nt lds
s_add_u32 m0, s30, 18432
mm a,8,v,100,v,192,8
ds_read_b128 a[224:227], v236 offset:6272
buffer_load_dwordx4 v168, s[16:19], s32 offen nt lds
mm a,8,v,108,v,196,8
ds_read_b128 a[228:231], v237 offset:6272
s_add_u32 m0, s30, 0
mm v,140,a,192,v,48,172
v_exp_f32 v132, v132
mm v,140,a,196,v,56,140
ds_read_b128 a[232:235], v236 offset:6400
mm v,140,a,200,v,64,140
v_exp_f32 v133, v133
mm v,140,a,204,v,72,140
ds_read_b128 a[236:239], v237 offset:6400
mm v,140,a,208,v,80,140
s_waitcnt lgkmcnt(15)
v_exp_f32 v134, v134
mm v,140,a,212,v,88,140
tr 192,238,128
v_cvt_pk_bf16_f32 v4, v132, v133
mm a,16,v,68,v,200,16
s_waitcnt lgkmcnt(15)
v_exp_f32 v135, v135
mm a,16,v,76,v,204,16
tr 194,238,6272
mm a,20,v,84,v,200,20
tr 196,238,12416
buffer_load_dwordx4 v145, s[16:19], s32 offen offset:1024 nt lds
s_add_u32 m0, s30, 6144
mm a,20,v,92,v,204,20
tr 198,238,18560
buffer_load_dwordx4 v152, s[16:19], s32 offen nt lds
s_add_u32 m0, s30, 12288
v_cvt_pk_bf16_f32 v5, v134, v135
mm a,24,v,100,v,200,24
buffer_load_dwordx4 v162, s[16:19], s32 offen offset:2048 nt lds
s_add_u32 m0, s30, 18432
mm a,24,v,108,v,204,24
buffer_load_dwordx4 v169, s[16:19], s32 offen offset:1024 nt lds
mm v,148,a,192,v,96,180
s_add_u32 m0, s30, 0
v_exp_f32 v140, v140
mm v,148,a,196,v,104,148
tr 200,239,128
mm v,148,a,200,v,112,148
v_exp_f32 v141, v141
mm v,148,a,204,v,120,148
tr 202,239,6272
mm v,148,a,208,v,128,148
s_waitcnt lgkmcnt(15)
v_exp_f32 v142, v142
mm v,148,a,212,v,136,148
tr 204,239,12416
v_cvt_pk_bf16_f32 v20, v140, v141
mm a,32,v,68,v,208,32
v_exp_f32 v143, v143
mm a,32,v,76,v,212,32
tr 206,239,18560
mm a,36,v,84,v,208,36
buffer_load_dwordx4 v146, s[16:19], s32 offen offset:2048 nt lds
s_add_u32 m0, s30, 6144
mm a,36,v,92,v,212,36
buffer_load_dwordx4 v153, s[16:19], s32 offen offset:1024 nt lds
s_add_u32 s41, s32, 3072
s_add_u32 m0, s30, 15360
v_cvt_pk_bf16_f32 v21, v142, v143
mm a,40,v,100,v,208,40
buffer_load_dwordx4 v160, s[16:19], s41 offen nt lds
s_add_u32 m0, s30, 18432
mm a,40,v,108,v,212,40
s_waitcnt lgkmcnt(12)
buffer_load_dwordx4 v170, s[16:19], s32 offen offset:2048 nt lds
mm a,240,v,232,v,68,240
mm a,240,v,232,v,76,240
mm v,156,a,216,v,0,164
s_add_u32 m0, s30, 3072
v_exp_f32 v148, v148
mm v,156,a,220,v,8,156
tr 208,240,128
s_waitcnt lgkmcnt(12)
mm v,156,a,224,v,16,156
s_waitcnt lgkmcnt(11)
v_exp_f32 v149, v149
mm v,156,a,228,v,24,156
tr 210,240,6272
s_waitcnt lgkmcnt(11)
mm v,156,a,232,v,32,156
s_waitcnt lgkmcnt(10)
v_exp_f32 v150, v150
mm v,156,a,236,v,40,156
tr 212,240,12416
v_cvt_pk_bf16_f32 v36, v148, v149
mm a,48,v,68,v,216,48
v_exp_f32 v151, v151
mm a,48,v,76,v,220,48
tr 214,240,18560
buffer_load_dwordx4 v144, s[16:19], s41 offen nt lds
s_add_u32 m0, s30, 6144
mm a,52,v,84,v,216,52
ds_read_b128 a[192:195], v236 offset:12288
buffer_load_dwordx4 v154, s[16:19], s32 offen offset:2048 nt lds
s_add_u32 m0, s30, 15360
mm a,52,v,92,v,220,52
ds_read_b128 a[196:199], v237 offset:12288
buffer_load_dwordx4 v161, s[16:19], s41 offen offset:1024 nt lds
s_add_u32 m0, s30, 21504
v_cvt_pk_bf16_f32 v37, v150, v151
mm a,56,v,100,v,216,56
ds_read_b128 a[200:203], v236 offset:12416
buffer_load_dwordx4 v168, s[16:19], s41 offen nt lds
mm a,56,v,108,v,220,56
ds_read_b128 a[204:207], v237 offset:12416
s_add_u32 m0, s30, 3072
mm v,132,a,216,v,48,172
v_exp_f32 v156, v156
mm v,132,a,220,v,56,132
ds_read_b128 a[208:211], v236 offset:12544
mm v,132,a,224,v,64,132
v_exp_f32 v157, v157
mm v,132,a,228,v,72,132
ds_read_b128 a[212:215], v237 offset:12544
mm v,132,a,232,v,80,132
s_waitcnt lgkmcnt(15)
v_exp_f32 v158, v158
mm v,132,a,236,v,88,132
tr 216,241,128
v_cvt_pk_bf16_f32 v6, v156, v157
mm a,64,v,68,v,192,64
s_waitcnt lgkmcnt(15)
v_exp_f32 v159, v159
mm a,64,v,76,v,196,64
tr 218,241,6272
mm a,68,v,84,v,192,68
tr 220,241,12416
buffer_load_dwordx4 v145, s[16:19], s41 offen offset:1024 nt lds
s_add_u32 m0, s30, 9216
mm a,68,v,92,v,196,68
tr 222,241,18560
buffer_load_dwordx4 v152, s[16:19], s41 offen nt lds
s_add_u32 m0, s30, 15360
v_cvt_pk_bf16_f32 v7, v158, v159
mm a,72,v,100,v,192,72
buffer_load_dwordx4 v162, s[16:19], s41 offen offset:2048 nt lds
s_add_u32 m0, s30, 21504
mm a,72,v,108,v,196,72
buffer_load_dwordx4 v169, s[16:19], s41 offen offset:1024 nt lds
mm v,140,a,216,v,96,180
s_add_u32 m0, s30, 3072
v_exp_f32 v132, v132
mm v,140,a,220,v,104,140
tr 192,238,256
mm v,140,a,224,v,112,140
v_exp_f32 v133, v133
mm v,140,a,228,v,120,140
tr 194,238,6400
mm v,140,a,232,v,128,140
s_waitcnt lgkmcnt(15)
v_exp_f32 v134, v134
mm v,140,a,236,v,136,140
tr 196,238,12544
v_cvt_pk_bf16_f32 v22, v132, v133
mm a,80,v,68,v,200,80
v_exp_f32 v135, v135
mm a,80,v,76,v,204,80
tr 198,238,18688
mm a,84,v,84,v,200,84
buffer_load_dwordx4 v146, s[16:19], s41 offen offset:2048 nt lds
s_add_u32 m0, s30, 9216
mm a,84,v,92,v,204,84
buffer_load_dwordx4 v153, s[16:19], s41 offen offset:1024 nt lds
s_add_u32 m0, s30, 21504
v_cvt_pk_bf16_f32 v23, v134, v135
mm a,88,v,100,v,200,88
buffer_load_dwordx4 v170, s[16:19], s41 offen offset:2048 nt lds
mm a,88,v,108,v,204,88
s_waitcnt lgkmcnt(13)
s_add_u32 m0, s30, 9216
mm v,148,a,192,v,0,164
s_waitcnt lgkmcnt(12)
v_exp_f32 v140, v140
mm v,148,a,196,v,8,148
tr 200,239,256
s_waitcnt lgkmcnt(12)
mm v,148,a,200,v,16,148
s_waitcnt lgkmcnt(11)
v_exp_f32 v141, v141
mm v,148,a,204,v,24,148
tr 202,239,6400
s_waitcnt lgkmcnt(11)
mm v,148,a,208,v,32,148
s_waitcnt lgkmcnt(10)
v_exp_f32 v142, v142
mm v,148,a,212,v,40,148
tr 204,239,12544
v_cvt_pk_bf16_f32 v38, v140, v141
mm a,96,v,68,v,208,96
v_exp_f32 v143, v143
mm a,96,v,76,v,212,96
tr 206,239,18688
mm a,100,v,84,v,208,100
ds_read_b128 a[216:219], v236 offset:18432
mm a,100,v,92,v,212,100
ds_read_b128 a[220:223], v237 offset:18432
v_cvt_pk_bf16_f32 v39, v142, v143
mm a,104,v,100,v,208,104
ds_read_b128 a[224:227], v236 offset:18560
buffer_load_dwordx4 v154, s[16:19], s41 offen offset:2048 nt lds
mm a,104,v,108,v,212,104
ds_read_b128 a[228:231], v237 offset:18560
s_add_u32 s93, s93, 1
mm a,244,v,232,v,84,244
mm a,244,v,232,v,92,244
mm v,156,a,192,v,48,172
s_cmp_eq_u32 s93, 15
s_cselect_b32 s93, 0, s93
s_mul_i32 s55, s93, 13
s_lshr_b32 s55, s55, 6
s_mul_i32 s55, s55, 101376
s_mul_i32 s32, s93, 6144
s_add_u32 s32, s32, s55
s_add_u32 s32, s32, s89
s_add_u32 s31, s31, 6291456
s_add_u32 s89, s89, 6291456
s_add_u32 s32, s32, 6291456
s_add_u32 s33, s33, 6144
s_add_u32 s94, s94, 6144
s_add_u32 s33, s33, s0
s_add_u32 s34, s34, s1
s_add_u32 m0, s44, 0
s_add_u32 s51, s34, 0
v_exp_f32 v148, v148
mm v,156,a,196,v,56,156
ds_read_b128 a[232:235], v236 offset:18688
buffer_load_dwordx4 v252, s[4:7], s51 offen lds
mm v,156,a,200,v,64,156
s_add_u32 s51, s34, 9216
v_exp_f32 v149, v149
mm v,156,a,204,v,72,156
ds_read_b128 a[236:239], v237 offset:18688
mm v,156,a,208,v,80,156
s_waitcnt lgkmcnt(15)
v_exp_f32 v150, v150
mm v,156,a,212,v,88,156
tr 208,240,256
v_cvt_pk_bf16_f32 v12, v148, v149
mm a,112,v,68,v,216,112
s_waitcnt lgkmcnt(15)
v_exp_f32 v151, v151
mm a,112,v,76,v,220,112
tr 210,240,6400
mm a,116,v,84,v,216,116
tr 212,240,12544
mm a,116,v,92,v,220,116
tr 214,240,18688
v_cvt_pk_bf16_f32 v13, v150, v151
mm a,120,v,100,v,216,120
buffer_load_dwordx4 v252, s[4:7], s51 offen offset:1024 lds
s_add_u32 s51, s34, 18432
mm a,120,v,108,v,220,120
buffer_load_dwordx4 v252, s[4:7], s51 offen offset:2048 lds
mm v,132,a,192,v,96,180
s_add_u32 s51, s34, 27648
v_exp_f32 v156, v156
mm v,132,a,196,v,104,132
tr 216,241,256
buffer_load_dwordx4 v252, s[4:7], s51 offen offset:3072 lds
mm v,132,a,200,v,112,132
s_add_u32 m0, s44, 4096
s_add_u32 s51, s34, 40960
v_exp_f32 v157, v157
mm v,132,a,204,v,120,132
tr 218,241,6400
buffer_load_dwordx4 v252, s[4:7], s51 offen lds
mm v,132,a,208,v,128,132
s_waitcnt lgkmcnt(15)
v_exp_f32 v158, v158
mm v,132,a,212,v,136,132
tr 220,241,12544
v_cvt_pk_bf16_f32 v28, v156, v157
mm a,128,v,68,v,192,128
s_add_u32 s51, s34, 50176
v_exp_f32 v159, v159
mm a,128,v,76,v,196,128
tr 222,241,18688
s_sub_u32 s42, s29, s49
mm a,132,v,84,v,192,132
s_mov_b32 s49, s29
v_add_u32 v238, s42, v238
v_add_u32 v239, s42, v239
mm a,132,v,92,v,196,132
v_cvt_pk_bf16_f32 v29, v158, v159
v_add_u32 v240, s42, v240
mm a,136,v,100,v,192,136
buffer_load_dwordx4 v252, s[4:7], s51 offen offset:1024 lds
s_add_u32 s34, s34, 128
s_cmp_eq_u32 s34, s95
s_cselect_b32 s55, 1280, 0
s_sub_u32 s34, s34, s55
v_add_u32 v241, s42, v241
mm a,136,v,108,v,196,136
s_waitcnt lgkmcnt(13)
s_sub_u32 s47, s26, s25
v_add_u32 v236, s47, v236
mm v,140,a,216,v,0,164
s_waitcnt vmcnt(30) lgkmcnt(0)
v_exp_f32 v132, v132
mm v,140,a,220,v,8,140
v_add_u32 v237, s47, v237
mm v,140,a,224,v,16,140
s_barrier
v_exp_f32 v133, v133
mm v,140,a,228,v,24,140
tr 192,238,0
s_mov_b32 s43, s28
mm v,140,a,232,v,32,140
v_exp_f32 v134, v134
s_mov_b64 exec, 0
s_branch L_pg50
L_ir49:
s_mov_b64 exec, -1
L_ir49x:
mm v,140,a,236,v,40,140
tr 194,238,6144
v_cvt_pk_bf16_f32 v44, v132, v133
mm a,144,v,68,v,200,144
s_mov_b32 s28, s29
v_exp_f32 v135, v135
mm a,144,v,76,v,204,144
tr 196,238,12288
s_mov_b32 s29, s30
mm a,148,v,84,v,200,148
tr 198,238,18432
s_mov_b32 s30, s43
mm a,148,v,92,v,204,148
ds_read_b128 a[192:195], v236
v_cvt_pk_bf16_f32 v45, v134, v135
mm a,152,v,100,v,200,152
ds_read_b128 a[196:199], v237
s_mov_b32 s43, s25
mm a,152,v,108,v,204,152
ds_read_b128 a[200:203], v236 offset:128
s_mov_b32 s25, s26
mm v,148,a,216,v,48,172
s_mov_b32 s26, s27
v_exp_f32 v140, v140
mm v,148,a,220,v,56,148
ds_read_b128 a[204:207], v237 offset:128
s_mov_b32 s27, s43
mm v,148,a,224,v,64,148
v_exp_f32 v141, v141
mm v,148,a,228,v,72,148
ds_read_b128 a[208:211], v236 offset:256
mm v,148,a,232,v,80,148
v_exp_f32 v142, v142
mm v,148,a,236,v,88,148
ds_read_b128 a[212:215], v237 offset:256
v_cvt_pk_bf16_f32 v14, v140, v141
mm a,160,v,68,v,208,160
v_exp_f32 v143, v143
mm a,160,v,76,v,212,160
tr 200,239,0
mm a,164,v,84,v,208,164
tr 202,239,6144
mm a,164,v,92,v,212,164
tr 204,239,12288
v_cvt_pk_bf16_f32 v15, v142, v143
mm a,168,v,100,v,208,168
tr 206,239,18432
mm a,168,v,108,v,212,168
mm a,248,v,232,v,100,248
mm a,248,v,232,v,108,248
mm v,156,a,216,v,96,180
v_exp_f32 v148, v148
mm v,156,a,220,v,104,156
tr 208,240,0
mm v,156,a,224,v,112,156
v_exp_f32 v149, v149
mm v,156,a,228,v,120,156
tr 210,240,6144
mm v,156,a,232,v,128,156
v_exp_f32 v150, v150
mm v,156,a,236,v,136,156
tr 212,240,12288
v_cvt_pk_bf16_f32 v30, v148, v149
mm a,176,v,68,v,216,176
v_exp_f32 v151, v151
mm a,176,v,76,v,220,176
tr 214,240,18432
mm a,180,v,84,v,216,180
mm a,180,v,92,v,220,180
v_cvt_pk_bf16_f32 v31, v150, v151
mm a,184,v,100,v,216,184
mm a,184,v,108,v,220,184
s_waitcnt lgkmcnt(9)
mm v,132,a,192,v,0,164
s_add_u32 m0, s30, 9216
v_exp_f32 v156, v156
mm v,132,a,196,v,8,132
tr 216,241,0
s_add_u32 s41, s33, 442368
mm v,132,a,200,v,16,132
buffer_load_dwordx4 v249, s[8:11], s41 offen lds
v_exp_f32 v157, v157
mm v,132,a,204,v,24,132
tr 218,241,6144
v_cvt_pk_bf16_f32 v46, v156, v157
mm v,132,a,208,v,32,132
s_waitcnt lgkmcnt(10)
v_exp_f32 v158, v158
mm v,132,a,212,v,40,132
tr 220,241,12288
buffer_load_dwordx4 v250, s[8:11], s41 offen offset:1024 lds
mm a,0,v,4,v,192,0
v_exp_f32 v159, v159
mm a,0,v,12,v,196,0
tr 222,241,18432
v_cvt_pk_bf16_f32 v47, v158, v159
mm a,4,v,20,v,192,4
ds_read_b128 a[216:219], v236 offset:6144
mm a,4,v,28,v,196,4
ds_read_b128 a[220:223], v237 offset:6144
mm a,8,v,36,v,192,8
ds_read_b128 a[224:227], v236 offset:6272
buffer_load_dwordx4 v251, s[8:11], s41 offen offset:2048 lds
mm a,8,v,44,v,196,8
ds_read_b128 a[228:231], v237 offset:6272
s_add_u32 m0, s30, 12296
mm v,140,a,192,v,48,172
s_add_u32 s41, s33, 98304
v_exp_f32 v132, v132
mm v,140,a,196,v,56,140
ds_read_b128 a[232:235], v236 offset:6400
mm v,140,a,200,v,64,140
v_exp_f32 v133, v133
mm v,140,a,204,v,72,140
ds_read_b128 a[236:239], v237 offset:6400
buffer_load_dwordx4 v249, s[8:11], s41 offen lds
mm v,140,a,208,v,80,140
s_waitcnt lgkmcnt(15)
v_exp_f32 v134, v134
mm v,140,a,212,v,88,140
tr 192,238,128
v_cvt_pk_bf16_f32 v68, v132, v133
mm a,16,v,4,v,200,16
s_waitcnt lgkmcnt(15)
v_exp_f32 v135, v135
mm a,16,v,12,v,204,16
tr 194,238,6272
mm a,20,v,20,v,200,20
tr 196,238,12416
buffer_load_dwordx4 v250, s[8:11], s41 offen offset:1024 lds
mm a,20,v,28,v,204,20
tr 198,238,18560
v_cvt_pk_bf16_f32 v69, v134, v135
mm a,24,v,36,v,200,24
mm a,24,v,44,v,204,24
buffer_load_dwordx4 v251, s[8:11], s41 offen offset:2048 lds
mm v,148,a,192,v,96,180
s_add_u32 m0, s30, 15368
v_exp_f32 v140, v140
mm v,148,a,196,v,104,148
tr 200,239,128
s_add_u32 s41, s33, 147456
mm v,148,a,200,v,112,148
v_exp_f32 v141, v141
mm v,148,a,204,v,120,148
tr 202,239,6272
mm v,148,a,208,v,128,148
s_waitcnt lgkmcnt(15)
v_exp_f32 v142, v142
mm v,148,a,212,v,136,148
tr 204,239,12416
v_cvt_pk_bf16_f32 v84, v140, v141
mm a,32,v,4,v,208,32
buffer_load_dwordx4 v249, s[8:11], s41 offen lds
v_exp_f32 v143, v143
mm a,32,v,12,v,212,32
tr 206,239,18560
mm a,36,v,20,v,208,36
mm a,36,v,28,v,212,36
buffer_load_dwordx4 v250, s[8:11], s41 offen offset:1024 lds
v_cvt_pk_bf16_f32 v85, v142, v143
mm a,40,v,36,v,208,40
mm a,40,v,44,v,212,40
s_waitcnt lgkmcnt(11)
buffer_load_dwordx4 v251, s[8:11], s41 offen offset:2048 lds
mm a,240,v,232,v,4,240
mm a,240,v,232,v,12,240
mm v,156,a,216,v,0,164
s_add_u32 m0, s30, 18440
v_exp_f32 v148, v148
mm v,156,a,220,v,8,156
tr 208,240,128
s_add_u32 s41, s33, 491520
mm v,156,a,224,v,16,156
s_waitcnt lgkmcnt(11)
v_exp_f32 v149, v149
mm v,156,a,228,v,24,156
tr 210,240,6272
s_waitcnt lgkmcnt(11)
mm v,156,a,232,v,32,156
s_waitcnt lgkmcnt(10)
v_exp_f32 v150, v150
s_mov_b64 exec, 0
s_branch L_pg52
L_ir51:
s_mov_b64 exec, -1
L_ir51x:
mm v,156,a,236,v,40,156
tr 212,240,12416
v_cvt_pk_bf16_f32 v100, v148, v149
mm a,48,v,4,v,216,48
buffer_load_dwordx4 v249, s[8:11], s41 offen lds
v_exp_f32 v151, v151
mm a,48,v,12,v,220,48
tr 214,240,18560
mm a,52,v,20,v,216,52
ds_read_b128 a[192:195], v236 offset:12288
mm a,52,v,28,v,220,52
ds_read_b128 a[196:199], v237 offset:12288
buffer_load_dwordx4 v250, s[8:11], s41 offen offset:1024 lds
v_cvt_pk_bf16_f32 v101, v150, v151
mm a,56,v,36,v,216,56
ds_read_b128 a[200:203], v236 offset:12416
mm a,56,v,44,v,220,56
ds_read_b128 a[204:207], v237 offset:12416
buffer_load_dwordx4 v251, s[8:11], s41 offen offset:2048 lds
mm v,132,a,216,v,48,172
s_add_u32 m0, s30, 21512
v_exp_f32 v156, v156
mm v,132,a,220,v,56,132
ds_read_b128 a[208:211], v236 offset:12544
s_add_u32 s41, s33, 540672
mm v,132,a,224,v,64,132
v_exp_f32 v157, v157
mm v,132,a,228,v,72,132
ds_read_b128 a[212:215], v237 offset:12544
mm v,132,a,232,v,80,132
s_waitcnt lgkmcnt(14)
v_exp_f32 v158, v158
mm v,132,a,236,v,88,132
tr 216,241,128
v_cvt_pk_bf16_f32 v70, v156, v157
mm a,64,v,4,v,192,64
buffer_load_dwordx4 v249, s[8:11], s41 offen lds
v_exp_f32 v159, v159
mm a,64,v,12,v,196,64
tr 218,241,6272
mm a,68,v,20,v,192,68
tr 220,241,12416
mm a,68,v,28,v,196,68
tr 222,241,18560
buffer_load_dwordx4 v250, s[8:11], s41 offen offset:1024 lds
v_cvt_pk_bf16_f32 v71, v158, v159
mm a,72,v,36,v,192,72
mm a,72,v,44,v,196,72
buffer_load_dwordx4 v251, s[8:11], s41 offen offset:2048 lds
mm v,140,a,216,v,96,180
s_add_u32 s33, s33, 786432
v_exp_f32 v132, v132
mm v,140,a,220,v,104,140
tr 192,238,256
s_cmp_eq_u32 s33, s94
s_cselect_b32 s55, 7864320, 0
mm v,140,a,224,v,112,140
s_sub_u32 s33, s33, s55
v_exp_f32 v133, v133
mm v,140,a,228,v,120,140
tr 194,238,6400
s_add_u32 m0, s45, 0
mm v,140,a,232,v,128,140
s_waitcnt lgkmcnt(15)
v_exp_f32 v134, v134
mm v,140,a,236,v,136,140
tr 196,238,12544
v_cvt_pk_bf16_f32 v86, v132, v133
mm a,80,v,4,v,200,80
s_add_u32 s51, s34, 0
v_exp_f32 v135, v135
mm a,80,v,12,v,204,80
tr 198,238,18688
mm a,84,v,20,v,200,84
mm a,84,v,28,v,204,84
v_cvt_pk_bf16_f32 v87, v134, v135
mm a,88,v,36,v,200,88
mm a,88,v,44,v,204,88
s_waitcnt lgkmcnt(13)
mm v,148,a,192,v,0,164
s_waitcnt lgkmcnt(10)
v_exp_f32 v140, v140
mm v,148,a,196,v,8,148
tr 200,239,256
buffer_load_dwordx4 v252, s[4:7], s51 offen lds
mm v,148,a,200,v,16,148
s_add_u32 s51, s34, 9216
v_exp_f32 v141, v141
mm v,148,a,204,v,24,148
tr 202,239,6400
s_waitcnt lgkmcnt(11)
mm v,148,a,208,v,32,148
s_waitcnt lgkmcnt(10)
v_exp_f32 v142, v142
mm v,148,a,212,v,40,148
tr 204,239,12544
v_cvt_pk_bf16_f32 v102, v140, v141
mm a,96,v,4,v,208,96
buffer_load_dwordx4 v252, s[4:7], s51 offen offset:1024 lds
v_exp_f32 v143, v143
mm a,96,v,12,v,212,96
tr 206,239,18688
s_add_u32 s51, s34, 18432
mm a,100,v,20,v,208,100
ds_read_b128 a[216:219], v236 offset:18432
mm a,100,v,28,v,212,100
ds_read_b128 a[220:223], v237 offset:18432
v_cvt_pk_bf16_f32 v103, v142, v143
mm a,104,v,36,v,208,104
ds_read_b128 a[224:227], v236 offset:18560
mm a,104,v,44,v,212,104
ds_read_b128 a[228:231], v237 offset:18560
buffer_load_dwordx4 v252, s[4:7], s51 offen offset:2048 lds
mm a,244,v,232,v,20,244
mm a,244,v,232,v,28,244
mm v,156,a,192,v,48,172
s_add_u32 s51, s34, 27648
v_exp_f32 v148, v148
mm v,156,a,196,v,56,156
ds_read_b128 a[232:235], v236 offset:18688
mm v,156,a,200,v,64,156
v_exp_f32 v149, v149
mm v,156,a,204,v,72,156
ds_read_b128 a[236:239], v237 offset:18688
buffer_load_dwordx4 v252, s[4:7], s51 offen offset:3072 lds
mm v,156,a,208,v,80,156
s_waitcnt lgkmcnt(14)
v_exp_f32 v150, v150
mm v,156,a,212,v,88,156
tr 208,240,256
v_cvt_pk_bf16_f32 v76, v148, v149
mm a,112,v,4,v,216,112
s_add_u32 m0, s45, 4096
v_exp_f32 v151, v151
mm a,112,v,12,v,220,112
tr 210,240,6400
s_add_u32 s51, s34, 40960
mm a,116,v,20,v,216,116
tr 212,240,12544
mm a,116,v,28,v,220,116
tr 214,240,18688
v_cvt_pk_bf16_f32 v77, v150, v151
mm a,120,v,36,v,216,120
mm a,120,v,44,v,220,120
buffer_load_dwordx4 v252, s[4:7], s51 offen lds
mm v,132,a,192,v,96,180
s_add_u32 s51, s34, 50176
v_exp_f32 v156, v156
mm v,132,a,196,v,104,132
tr 216,241,256
mm v,132,a,200,v,112,132
v_exp_f32 v157, v157
mm v,132,a,204,v,120,132
tr 218,241,6400
buffer_load_dwordx4 v252, s[4:7], s51 offen offset:1024 lds
mm v,132,a,208,v,128,132
s_waitcnt lgkmcnt(15)
v_exp_f32 v158, v158
mm v,132,a,212,v,136,132
tr 220,241,12544
v_cvt_pk_bf16_f32 v92, v156, v157
mm a,128,v,4,v,192,128
s_add_u32 s34, s34, 128
s_cmp_eq_u32 s34, s95
s_cselect_b32 s55, 1280, 0
v_exp_f32 v159, v159
mm a,128,v,12,v,196,128
tr 222,241,18688
s_sub_u32 s42, s29, s49
mm a,132,v,20,v,192,132
s_mov_b32 s49, s29
v_add_u32 v238, s42, v238
v_add_u32 v239, s42, v239
mm a,132,v,28,v,196,132
s_sub_u32 s34, s34, s55
v_cvt_pk_bf16_f32 v93, v158, v159
v_add_u32 v240, s42, v240
mm a,136,v,36,v,192,136
v_add_u32 v241, s42, v241
mm a,136,v,44,v,196,136
s_waitcnt lgkmcnt(13)
mm v,140,a,216,v,0,164
s_waitcnt vmcnt(27) lgkmcnt(0)
v_exp_f32 v132, v132
mm v,140,a,220,v,8,140
mm v,140,a,224,v,16,140
s_barrier
v_exp_f32 v133, v133
mm v,140,a,228,v,24,140
tr 192,238,0
s_mov_b32 s43, s28
s_mov_b32 s28, s29
mm v,140,a,232,v,32,140
v_exp_f32 v134, v134
s_mov_b64 exec, 0
s_branch L_pg54
L_ir53:
s_mov_b64 exec, -1
L_ir53x:
mm v,140,a,236,v,40,140
tr 194,238,6144
v_cvt_pk_bf16_f32 v108, v132, v133
mm a,144,v,4,v,200,144
s_mov_b32 s29, s30
s_mov_b32 s30, s43
v_exp_f32 v135, v135
mm a,144,v,12,v,204,144
tr 196,238,12288
s_add_u32 m0, s30, 9216
mm a,148,v,20,v,200,148
tr 198,238,18432
s_add_u32 s41, s33, 442368
mm a,148,v,28,v,204,148
buffer_load_dwordx4 v249, s[8:11], s41 offen lds
v_cvt_pk_bf16_f32 v109, v134, v135
mm a,152,v,36,v,200,152
buffer_load_dwordx4 v250, s[8:11], s41 offen offset:1024 lds
mm a,152,v,44,v,204,152
buffer_load_dwordx4 v251, s[8:11], s41 offen offset:2048 lds
mm v,148,a,216,v,48,172
s_add_u32 m0, s30, 12296
v_exp_f32 v140, v140
mm v,148,a,220,v,56,148
tr 200,239,0
s_add_u32 s41, s33, 98304
mm v,148,a,224,v,64,148
buffer_load_dwordx4 v249, s[8:11], s41 offen lds
v_exp_f32 v141, v141
mm v,148,a,228,v,72,148
tr 202,239,6144
buffer_load_dwordx4 v250, s[8:11], s41 offen offset:1024 lds
mm v,148,a,232,v,80,148
buffer_load_dwordx4 v251, s[8:11], s41 offen offset:2048 lds
v_exp_f32 v142, v142
mm v,148,a,236,v,88,148
tr 204,239,12288
s_add_u32 m0, s30, 15368
v_cvt_pk_bf16_f32 v78, v140, v141
mm a,160,v,4,v,208,160
s_add_u32 s41, s33, 147456
v_exp_f32 v143, v143
mm a,160,v,12,v,212,160
tr 206,239,18432
buffer_load_dwordx4 v249, s[8:11], s41 offen lds
mm a,164,v,20,v,208,164
buffer_load_dwordx4 v250, s[8:11], s41 offen offset:1024 lds
mm a,164,v,28,v,212,164
buffer_load_dwordx4 v251, s[8:11], s41 offen offset:2048 lds
v_cvt_pk_bf16_f32 v79, v142, v143
mm a,168,v,36,v,208,168
s_add_u32 m0, s30, 18440
s_add_u32 s41, s33, 491520
s_mov_b64 exec, 0
s_branch L_pg56
L_ir55:
s_mov_b64 exec, -1
L_ir55x:
mm a,168,v,44,v,212,168
buffer_load_dwordx4 v249, s[8:11], s41 offen lds
mm a,248,v,232,v,36,248
mm a,248,v,232,v,44,248
mm v,156,a,216,v,96,180
v_exp_f32 v148, v148
mm v,156,a,220,v,104,156
tr 208,240,0
buffer_load_dwordx4 v250, s[8:11], s41 offen offset:1024 lds
mm v,156,a,224,v,112,156
buffer_load_dwordx4 v251, s[8:11], s41 offen offset:2048 lds
v_exp_f32 v149, v149
mm v,156,a,228,v,120,156
tr 210,240,6144
s_add_u32 m0, s30, 21512
s_add_u32 s41, s33, 540672
mm v,156,a,232,v,128,156
v_exp_f32 v150, v150
mm v,156,a,236,v,136,156
tr 212,240,12288
buffer_load_dwordx4 v249, s[8:11], s41 offen lds
v_cvt_pk_bf16_f32 v94, v148, v149
mm a,176,v,4,v,216,176
buffer_load_dwordx4 v250, s[8:11], s41 offen offset:1024 lds
v_exp_f32 v151, v151
mm a,176,v,12,v,220,176
tr 214,240,18432
buffer_load_dwordx4 v251, s[8:11], s41 offen offset:2048 lds
mm a,180,v,20,v,216,180
s_add_u32 s33, s33, 786432
s_cmp_eq_u32 s33, s94
s_cselect_b32 s55, 7864320, 0
mm a,180,v,28,v,220,180
s_sub_u32 s33, s33, s55
v_cvt_pk_bf16_f32 v95, v150, v151
mm a,184,v,36,v,216,184
mm a,184,v,44,v,220,184
s_waitcnt lgkmcnt(10)
mm a,0,v,68,v,192,0
s_waitcnt lgkmcnt(8)
v_exp_f32 v156, v156
v_exp_f32 v157, v157
mm a,0,v,76,v,196,0
v_exp_f32 v158, v158
v_exp_f32 v159, v159
mm a,4,v,84,v,192,4
v_cvt_pk_bf16_f32 v110, v156, v157
v_cvt_pk_bf16_f32 v111, v158, v159
mm a,4,v,92,v,196,4
s_nop 0
s_waitcnt lgkmcnt(4)
mm a,8,v,100,v,192,8
tr 216,241,0
v_bfe_u32 v134, v253, 4, 4
mm a,8,v,108,v,196,8
tr 218,241,6144
v_lshrrev_b32 v135, 8, v253
mm a,240,v,232,v,68,240
mm a,240,v,232,v,76,240
mm a,244,v,232,v,84,244
mm a,244,v,232,v,92,244
mm a,248,v,232,v,100,248
mm a,248,v,232,v,108,248
mm a,16,v,68,v,200,16
tr 220,241,12288
v_lshlrev_b32 v135, 2, v135
mm a,16,v,76,v,204,16
tr 222,241,18432
mm a,20,v,84,v,200,20
tr 192,238,128
v_sub_u32 v134, v134, v135
mm a,20,v,92,v,204,20
tr 194,238,6272
v_min_u32 v134, 4, v134
mm a,24,v,100,v,200,24
tr 196,238,12416
v_lshlrev_b32 v134, 4, v134
mm a,24,v,108,v,204,24
tr 198,238,18560
s_waitcnt lgkmcnt(8)
mm a,32,v,68,v,208,32
tr 200,239,128
v_mov_b32 v140, 0x3f80
mm a,32,v,76,v,212,32
tr 202,239,6272
v_mov_b32 v141, 0
v_lshlrev_b64 v[132:133], v134, v[140:141]
mm a,36,v,84,v,208,36
tr 204,239,12416
v_accvgpr_read_b32 v232, a240
v_cmp_gt_u32 vcc, 64, v134
mm a,36,v,92,v,212,36
tr 206,239,18560
v_mov_b32 v140, 0
mm a,40,v,100,v,208,40
v_accvgpr_read_b32 v233, a244
v_accvgpr_read_b32 v234, a248
v_mov_b32 v134, 0
mm a,40,v,108,v,212,40
s_waitcnt lgkmcnt(8)
v_add_f32 v224, v232, v233
v_add_f32 v224, v224, v234
mm a,48,v,68,v,216,48
tr 208,240,128
v_cmp_ngt_f32 s[52:53], s37, v224
mm a,48,v,76,v,220,48
tr 210,240,6272
v_mov_b32 v135, 0
v_cndmask_b32 v132, 0, v132, vcc
mm a,52,v,84,v,216,52
tr 212,240,12416
v_mov_b32 v143, v133
v_mov_b32 v142, v132
s_mov_b64 exec, 0
s_branch L_pg58
L_ir57:
s_mov_b64 exec, -1
L_ir57x:
mm a,52,v,92,v,220,52
tr 214,240,18560
s_waitcnt lgkmcnt(8)
mm a,56,v,100,v,216,56
s_waitcnt vmcnt(36)
v_rcp_f32 v232, v232
mm a,56,v,108,v,220,56
ds_read_b128 a[192:195], v244
v_rcp_f32 v233, v233
mm a,64,v,68,v,192,64
tr 216,241,128
ds_read_b128 a[196:199], v245
mm a,64,v,76,v,196,64
tr 218,241,6272
ds_read_b128 a[200:203], v244 offset:2048
mm a,68,v,84,v,192,68
tr 220,241,12416
ds_read_b128 a[204:207], v245 offset:2048
mm a,68,v,92,v,196,68
tr 222,241,18560
s_waitcnt lgkmcnt(12)
mm a,72,v,100,v,192,72
ds_read_b128 a[208:211], v244 offset:4096
v_rcp_f32 v234, v234
mm a,72,v,108,v,196,72
s_lshl_b32 s101, s24, 8
s_add_u32 s101, s101, 161536
v_bfe_u32 v225, v253, 4, 4
mm a,80,v,68,v,200,80
tr 192,238,256
v_lshl_add_u32 v225, v225, 2, s101
mm a,80,v,76,v,204,80
tr 194,238,6400
ds_read_b128 a[212:215], v245 offset:4096
mm a,84,v,84,v,200,84
tr 196,238,12544
ds_read_b128 v[36:39], v244
mm a,84,v,92,v,204,84
tr 198,238,18688
mm a,88,v,100,v,200,88
ds_write_b32 v225, v232
ds_read_b128 v[44:47], v245
mm a,88,v,108,v,204,88
ds_write_b32 v225, v233 offset:64
s_waitcnt lgkmcnt(15)
mm a,96,v,68,v,208,96
tr 200,239,256
mm a,96,v,76,v,212,96
tr 202,239,6400
mm a,100,v,84,v,208,100
tr 204,239,12544
mm a,100,v,92,v,212,100
tr 206,239,18688
s_waitcnt lgkmcnt(5)
mm a,104,v,100,v,208,104
ds_write_b32 v225, v234 offset:128
s_add_u32 m0, s44, 0
s_add_u32 s51, s34, 0
mm a,104,v,108,v,212,104
s_cmp_lg_u64 s[52:53], 0
s_cselect_b32 s52, 1, 0
s_lshl_b32 s101, s24, 2
buffer_load_dwordx4 v252, s[4:7], s51 offen lds
mm a,112,v,68,v,216,112
tr 208,240,256
s_add_u32 s101, s101, 161280
s_add_u32 s51, s34, 9216
mm a,112,v,76,v,220,112
tr 210,240,6400
v_mov_b32 v224, s52
mm a,116,v,84,v,216,116
tr 212,240,12544
v_mov_b32 v225, s101
mm a,116,v,92,v,220,116
tr 214,240,18688
mm a,120,v,100,v,216,120
ds_write_b32 v225, v224
v_mov_b32 v254, 161280
mm a,120,v,108,v,220,120
buffer_load_dwordx4 v252, s[4:7], s51 offen offset:1024 lds
ds_read_b128 v[232:235], v246
v_accvgpr_read_b32 v4, a0
v_accvgpr_read_b32 v5, a1
v_accvgpr_read_b32 v6, a2
v_accvgpr_read_b32 v7, a3
v_accvgpr_read_b32 v12, a16
v_accvgpr_read_b32 v13, a17
mm a,128,v,68,v,192,128
tr 216,241,256
s_add_u32 s51, s34, 18432
v_accvgpr_read_b32 v14, a18
v_accvgpr_read_b32 v15, a19
mm a,128,v,76,v,196,128
tr 218,241,6400
s_waitcnt lgkmcnt(2)
v_mul_f32_e64 v148, -v248, v232
v_mul_f32_e64 v149, -v248, v233
v_mul_f32_e64 v150, -v248, v234
v_mul_f32_e64 v151, -v248, v235
v_fma_f32 v4, v4, v232, v148
v_fma_f32 v5, v5, v233, v149
v_fma_f32 v6, v6, v234, v150
v_fma_f32 v7, v7, v235, v151
v_fma_f32 v12, v12, v232, v148
v_fma_f32 v13, v13, v233, v149
v_fma_f32 v14, v14, v234, v150
v_fma_f32 v15, v15, v235, v151
v_cvt_pk_bf16_f32 v4, v4, v5
mm a,132,v,84,v,192,132
tr 220,241,12544
v_cvt_pk_bf16_f32 v5, v6, v7
v_cvt_pk_bf16_f32 v6, v12, v13
v_cvt_pk_bf16_f32 v7, v14, v15
mm a,132,v,92,v,196,132
tr 222,241,18688
mz v,20,v,4,v,132
mz v,28,v,4,v,140
mm a,136,v,100,v,192,136
buffer_load_dwordx4 v252, s[4:7], s51 offen offset:2048 lds
ds_read_b128 v[232:235], v246 offset:64
v_accvgpr_read_b32 v4, a4
v_accvgpr_read_b32 v5, a5
v_accvgpr_read_b32 v6, a6
v_accvgpr_read_b32 v7, a7
v_accvgpr_read_b32 v12, a20
v_accvgpr_read_b32 v13, a21
v_accvgpr_read_b32 v14, a22
v_accvgpr_read_b32 v15, a23
v_cvt_pk_bf16_f32 v20, v20, v21
v_cvt_pk_bf16_f32 v21, v22, v23
v_cvt_pk_bf16_f32 v22, v28, v29
v_cvt_pk_bf16_f32 v23, v30, v31
mm a,136,v,108,v,196,136
s_add_u32 s51, s34, 27648
s_sub_u32 s42, s29, s48
s_mov_b32 s48, s29
s_add_u32 s50, s46, 0
buffer_store_dwordx4 v[20:23], v253, s[20:23], s50 offen sc1
s_waitcnt lgkmcnt(0)
v_mul_f32_e64 v148, -v248, v232
v_mul_f32_e64 v149, -v248, v233
v_mul_f32_e64 v150, -v248, v234
v_mul_f32_e64 v151, -v248, v235
v_fma_f32 v4, v4, v232, v148
v_fma_f32 v5, v5, v233, v149
v_fma_f32 v6, v6, v234, v150
v_fma_f32 v7, v7, v235, v151
v_fma_f32 v12, v12, v232, v148
v_fma_f32 v13, v13, v233, v149
v_fma_f32 v14, v14, v234, v150
mm a,144,v,68,v,200,144
v_add_u32 v242, s42, v242
v_add_u32 v243, s42, v243
v_fma_f32 v15, v15, v235, v151
v_cvt_pk_bf16_f32 v4, v4, v5
v_cvt_pk_bf16_f32 v5, v6, v7
v_cvt_pk_bf16_f32 v6, v12, v13
v_cvt_pk_bf16_f32 v7, v14, v15
mm a,144,v,76,v,204,144
buffer_load_dwordx4 v252, s[4:7], s51 offen offset:3072 lds
mz v,20,v,4,v,132
mz v,28,v,4,v,140
mm a,148,v,84,v,200,148
s_add_u32 m0, s44, 4096
s_add_u32 s51, s34, 40960
ds_read_b128 v[232:235], v246 offset:128
v_accvgpr_read_b32 v4, a8
v_accvgpr_read_b32 v5, a9
v_accvgpr_read_b32 v6, a10
v_accvgpr_read_b32 v7, a11
v_accvgpr_read_b32 v12, a24
v_accvgpr_read_b32 v13, a25
v_accvgpr_read_b32 v14, a26
v_accvgpr_read_b32 v15, a27
v_cvt_pk_bf16_f32 v20, v20, v21
v_cvt_pk_bf16_f32 v21, v22, v23
v_cvt_pk_bf16_f32 v22, v28, v29
v_cvt_pk_bf16_f32 v23, v30, v31
mm a,148,v,92,v,204,148
s_add_u32 s50, s46, 6144
buffer_store_dwordx4 v[20:23], v253, s[20:23], s50 offen sc1
s_waitcnt lgkmcnt(0)
v_mul_f32_e64 v148, -v248, v232
v_mul_f32_e64 v149, -v248, v233
v_mul_f32_e64 v150, -v248, v234
v_mul_f32_e64 v151, -v248, v235
v_fma_f32 v4, v4, v232, v148
v_fma_f32 v5, v5, v233, v149
v_fma_f32 v6, v6, v234, v150
v_fma_f32 v7, v7, v235, v151
v_fma_f32 v12, v12, v232, v148
mm a,152,v,100,v,200,152
v_fma_f32 v13, v13, v233, v149
v_fma_f32 v14, v14, v234, v150
v_fma_f32 v15, v15, v235, v151
v_cvt_pk_bf16_f32 v4, v4, v5
v_cvt_pk_bf16_f32 v5, v6, v7
v_cvt_pk_bf16_f32 v6, v12, v13
v_cvt_pk_bf16_f32 v7, v14, v15
mm a,152,v,108,v,204,152
s_waitcnt vmcnt(27) lgkmcnt(0)
s_barrier
mz v,20,v,4,v,132
mz v,28,v,4,v,140
mm a,160,v,68,v,208,160
ds_read_b128 v[228:231], v254
s_mov_b32 s43, s28
mm a,160,v,76,v,212,160
buffer_load_dwordx4 v252, s[4:7], s51 offen lds
tr 192,242,0
mm a,164,v,84,v,208,164
s_add_u32 s51, s34, 50176
s_mov_b32 s28, s29
s_mov_b32 s29, s30
mm a,164,v,92,v,212,164
s_mov_b32 s30, s43
tr 194,242,3072
mm a,168,v,100,v,208,168
tr 196,242,6144
v_accvgpr_write_b32 a24, v140
v_accvgpr_write_b32 a25, v141
mm a,168,v,108,v,212,168
tr 198,242,9216
v_accvgpr_write_b32 a26, v142
v_accvgpr_write_b32 a27, v143
mm a,176,v,68,v,216,176
buffer_load_dwordx4 v252, s[4:7], s51 offen offset:1024 lds
tr 200,242,8
s_waitcnt lgkmcnt(5)
v_or3_b32 v228, v228, v229, v230
v_or_b32 v228, v228, v231
mm a,176,v,76,v,220,176
s_add_u32 s34, s34, 128
s_cmp_eq_u32 s34, s95
s_cselect_b32 s55, 1280, 0
v_cvt_pk_bf16_f32 v20, v20, v21
v_readfirstlane_b32 s52, v228
mm a,180,v,84,v,216,180
s_sub_u32 s34, s34, s55
tr 202,242,3080
v_cvt_pk_bf16_f32 v21, v22, v23
mm a,180,v,92,v,220,180
tr 204,242,6152
v_cvt_pk_bf16_f32 v22, v28, v29
v_cvt_pk_bf16_f32 v23, v30, v31
mm a,184,v,100,v,216,184
tr 206,242,9224
s_add_u32 s50, s46, 12288
buffer_store_dwordx4 v[20:23], v253, s[20:23], s50 offen sc1
mm a,184,v,108,v,220,184
v_accvgpr_write_b32 a28, 0
v_accvgpr_write_b32 a29, 0
s_and_b32 s53, s52, 1
s_andn2_b32 s53, s53, s87
s_cbranch_scc1 L_slow_3
s_mov_b32 s87, 0
s_waitcnt lgkmcnt(4)
v_max3_f32 v224, |v36|, |v37|, |v38|
v_max3_f32 v224, v224, |v39|, |v44|
v_max3_f32 v224, v224, |v45|, |v46|
v_max3_f32 v224, v224, |v47|, |v47|
v_max3_f32 v247, |v192|, |v193|, |v194|
v_max3_f32 v247, v247, |v195|, |v196|
v_max3_f32 v247, v247, |v197|, |v198|
v_max3_f32 v247, v247, |v199|, |v199|
v_mul_f32 v247, v247, v224
v_and_b32 v247, 0x7f800000, v247
v_mul_f32 v247, 0x43c00000, v247
v_min_f32 v247, 0x71800000, v247
s_nop 0
v_readlane_b32 s57, v247, 0
v_readlane_b32 s58, v247, 21
v_readlane_b32 s59, v247, 42
s_nop 3
s_min_u32 s57, s57, s58
s_min_u32 s57, s57, s59
v_mov_b32 v247, s57
v_mov_b32 v140, v247
v_mov_b32 v141, v247
v_mov_b32 v142, v247
v_mov_b32 v143, v247
s_nop 1
v_accvgpr_write_b32 a0, v236
v_accvgpr_write_b32 a1, v237
v_accvgpr_write_b32 a2, v238
v_accvgpr_write_b32 a3, v239
mm v,0,v,192,a,192,140
tr 208,243,0
s_add_u32 m0, s30, 9216
mm v,0,v,196,a,196,0
tr 210,243,3072
s_add_u32 s41, s33, 442368
mm v,48,v,192,a,200,140
tr 212,243,6144
v_accvgpr_read_b32 v216, a40
v_accvgpr_read_b32 v217, a41
mm v,48,v,196,a,204,48
tr 214,243,9216
s_waitcnt lgkmcnt(4)
v_accvgpr_read_b32 v218, a42
mm v,96,v,192,a,208,140
buffer_load_dwordx4 v249, s[8:11], s41 offen lds
v_accvgpr_read_b32 v219, a43
mm v,96,v,196,a,212,96
buffer_load_dwordx4 v250, s[8:11], s41 offen offset:1024 lds
v_accvgpr_read_b32 v220, a56
mm v,4,v,200,a,192,140
tr 192,243,8
buffer_load_dwordx4 v251, s[8:11], s41 offen offset:2048 lds
mm v,4,v,204,a,196,4
tr 194,243,3080
s_add_u32 m0, s30, 12296
v_accvgpr_read_b32 v221, a57
mm v,52,v,200,a,200,140
tr 196,243,6152
s_add_u32 s41, s33, 98304
v_accvgpr_read_b32 v222, a58
mm v,52,v,204,a,204,52
tr 198,243,9224
s_waitcnt lgkmcnt(4)
v_accvgpr_read_b32 v223, a59
mm v,100,v,200,a,208,140
buffer_load_dwordx4 v249, s[8:11], s41 offen lds
mm v,100,v,204,a,212,100
buffer_load_dwordx4 v250, s[8:11], s41 offen offset:1024 lds
mm v,8,v,208,a,192,140
tr 200,242,128
v_mul_f32_e64 v236, -v248, v232
mm v,8,v,212,a,196,8
tr 202,242,3200
v_mul_f32_e64 v237, -v248, v233
v_mul_f32_e64 v238, -v248, v234
mm v,56,v,208,a,200,140
tr 204,242,6272
buffer_load_dwordx4 v251, s[8:11], s41 offen offset:2048 lds
mm v,56,v,212,a,204,56
tr 206,242,9344
s_waitcnt lgkmcnt(4)
v_mul_f32_e64 v239, -v248, v235
mm v,104,v,208,a,208,140
s_add_u32 m0, s30, 15368
s_add_u32 s41, s33, 147456
v_fma_f32 v216, v216, v232, v236
mm v,104,v,212,a,212,104
buffer_load_dwordx4 v249, s[8:11], s41 offen lds
mm v,12,v,192,a,192,140
tr 208,242,136
v_fma_f32 v217, v217, v233, v237
mm v,12,v,196,a,196,12
tr 210,242,3208
v_fma_f32 v218, v218, v234, v238
v_fma_f32 v219, v219, v235, v239
mm v,60,v,192,a,200,140
tr 212,242,6280
buffer_load_dwordx4 v250, s[8:11], s41 offen offset:1024 lds
mm v,60,v,196,a,204,60
tr 214,242,9352
s_waitcnt lgkmcnt(4)
v_fma_f32 v220, v220, v232, v236
mm v,108,v,192,a,208,140
buffer_load_dwordx4 v251, s[8:11], s41 offen offset:2048 lds
v_fma_f32 v221, v221, v233, v237
mm v,108,v,196,a,212,108
s_add_u32 m0, s30, 18440
s_add_u32 s41, s33, 491520
v_fma_f32 v222, v222, v234, v238
v_fma_f32 v223, v223, v235, v239
mm v,16,v,200,a,192,140
tr 192,243,128
s_waitcnt vmcnt(33)
mm v,16,v,204,a,196,16
tr 194,243,3200
buffer_load_dwordx4 v249, s[8:11], s41 offen lds
mm v,64,v,200,a,200,140
tr 196,243,6272
v_cvt_pk_bf16_f32 v216, v216, v217
v_cvt_pk_bf16_f32 v217, v218, v219
mm v,64,v,204,a,204,64
tr 198,243,9344
s_waitcnt lgkmcnt(4)
v_cvt_pk_bf16_f32 v218, v220, v221
mm v,112,v,200,a,208,140
ds_read_b128 a[224:227], v244 offset:6144
buffer_load_dwordx4 v250, s[8:11], s41 offen offset:1024 lds
mm v,112,v,204,a,212,112
ds_read_b128 a[228:231], v245 offset:6144
v_cvt_pk_bf16_f32 v219, v222, v223
mm v,20,v,208,a,192,140
tr 200,243,136
buffer_load_dwordx4 v251, s[8:11], s41 offen offset:2048 lds
mm v,20,v,212,a,196,20
tr 202,243,3208
s_add_u32 m0, s30, 21512
mz v,224,v,216,a,26
mz v,228,v,216,a,24
mm v,68,v,208,a,200,140
tr 204,243,6280
s_add_u32 s41, s33, 540672
v_accvgpr_read_b32 v216, a72
mm v,68,v,212,a,204,68
tr 206,243,9352
s_waitcnt lgkmcnt(6)
v_accvgpr_read_b32 v217, a73
v_accvgpr_read_b32 v218, a74
mm v,116,v,208,a,208,140
ds_read_b128 a[232:235], v244 offset:8192
buffer_load_dwordx4 v249, s[8:11], s41 offen lds
mm v,116,v,212,a,212,116
ds_read_b128 a[236:239], v245 offset:8192
v_accvgpr_read_b32 v219, a75
v_accvgpr_read_b32 v220, a88
mm v,24,v,192,a,192,140
tr 208,242,256
buffer_load_dwordx4 v250, s[8:11], s41 offen offset:1024 lds
mm v,24,v,196,a,196,24
tr 210,242,3328
v_accvgpr_read_b32 v221, a89
v_accvgpr_read_b32 v222, a90
v_accvgpr_read_b32 v223, a91
mm v,72,v,192,a,200,140
tr 212,242,6400
buffer_load_dwordx4 v251, s[8:11], s41 offen offset:2048 lds
mm v,72,v,196,a,204,72
tr 214,242,9472
s_waitcnt lgkmcnt(6)
s_add_u32 s33, s33, 786432
mm v,120,v,192,a,208,140
ds_read_b128 a[240:243], v244 offset:10240
s_cmp_eq_u32 s33, s94
s_cselect_b32 s55, 7864320, 0
mm v,120,v,196,a,212,120
ds_read_b128 a[244:247], v245 offset:10240
s_sub_u32 s33, s33, s55
v_cvt_pk_bf16_f32 v224, v224, v225
mm v,28,v,200,a,192,140
tr 192,242,264
v_cvt_pk_bf16_f32 v225, v226, v227
mm v,28,v,204,a,196,28
tr 194,242,3336
v_cvt_pk_bf16_f32 v226, v228, v229
mm v,76,v,200,a,200,140
tr 196,242,6408
v_cvt_pk_bf16_f32 v227, v230, v231
mm v,76,v,204,a,204,76
tr 198,242,9480
s_add_u32 s50, s46, 12288
mm v,124,v,200,a,208,140
s_waitcnt lgkmcnt(4)
buffer_store_dwordx4 v[224:227], v253, s[20:23], s50 offen offset:1024 sc1
mm v,124,v,204,a,212,124
s_add_u32 m0, s45, 0
s_add_u32 s51, s34, 0
buffer_load_dwordx4 v252, s[4:7], s51 offen lds
mm v,32,v,208,a,192,140
tr 200,243,256
s_add_u32 s51, s34, 9216
v_fma_f32 v216, v216, v232, v236
mm v,32,v,212,a,196,32
tr 202,243,3328
v_fma_f32 v217, v217, v233, v237
mm v,80,v,208,a,200,140
tr 204,243,6400
v_fma_f32 v218, v218, v234, v238
v_fma_f32 v219, v219, v235, v239
mm v,80,v,212,a,204,80
tr 206,243,9472
s_waitcnt lgkmcnt(4)
v_fma_f32 v220, v220, v232, v236
mm v,128,v,208,a,208,140
buffer_load_dwordx4 v252, s[4:7], s51 offen offset:1024 lds
mm v,128,v,212,a,212,128
s_add_u32 s51, s34, 18432
v_fma_f32 v221, v221, v233, v237
v_fma_f32 v222, v222, v234, v238
mm v,36,v,192,a,192,140
tr 208,243,264
v_fma_f32 v223, v223, v235, v239
v_cvt_pk_bf16_f32 v216, v216, v217
mm v,36,v,196,a,196,36
tr 210,243,3336
buffer_load_dwordx4 v252, s[4:7], s51 offen offset:2048 lds
mm v,84,v,192,a,200,140
tr 212,243,6408
s_add_u32 s51, s34, 27648
v_cvt_pk_bf16_f32 v217, v218, v219
mm v,84,v,196,a,204,84
tr 214,243,9480
s_waitcnt lgkmcnt(6)
v_cvt_pk_bf16_f32 v218, v220, v221
mm v,132,v,192,a,208,140
s_sub_u32 s42, s29, s48
s_mov_b32 s48, s29
v_add_u32 v242, s42, v242
v_cvt_pk_bf16_f32 v219, v222, v223
mm v,132,v,196,a,212,132
buffer_load_dwordx4 v252, s[4:7], s51 offen offset:3072 lds
v_add_u32 v243, s42, v243
mz v,224,v,216,a,26
mz v,228,v,216,a,24
mm v,40,v,200,a,192,140
s_waitcnt vmcnt(29) lgkmcnt(0)
s_barrier
s_add_u32 m0, s45, 4096
s_add_u32 s51, s34, 40960
mm v,40,v,204,a,196,40
tr 192,242,0
s_mov_b32 s43, s28
v_accvgpr_read_b32 v216, a104
mm v,88,v,200,a,200,140
tr 194,242,3072
s_mov_b32 s28, s29
v_accvgpr_read_b32 v217, a105
mm v,88,v,204,a,204,88
tr 196,242,6144
s_mov_b32 s29, s30
buffer_load_dwordx4 v252, s[4:7], s51 offen lds
mm v,136,v,200,a,208,140
tr 198,242,9216
mm v,136,v,204,a,212,136
s_mov_b32 s30, s43
s_add_u32 s51, s34, 50176
v_accvgpr_read_b32 v218, a106
mm v,44,v,208,a,192,140
tr 200,242,8
v_accvgpr_read_b32 v219, a107
v_accvgpr_read_b32 v220, a120
mm v,44,v,212,a,196,44
tr 202,242,3080
buffer_load_dwordx4 v252, s[4:7], s51 offen offset:1024 lds
mm v,92,v,208,a,200,140
tr 204,242,6152
s_add_u32 s34, s34, 128
v_accvgpr_read_b32 v221, a121
mm v,92,v,212,a,204,92
tr 206,242,9224
v_accvgpr_read_b32 v222, a122
mm v,140,v,208,a,208,140
s_cmp_eq_u32 s34, s95
s_cselect_b32 s55, 1280, 0
s_sub_u32 s34, s34, s55
mm v,140,v,212,a,212,140
s_waitcnt lgkmcnt(4)
v_accvgpr_read_b32 v223, a123
v_cvt_pk_bf16_f32 v224, v224, v225
v_cvt_pk_bf16_f32 v225, v226, v227
mm v,0,v,192,a,224,0
tr 208,243,0
s_add_u32 m0, s30, 9216
mm v,0,v,196,a,228,0
tr 210,243,3072
s_add_u32 s41, s33, 442368
mm v,48,v,192,a,232,48
tr 212,243,6144
v_cvt_pk_bf16_f32 v226, v228, v229
v_cvt_pk_bf16_f32 v227, v230, v231
mm v,48,v,196,a,236,48
tr 214,243,9216
s_waitcnt lgkmcnt(4)
s_add_u32 s50, s46, 12288
mm v,96,v,192,a,240,96
buffer_load_dwordx4 v249, s[8:11], s41 offen lds
buffer_store_dwordx4 v[224:227], v253, s[20:23], s50 offen offset:2048 sc1
mm v,96,v,196,a,244,96
buffer_load_dwordx4 v250, s[8:11], s41 offen offset:1024 lds
v_fma_f32 v216, v216, v232, v236
mm v,4,v,200,a,224,4
tr 192,243,8
buffer_load_dwordx4 v251, s[8:11], s41 offen offset:2048 lds
mm v,4,v,204,a,228,4
tr 194,243,3080
s_add_u32 m0, s30, 12296
v_fma_f32 v217, v217, v233, v237
mm v,52,v,200,a,232,52
tr 196,243,6152
s_add_u32 s41, s33, 98304
v_fma_f32 v218, v218, v234, v238
mm v,52,v,204,a,236,52
tr 198,243,9224
s_waitcnt lgkmcnt(4)
v_fma_f32 v219, v219, v235, v239
mm v,100,v,200,a,240,100
buffer_load_dwordx4 v249, s[8:11], s41 offen lds
v_fma_f32 v220, v220, v232, v236
mm v,100,v,204,a,244,100
buffer_load_dwordx4 v250, s[8:11], s41 offen offset:1024 lds
mm v,8,v,208,a,224,8
tr 200,242,128
v_fma_f32 v221, v221, v233, v237
mm v,8,v,212,a,228,8
tr 202,242,3200
v_fma_f32 v222, v222, v234, v238
v_fma_f32 v223, v223, v235, v239
mm v,56,v,208,a,232,56
tr 204,242,6272
buffer_load_dwordx4 v251, s[8:11], s41 offen offset:2048 lds
mm v,56,v,212,a,236,56
tr 206,242,9344
s_waitcnt lgkmcnt(4)
mm v,104,v,208,a,240,104
s_add_u32 m0, s30, 15368
s_add_u32 s41, s33, 147456
v_cvt_pk_bf16_f32 v216, v216, v217
v_cvt_pk_bf16_f32 v217, v218, v219
mm v,104,v,212,a,244,104
buffer_load_dwordx4 v249, s[8:11], s41 offen lds
mm v,12,v,192,a,224,12
tr 208,242,136
v_cvt_pk_bf16_f32 v218, v220, v221
mm v,12,v,196,a,228,12
tr 210,242,3208
v_cvt_pk_bf16_f32 v219, v222, v223
mm v,60,v,192,a,232,60
tr 212,242,6280
buffer_load_dwordx4 v250, s[8:11], s41 offen offset:1024 lds
mm v,60,v,196,a,236,60
tr 214,242,9352
s_waitcnt lgkmcnt(4)
mz v,224,v,216,a,26
mz v,228,v,216,a,24
mm v,108,v,192,a,240,108
buffer_load_dwordx4 v251, s[8:11], s41 offen offset:2048 lds
v_accvgpr_read_b32 v216, a136
mm v,108,v,196,a,244,108
s_add_u32 m0, s30, 18440
s_add_u32 s41, s33, 491520
v_accvgpr_read_b32 v217, a137
v_accvgpr_read_b32 v218, a138
mm v,16,v,200,a,224,16
tr 192,243,128
s_waitcnt vmcnt(33)
v_accvgpr_read_b32 v219, a139
mm v,16,v,204,a,228,16
tr 194,243,3200
buffer_load_dwordx4 v249, s[8:11], s41 offen lds
mm v,64,v,200,a,232,64
tr 196,243,6272
v_accvgpr_read_b32 v220, a152
v_accvgpr_read_b32 v221, a153
mm v,64,v,204,a,236,64
tr 198,243,9344
s_waitcnt lgkmcnt(4)
mm v,112,v,200,a,240,112
ds_read_b128 a[192:195], v244
buffer_load_dwordx4 v250, s[8:11], s41 offen offset:1024 lds
mm v,112,v,204,a,244,112
ds_read_b128 a[196:199], v245
v_accvgpr_read_b32 v222, a154
v_accvgpr_read_b32 v223, a155
mm v,20,v,208,a,224,20
tr 200,243,136
buffer_load_dwordx4 v251, s[8:11], s41 offen offset:2048 lds
mm v,20,v,212,a,228,20
tr 202,243,3208
s_add_u32 m0, s30, 21512
v_cvt_pk_bf16_f32 v224, v224, v225
mm v,68,v,208,a,232,68
tr 204,243,6280
s_add_u32 s41, s33, 540672
v_cvt_pk_bf16_f32 v225, v226, v227
mm v,68,v,212,a,236,68
tr 206,243,9352
s_waitcnt lgkmcnt(6)
v_cvt_pk_bf16_f32 v226, v228, v229
mm v,116,v,208,a,240,116
ds_read_b128 a[200:203], v244 offset:2048
buffer_load_dwordx4 v249, s[8:11], s41 offen lds
mm v,116,v,212,a,244,116
ds_read_b128 a[204:207], v245 offset:2048
v_cvt_pk_bf16_f32 v227, v230, v231
mm v,24,v,192,a,224,24
tr 208,242,256
buffer_load_dwordx4 v250, s[8:11], s41 offen offset:1024 lds
s_add_u32 s50, s46, 12288
mm v,24,v,196,a,228,24
tr 210,242,3328
buffer_store_dwordx4 v[224:227], v253, s[20:23], s50 offen offset:3072 sc1
v_fma_f32 v216, v216, v232, v236
mm v,72,v,192,a,232,72
tr 212,242,6400
buffer_load_dwordx4 v251, s[8:11], s41 offen offset:2048 lds
mm v,72,v,196,a,236,72
tr 214,242,9472
s_waitcnt lgkmcnt(6)
s_add_u32 s33, s33, 786432
v_fma_f32 v217, v217, v233, v237
mm v,120,v,192,a,240,120
ds_read_b128 a[208:211], v244 offset:4096
s_cmp_eq_u32 s33, s94
s_cselect_b32 s55, 7864320, 0
v_fma_f32 v218, v218, v234, v238
mm v,120,v,196,a,244,120
ds_read_b128 a[212:215], v245 offset:4096
s_sub_u32 s33, s33, s55
v_fma_f32 v219, v219, v235, v239
mm v,28,v,200,a,224,28
tr 192,242,264
v_fma_f32 v220, v220, v232, v236
mm v,28,v,204,a,228,28
tr 194,242,3336
v_fma_f32 v221, v221, v233, v237
mm v,76,v,200,a,232,76
tr 196,242,6408
v_fma_f32 v222, v222, v234, v238
mm v,76,v,204,a,236,76
tr 198,242,9480
mm v,124,v,200,a,240,124
s_waitcnt lgkmcnt(4)
v_fma_f32 v223, v223, v235, v239
v_cvt_pk_bf16_f32 v216, v216, v217
v_cvt_pk_bf16_f32 v217, v218, v219
mm v,124,v,204,a,244,124
L_pg50:
s_cbranch_execz L_ir49
s_add_u32 m0, s44, 0
s_add_u32 s51, s34, 0
buffer_load_dwordx4 v252, s[4:7], s51 offen lds
mm v,32,v,208,a,224,32
tr 200,243,256
s_add_u32 s51, s34, 9216
mm v,32,v,212,a,228,32
tr 202,243,3328
v_cvt_pk_bf16_f32 v218, v220, v221
mm v,80,v,208,a,232,80
tr 204,243,6400
v_cvt_pk_bf16_f32 v219, v222, v223
mm v,80,v,212,a,236,80
tr 206,243,9472
s_waitcnt lgkmcnt(4)
mz v,224,v,216,a,26
mz v,228,v,216,a,24
mm v,128,v,208,a,240,128
buffer_load_dwordx4 v252, s[4:7], s51 offen offset:1024 lds
mm v,128,v,212,a,244,128
s_add_u32 s51, s34, 18432
v_accvgpr_read_b32 v216, a168
v_accvgpr_read_b32 v217, a169
mm v,36,v,192,a,224,36
tr 208,243,264
v_accvgpr_read_b32 v218, a170
v_accvgpr_read_b32 v219, a171
mm v,36,v,196,a,228,36
tr 210,243,3336
buffer_load_dwordx4 v252, s[4:7], s51 offen offset:2048 lds
mm v,84,v,192,a,232,84
tr 212,243,6408
s_add_u32 s51, s34, 27648
v_accvgpr_read_b32 v220, a184
mm v,84,v,196,a,236,84
tr 214,243,9480
s_waitcnt lgkmcnt(6)
v_accvgpr_read_b32 v221, a185
mm v,132,v,192,a,240,132
s_sub_u32 s42, s29, s48
s_mov_b32 s48, s29
v_add_u32 v242, s42, v242
v_accvgpr_read_b32 v222, a186
mm v,132,v,196,a,244,132
buffer_load_dwordx4 v252, s[4:7], s51 offen offset:3072 lds
v_add_u32 v243, s42, v243
mm v,40,v,200,a,224,40
s_waitcnt vmcnt(28) lgkmcnt(0)
s_barrier
s_add_u32 m0, s44, 4096
s_add_u32 s51, s34, 40960
mm v,40,v,204,a,228,40
tr 192,242,0
s_mov_b32 s43, s28
v_accvgpr_read_b32 v223, a187
mm v,88,v,200,a,232,88
tr 194,242,3072
s_mov_b32 s28, s29
v_cvt_pk_bf16_f32 v224, v224, v225
v_cvt_pk_bf16_f32 v225, v226, v227
mm v,88,v,204,a,236,88
tr 196,242,6144
s_mov_b32 s29, s30
buffer_load_dwordx4 v252, s[4:7], s51 offen lds
mm v,136,v,200,a,240,136
tr 198,242,9216
mm v,136,v,204,a,244,136
s_mov_b32 s30, s43
s_add_u32 s51, s34, 50176
v_cvt_pk_bf16_f32 v226, v228, v229
mm v,44,v,208,a,224,44
tr 200,242,8
v_cvt_pk_bf16_f32 v227, v230, v231
mm v,44,v,212,a,228,44
tr 202,242,3080
buffer_load_dwordx4 v252, s[4:7], s51 offen offset:1024 lds
s_add_u32 s50, s46, 16384
mm v,92,v,208,a,232,92
tr 204,242,6152
s_add_u32 s34, s34, 128
buffer_store_dwordx4 v[224:227], v253, s[20:23], s50 offen sc1
mm v,92,v,212,a,236,92
tr 206,242,9224
v_fma_f32 v216, v216, v232, v236
mm v,140,v,208,a,240,140
s_cmp_eq_u32 s34, s95
s_cselect_b32 s55, 1280, 0
s_sub_u32 s34, s34, s55
v_fma_f32 v217, v217, v233, v237
mm v,140,v,212,a,244,140
s_waitcnt lgkmcnt(4)
v_fma_f32 v218, v218, v234, v238
v_fma_f32 v219, v219, v235, v239
mm v,0,v,192,a,192,0
tr 208,243,0
s_add_u32 m0, s30, 9216
mm v,0,v,196,a,196,0
tr 210,243,3072
s_add_u32 s41, s33, 442368
mm v,48,v,192,a,200,48
tr 212,243,6144
v_fma_f32 v220, v220, v232, v236
v_fma_f32 v221, v221, v233, v237
mm v,48,v,196,a,204,48
tr 214,243,9216
s_waitcnt lgkmcnt(4)
v_fma_f32 v222, v222, v234, v238
mm v,96,v,192,a,208,96
buffer_load_dwordx4 v249, s[8:11], s41 offen lds
v_fma_f32 v223, v223, v235, v239
mm v,96,v,196,a,212,96
buffer_load_dwordx4 v250, s[8:11], s41 offen offset:1024 lds
v_cvt_pk_bf16_f32 v216, v216, v217
mm v,4,v,200,a,192,4
tr 192,243,8
buffer_load_dwordx4 v251, s[8:11], s41 offen offset:2048 lds
mm v,4,v,204,a,196,4
tr 194,243,3080
s_add_u32 m0, s30, 12296
v_cvt_pk_bf16_f32 v217, v218, v219
mm v,52,v,200,a,200,52
tr 196,243,6152
s_add_u32 s41, s33, 98304
v_cvt_pk_bf16_f32 v218, v220, v221
mm v,52,v,204,a,204,52
tr 198,243,9224
s_waitcnt lgkmcnt(4)
v_cvt_pk_bf16_f32 v219, v222, v223
mm v,100,v,200,a,208,100
buffer_load_dwordx4 v249, s[8:11], s41 offen lds
mm v,100,v,204,a,212,100
buffer_load_dwordx4 v250, s[8:11], s41 offen offset:1024 lds
mz v,224,v,216,a,26
mz v,228,v,216,a,24
mm v,8,v,208,a,192,8
tr 200,242,128
ds_read_b128 v[232:235], v246 offset:64
mm v,8,v,212,a,196,8
tr 202,242,3200
v_accvgpr_read_b32 v216, a36
v_accvgpr_read_b32 v217, a37
mm v,56,v,208,a,200,56
tr 204,242,6272
buffer_load_dwordx4 v251, s[8:11], s41 offen offset:2048 lds
mm v,56,v,212,a,204,56
tr 206,242,9344
s_waitcnt lgkmcnt(5)
mm v,104,v,208,a,208,104
s_add_u32 m0, s30, 15368
s_add_u32 s41, s33, 147456
v_accvgpr_read_b32 v218, a38
v_accvgpr_read_b32 v219, a39
mm v,104,v,212,a,212,104
buffer_load_dwordx4 v249, s[8:11], s41 offen lds
mm v,12,v,192,a,192,12
tr 208,242,136
v_accvgpr_read_b32 v220, a52
mm v,12,v,196,a,196,12
tr 210,242,3208
v_accvgpr_read_b32 v221, a53
v_accvgpr_read_b32 v222, a54
mm v,60,v,192,a,200,60
tr 212,242,6280
buffer_load_dwordx4 v250, s[8:11], s41 offen offset:1024 lds
mm v,60,v,196,a,204,60
tr 214,242,9352
s_waitcnt lgkmcnt(4)
v_accvgpr_read_b32 v223, a55
mm v,108,v,192,a,208,108
buffer_load_dwordx4 v251, s[8:11], s41 offen offset:2048 lds
mm v,108,v,196,a,212,108
s_add_u32 m0, s30, 18440
s_add_u32 s41, s33, 491520
v_cvt_pk_bf16_f32 v224, v224, v225
v_cvt_pk_bf16_f32 v225, v226, v227
mm v,16,v,200,a,192,16
tr 192,243,128
s_waitcnt vmcnt(33)
v_cvt_pk_bf16_f32 v226, v228, v229
mm v,16,v,204,a,196,16
tr 194,243,3200
buffer_load_dwordx4 v249, s[8:11], s41 offen lds
mm v,64,v,200,a,200,64
tr 196,243,6272
v_cvt_pk_bf16_f32 v227, v230, v231
mm v,64,v,204,a,204,64
tr 198,243,9344
s_add_u32 s50, s46, 16384
buffer_store_dwordx4 v[224:227], v253, s[20:23], s50 offen offset:1024 sc1
mm v,112,v,200,a,208,112
ds_read_b128 a[224:227], v244 offset:6144
buffer_load_dwordx4 v250, s[8:11], s41 offen offset:1024 lds
mm v,112,v,204,a,212,112
ds_read_b128 a[228:231], v245 offset:6144
s_waitcnt lgkmcnt(6)
v_mul_f32_e64 v236, -v248, v232
mm v,20,v,208,a,192,20
tr 200,243,136
buffer_load_dwordx4 v251, s[8:11], s41 offen offset:2048 lds
mm v,20,v,212,a,196,20
tr 202,243,3208
s_add_u32 m0, s30, 21512
v_mul_f32_e64 v237, -v248, v233
mm v,68,v,208,a,200,68
tr 204,243,6280
s_add_u32 s41, s33, 540672
v_mul_f32_e64 v238, -v248, v234
mm v,68,v,212,a,204,68
tr 206,243,9352
s_waitcnt lgkmcnt(6)
v_mul_f32_e64 v239, -v248, v235
mm v,116,v,208,a,208,116
ds_read_b128 a[232:235], v244 offset:8192
buffer_load_dwordx4 v249, s[8:11], s41 offen lds
mm v,116,v,212,a,212,116
ds_read_b128 a[236:239], v245 offset:8192
v_fma_f32 v216, v216, v232, v236
v_fma_f32 v217, v217, v233, v237
mm v,24,v,192,a,192,24
tr 208,242,256
buffer_load_dwordx4 v250, s[8:11], s41 offen offset:1024 lds
mm v,24,v,196,a,196,24
tr 210,242,3328
v_fma_f32 v218, v218, v234, v238
v_fma_f32 v219, v219, v235, v239
v_fma_f32 v220, v220, v232, v236
mm v,72,v,192,a,200,72
tr 212,242,6400
buffer_load_dwordx4 v251, s[8:11], s41 offen offset:2048 lds
mm v,72,v,196,a,204,72
tr 214,242,9472
s_waitcnt lgkmcnt(6)
s_add_u32 s33, s33, 786432
mm v,120,v,192,a,208,120
ds_read_b128 a[240:243], v244 offset:10240
s_cmp_eq_u32 s33, s94
s_cselect_b32 s55, 7864320, 0
mm v,120,v,196,a,212,120
ds_read_b128 a[244:247], v245 offset:10240
s_sub_u32 s33, s33, s55
v_fma_f32 v221, v221, v233, v237
mm v,28,v,200,a,192,28
tr 192,242,264
v_fma_f32 v222, v222, v234, v238
mm v,28,v,204,a,196,28
tr 194,242,3336
v_fma_f32 v223, v223, v235, v239
mm v,76,v,200,a,200,76
tr 196,242,6408
v_cvt_pk_bf16_f32 v216, v216, v217
mm v,76,v,204,a,204,76
tr 198,242,9480
mm v,124,v,200,a,208,124
s_waitcnt lgkmcnt(4)
v_cvt_pk_bf16_f32 v217, v218, v219
v_cvt_pk_bf16_f32 v218, v220, v221
v_cvt_pk_bf16_f32 v219, v222, v223
mm v,124,v,204,a,212,124
s_add_u32 m0, s45, 0
s_add_u32 s51, s34, 0
buffer_load_dwordx4 v252, s[4:7], s51 offen lds
mz v,224,v,216,a,26
mz v,228,v,216,a,24
mm v,32,v,208,a,192,32
tr 200,243,256
s_add_u32 s51, s34, 9216
mm v,32,v,212,a,196,32
tr 202,243,3328
v_accvgpr_read_b32 v216, a68
mm v,80,v,208,a,200,80
tr 204,243,6400
v_accvgpr_read_b32 v217, a69
mm v,80,v,212,a,204,80
tr 206,243,9472
s_waitcnt lgkmcnt(4)
mm v,128,v,208,a,208,128
buffer_load_dwordx4 v252, s[4:7], s51 offen offset:1024 lds
mm v,128,v,212,a,212,128
s_add_u32 s51, s34, 18432
v_accvgpr_read_b32 v218, a70
v_accvgpr_read_b32 v219, a71
mm v,36,v,192,a,192,36
tr 208,243,264
v_accvgpr_read_b32 v220, a84
v_accvgpr_read_b32 v221, a85
mm v,36,v,196,a,196,36
tr 210,243,3336
buffer_load_dwordx4 v252, s[4:7], s51 offen offset:2048 lds
mm v,84,v,192,a,200,84
tr 212,243,6408
s_add_u32 s51, s34, 27648
v_accvgpr_read_b32 v222, a86
mm v,84,v,196,a,204,84
tr 214,243,9480
s_waitcnt lgkmcnt(6)
v_accvgpr_read_b32 v223, a87
mm v,132,v,192,a,208,132
s_sub_u32 s42, s29, s48
s_mov_b32 s48, s29
v_add_u32 v242, s42, v242
v_cvt_pk_bf16_f32 v224, v224, v225
mm v,132,v,196,a,212,132
buffer_load_dwordx4 v252, s[4:7], s51 offen offset:3072 lds
v_add_u32 v243, s42, v243
mm v,40,v,200,a,192,40
s_waitcnt vmcnt(27) lgkmcnt(0)
s_barrier
s_add_u32 m0, s45, 4096
s_add_u32 s51, s34, 40960
mm v,40,v,204,a,196,40
tr 192,242,0
s_mov_b32 s43, s28
v_cvt_pk_bf16_f32 v225, v226, v227
mm v,88,v,200,a,200,88
tr 194,242,3072
s_mov_b32 s28, s29
v_cvt_pk_bf16_f32 v226, v228, v229
v_cvt_pk_bf16_f32 v227, v230, v231
mm v,88,v,204,a,204,88
tr 196,242,6144
s_mov_b32 s29, s30
buffer_load_dwordx4 v252, s[4:7], s51 offen lds
mm v,136,v,200,a,208,136
tr 198,242,9216
s_add_u32 s50, s46, 6144
mm v,136,v,204,a,212,136
s_mov_b32 s30, s43
s_add_u32 s51, s34, 50176
buffer_store_dwordx4 v[224:227], v253, s[20:23], s50 offen offset:1024 sc1
mm v,44,v,208,a,192,44
tr 200,242,8
v_fma_f32 v216, v216, v232, v236
v_fma_f32 v217, v217, v233, v237
mm v,44,v,212,a,196,44
tr 202,242,3080
buffer_load_dwordx4 v252, s[4:7], s51 offen offset:1024 lds
mm v,92,v,208,a,200,92
tr 204,242,6152
s_add_u32 s34, s34, 128
v_fma_f32 v218, v218, v234, v238
mm v,92,v,212,a,204,92
tr 206,242,9224
v_fma_f32 v219, v219, v235, v239
mm v,140,v,208,a,208,140
s_cmp_eq_u32 s34, s95
s_cselect_b32 s55, 1280, 0
s_sub_u32 s34, s34, s55
mm v,140,v,212,a,212,140
s_waitcnt lgkmcnt(4)
v_fma_f32 v220, v220, v232, v236
v_fma_f32 v221, v221, v233, v237
v_fma_f32 v222, v222, v234, v238
mm v,0,v,192,a,224,0
tr 208,243,0
s_add_u32 m0, s30, 9216
mm v,0,v,196,a,228,0
tr 210,243,3072
s_add_u32 s41, s33, 442368
mm v,48,v,192,a,232,48
tr 212,243,6144
v_fma_f32 v223, v223, v235, v239
v_cvt_pk_bf16_f32 v216, v216, v217
mm v,48,v,196,a,236,48
tr 214,243,9216
s_waitcnt lgkmcnt(4)
v_cvt_pk_bf16_f32 v217, v218, v219
mm v,96,v,192,a,240,96
buffer_load_dwordx4 v249, s[8:11], s41 offen lds
v_cvt_pk_bf16_f32 v218, v220, v221
mm v,96,v,196,a,244,96
buffer_load_dwordx4 v250, s[8:11], s41 offen offset:1024 lds
v_cvt_pk_bf16_f32 v219, v222, v223
mm v,4,v,200,a,224,4
tr 192,243,8
buffer_load_dwordx4 v251, s[8:11], s41 offen offset:2048 lds
mm v,4,v,204,a,228,4
tr 194,243,3080
s_add_u32 m0, s30, 12296
mz v,224,v,216,a,26
mz v,228,v,216,a,24
mm v,52,v,200,a,232,52
tr 196,243,6152
s_add_u32 s41, s33, 98304
v_accvgpr_read_b32 v216, a100
mm v,52,v,204,a,236,52
tr 198,243,9224
s_waitcnt lgkmcnt(4)
v_accvgpr_read_b32 v217, a101
mm v,100,v,200,a,240,100
buffer_load_dwordx4 v249, s[8:11], s41 offen lds
mm v,100,v,204,a,244,100
buffer_load_dwordx4 v250, s[8:11], s41 offen offset:1024 lds
mm v,8,v,208,a,224,8
tr 200,242,128
v_accvgpr_read_b32 v218, a102
mm v,8,v,212,a,228,8
tr 202,242,3200
v_accvgpr_read_b32 v219, a103
v_accvgpr_read_b32 v220, a116
mm v,56,v,208,a,232,56
tr 204,242,6272
buffer_load_dwordx4 v251, s[8:11], s41 offen offset:2048 lds
mm v,56,v,212,a,236,56
tr 206,242,9344
s_waitcnt lgkmcnt(4)
v_accvgpr_read_b32 v221, a117
mm v,104,v,208,a,240,104
s_add_u32 m0, s30, 15368
s_add_u32 s41, s33, 147456
v_accvgpr_read_b32 v222, a118
v_accvgpr_read_b32 v223, a119
mm v,104,v,212,a,244,104
buffer_load_dwordx4 v249, s[8:11], s41 offen lds
mm v,12,v,192,a,224,12
tr 208,242,136
v_cvt_pk_bf16_f32 v224, v224, v225
mm v,12,v,196,a,228,12
tr 210,242,3208
v_cvt_pk_bf16_f32 v225, v226, v227
v_cvt_pk_bf16_f32 v226, v228, v229
mm v,60,v,192,a,232,60
tr 212,242,6280
buffer_load_dwordx4 v250, s[8:11], s41 offen offset:1024 lds
mm v,60,v,196,a,236,60
tr 214,242,9352
s_waitcnt lgkmcnt(4)
v_cvt_pk_bf16_f32 v227, v230, v231
mm v,108,v,192,a,240,108
buffer_load_dwordx4 v251, s[8:11], s41 offen offset:2048 lds
mm v,108,v,196,a,244,108
s_add_u32 m0, s30, 18440
s_add_u32 s41, s33, 491520
s_add_u32 s50, s46, 6144
buffer_store_dwordx4 v[224:227], v253, s[20:23], s50 offen offset:2048 sc1
mm v,16,v,200,a,224,16
tr 192,243,128
s_waitcnt vmcnt(34)
mm v,16,v,204,a,228,16
tr 194,243,3200
buffer_load_dwordx4 v249, s[8:11], s41 offen lds
mm v,64,v,200,a,232,64
tr 196,243,6272
v_fma_f32 v216, v216, v232, v236
v_fma_f32 v217, v217, v233, v237
mm v,64,v,204,a,236,64
tr 198,243,9344
s_waitcnt lgkmcnt(4)
v_fma_f32 v218, v218, v234, v238
mm v,112,v,200,a,240,112
ds_read_b128 a[192:195], v244
buffer_load_dwordx4 v250, s[8:11], s41 offen offset:1024 lds
mm v,112,v,204,a,244,112
ds_read_b128 a[196:199], v245
v_fma_f32 v219, v219, v235, v239
v_fma_f32 v220, v220, v232, v236
mm v,20,v,208,a,224,20
tr 200,243,136
buffer_load_dwordx4 v251, s[8:11], s41 offen offset:2048 lds
mm v,20,v,212,a,228,20
tr 202,243,3208
s_add_u32 m0, s30, 21512
v_fma_f32 v221, v221, v233, v237
mm v,68,v,208,a,232,68
tr 204,243,6280
s_add_u32 s41, s33, 540672
v_fma_f32 v222, v222, v234, v238
mm v,68,v,212,a,236,68
tr 206,243,9352
s_waitcnt lgkmcnt(6)
v_fma_f32 v223, v223, v235, v239
mm v,116,v,208,a,240,116
ds_read_b128 a[200:203], v244 offset:2048
buffer_load_dwordx4 v249, s[8:11], s41 offen lds
mm v,116,v,212,a,244,116
ds_read_b128 a[204:207], v245 offset:2048
v_cvt_pk_bf16_f32 v216, v216, v217
v_cvt_pk_bf16_f32 v217, v218, v219
mm v,24,v,192,a,224,24
tr 208,242,256
buffer_load_dwordx4 v250, s[8:11], s41 offen offset:1024 lds
mm v,24,v,196,a,228,24
tr 210,242,3328
v_cvt_pk_bf16_f32 v218, v220, v221
v_cvt_pk_bf16_f32 v219, v222, v223
mm v,72,v,192,a,232,72
tr 212,242,6400
buffer_load_dwordx4 v251, s[8:11], s41 offen offset:2048 lds
mm v,72,v,196,a,236,72
tr 214,242,9472
s_waitcnt lgkmcnt(6)
s_add_u32 s33, s33, 786432
mz v,224,v,216,a,26
mz v,228,v,216,a,24
mm v,120,v,192,a,240,120
ds_read_b128 a[208:211], v244 offset:4096
s_cmp_eq_u32 s33, s94
s_cselect_b32 s55, 7864320, 0
mm v,120,v,196,a,244,120
ds_read_b128 a[212:215], v245 offset:4096
s_sub_u32 s33, s33, s55
v_accvgpr_read_b32 v216, a132
mm v,28,v,200,a,224,28
tr 192,242,264
v_accvgpr_read_b32 v217, a133
mm v,28,v,204,a,228,28
tr 194,242,3336
v_accvgpr_read_b32 v218, a134
mm v,76,v,200,a,232,76
tr 196,242,6408
v_accvgpr_read_b32 v219, a135
v_accvgpr_read_b32 v220, a148
mm v,76,v,204,a,236,76
tr 198,242,9480
mm v,124,v,200,a,240,124
s_waitcnt lgkmcnt(4)
v_accvgpr_read_b32 v221, a149
v_accvgpr_read_b32 v222, a150
mm v,124,v,204,a,244,124
s_add_u32 m0, s44, 0
s_add_u32 s51, s34, 0
buffer_load_dwordx4 v252, s[4:7], s51 offen lds
mm v,32,v,208,a,224,32
tr 200,243,256
s_add_u32 s51, s34, 9216
mm v,32,v,212,a,228,32
tr 202,243,3328
v_accvgpr_read_b32 v223, a151
mm v,80,v,208,a,232,80
tr 204,243,6400
v_cvt_pk_bf16_f32 v224, v224, v225
v_cvt_pk_bf16_f32 v225, v226, v227
mm v,80,v,212,a,236,80
tr 206,243,9472
v_cvt_pk_bf16_f32 v226, v228, v229
mm v,128,v,208,a,240,128
buffer_load_dwordx4 v252, s[4:7], s51 offen offset:1024 lds
mm v,128,v,212,a,244,128
s_add_u32 s51, s34, 18432
s_waitcnt lgkmcnt(4)
v_cvt_pk_bf16_f32 v227, v230, v231
mm v,36,v,192,a,224,36
L_pg54:
s_cbranch_execz L_ir53
tr 208,243,264
s_add_u32 s50, s46, 6144
buffer_store_dwordx4 v[224:227], v253, s[20:23], s50 offen offset:3072 sc1
mm v,36,v,196,a,228,36
tr 210,243,3336
buffer_load_dwordx4 v252, s[4:7], s51 offen offset:2048 lds
mm v,84,v,192,a,232,84
tr 212,243,6408
s_add_u32 s51, s34, 27648
v_fma_f32 v216, v216, v232, v236
mm v,84,v,196,a,236,84
tr 214,243,9480
s_waitcnt lgkmcnt(6)
v_fma_f32 v217, v217, v233, v237
mm v,132,v,192,a,240,132
s_sub_u32 s42, s29, s48
s_mov_b32 s48, s29
v_add_u32 v242, s42, v242
v_fma_f32 v218, v218, v234, v238
v_fma_f32 v219, v219, v235, v239
mm v,132,v,196,a,244,132
buffer_load_dwordx4 v252, s[4:7], s51 offen offset:3072 lds
v_add_u32 v243, s42, v243
mm v,40,v,200,a,224,40
s_waitcnt vmcnt(28) lgkmcnt(0)
s_barrier
s_add_u32 m0, s44, 4096
s_add_u32 s51, s34, 40960
mm v,40,v,204,a,228,40
tr 192,242,0
s_mov_b32 s43, s28
v_fma_f32 v220, v220, v232, v236
mm v,88,v,200,a,232,88
tr 194,242,3072
s_mov_b32 s28, s29
v_fma_f32 v221, v221, v233, v237
mm v,88,v,204,a,236,88
tr 196,242,6144
s_mov_b32 s29, s30
buffer_load_dwordx4 v252, s[4:7], s51 offen lds
mm v,136,v,200,a,240,136
tr 198,242,9216
v_fma_f32 v222, v222, v234, v238
mm v,136,v,204,a,244,136
s_mov_b32 s30, s43
s_add_u32 s51, s34, 50176
v_fma_f32 v223, v223, v235, v239
mm v,44,v,208,a,224,44
tr 200,242,8
v_cvt_pk_bf16_f32 v216, v216, v217
v_cvt_pk_bf16_f32 v217, v218, v219
mm v,44,v,212,a,228,44
tr 202,242,3080
buffer_load_dwordx4 v252, s[4:7], s51 offen offset:1024 lds
mm v,92,v,208,a,232,92
tr 204,242,6152
s_add_u32 s34, s34, 128
v_cvt_pk_bf16_f32 v218, v220, v221
mm v,92,v,212,a,236,92
tr 206,242,9224
s_waitcnt lgkmcnt(4)
v_cvt_pk_bf16_f32 v219, v222, v223
mm v,140,v,208,a,240,140
s_cmp_eq_u32 s34, s95
s_cselect_b32 s55, 1280, 0
s_sub_u32 s34, s34, s55
mm v,140,v,212,a,244,140
mz v,224,v,216,a,26
mz v,228,v,216,a,24
mm v,0,v,192,a,192,0
tr 208,243,0
s_add_u32 m0, s30, 9216
v_accvgpr_read_b32 v216, a164
mm v,0,v,196,a,196,0
tr 210,243,3072
s_add_u32 s41, s33, 442368
v_accvgpr_read_b32 v217, a165
mm v,48,v,192,a,200,48
tr 212,243,6144
v_accvgpr_read_b32 v218, a166
v_accvgpr_read_b32 v219, a167
mm v,48,v,196,a,204,48
tr 214,243,9216
s_waitcnt lgkmcnt(4)
v_accvgpr_read_b32 v220, a180
mm v,96,v,192,a,208,96
buffer_load_dwordx4 v249, s[8:11], s41 offen lds
v_accvgpr_read_b32 v221, a181
mm v,96,v,196,a,212,96
buffer_load_dwordx4 v250, s[8:11], s41 offen offset:1024 lds
v_accvgpr_read_b32 v222, a182
mm v,4,v,200,a,192,4
tr 192,243,8
buffer_load_dwordx4 v251, s[8:11], s41 offen offset:2048 lds
mm v,4,v,204,a,196,4
tr 194,243,3080
s_add_u32 m0, s30, 12296
v_accvgpr_read_b32 v223, a183
mm v,52,v,200,a,200,52
tr 196,243,6152
s_add_u32 s41, s33, 98304
v_cvt_pk_bf16_f32 v224, v224, v225
mm v,52,v,204,a,204,52
tr 198,243,9224
s_waitcnt lgkmcnt(4)
v_cvt_pk_bf16_f32 v225, v226, v227
mm v,100,v,200,a,208,100
buffer_load_dwordx4 v249, s[8:11], s41 offen lds
v_cvt_pk_bf16_f32 v226, v228, v229
mm v,100,v,204,a,212,100
buffer_load_dwordx4 v250, s[8:11], s41 offen offset:1024 lds
mm v,8,v,208,a,192,8
tr 200,242,128
v_cvt_pk_bf16_f32 v227, v230, v231
mm v,8,v,212,a,196,8
tr 202,242,3200
s_add_u32 s50, s46, 10240
buffer_store_dwordx4 v[224:227], v253, s[20:23], s50 offen sc1
mm v,56,v,208,a,200,56
tr 204,242,6272
buffer_load_dwordx4 v251, s[8:11], s41 offen offset:2048 lds
mm v,56,v,212,a,204,56
tr 206,242,9344
s_waitcnt lgkmcnt(4)
mm v,104,v,208,a,208,104
s_add_u32 m0, s30, 15368
s_add_u32 s41, s33, 147456
v_fma_f32 v216, v216, v232, v236
v_fma_f32 v217, v217, v233, v237
mm v,104,v,212,a,212,104
buffer_load_dwordx4 v249, s[8:11], s41 offen lds
mm v,12,v,192,a,192,12
tr 208,242,136
v_fma_f32 v218, v218, v234, v238
mm v,12,v,196,a,196,12
tr 210,242,3208
v_fma_f32 v219, v219, v235, v239
v_fma_f32 v220, v220, v232, v236
mm v,60,v,192,a,200,60
tr 212,242,6280
buffer_load_dwordx4 v250, s[8:11], s41 offen offset:1024 lds
mm v,60,v,196,a,204,60
tr 214,242,9352
s_waitcnt lgkmcnt(4)
v_fma_f32 v221, v221, v233, v237
mm v,108,v,192,a,208,108
buffer_load_dwordx4 v251, s[8:11], s41 offen offset:2048 lds
mm v,108,v,196,a,212,108
s_add_u32 m0, s30, 18440
s_add_u32 s41, s33, 491520
v_fma_f32 v222, v222, v234, v238
v_fma_f32 v223, v223, v235, v239
mm v,16,v,200,a,192,16
tr 192,243,128
s_waitcnt vmcnt(33)
v_cvt_pk_bf16_f32 v216, v216, v217
mm v,16,v,204,a,196,16
tr 194,243,3200
buffer_load_dwordx4 v249, s[8:11], s41 offen lds
mm v,64,v,200,a,200,64
tr 196,243,6272
v_cvt_pk_bf16_f32 v217, v218, v219
v_cvt_pk_bf16_f32 v218, v220, v221
mm v,64,v,204,a,204,64
tr 198,243,9344
s_waitcnt lgkmcnt(4)
mm v,112,v,200,a,208,112
ds_read_b128 a[224:227], v244 offset:6144
buffer_load_dwordx4 v250, s[8:11], s41 offen offset:1024 lds
mm v,112,v,204,a,212,112
ds_read_b128 a[228:231], v245 offset:6144
v_cvt_pk_bf16_f32 v219, v222, v223
mm v,20,v,208,a,192,20
tr 200,243,136
buffer_load_dwordx4 v251, s[8:11], s41 offen offset:2048 lds
mm v,20,v,212,a,196,20
tr 202,243,3208
s_add_u32 m0, s30, 21512
mz v,224,v,216,a,26
mz v,228,v,216,a,24
mm v,68,v,208,a,200,68
tr 204,243,6280
s_add_u32 s41, s33, 540672
ds_read_b128 v[232:235], v246
v_accvgpr_read_b32 v216, a32
mm v,68,v,212,a,204,68
tr 206,243,9352
s_waitcnt lgkmcnt(7)
v_accvgpr_read_b32 v217, a33
v_accvgpr_read_b32 v218, a34
mm v,116,v,208,a,208,116
ds_read_b128 a[232:235], v244 offset:8192
buffer_load_dwordx4 v249, s[8:11], s41 offen lds
mm v,116,v,212,a,212,116
ds_read_b128 a[236:239], v245 offset:8192
v_accvgpr_read_b32 v219, a35
mm v,24,v,192,a,192,24
tr 208,242,256
buffer_load_dwordx4 v250, s[8:11], s41 offen offset:1024 lds
mm v,24,v,196,a,196,24
tr 210,242,3328
v_accvgpr_read_b32 v220, a48
v_accvgpr_read_b32 v221, a49
v_accvgpr_read_b32 v222, a50
mm v,72,v,192,a,200,72
tr 212,242,6400
buffer_load_dwordx4 v251, s[8:11], s41 offen offset:2048 lds
mm v,72,v,196,a,204,72
tr 214,242,9472
s_waitcnt lgkmcnt(6)
s_add_u32 s33, s33, 786432
v_accvgpr_read_b32 v223, a51
mm v,120,v,192,a,208,120
ds_read_b128 a[240:243], v244 offset:10240
s_cmp_eq_u32 s33, s94
s_cselect_b32 s55, 7864320, 0
mm v,120,v,196,a,212,120
ds_read_b128 a[244:247], v245 offset:10240
s_sub_u32 s33, s33, s55
v_cvt_pk_bf16_f32 v224, v224, v225
mm v,28,v,200,a,192,28
tr 192,242,264
v_cvt_pk_bf16_f32 v225, v226, v227
mm v,28,v,204,a,196,28
tr 194,242,3336
v_cvt_pk_bf16_f32 v226, v228, v229
mm v,76,v,200,a,200,76
tr 196,242,6408
v_cvt_pk_bf16_f32 v227, v230, v231
mm v,76,v,204,a,204,76
tr 198,242,9480
mm v,124,v,200,a,208,124
s_waitcnt lgkmcnt(4)
s_add_u32 s50, s46, 10240
buffer_store_dwordx4 v[224:227], v253, s[20:23], s50 offen offset:1024 sc1
mm v,124,v,204,a,212,124
s_add_u32 m0, s45, 0
s_add_u32 s51, s34, 0
buffer_load_dwordx4 v252, s[4:7], s51 offen lds
mm v,32,v,208,a,192,32
tr 200,243,256
s_add_u32 s51, s34, 9216
mm v,32,v,212,a,196,32
tr 202,243,3328
v_mul_f32_e64 v236, -v248, v232
mm v,80,v,208,a,200,80
tr 204,243,6400
v_mul_f32_e64 v237, -v248, v233
v_mul_f32_e64 v238, -v248, v234
mm v,80,v,212,a,204,80
tr 206,243,9472
s_waitcnt lgkmcnt(4)
mm v,128,v,208,a,208,128
buffer_load_dwordx4 v252, s[4:7], s51 offen offset:1024 lds
mm v,128,v,212,a,212,128
s_add_u32 s51, s34, 18432
v_mul_f32_e64 v239, -v248, v235
v_fma_f32 v216, v216, v232, v236
mm v,36,v,192,a,192,36
tr 208,243,264
v_fma_f32 v217, v217, v233, v237
v_fma_f32 v218, v218, v234, v238
mm v,36,v,196,a,196,36
tr 210,243,3336
buffer_load_dwordx4 v252, s[4:7], s51 offen offset:2048 lds
mm v,84,v,192,a,200,84
tr 212,243,6408
s_add_u32 s51, s34, 27648
v_fma_f32 v219, v219, v235, v239
mm v,84,v,196,a,204,84
tr 214,243,9480
s_waitcnt lgkmcnt(6)
v_fma_f32 v220, v220, v232, v236
mm v,132,v,192,a,208,132
s_sub_u32 s42, s29, s48
s_mov_b32 s48, s29
v_add_u32 v242, s42, v242
v_fma_f32 v221, v221, v233, v237
mm v,132,v,196,a,212,132
buffer_load_dwordx4 v252, s[4:7], s51 offen offset:3072 lds
v_add_u32 v243, s42, v243
mm v,40,v,200,a,192,40
s_waitcnt vmcnt(28) lgkmcnt(0)
s_barrier
s_add_u32 m0, s45, 4096
s_add_u32 s51, s34, 40960
mm v,40,v,204,a,196,40
tr 192,242,0
s_mov_b32 s43, s28
v_fma_f32 v222, v222, v234, v238
v_lshlrev_b32 v184, 3, v253
s_add_u32 s58, s54, 0
buffer_load_dword v185, v184, s[96:99], s58 offen
v_lshlrev_b32 v184, 3, v253
s_add_u32 s58, s54, 8192
buffer_load_dword v185, v184, s[96:99], s58 offen
v_lshlrev_b32 v184, 3, v253
s_add_u32 s58, s54, 16384
buffer_load_dword v185, v184, s[96:99], s58 offen
v_lshlrev_b32 v184, 3, v253
s_add_u32 s58, s54, 22528
buffer_load_dword v185, v184, s[96:99], s58 offen
mm v,88,v,200,a,200,88
tr 194,242,3072
s_mov_b32 s28, s29
v_fma_f32 v223, v223, v235, v239
v_cvt_pk_bf16_f32 v216, v216, v217
mm v,88,v,204,a,204,88
tr 196,242,6144
s_mov_b32 s29, s30
buffer_load_dwordx4 v252, s[4:7], s51 offen lds
mm v,136,v,200,a,208,136
tr 198,242,9216
v_cvt_pk_bf16_f32 v217, v218, v219
mm v,136,v,204,a,212,136
s_mov_b32 s30, s43
s_add_u32 s51, s34, 50176
v_cvt_pk_bf16_f32 v218, v220, v221
mm v,44,v,208,a,192,44
tr 200,242,8
v_cvt_pk_bf16_f32 v219, v222, v223
mm v,44,v,212,a,196,44
tr 202,242,3080
buffer_load_dwordx4 v252, s[4:7], s51 offen offset:1024 lds
mz v,224,v,216,a,26
mz v,228,v,216,a,24
mm v,92,v,208,a,200,92
tr 204,242,6152
s_add_u32 s34, s34, 128
v_accvgpr_read_b32 v216, a64
mm v,92,v,212,a,204,92
tr 206,242,9224
v_accvgpr_read_b32 v217, a65
mm v,140,v,208,a,208,140
s_cmp_eq_u32 s34, s95
s_cselect_b32 s55, 1280, 0
s_sub_u32 s34, s34, s55
mm v,140,v,212,a,212,140
s_waitcnt lgkmcnt(4)
v_accvgpr_read_b32 v218, a66
v_accvgpr_read_b32 v219, a67
mm v,0,v,192,a,224,0
tr 208,243,0
s_add_u32 m0, s30, 9216
mm v,0,v,196,a,228,0
tr 210,243,3072
s_add_u32 s41, s33, 442368
mm v,48,v,192,a,232,48
tr 212,243,6144
v_accvgpr_read_b32 v220, a80
v_accvgpr_read_b32 v221, a81
mm v,48,v,196,a,236,48
tr 214,243,9216
s_waitcnt lgkmcnt(4)
v_accvgpr_read_b32 v222, a82
mm v,96,v,192,a,240,96
buffer_load_dwordx4 v249, s[8:11], s41 offen lds
v_accvgpr_read_b32 v223, a83
mm v,96,v,196,a,244,96
buffer_load_dwordx4 v250, s[8:11], s41 offen offset:1024 lds
v_cvt_pk_bf16_f32 v224, v224, v225
s_getpc_b64 s[58:59]
L_ct70:
s_add_u32 s58, s58, L_head_4-L_ct70
s_addc_u32 s59, s59, 0-((L_head_4-L_ct70)>>63)
s_and_b32 s57, s58, 0xf80
s_and_b32 s58, s58, 0xfffff000
v_lshrrev_b32 v176, 7, v253
v_lshlrev_b32 v176, 12, v176
v_max_u32 v176, s57, v176
v_and_b32 v177, 0x70, v253
v_lshl_add_u32 v176, v177, 3, v176
v_min_u32 v176, L_code_end-(L_head_4)-4, v176
v_mov_b32 v177, s59
v_add_co_u32 v176, vcc, s58, v176
s_nop 1
v_addc_co_u32 v177, vcc, 0, v177, vcc
global_load_dword v178, v[176:177], off
s_getpc_b64 s[58:59]
L_ct71:
s_add_u32 s58, s58, L_head_3-L_ct71
s_addc_u32 s59, s59, 0-((L_head_3-L_ct71)>>63)
s_and_b32 s57, s58, 0xf80
s_and_b32 s58, s58, 0xfffff000
v_lshrrev_b32 v176, 7, v253
v_lshlrev_b32 v176, 12, v176
v_max_u32 v176, s57, v176
v_and_b32 v177, 0x70, v253
v_lshl_add_u32 v176, v177, 3, v176
v_min_u32 v176, L_code_end-(L_head_3)-4, v176
v_mov_b32 v177, s59
v_add_co_u32 v176, vcc, s58, v176
s_nop 1
v_addc_co_u32 v177, vcc, 0, v177, vcc
global_load_dword v178, v[176:177], off
L_cts69:
mm v,4,v,200,a,224,4
tr 192,243,8
buffer_load_dwordx4 v251, s[8:11], s41 offen offset:2048 lds
mm v,4,v,204,a,228,4
tr 194,243,3080
s_add_u32 m0, s30, 12296
v_cvt_pk_bf16_f32 v225, v226, v227
mm v,52,v,200,a,232,52
tr 196,243,6152
s_add_u32 s41, s33, 98304
v_cvt_pk_bf16_f32 v226, v228, v229
mm v,52,v,204,a,236,52
tr 198,243,9224
s_waitcnt lgkmcnt(4)
v_cvt_pk_bf16_f32 v227, v230, v231
mm v,100,v,200,a,240,100
buffer_load_dwordx4 v249, s[8:11], s41 offen lds
s_add_u32 s50, s46, 0
mm v,100,v,204,a,244,100
buffer_load_dwordx4 v250, s[8:11], s41 offen offset:1024 lds
mm v,8,v,208,a,224,8
tr 200,242,128
buffer_store_dwordx4 v[224:227], v253, s[20:23], s50 offen offset:1024 sc1
mm v,8,v,212,a,228,8
tr 202,242,3200
v_fma_f32 v216, v216, v232, v236
v_fma_f32 v217, v217, v233, v237
mm v,56,v,208,a,232,56
tr 204,242,6272
buffer_load_dwordx4 v251, s[8:11], s41 offen offset:2048 lds
mm v,56,v,212,a,236,56
tr 206,242,9344
s_waitcnt lgkmcnt(4)
v_fma_f32 v218, v218, v234, v238
mm v,104,v,208,a,240,104
s_add_u32 m0, s30, 15368
s_add_u32 s41, s33, 147456
v_fma_f32 v219, v219, v235, v239
mm v,104,v,212,a,244,104
buffer_load_dwordx4 v249, s[8:11], s41 offen lds
mm v,12,v,192,a,224,12
tr 208,242,136
v_fma_f32 v220, v220, v232, v236
mm v,12,v,196,a,228,12
tr 210,242,3208
v_fma_f32 v221, v221, v233, v237
v_fma_f32 v222, v222, v234, v238
mm v,60,v,192,a,232,60
tr 212,242,6280
buffer_load_dwordx4 v250, s[8:11], s41 offen offset:1024 lds
mm v,60,v,196,a,236,60
tr 214,242,9352
s_waitcnt lgkmcnt(4)
v_fma_f32 v223, v223, v235, v239
mm v,108,v,192,a,240,108
buffer_load_dwordx4 v251, s[8:11], s41 offen offset:2048 lds
v_cvt_pk_bf16_f32 v216, v216, v217
mm v,108,v,196,a,244,108
s_add_u32 m0, s30, 18440
s_add_u32 s41, s33, 491520
v_cvt_pk_bf16_f32 v217, v218, v219
v_cvt_pk_bf16_f32 v218, v220, v221
mm v,16,v,200,a,224,16
tr 192,243,128
s_waitcnt vmcnt(33)
mm v,16,v,204,a,228,16
tr 194,243,3200
buffer_load_dwordx4 v249, s[8:11], s41 offen lds
mm v,64,v,200,a,232,64
tr 196,243,6272
v_cvt_pk_bf16_f32 v219, v222, v223
mm v,64,v,204,a,236,64
tr 198,243,9344
s_waitcnt lgkmcnt(4)
mz v,224,v,216,a,26
mz v,228,v,216,a,24
mm v,112,v,200,a,240,112
ds_read_b128 a[192:195], v244
buffer_load_dwordx4 v250, s[8:11], s41 offen offset:1024 lds
v_accvgpr_read_b32 v216, a96
mm v,112,v,204,a,244,112
ds_read_b128 a[196:199], v245
v_accvgpr_read_b32 v217, a97
v_accvgpr_read_b32 v218, a98
mm v,20,v,208,a,224,20
tr 200,243,136
buffer_load_dwordx4 v251, s[8:11], s41 offen offset:2048 lds
mm v,20,v,212,a,228,20
tr 202,243,3208
s_add_u32 m0, s30, 21512
v_accvgpr_read_b32 v219, a99
mm v,68,v,208,a,232,68
tr 204,243,6280
s_add_u32 s41, s33, 540672
v_accvgpr_read_b32 v220, a112
mm v,68,v,212,a,236,68
tr 206,243,9352
s_waitcnt lgkmcnt(6)
v_accvgpr_read_b32 v221, a113
mm v,116,v,208,a,240,116
ds_read_b128 a[200:203], v244 offset:2048
buffer_load_dwordx4 v249, s[8:11], s41 offen lds
mm v,116,v,212,a,244,116
ds_read_b128 a[204:207], v245 offset:2048
v_accvgpr_read_b32 v222, a114
v_accvgpr_read_b32 v223, a115
mm v,24,v,192,a,224,24
tr 208,242,256
buffer_load_dwordx4 v250, s[8:11], s41 offen offset:1024 lds
mm v,24,v,196,a,228,24
tr 210,242,3328
v_cvt_pk_bf16_f32 v224, v224, v225
v_cvt_pk_bf16_f32 v225, v226, v227
v_cvt_pk_bf16_f32 v226, v228, v229
mm v,72,v,192,a,232,72
tr 212,242,6400
buffer_load_dwordx4 v251, s[8:11], s41 offen offset:2048 lds
mm v,72,v,196,a,236,72
tr 214,242,9472
s_waitcnt lgkmcnt(6)
s_add_u32 s33, s33, 786432
mm v,120,v,192,a,240,120
ds_read_b128 a[208:211], v244 offset:4096
s_cmp_eq_u32 s33, s94
s_cselect_b32 s55, 7864320, 0
mm v,120,v,196,a,244,120
ds_read_b128 a[212:215], v245 offset:4096
s_sub_u32 s33, s33, s55
v_cvt_pk_bf16_f32 v227, v230, v231
mm v,28,v,200,a,224,28
tr 192,242,264
s_add_u32 s50, s46, 0
mm v,28,v,204,a,228,28
tr 194,242,3336
buffer_store_dwordx4 v[224:227], v253, s[20:23], s50 offen offset:2048 sc1
mm v,76,v,200,a,232,76
tr 196,242,6408
v_fma_f32 v216, v216, v232, v236
v_fma_f32 v217, v217, v233, v237
mm v,76,v,204,a,236,76
tr 198,242,9480
mm v,124,v,200,a,240,124
s_waitcnt lgkmcnt(4)
v_fma_f32 v218, v218, v234, v238
v_fma_f32 v219, v219, v235, v239
mm v,124,v,204,a,244,124
s_add_u32 m0, s44, 0
s_add_u32 s51, s34, 0
buffer_load_dwordx4 v252, s[4:7], s51 offen lds
mm v,32,v,208,a,224,32
tr 200,243,256
s_add_u32 s51, s34, 9216
mm v,32,v,212,a,228,32
tr 202,243,3328
v_fma_f32 v220, v220, v232, v236
mm v,80,v,208,a,232,80
tr 204,243,6400
v_fma_f32 v221, v221, v233, v237
v_fma_f32 v222, v222, v234, v238
mm v,80,v,212,a,236,80
L_pg58:
s_cbranch_execz L_ir57
tr 206,243,9472
s_waitcnt lgkmcnt(4)
v_fma_f32 v223, v223, v235, v239
mm v,128,v,208,a,240,128
buffer_load_dwordx4 v252, s[4:7], s51 offen offset:1024 lds
mm v,128,v,212,a,244,128
s_add_u32 s51, s34, 18432
v_cvt_pk_bf16_f32 v216, v216, v217
v_cvt_pk_bf16_f32 v217, v218, v219
mm v,36,v,192,a,224,36
tr 208,243,264
v_cvt_pk_bf16_f32 v218, v220, v221
v_cvt_pk_bf16_f32 v219, v222, v223
mm v,36,v,196,a,228,36
tr 210,243,3336
buffer_load_dwordx4 v252, s[4:7], s51 offen offset:2048 lds
mz v,224,v,216,a,26
mz v,228,v,216,a,24
mm v,84,v,192,a,232,84
tr 212,243,6408
s_add_u32 s51, s34, 27648
v_accvgpr_read_b32 v216, a128
mm v,84,v,196,a,236,84
tr 214,243,9480
s_waitcnt lgkmcnt(6)
v_accvgpr_read_b32 v217, a129
mm v,132,v,192,a,240,132
s_sub_u32 s42, s29, s48
s_mov_b32 s48, s29
v_add_u32 v242, s42, v242
v_accvgpr_read_b32 v218, a130
mm v,132,v,196,a,244,132
buffer_load_dwordx4 v252, s[4:7], s51 offen offset:3072 lds
v_add_u32 v243, s42, v243
mm v,40,v,200,a,224,40
s_waitcnt vmcnt(28) lgkmcnt(0)
s_barrier
s_add_u32 m0, s44, 4096
s_add_u32 s51, s34, 40960
mm v,40,v,204,a,228,40
tr 192,242,0
s_mov_b32 s43, s28
v_accvgpr_read_b32 v219, a131
mm v,88,v,200,a,232,88
tr 194,242,3072
s_mov_b32 s28, s29
v_accvgpr_read_b32 v220, a144
mm v,88,v,204,a,236,88
tr 196,242,6144
s_mov_b32 s29, s30
buffer_load_dwordx4 v252, s[4:7], s51 offen lds
mm v,136,v,200,a,240,136
tr 198,242,9216
mm v,136,v,204,a,244,136
s_mov_b32 s30, s43
s_add_u32 s51, s34, 50176
v_accvgpr_read_b32 v221, a145
mm v,44,v,208,a,224,44
tr 200,242,8
v_accvgpr_read_b32 v222, a146
v_accvgpr_read_b32 v223, a147
mm v,44,v,212,a,228,44
tr 202,242,3080
buffer_load_dwordx4 v252, s[4:7], s51 offen offset:1024 lds
mm v,92,v,208,a,232,92
tr 204,242,6152
s_add_u32 s34, s34, 128
v_cvt_pk_bf16_f32 v224, v224, v225
mm v,92,v,212,a,236,92
tr 206,242,9224
v_cvt_pk_bf16_f32 v225, v226, v227
mm v,140,v,208,a,240,140
s_cmp_eq_u32 s34, s95
s_cselect_b32 s55, 1280, 0
s_sub_u32 s34, s34, s55
mm v,140,v,212,a,244,140
s_waitcnt lgkmcnt(4)
v_cvt_pk_bf16_f32 v226, v228, v229
v_cvt_pk_bf16_f32 v227, v230, v231
mm v,0,v,192,a,192,0
tr 208,243,0
s_add_u32 m0, s30, 9216
s_add_u32 s50, s46, 0
mm v,0,v,196,a,196,0
tr 210,243,3072
s_add_u32 s41, s33, 442368
buffer_store_dwordx4 v[224:227], v253, s[20:23], s50 offen offset:3072 sc1
mm v,48,v,192,a,200,48
tr 212,243,6144
buffer_load_dwordx4 v249, s[8:11], s41 offen lds
v_fma_f32 v216, v216, v232, v236
mm v,48,v,196,a,204,48
tr 214,243,9216
s_waitcnt lgkmcnt(4)
buffer_load_dwordx4 v250, s[8:11], s41 offen offset:1024 lds
mm v,96,v,192,a,208,96
buffer_load_dwordx4 v251, s[8:11], s41 offen offset:2048 lds
v_fma_f32 v217, v217, v233, v237
v_fma_f32 v218, v218, v234, v238
v_fma_f32 v219, v219, v235, v239
mm v,96,v,196,a,212,96
s_add_u32 m0, s30, 12296
s_add_u32 s41, s33, 98304
buffer_load_dwordx4 v249, s[8:11], s41 offen lds
mm v,4,v,200,a,192,4
tr 192,243,8
buffer_load_dwordx4 v250, s[8:11], s41 offen offset:1024 lds
mm v,4,v,204,a,196,4
tr 194,243,3080
buffer_load_dwordx4 v251, s[8:11], s41 offen offset:2048 lds
mm v,52,v,200,a,200,52
tr 196,243,6152
s_add_u32 m0, s30, 15368
v_fma_f32 v220, v220, v232, v236
mm v,52,v,204,a,204,52
tr 198,243,9224
s_waitcnt lgkmcnt(4)
v_fma_f32 v221, v221, v233, v237
mm v,100,v,200,a,208,100
s_add_u32 s41, s33, 147456
v_fma_f32 v222, v222, v234, v238
v_fma_f32 v223, v223, v235, v239
v_cvt_pk_bf16_f32 v216, v216, v217
mm v,100,v,204,a,212,100
buffer_load_dwordx4 v249, s[8:11], s41 offen lds
v_cvt_pk_bf16_f32 v217, v218, v219
mm v,8,v,208,a,192,8
tr 200,242,128
buffer_load_dwordx4 v250, s[8:11], s41 offen offset:1024 lds
mm v,8,v,212,a,196,8
tr 202,242,3200
buffer_load_dwordx4 v251, s[8:11], s41 offen offset:2048 lds
mm v,56,v,208,a,200,56
tr 204,242,6272
s_add_u32 m0, s30, 18440
s_add_u32 s41, s33, 491520
mm v,56,v,212,a,204,56
tr 206,242,9344
s_waitcnt lgkmcnt(4)
v_cvt_pk_bf16_f32 v218, v220, v221
mm v,104,v,208,a,208,104
buffer_load_dwordx4 v249, s[8:11], s41 offen lds
v_cvt_pk_bf16_f32 v219, v222, v223
mm v,104,v,212,a,212,104
buffer_load_dwordx4 v250, s[8:11], s41 offen offset:1024 lds
buffer_load_dwordx4 v251, s[8:11], s41 offen offset:2048 lds
mz v,224,v,216,a,26
mz v,228,v,216,a,24
mm v,12,v,192,a,192,12
tr 208,242,136
s_add_u32 m0, s30, 21512
v_accvgpr_read_b32 v216, a160
mm v,12,v,196,a,196,12
tr 210,242,3208
s_add_u32 s41, s33, 540672
v_accvgpr_read_b32 v217, a161
v_accvgpr_read_b32 v218, a162
mm v,60,v,192,a,200,60
tr 212,242,6280
buffer_load_dwordx4 v249, s[8:11], s41 offen lds
mm v,60,v,196,a,204,60
tr 214,242,9352
s_waitcnt lgkmcnt(4)
buffer_load_dwordx4 v250, s[8:11], s41 offen offset:1024 lds
mm v,108,v,192,a,208,108
buffer_load_dwordx4 v251, s[8:11], s41 offen offset:2048 lds
v_accvgpr_read_b32 v219, a163
mm v,108,v,196,a,212,108
s_add_u32 s33, s33, 786432
s_cmp_eq_u32 s33, s94
s_cselect_b32 s55, 7864320, 0
v_accvgpr_read_b32 v220, a176
mm v,16,v,200,a,192,16
tr 192,243,128
s_waitcnt vmcnt(39)
v_accvgpr_read_b32 v221, a177
v_accvgpr_read_b32 v222, a178
mm v,16,v,204,a,196,16
tr 194,243,3200
s_sub_u32 s33, s33, s55
s_add_u32 m0, s25, 0
mm v,64,v,200,a,200,64
tr 196,243,6272
s_add_u32 s41, s89, 30720
buffer_load_dwordx4 v144, s[12:15], s41 offen nt lds
mm v,64,v,204,a,204,64
tr 198,243,9344
s_waitcnt lgkmcnt(4)
v_accvgpr_read_b32 v223, a179
v_cvt_pk_bf16_f32 v224, v224, v225
v_cvt_pk_bf16_f32 v225, v226, v227
mm v,112,v,200,a,208,112
ds_read_b128 a[224:227], v244 offset:6144
buffer_load_dwordx4 v145, s[12:15], s41 offen offset:1024 nt lds
mm v,112,v,204,a,212,112
ds_read_b128 a[228:231], v245 offset:6144
buffer_load_dwordx4 v146, s[12:15], s41 offen offset:2048 nt lds
mm v,20,v,208,a,192,20
tr 200,243,136
s_add_u32 m0, s25, 3072
v_cvt_pk_bf16_f32 v226, v228, v229
mm v,20,v,212,a,196,20
tr 202,243,3208
s_add_u32 s41, s89, 95232
v_cvt_pk_bf16_f32 v227, v230, v231
mm v,68,v,208,a,200,68
tr 204,243,6280
buffer_load_dwordx4 v144, s[12:15], s41 offen nt lds
s_add_u32 s50, s46, 4096
buffer_store_dwordx4 v[224:227], v253, s[20:23], s50 offen sc1
mm v,68,v,212,a,204,68
tr 206,243,9352
s_waitcnt lgkmcnt(6)
buffer_load_dwordx4 v145, s[12:15], s41 offen offset:1024 nt lds
mm v,116,v,208,a,208,116
ds_read_b128 a[232:235], v244 offset:8192
buffer_load_dwordx4 v146, s[12:15], s41 offen offset:2048 nt lds
s_add_u32 m0, s25, 6144
mm v,116,v,212,a,212,116
ds_read_b128 a[236:239], v245 offset:8192
s_add_u32 s41, s89, 129024
v_fma_f32 v216, v216, v232, v236
v_fma_f32 v217, v217, v233, v237
v_fma_f32 v218, v218, v234, v238
mm v,24,v,192,a,192,24
tr 208,242,256
buffer_load_dwordx4 v144, s[12:15], s41 offen nt lds
v_fma_f32 v219, v219, v235, v239
mm v,24,v,196,a,196,24
tr 210,242,3328
buffer_load_dwordx4 v145, s[12:15], s41 offen offset:1024 nt lds
mm v,72,v,192,a,200,72
tr 212,242,6400
buffer_load_dwordx4 v146, s[12:15], s41 offen offset:2048 nt lds
mm v,72,v,196,a,204,72
tr 214,242,9472
s_waitcnt lgkmcnt(6)
s_add_u32 m0, s25, 9216
v_fma_f32 v220, v220, v232, v236
mm v,120,v,192,a,208,120
ds_read_b128 a[240:243], v244 offset:10240
s_add_u32 s41, s89, 162816
v_fma_f32 v221, v221, v233, v237
v_fma_f32 v222, v222, v234, v238
mm v,120,v,196,a,212,120
ds_read_b128 a[244:247], v245 offset:10240
buffer_load_dwordx4 v144, s[12:15], s41 offen nt lds
mm v,28,v,200,a,192,28
tr 192,242,264
buffer_load_dwordx4 v145, s[12:15], s41 offen offset:1024 nt lds
buffer_load_dwordx4 v146, s[12:15], s41 offen offset:2048 nt lds
mm v,28,v,204,a,196,28
tr 194,242,3336
v_fma_f32 v223, v223, v235, v239
mm v,76,v,200,a,200,76
tr 196,242,6408
v_cvt_pk_bf16_f32 v216, v216, v217
v_cvt_pk_bf16_f32 v217, v218, v219
mm v,76,v,204,a,204,76
tr 198,242,9480
mm v,124,v,200,a,208,124
s_waitcnt lgkmcnt(4)
v_cvt_pk_bf16_f32 v218, v220, v221
v_cvt_pk_bf16_f32 v219, v222, v223
mm v,124,v,204,a,212,124
s_add_u32 m0, s45, 0
s_add_u32 s51, s34, 0
buffer_load_dwordx4 v252, s[4:7], s51 offen lds
mz v,224,v,216,a,26
mz v,228,v,216,a,24
mm v,32,v,208,a,192,32
tr 200,243,256
s_add_u32 s51, s34, 9216
mm v,32,v,212,a,196,32
tr 202,243,3328
mm v,80,v,208,a,200,80
tr 204,243,6400
mm v,80,v,212,a,204,80
tr 206,243,9472
mm v,128,v,208,a,208,128
buffer_load_dwordx4 v252, s[4:7], s51 offen offset:1024 lds
mm v,128,v,212,a,212,128
s_add_u32 s51, s34, 18432
s_waitcnt lgkmcnt(4)
mm v,36,v,192,a,192,36
tr 208,243,264
v_cvt_pk_bf16_f32 v224, v224, v225
v_cvt_pk_bf16_f32 v225, v226, v227
mm v,36,v,196,a,196,36
tr 210,243,3336
buffer_load_dwordx4 v252, s[4:7], s51 offen offset:2048 lds
mm v,84,v,192,a,200,84
tr 212,243,6408
s_add_u32 s51, s34, 27648
v_cvt_pk_bf16_f32 v226, v228, v229
mm v,84,v,196,a,204,84
tr 214,243,9480
s_waitcnt lgkmcnt(6)
v_cvt_pk_bf16_f32 v227, v230, v231
mm v,132,v,192,a,208,132
s_sub_u32 s42, s29, s48
s_mov_b32 s48, s29
s_add_u32 s50, s46, 4096
buffer_store_dwordx4 v[224:227], v253, s[20:23], s50 offen offset:1024 sc1
v_add_u32 v242, s42, v242
mm v,132,v,196,a,212,132
buffer_load_dwordx4 v252, s[4:7], s51 offen offset:3072 lds
v_add_u32 v243, s42, v243
mm v,40,v,200,a,192,40
s_waitcnt vmcnt(41) lgkmcnt(0)
s_barrier
s_add_u32 m0, s45, 4096
s_add_u32 s51, s34, 40960
mm v,40,v,204,a,196,40
tr 192,242,0
s_mov_b32 s43, s28
mm v,88,v,200,a,200,88
tr 194,242,3072
s_mov_b32 s28, s29
mm v,88,v,204,a,204,88
tr 196,242,6144
s_mov_b32 s29, s30
buffer_load_dwordx4 v252, s[4:7], s51 offen lds
mm v,136,v,200,a,208,136
tr 198,242,9216
mm v,136,v,204,a,212,136
s_mov_b32 s30, s43
s_add_u32 s51, s34, 50176
mm v,44,v,208,a,192,44
tr 200,242,8
mm v,44,v,212,a,196,44
tr 202,242,3080
buffer_load_dwordx4 v252, s[4:7], s51 offen offset:1024 lds
mm v,92,v,208,a,200,92
tr 204,242,6152
s_add_u32 s34, s34, 128
mm v,92,v,212,a,204,92
tr 206,242,9224
mm v,140,v,208,a,208,140
s_cmp_eq_u32 s34, s95
s_cselect_b32 s55, 1280, 0
s_sub_u32 s34, s34, s55
mm v,140,v,212,a,212,140
s_waitcnt lgkmcnt(4)
mm v,0,v,192,a,224,0
tr 208,243,0
s_add_u32 m0, s30, 9216
mm v,0,v,196,a,228,0
tr 210,243,3072
s_add_u32 s41, s33, 442368
mm v,48,v,192,a,232,48
tr 212,243,6144
buffer_load_dwordx4 v249, s[8:11], s41 offen lds
mm v,48,v,196,a,236,48
tr 214,243,9216
s_waitcnt lgkmcnt(4)
mm v,96,v,192,a,240,96
buffer_load_dwordx4 v250, s[8:11], s41 offen offset:1024 lds
mm v,96,v,196,a,244,96
buffer_load_dwordx4 v251, s[8:11], s41 offen offset:2048 lds
mm v,4,v,200,a,224,4
tr 192,243,8
s_add_u32 m0, s30, 12296
mm v,4,v,204,a,228,4
tr 194,243,3080
s_add_u32 s41, s33, 98304
mm v,52,v,200,a,232,52
tr 196,243,6152
buffer_load_dwordx4 v249, s[8:11], s41 offen lds
mm v,52,v,204,a,236,52
tr 198,243,9224
s_waitcnt lgkmcnt(4)
mm v,100,v,200,a,240,100
buffer_load_dwordx4 v250, s[8:11], s41 offen offset:1024 lds
mm v,100,v,204,a,244,100
buffer_load_dwordx4 v251, s[8:11], s41 offen offset:2048 lds
mm v,8,v,208,a,224,8
tr 200,242,128
s_add_u32 m0, s30, 15368
mm v,8,v,212,a,228,8
tr 202,242,3200
s_add_u32 s41, s33, 147456
mm v,56,v,208,a,232,56
tr 204,242,6272
buffer_load_dwordx4 v249, s[8:11], s41 offen lds
mm v,56,v,212,a,236,56
tr 206,242,9344
s_waitcnt lgkmcnt(4)
mm v,104,v,208,a,240,104
buffer_load_dwordx4 v250, s[8:11], s41 offen offset:1024 lds
mm v,104,v,212,a,244,104
buffer_load_dwordx4 v251, s[8:11], s41 offen offset:2048 lds
mm v,12,v,192,a,224,12
tr 208,242,136
s_add_u32 m0, s30, 18440
mm v,12,v,196,a,228,12
tr 210,242,3208
s_add_u32 s41, s33, 491520
mm v,60,v,192,a,232,60
tr 212,242,6280
mm v,60,v,196,a,236,60
tr 214,242,9352
s_waitcnt lgkmcnt(4)
mm v,108,v,192,a,240,108
buffer_load_dwordx4 v249, s[8:11], s41 offen lds
mm v,108,v,196,a,244,108
buffer_load_dwordx4 v250, s[8:11], s41 offen offset:1024 lds
mm v,16,v,200,a,224,16
tr 192,243,128
s_waitcnt vmcnt(47)
buffer_load_dwordx4 v251, s[8:11], s41 offen offset:2048 lds
mm v,16,v,204,a,228,16
tr 194,243,3200
s_add_u32 m0, s30, 21512
mm v,64,v,200,a,232,64
tr 196,243,6272
s_add_u32 s41, s33, 540672
mm v,64,v,204,a,236,64
tr 198,243,9344
s_waitcnt lgkmcnt(4)
mm v,112,v,200,a,240,112
ds_read_b128 a[192:195], v244
buffer_load_dwordx4 v249, s[8:11], s41 offen lds
mm v,112,v,204,a,244,112
ds_read_b128 a[196:199], v245
buffer_load_dwordx4 v250, s[8:11], s41 offen offset:1024 lds
mm v,20,v,208,a,224,20
tr 200,243,136
buffer_load_dwordx4 v251, s[8:11], s41 offen offset:2048 lds
mm v,20,v,212,a,228,20
tr 202,243,3208
s_add_u32 s33, s33, 786432
mm v,68,v,208,a,232,68
tr 204,243,6280
s_cmp_eq_u32 s33, s94
s_cselect_b32 s55, 7864320, 0
mm v,68,v,212,a,236,68
tr 206,243,9352
s_waitcnt lgkmcnt(6)
mm v,116,v,208,a,240,116
ds_read_b128 a[200:203], v244 offset:2048
s_sub_u32 s33, s33, s55
mm v,116,v,212,a,244,116
ds_read_b128 a[204:207], v245 offset:2048
s_add_u32 m0, s25, 12288
mm v,24,v,192,a,224,24
tr 208,242,256
s_add_u32 s41, s89, 227328
mm v,24,v,196,a,228,24
tr 210,242,3328
buffer_load_dwordx4 v144, s[12:15], s41 offen nt lds
mm v,72,v,192,a,232,72
tr 212,242,6400
buffer_load_dwordx4 v145, s[12:15], s41 offen offset:1024 nt lds
mm v,72,v,196,a,236,72
tr 214,242,9472
s_waitcnt lgkmcnt(6)
mm v,120,v,192,a,240,120
ds_read_b128 a[208:211], v244 offset:4096
buffer_load_dwordx4 v146, s[12:15], s41 offen offset:2048 nt lds
mm v,120,v,196,a,244,120
ds_read_b128 a[212:215], v245 offset:4096
s_add_u32 m0, s25, 15360
mm v,28,v,200,a,224,28
tr 192,242,264
s_add_u32 s41, s89, 261120
mm v,28,v,204,a,228,28
tr 194,242,3336
buffer_load_dwordx4 v144, s[12:15], s41 offen nt lds
mm v,76,v,200,a,232,76
tr 196,242,6408
buffer_load_dwordx4 v145, s[12:15], s41 offen offset:1024 nt lds
mm v,76,v,204,a,236,76
tr 198,242,9480
s_waitcnt lgkmcnt(6)
mm v,124,v,200,a,240,124
buffer_load_dwordx4 v146, s[12:15], s41 offen offset:2048 nt lds
mm v,124,v,204,a,244,124
s_add_u32 m0, s25, 18432
s_add_u32 s41, s89, 294912
buffer_load_dwordx4 v144, s[12:15], s41 offen nt lds
mm v,32,v,208,a,224,32
tr 200,243,256
buffer_load_dwordx4 v145, s[12:15], s41 offen offset:1024 nt lds
mm v,32,v,212,a,228,32
tr 202,243,3328
mm v,80,v,208,a,232,80
tr 204,243,6400
mm v,80,v,212,a,236,80
tr 206,243,9472
s_waitcnt lgkmcnt(4)
mm v,128,v,208,a,240,128
buffer_load_dwordx4 v146, s[12:15], s41 offen offset:2048 nt lds
mm v,128,v,212,a,244,128
s_add_u32 m0, s25, 21504
s_add_u32 s41, s89, 359424
buffer_load_dwordx4 v144, s[12:15], s41 offen nt lds
mm v,36,v,192,a,224,36
tr 208,243,264
buffer_load_dwordx4 v145, s[12:15], s41 offen offset:1024 nt lds
mm v,36,v,196,a,228,36
tr 210,243,3336
mm v,84,v,192,a,232,84
tr 212,243,6408
buffer_load_dwordx4 v146, s[12:15], s41 offen offset:2048 nt lds
mm v,84,v,196,a,236,84
tr 214,243,9480
mm v,132,v,192,a,240,132
s_sub_u32 s42, s29, s48
s_mov_b32 s48, s29
v_add_u32 v242, s42, v242
mm v,132,v,196,a,244,132
s_waitcnt lgkmcnt(6)
v_add_u32 v243, s42, v243
mm v,40,v,200,a,224,40
s_waitcnt vmcnt(47) lgkmcnt(0)
s_barrier
mm v,40,v,204,a,228,40
tr 192,242,0
s_mov_b32 s43, s28
mm v,88,v,200,a,232,88
tr 194,242,3072
s_mov_b32 s28, s29
mm v,88,v,204,a,236,88
tr 196,242,6144
s_mov_b32 s29, s30
mm v,136,v,200,a,240,136
tr 198,242,9216
s_mov_b64 exec, 0
s_branch L_pg73
L_ir72:
s_mov_b64 exec, -1
L_ir72x:
mm v,136,v,204,a,244,136
s_mov_b32 s30, s43
mm v,44,v,208,a,224,44
tr 200,242,8
mm v,44,v,212,a,228,44
tr 202,242,3080
mm v,92,v,208,a,232,92
tr 204,242,6152
mm v,92,v,212,a,236,92
tr 206,242,9224
mm v,140,v,208,a,240,140
mm v,140,v,212,a,244,140
s_waitcnt lgkmcnt(4)
mm v,0,v,192,a,192,0
tr 208,243,0
s_add_u32 m0, s30, 0
mm v,0,v,196,a,196,0
tr 210,243,3072
s_add_u32 s41, s89, 30720
mm v,48,v,192,a,200,48
tr 212,243,6144
mm v,48,v,196,a,204,48
tr 214,243,9216
s_waitcnt lgkmcnt(4)
mm v,96,v,192,a,208,96
buffer_load_dwordx4 v144, s[16:19], s41 offen nt lds
mm v,96,v,196,a,212,96
buffer_load_dwordx4 v145, s[16:19], s41 offen offset:1024 nt lds
mm v,4,v,200,a,192,4
tr 192,243,8
buffer_load_dwordx4 v146, s[16:19], s41 offen offset:2048 nt lds
mm v,4,v,204,a,196,4
tr 194,243,3080
s_add_u32 m0, s30, 3072
mm v,52,v,200,a,200,52
tr 196,243,6152
s_add_u32 s41, s89, 95232
mm v,52,v,204,a,204,52
tr 198,243,9224
s_waitcnt lgkmcnt(4)
mm v,100,v,200,a,208,100
buffer_load_dwordx4 v144, s[16:19], s41 offen nt lds
mm v,100,v,204,a,212,100
buffer_load_dwordx4 v145, s[16:19], s41 offen offset:1024 nt lds
mm v,8,v,208,a,192,8
tr 200,242,128
buffer_load_dwordx4 v146, s[16:19], s41 offen offset:2048 nt lds
mm v,8,v,212,a,196,8
tr 202,242,3200
s_add_u32 m0, s30, 6144
mm v,56,v,208,a,200,56
tr 204,242,6272
s_add_u32 s41, s89, 129024
mm v,56,v,212,a,204,56
tr 206,242,9344
s_waitcnt lgkmcnt(6)
mm v,104,v,208,a,208,104
buffer_load_dwordx4 v144, s[16:19], s41 offen nt lds
mm v,104,v,212,a,212,104
buffer_load_dwordx4 v145, s[16:19], s41 offen offset:1024 nt lds
mm v,12,v,192,a,192,12
tr 208,242,136
s_waitcnt lgkmcnt(5)
mm v,12,v,196,a,196,12
tr 210,242,3208
mm v,60,v,192,a,200,60
tr 212,242,6280
mm v,60,v,196,a,204,60
tr 214,242,9352
s_waitcnt lgkmcnt(4)
mm v,108,v,192,a,208,108
buffer_load_dwordx4 v146, s[16:19], s41 offen offset:2048 nt lds
mm v,108,v,196,a,212,108
s_add_u32 m0, s30, 9216
s_add_u32 s41, s89, 162816
buffer_load_dwordx4 v144, s[16:19], s41 offen nt lds
mm v,16,v,200,a,192,16
tr 192,243,128
s_waitcnt vmcnt(37)
mm v,16,v,204,a,196,16
tr 194,243,3200
buffer_load_dwordx4 v145, s[16:19], s41 offen offset:1024 nt lds
mm v,64,v,200,a,200,64
tr 196,243,6272
mm v,64,v,204,a,204,64
tr 198,243,9344
s_waitcnt lgkmcnt(4)
mm v,112,v,200,a,208,112
ds_read_b128 a[224:227], v244 offset:6144
buffer_load_dwordx4 v146, s[16:19], s41 offen offset:2048 nt lds
mm v,112,v,204,a,212,112
ds_read_b128 a[228:231], v245 offset:6144
s_add_u32 m0, s30, 12288
mm v,20,v,208,a,192,20
tr 200,243,136
s_add_u32 s41, s89, 227328
mm v,20,v,212,a,196,20
tr 202,243,3208
buffer_load_dwordx4 v144, s[16:19], s41 offen nt lds
mm v,68,v,208,a,200,68
tr 204,243,6280
buffer_load_dwordx4 v145, s[16:19], s41 offen offset:1024 nt lds
mm v,68,v,212,a,204,68
tr 206,243,9352
s_waitcnt lgkmcnt(6)
mm v,116,v,208,a,208,116
ds_read_b128 a[232:235], v244 offset:8192
buffer_load_dwordx4 v146, s[16:19], s41 offen offset:2048 nt lds
mm v,116,v,212,a,212,116
ds_read_b128 a[236:239], v245 offset:8192
s_add_u32 m0, s30, 15360
mm v,24,v,192,a,192,24
tr 208,242,256
s_add_u32 s41, s89, 261120
mm v,24,v,196,a,196,24
tr 210,242,3328
buffer_load_dwordx4 v144, s[16:19], s41 offen nt lds
mm v,72,v,192,a,200,72
tr 212,242,6400
mm v,72,v,196,a,204,72
tr 214,242,9472
s_waitcnt lgkmcnt(6)
mm v,120,v,192,a,208,120
ds_read_b128 a[240:243], v244 offset:10240
buffer_load_dwordx4 v145, s[16:19], s41 offen offset:1024 nt lds
mm v,120,v,196,a,212,120
ds_read_b128 a[244:247], v245 offset:10240
buffer_load_dwordx4 v146, s[16:19], s41 offen offset:2048 nt lds
mm v,28,v,200,a,192,28
tr 192,242,264
s_add_u32 m0, s30, 18432
mm v,28,v,204,a,196,28
tr 194,242,3336
s_add_u32 s41, s89, 294912
mm v,76,v,200,a,200,76
tr 196,242,6408
v_accvgpr_read_b32 v236, a0
mm v,76,v,204,a,204,76
tr 198,242,9480
s_waitcnt lgkmcnt(6)
mm v,124,v,200,a,208,124
buffer_load_dwordx4 v144, s[16:19], s41 offen nt lds
mm v,124,v,204,a,212,124
buffer_load_dwordx4 v145, s[16:19], s41 offen offset:1024 nt lds
mm v,32,v,208,a,192,32
tr 200,243,256
v_accvgpr_read_b32 v237, a1
mm v,32,v,212,a,196,32
tr 202,243,3328
buffer_load_dwordx4 v146, s[16:19], s41 offen offset:2048 nt lds
mm v,80,v,208,a,200,80
tr 204,243,6400
s_add_u32 m0, s30, 21504
mm v,80,v,212,a,204,80
tr 206,243,9472
s_waitcnt lgkmcnt(4)
mm v,128,v,208,a,208,128
s_add_u32 s41, s89, 359424
v_accvgpr_read_b32 v238, a2
v_accvgpr_read_b32 v239, a3
mm v,128,v,212,a,212,128
buffer_load_dwordx4 v144, s[16:19], s41 offen nt lds
mm v,36,v,192,a,192,36
tr 208,243,264
buffer_load_dwordx4 v145, s[16:19], s41 offen offset:1024 nt lds
mm v,36,v,196,a,196,36
tr 210,243,3336
mm v,84,v,192,a,200,84
tr 212,243,6408
buffer_load_dwordx4 v146, s[16:19], s41 offen offset:2048 nt lds
mm v,84,v,196,a,204,84
tr 214,243,9480
mm v,132,v,192,a,208,132
s_sub_u32 s42, s29, s48
s_mov_b32 s48, s29
v_add_u32 v242, s42, v242
mm v,132,v,196,a,212,132
s_waitcnt lgkmcnt(6)
v_add_u32 v243, s42, v243
mm v,40,v,200,a,192,40
s_waitcnt vmcnt(36) lgkmcnt(0)
s_barrier
mm v,40,v,204,a,196,40
tr 192,242,0
s_mov_b32 s43, s28
mm v,88,v,200,a,200,88
tr 194,242,3072
s_mov_b32 s28, s29
mm v,88,v,204,a,204,88
tr 196,242,6144
s_mov_b32 s29, s30
mm v,136,v,200,a,208,136
tr 198,242,9216
s_mov_b64 exec, 0
s_branch L_pg75
L_ir74:
s_mov_b64 exec, -1
L_ir74x:
mm v,136,v,204,a,212,136
s_mov_b32 s30, s43
mm v,44,v,208,a,192,44
tr 200,242,8
mm v,44,v,212,a,196,44
tr 202,242,3080
mm v,92,v,208,a,200,92
tr 204,242,6152
mm v,92,v,212,a,204,92
tr 206,242,9224
mm v,140,v,208,a,208,140
mm v,140,v,212,a,212,140
s_waitcnt lgkmcnt(4)
mm v,0,v,192,a,224,0
tr 208,243,0
s_add_u32 m0, s26, 12288
mm v,0,v,196,a,228,0
tr 210,243,3072
mm v,48,v,192,a,232,48
tr 212,243,6144
mm v,48,v,196,a,236,48
tr 214,243,9216
s_waitcnt lgkmcnt(4)
mm v,96,v,192,a,240,96
buffer_load_dwordx4 v160, s[12:15], s31 offen nt lds
s_add_u32 m0, s26, 0
mm v,96,v,196,a,244,96
buffer_load_dwordx4 v144, s[12:15], s31 offen nt lds
s_add_u32 m0, s26, 12288
mm v,4,v,200,a,224,4
tr 192,243,8
buffer_load_dwordx4 v161, s[12:15], s31 offen offset:1024 nt lds
s_add_u32 m0, s26, 18432
mm v,4,v,204,a,228,4
tr 194,243,3080
buffer_load_dwordx4 v168, s[12:15], s31 offen nt lds
mm v,52,v,200,a,232,52
tr 196,243,6152
s_add_u32 m0, s26, 0
mm v,52,v,204,a,236,52
tr 198,243,9224
s_waitcnt lgkmcnt(4)
mm v,100,v,200,a,240,100
buffer_load_dwordx4 v145, s[12:15], s31 offen offset:1024 nt lds
s_add_u32 m0, s26, 6144
mm v,100,v,204,a,244,100
buffer_load_dwordx4 v152, s[12:15], s31 offen nt lds
s_add_u32 m0, s26, 12288
mm v,8,v,208,a,224,8
tr 200,242,128
buffer_load_dwordx4 v162, s[12:15], s31 offen offset:2048 nt lds
s_add_u32 m0, s26, 18432
mm v,8,v,212,a,228,8
tr 202,242,3200
buffer_load_dwordx4 v169, s[12:15], s31 offen offset:1024 nt lds
mm v,56,v,208,a,232,56
tr 204,242,6272
s_add_u32 m0, s26, 0
mm v,56,v,212,a,236,56
tr 206,242,9344
s_waitcnt lgkmcnt(4)
mm v,104,v,208,a,240,104
buffer_load_dwordx4 v146, s[12:15], s31 offen offset:2048 nt lds
s_add_u32 m0, s26, 6144
mm v,104,v,212,a,244,104
buffer_load_dwordx4 v153, s[12:15], s31 offen offset:1024 nt lds
s_add_u32 s41, s31, 3072
s_add_u32 m0, s26, 15360
mm v,12,v,192,a,224,12
tr 208,242,136
buffer_load_dwordx4 v160, s[12:15], s41 offen nt lds
s_add_u32 m0, s26, 18432
mm v,12,v,196,a,228,12
tr 210,242,3208
buffer_load_dwordx4 v170, s[12:15], s31 offen offset:2048 nt lds
mm v,60,v,192,a,232,60
tr 212,242,6280
s_add_u32 m0, s26, 3072
mm v,60,v,196,a,236,60
tr 214,242,9352
s_waitcnt lgkmcnt(4)
mm v,108,v,192,a,240,108
buffer_load_dwordx4 v144, s[12:15], s41 offen nt lds
s_add_u32 m0, s26, 6144
mm v,108,v,196,a,244,108
buffer_load_dwordx4 v154, s[12:15], s31 offen offset:2048 nt lds
s_add_u32 m0, s26, 15360
mm v,16,v,200,a,224,16
tr 192,243,128
buffer_load_dwordx4 v161, s[12:15], s41 offen offset:1024 nt lds
s_add_u32 m0, s26, 21504
mm v,16,v,204,a,228,16
tr 194,243,3200
buffer_load_dwordx4 v168, s[12:15], s41 offen nt lds
mm v,64,v,200,a,232,64
tr 196,243,6272
s_add_u32 m0, s26, 3072
mm v,64,v,204,a,236,64
tr 198,243,9344
s_waitcnt lgkmcnt(4)
mm v,112,v,200,a,240,112
buffer_load_dwordx4 v145, s[12:15], s41 offen offset:1024 nt lds
s_add_u32 m0, s26, 9216
mm v,112,v,204,a,244,112
buffer_load_dwordx4 v152, s[12:15], s41 offen nt lds
s_add_u32 m0, s26, 15360
mm v,20,v,208,a,224,20
tr 200,243,136
buffer_load_dwordx4 v162, s[12:15], s41 offen offset:2048 nt lds
s_add_u32 m0, s26, 21504
s_mov_b64 exec, 0
s_branch L_pg77
L_ir76:
s_mov_b64 exec, -1
L_ir76x:
mm v,20,v,212,a,228,20
tr 202,243,3208
buffer_load_dwordx4 v169, s[12:15], s41 offen offset:1024 nt lds
mm v,68,v,208,a,232,68
tr 204,243,6280
s_add_u32 m0, s26, 3072
mm v,68,v,212,a,236,68
tr 206,243,9352
mm v,116,v,208,a,240,116
mm v,116,v,212,a,244,116
s_waitcnt lgkmcnt(6)
mm v,24,v,192,a,224,24
tr 208,242,256
s_waitcnt lgkmcnt(5)
mm v,24,v,196,a,228,24
tr 210,242,3328
mm v,72,v,192,a,232,72
tr 212,242,6400
mm v,72,v,196,a,236,72
tr 214,242,9472
s_waitcnt lgkmcnt(4)
mm v,120,v,192,a,240,120
buffer_load_dwordx4 v146, s[12:15], s41 offen offset:2048 nt lds
s_add_u32 m0, s26, 9216
mm v,120,v,196,a,244,120
buffer_load_dwordx4 v153, s[12:15], s41 offen offset:1024 nt lds
s_add_u32 m0, s26, 21504
mm v,28,v,200,a,224,28
tr 192,242,264
buffer_load_dwordx4 v170, s[12:15], s41 offen offset:2048 nt lds
mm v,28,v,204,a,228,28
tr 194,242,3336
s_add_u32 m0, s26, 9216
mm v,76,v,200,a,232,76
tr 196,242,6408
mm v,76,v,204,a,236,76
tr 198,242,9480
s_waitcnt lgkmcnt(4)
mm v,124,v,200,a,240,124
buffer_load_dwordx4 v154, s[12:15], s41 offen offset:2048 nt lds
s_add_u32 s92, s92, 1
s_cmp_eq_u32 s92, 15
s_cselect_b32 s92, 0, s92
s_mul_i32 s55, s92, 13
s_lshr_b32 s55, s55, 6
s_mul_i32 s55, s55, 101376
s_mul_i32 s31, s92, 6144
s_add_u32 s31, s31, s55
s_add_u32 s31, s31, s89
s_add_u32 m0, s30, 12288
mm v,124,v,204,a,244,124
buffer_load_dwordx4 v160, s[16:19], s32 offen nt lds
mm v,32,v,208,a,224,32
tr 200,243,256
s_add_u32 m0, s30, 0
mm v,32,v,212,a,228,32
tr 202,243,3328
mm v,80,v,208,a,232,80
tr 204,243,6400
mm v,80,v,212,a,236,80
tr 206,243,9472
s_waitcnt lgkmcnt(4)
mm v,128,v,208,a,240,128
buffer_load_dwordx4 v144, s[16:19], s32 offen nt lds
s_add_u32 m0, s30, 12288
mm v,128,v,212,a,244,128
buffer_load_dwordx4 v161, s[16:19], s32 offen offset:1024 nt lds
s_add_u32 m0, s30, 18432
mm v,36,v,192,a,224,36
tr 208,243,264
buffer_load_dwordx4 v168, s[16:19], s32 offen nt lds
s_add_u32 m0, s30, 0
mm v,36,v,196,a,228,36
tr 210,243,3336
buffer_load_dwordx4 v145, s[16:19], s32 offen offset:1024 nt lds
s_add_u32 m0, s30, 6144
mm v,84,v,192,a,232,84
tr 212,243,6408
buffer_load_dwordx4 v152, s[16:19], s32 offen nt lds
mm v,84,v,196,a,236,84
tr 214,243,9480
mm v,132,v,192,a,240,132
s_sub_u32 s42, s29, s49
s_mov_b32 s49, s29
v_add_u32 v238, s42, v238
mm v,132,v,196,a,244,132
s_waitcnt lgkmcnt(6)
v_add_u32 v239, s42, v239
v_add_u32 v240, s42, v240
v_add_u32 v241, s42, v241
mm v,40,v,200,a,224,40
s_waitcnt vmcnt(54) lgkmcnt(0)
s_barrier
v_mov_b32 v254, s40
s_mov_b64 exec, 1
buffer_atomic_add v254, off, s[72:75], s86 sc1
s_mov_b64 exec, -1
mm v,40,v,204,a,228,40
ds_read_b128 a[192:195], v236
s_mov_b32 s43, s28
mm v,88,v,200,a,232,88
ds_read_b128 a[196:199], v237
s_mov_b32 s28, s29
mm v,88,v,204,a,236,88
ds_read_b128 a[200:203], v236 offset:128
s_mov_b32 s29, s30
mm v,136,v,200,a,240,136
ds_read_b128 a[204:207], v237 offset:128
s_mov_b32 s30, s43
mm v,136,v,204,a,244,136
ds_read_b128 a[208:211], v236 offset:256
s_add_u32 s46, s46, 1474560
mm v,44,v,208,a,224,44
ds_read_b128 a[212:215], v237 offset:256
mm v,44,v,212,a,228,44
mm v,92,v,208,a,232,92
mm v,92,v,212,a,236,92
mm v,140,v,208,a,240,140
mm v,140,v,212,a,244,140
s_mov_b32 s36, 1
s_branch L_head_3
L_slow_3:
s_waitcnt vmcnt(0) lgkmcnt(0)
s_barrier
s_mov_b32 s87, -1
s_cmp_eq_u32 s36, 0
s_cselect_b32 s41, 6291456, 0
s_cselect_b32 s42, 6144, 0
s_cselect_b32 s43, 0, 6291456
s_mov_b32 s28, 74496
s_mov_b32 s29, 99328
s_mov_b32 s30, 124160
s_cselect_b32 s28, 99328, s28
s_cselect_b32 s29, 124160, s29
s_cselect_b32 s30, 74496, s30
s_sub_u32 s94, s94, s42
s_sub_u32 s89, s89, s41
s_sub_u32 s31, s31, s41
s_sub_u32 s32, s32, s41
s_mov_b32 s100, s89
s_mov_b32 s33, s90
s_mov_b32 s34, s91
s_sub_u32 s42, s28, s49
s_mov_b32 s49, s28
v_add_u32 v238, s42, v238
v_add_u32 v239, s42, v239
v_add_u32 v240, s42, v240
v_add_u32 v241, s42, v241
v_mov_b32 v164, 0xff800000
v_mov_b32 v172, 0xff800000
v_mov_b32 v180, 0xff800000
s_mov_b32 s35, 16
L_slowl_3:
s_add_u32 m0, s25, 0
s_nop 0
buffer_load_dwordx4 v144, s[12:15], s100 offen nt lds
buffer_load_dwordx4 v145, s[12:15], s100 offen offset:1024 nt lds
buffer_load_dwordx4 v146, s[12:15], s100 offen offset:2048 nt lds
s_add_u32 s100, s100, 3072
s_add_u32 m0, s25, 3072
s_nop 0
buffer_load_dwordx4 v144, s[12:15], s100 offen nt lds
buffer_load_dwordx4 v145, s[12:15], s100 offen offset:1024 nt lds
buffer_load_dwordx4 v146, s[12:15], s100 offen offset:2048 nt lds
s_add_u32 s100, s100, 3072
s_add_u32 m0, s25, 6144
s_nop 0
buffer_load_dwordx4 v144, s[12:15], s100 offen nt lds
buffer_load_dwordx4 v145, s[12:15], s100 offen offset:1024 nt lds
buffer_load_dwordx4 v146, s[12:15], s100 offen offset:2048 nt lds
s_add_u32 s100, s100, 3072
s_add_u32 m0, s25, 9216
s_nop 0
buffer_load_dwordx4 v144, s[12:15], s100 offen nt lds
buffer_load_dwordx4 v145, s[12:15], s100 offen offset:1024 nt lds
buffer_load_dwordx4 v146, s[12:15], s100 offen offset:2048 nt lds
s_add_u32 s100, s100, 3072
s_add_u32 m0, s25, 12288
s_nop 0
buffer_load_dwordx4 v144, s[12:15], s100 offen nt lds
buffer_load_dwordx4 v145, s[12:15], s100 offen offset:1024 nt lds
buffer_load_dwordx4 v146, s[12:15], s100 offen offset:2048 nt lds
s_add_u32 s100, s100, 3072
s_add_u32 m0, s25, 15360
s_nop 0
buffer_load_dwordx4 v144, s[12:15], s100 offen nt lds
buffer_load_dwordx4 v145, s[12:15], s100 offen offset:1024 nt lds
buffer_load_dwordx4 v146, s[12:15], s100 offen offset:2048 nt lds
s_add_u32 s100, s100, 3072
s_add_u32 m0, s25, 18432
s_nop 0
buffer_load_dwordx4 v144, s[12:15], s100 offen nt lds
buffer_load_dwordx4 v145, s[12:15], s100 offen offset:1024 nt lds
buffer_load_dwordx4 v146, s[12:15], s100 offen offset:2048 nt lds
s_add_u32 s100, s100, 3072
s_add_u32 m0, s25, 21504
s_nop 0
buffer_load_dwordx4 v144, s[12:15], s100 offen nt lds
buffer_load_dwordx4 v145, s[12:15], s100 offen offset:1024 nt lds
buffer_load_dwordx4 v146, s[12:15], s100 offen offset:2048 nt lds
s_add_u32 s100, s100, 3072
s_waitcnt vmcnt(0)
s_barrier
ds_read_b128 a[192:195], v236
ds_read_b128 a[196:199], v237
ds_read_b128 a[200:203], v236 offset:128
ds_read_b128 a[204:207], v237 offset:128
ds_read_b128 a[208:211], v236 offset:256
ds_read_b128 a[212:215], v237 offset:256
s_waitcnt lgkmcnt(0)
mz v,132,a,192,v,0
mm v,132,a,196,v,8,132
mm v,132,a,200,v,16,132
mm v,132,a,204,v,24,132
mm v,132,a,208,v,32,132
mm v,132,a,212,v,40,132
mz v,140,a,192,v,48
mm v,140,a,196,v,56,140
mm v,140,a,200,v,64,140
mm v,140,a,204,v,72,140
mm v,140,a,208,v,80,140
mm v,140,a,212,v,88,140
mz v,148,a,192,v,96
mm v,148,a,196,v,104,148
mm v,148,a,200,v,112,148
mm v,148,a,204,v,120,148
mm v,148,a,208,v,128,148
mm v,148,a,212,v,136,148
s_nop 7
v_max3_f32 v164, v164, v132, v133
v_max3_f32 v164, v164, v134, v135
v_max3_f32 v172, v172, v140, v141
v_max3_f32 v172, v172, v142, v143
v_max3_f32 v180, v180, v148, v149
v_max3_f32 v180, v180, v150, v151
ds_read_b128 a[216:219], v236 offset:6144
ds_read_b128 a[220:223], v237 offset:6144
ds_read_b128 a[224:227], v236 offset:6272
ds_read_b128 a[228:231], v237 offset:6272
ds_read_b128 a[232:235], v236 offset:6400
ds_read_b128 a[236:239], v237 offset:6400
s_waitcnt lgkmcnt(0)
mz v,132,a,216,v,0
mm v,132,a,220,v,8,132
mm v,132,a,224,v,16,132
mm v,132,a,228,v,24,132
mm v,132,a,232,v,32,132
mm v,132,a,236,v,40,132
mz v,140,a,216,v,48
mm v,140,a,220,v,56,140
mm v,140,a,224,v,64,140
mm v,140,a,228,v,72,140
mm v,140,a,232,v,80,140
mm v,140,a,236,v,88,140
mz v,148,a,216,v,96
mm v,148,a,220,v,104,148
mm v,148,a,224,v,112,148
mm v,148,a,228,v,120,148
mm v,148,a,232,v,128,148
mm v,148,a,236,v,136,148
s_nop 7
v_max3_f32 v164, v164, v132, v133
v_max3_f32 v164, v164, v134, v135
v_max3_f32 v172, v172, v140, v141
v_max3_f32 v172, v172, v142, v143
v_max3_f32 v180, v180, v148, v149
v_max3_f32 v180, v180, v150, v151
ds_read_b128 a[192:195], v236 offset:12288
ds_read_b128 a[196:199], v237 offset:12288
ds_read_b128 a[200:203], v236 offset:12416
ds_read_b128 a[204:207], v237 offset:12416
ds_read_b128 a[208:211], v236 offset:12544
ds_read_b128 a[212:215], v237 offset:12544
s_waitcnt lgkmcnt(0)
mz v,132,a,192,v,0
mm v,132,a,196,v,8,132
mm v,132,a,200,v,16,132
mm v,132,a,204,v,24,132
mm v,132,a,208,v,32,132
mm v,132,a,212,v,40,132
mz v,140,a,192,v,48
mm v,140,a,196,v,56,140
mm v,140,a,200,v,64,140
mm v,140,a,204,v,72,140
mm v,140,a,208,v,80,140
mm v,140,a,212,v,88,140
mz v,148,a,192,v,96
mm v,148,a,196,v,104,148
mm v,148,a,200,v,112,148
mm v,148,a,204,v,120,148
mm v,148,a,208,v,128,148
mm v,148,a,212,v,136,148
s_nop 7
v_max3_f32 v164, v164, v132, v133
v_max3_f32 v164, v164, v134, v135
v_max3_f32 v172, v172, v140, v141
v_max3_f32 v172, v172, v142, v143
v_max3_f32 v180, v180, v148, v149
v_max3_f32 v180, v180, v150, v151
ds_read_b128 a[216:219], v236 offset:18432
ds_read_b128 a[220:223], v237 offset:18432
ds_read_b128 a[224:227], v236 offset:18560
ds_read_b128 a[228:231], v237 offset:18560
ds_read_b128 a[232:235], v236 offset:18688
ds_read_b128 a[236:239], v237 offset:18688
s_waitcnt lgkmcnt(0)
mz v,132,a,216,v,0
mm v,132,a,220,v,8,132
mm v,132,a,224,v,16,132
mm v,132,a,228,v,24,132
mm v,132,a,232,v,32,132
mm v,132,a,236,v,40,132
mz v,140,a,216,v,48
mm v,140,a,220,v,56,140
mm v,140,a,224,v,64,140
mm v,140,a,228,v,72,140
mm v,140,a,232,v,80,140
mm v,140,a,236,v,88,140
mz v,148,a,216,v,96
mm v,148,a,220,v,104,148
mm v,148,a,224,v,112,148
mm v,148,a,228,v,120,148
mm v,148,a,232,v,128,148
mm v,148,a,236,v,136,148
s_nop 7
v_max3_f32 v164, v164, v132, v133
v_max3_f32 v164, v164, v134, v135
v_max3_f32 v172, v172, v140, v141
v_max3_f32 v172, v172, v142, v143
v_max3_f32 v180, v180, v148, v149
v_max3_f32 v180, v180, v150, v151
s_barrier
s_sub_u32 s35, s35, 1
s_cmp_lg_u32 s35, 0
s_cbranch_scc1 L_slowl_3
s_add_u32 m0, s25, 0
s_nop 0
s_add_u32 s41, s89, 30720
buffer_load_dwordx4 v144, s[12:15], s41 offen nt lds
buffer_load_dwordx4 v145, s[12:15], s41 offen offset:1024 nt lds
buffer_load_dwordx4 v146, s[12:15], s41 offen offset:2048 nt lds
s_add_u32 m0, s25, 3072
s_nop 0
s_add_u32 s41, s89, 95232
buffer_load_dwordx4 v144, s[12:15], s41 offen nt lds
buffer_load_dwordx4 v145, s[12:15], s41 offen offset:1024 nt lds
buffer_load_dwordx4 v146, s[12:15], s41 offen offset:2048 nt lds
s_add_u32 m0, s25, 6144
s_nop 0
s_add_u32 s41, s89, 129024
buffer_load_dwordx4 v144, s[12:15], s41 offen nt lds
buffer_load_dwordx4 v145, s[12:15], s41 offen offset:1024 nt lds
buffer_load_dwordx4 v146, s[12:15], s41 offen offset:2048 nt lds
s_add_u32 m0, s25, 9216
s_nop 0
s_add_u32 s41, s89, 162816
buffer_load_dwordx4 v144, s[12:15], s41 offen nt lds
buffer_load_dwordx4 v145, s[12:15], s41 offen offset:1024 nt lds
buffer_load_dwordx4 v146, s[12:15], s41 offen offset:2048 nt lds
s_add_u32 m0, s25, 12288
s_nop 0
s_add_u32 s41, s89, 227328
buffer_load_dwordx4 v144, s[12:15], s41 offen nt lds
buffer_load_dwordx4 v145, s[12:15], s41 offen offset:1024 nt lds
buffer_load_dwordx4 v146, s[12:15], s41 offen offset:2048 nt lds
s_add_u32 m0, s25, 15360
s_nop 0
s_add_u32 s41, s89, 261120
buffer_load_dwordx4 v144, s[12:15], s41 offen nt lds
buffer_load_dwordx4 v145, s[12:15], s41 offen offset:1024 nt lds
buffer_load_dwordx4 v146, s[12:15], s41 offen offset:2048 nt lds
s_add_u32 m0, s25, 18432
s_nop 0
s_add_u32 s41, s89, 294912
buffer_load_dwordx4 v144, s[12:15], s41 offen nt lds
buffer_load_dwordx4 v145, s[12:15], s41 offen offset:1024 nt lds
buffer_load_dwordx4 v146, s[12:15], s41 offen offset:2048 nt lds
s_add_u32 m0, s25, 21504
s_nop 0
s_add_u32 s41, s89, 359424
buffer_load_dwordx4 v144, s[12:15], s41 offen nt lds
buffer_load_dwordx4 v145, s[12:15], s41 offen offset:1024 nt lds
buffer_load_dwordx4 v146, s[12:15], s41 offen offset:2048 nt lds
s_add_u32 m0, s26, 12288
s_nop 0
buffer_load_dwordx4 v160, s[12:15], s31 offen nt lds
s_add_u32 m0, s26, 0
s_nop 0
buffer_load_dwordx4 v144, s[12:15], s31 offen nt lds
s_add_u32 m0, s26, 12288
s_nop 0
buffer_load_dwordx4 v161, s[12:15], s31 offen offset:1024 nt lds
s_add_u32 m0, s26, 18432
s_nop 0
buffer_load_dwordx4 v168, s[12:15], s31 offen nt lds
s_add_u32 m0, s26, 0
s_nop 0
buffer_load_dwordx4 v145, s[12:15], s31 offen offset:1024 nt lds
s_add_u32 m0, s26, 6144
s_nop 0
buffer_load_dwordx4 v152, s[12:15], s31 offen nt lds
s_add_u32 m0, s26, 12288
s_nop 0
buffer_load_dwordx4 v162, s[12:15], s31 offen offset:2048 nt lds
s_add_u32 m0, s26, 18432
s_nop 0
buffer_load_dwordx4 v169, s[12:15], s31 offen offset:1024 nt lds
s_add_u32 m0, s26, 0
s_nop 0
buffer_load_dwordx4 v146, s[12:15], s31 offen offset:2048 nt lds
s_add_u32 m0, s26, 6144
s_nop 0
buffer_load_dwordx4 v153, s[12:15], s31 offen offset:1024 nt lds
s_add_u32 s41, s31, 3072
s_add_u32 m0, s26, 15360
s_nop 0
buffer_load_dwordx4 v160, s[12:15], s41 offen nt lds
s_add_u32 m0, s26, 18432
s_nop 0
buffer_load_dwordx4 v170, s[12:15], s31 offen offset:2048 nt lds
s_add_u32 m0, s26, 3072
s_nop 0
buffer_load_dwordx4 v144, s[12:15], s41 offen nt lds
s_add_u32 m0, s26, 6144
s_nop 0
buffer_load_dwordx4 v154, s[12:15], s31 offen offset:2048 nt lds
s_add_u32 m0, s26, 15360
s_nop 0
buffer_load_dwordx4 v161, s[12:15], s41 offen offset:1024 nt lds
s_add_u32 m0, s26, 21504
s_nop 0
buffer_load_dwordx4 v168, s[12:15], s41 offen nt lds
s_add_u32 m0, s26, 3072
s_nop 0
buffer_load_dwordx4 v145, s[12:15], s41 offen offset:1024 nt lds
s_add_u32 m0, s26, 9216
s_nop 0
buffer_load_dwordx4 v152, s[12:15], s41 offen nt lds
s_add_u32 m0, s26, 15360
s_nop 0
buffer_load_dwordx4 v162, s[12:15], s41 offen offset:2048 nt lds
s_add_u32 m0, s26, 21504
s_nop 0
buffer_load_dwordx4 v169, s[12:15], s41 offen offset:1024 nt lds
s_add_u32 m0, s26, 3072
s_nop 0
buffer_load_dwordx4 v146, s[12:15], s41 offen offset:2048 nt lds
s_add_u32 m0, s26, 9216
s_nop 0
buffer_load_dwordx4 v153, s[12:15], s41 offen offset:1024 nt lds
s_add_u32 m0, s26, 21504
s_nop 0
buffer_load_dwordx4 v170, s[12:15], s41 offen offset:2048 nt lds
s_add_u32 m0, s26, 9216
s_nop 0
buffer_load_dwordx4 v154, s[12:15], s41 offen offset:2048 nt lds
s_add_u32 s92, s92, 1
s_cmp_eq_u32 s92, 15
s_cselect_b32 s92, 0, s92
s_mul_i32 s55, s92, 13
s_lshr_b32 s55, s55, 6
s_mul_i32 s55, s55, 101376
s_mul_i32 s31, s92, 6144
s_add_u32 s31, s31, s55
s_add_u32 s31, s31, s89
s_waitcnt vmcnt(0)
s_add_u32 m0, s28, 0
s_nop 0
s_add_u32 s41, s89, 30720
buffer_load_dwordx4 v144, s[16:19], s41 offen nt lds
buffer_load_dwordx4 v145, s[16:19], s41 offen offset:1024 nt lds
buffer_load_dwordx4 v146, s[16:19], s41 offen offset:2048 nt lds
s_add_u32 m0, s28, 3072
s_nop 0
s_add_u32 s41, s89, 95232
buffer_load_dwordx4 v144, s[16:19], s41 offen nt lds
buffer_load_dwordx4 v145, s[16:19], s41 offen offset:1024 nt lds
buffer_load_dwordx4 v146, s[16:19], s41 offen offset:2048 nt lds
s_add_u32 m0, s28, 6144
s_nop 0
s_add_u32 s41, s89, 129024
buffer_load_dwordx4 v144, s[16:19], s41 offen nt lds
buffer_load_dwordx4 v145, s[16:19], s41 offen offset:1024 nt lds
buffer_load_dwordx4 v146, s[16:19], s41 offen offset:2048 nt lds
s_add_u32 m0, s28, 9216
s_nop 0
s_add_u32 s41, s89, 162816
buffer_load_dwordx4 v144, s[16:19], s41 offen nt lds
buffer_load_dwordx4 v145, s[16:19], s41 offen offset:1024 nt lds
buffer_load_dwordx4 v146, s[16:19], s41 offen offset:2048 nt lds
s_add_u32 m0, s28, 12288
s_nop 0
s_add_u32 s41, s89, 227328
buffer_load_dwordx4 v144, s[16:19], s41 offen nt lds
buffer_load_dwordx4 v145, s[16:19], s41 offen offset:1024 nt lds
buffer_load_dwordx4 v146, s[16:19], s41 offen offset:2048 nt lds
s_add_u32 m0, s28, 15360
s_nop 0
s_add_u32 s41, s89, 261120
buffer_load_dwordx4 v144, s[16:19], s41 offen nt lds
buffer_load_dwordx4 v145, s[16:19], s41 offen offset:1024 nt lds
buffer_load_dwordx4 v146, s[16:19], s41 offen offset:2048 nt lds
s_add_u32 m0, s28, 18432
s_nop 0
s_add_u32 s41, s89, 294912
buffer_load_dwordx4 v144, s[16:19], s41 offen nt lds
buffer_load_dwordx4 v145, s[16:19], s41 offen offset:1024 nt lds
buffer_load_dwordx4 v146, s[16:19], s41 offen offset:2048 nt lds
s_add_u32 m0, s28, 21504
s_nop 0
s_add_u32 s41, s89, 359424
buffer_load_dwordx4 v144, s[16:19], s41 offen nt lds
buffer_load_dwordx4 v145, s[16:19], s41 offen offset:1024 nt lds
buffer_load_dwordx4 v146, s[16:19], s41 offen offset:2048 nt lds
s_add_u32 m0, s29, 12288
s_nop 0
buffer_load_dwordx4 v160, s[16:19], s32 offen nt lds
s_add_u32 m0, s29, 0
s_nop 0
buffer_load_dwordx4 v144, s[16:19], s32 offen nt lds
s_add_u32 m0, s29, 12288
s_nop 0
buffer_load_dwordx4 v161, s[16:19], s32 offen offset:1024 nt lds
s_add_u32 m0, s29, 18432
s_nop 0
buffer_load_dwordx4 v168, s[16:19], s32 offen nt lds
s_add_u32 m0, s29, 0
s_nop 0
buffer_load_dwordx4 v145, s[16:19], s32 offen offset:1024 nt lds
s_add_u32 m0, s29, 6144
s_nop 0
buffer_load_dwordx4 v152, s[16:19], s32 offen nt lds
s_add_u32 m0, s29, 12288
s_nop 0
buffer_load_dwordx4 v162, s[16:19], s32 offen offset:2048 nt lds
s_add_u32 m0, s29, 18432
s_nop 0
buffer_load_dwordx4 v169, s[16:19], s32 offen offset:1024 nt lds
s_add_u32 m0, s29, 0
s_nop 0
buffer_load_dwordx4 v146, s[16:19], s32 offen offset:2048 nt lds
s_add_u32 m0, s29, 6144
s_nop 0
buffer_load_dwordx4 v153, s[16:19], s32 offen offset:1024 nt lds
s_add_u32 s41, s32, 3072
s_add_u32 m0, s29, 15360
s_nop 0
buffer_load_dwordx4 v160, s[16:19], s41 offen nt lds
s_add_u32 m0, s29, 18432
s_nop 0
buffer_load_dwordx4 v170, s[16:19], s32 offen offset:2048 nt lds
s_add_u32 m0, s29, 3072
s_nop 0
buffer_load_dwordx4 v144, s[16:19], s41 offen nt lds
s_add_u32 m0, s29, 6144
s_nop 0
buffer_load_dwordx4 v154, s[16:19], s32 offen offset:2048 nt lds
s_add_u32 m0, s29, 15360
s_nop 0
buffer_load_dwordx4 v161, s[16:19], s41 offen offset:1024 nt lds
s_add_u32 m0, s29, 21504
s_nop 0
buffer_load_dwordx4 v168, s[16:19], s41 offen nt lds
s_add_u32 m0, s29, 3072
s_nop 0
buffer_load_dwordx4 v145, s[16:19], s41 offen offset:1024 nt lds
s_add_u32 m0, s29, 9216
s_nop 0
buffer_load_dwordx4 v152, s[16:19], s41 offen nt lds
s_add_u32 m0, s29, 15360
s_nop 0
buffer_load_dwordx4 v162, s[16:19], s41 offen offset:2048 nt lds
s_add_u32 m0, s29, 21504
s_nop 0
buffer_load_dwordx4 v169, s[16:19], s41 offen offset:1024 nt lds
s_add_u32 m0, s29, 3072
s_nop 0
buffer_load_dwordx4 v146, s[16:19], s41 offen offset:2048 nt lds
s_add_u32 m0, s29, 9216
s_nop 0
buffer_load_dwordx4 v153, s[16:19], s41 offen offset:1024 nt lds
s_add_u32 m0, s29, 21504
s_nop 0
buffer_load_dwordx4 v170, s[16:19], s41 offen offset:2048 nt lds
s_add_u32 m0, s29, 9216
s_nop 0
buffer_load_dwordx4 v154, s[16:19], s41 offen offset:2048 nt lds
s_waitcnt vmcnt(0)
s_barrier
ds_read_b128 a[192:195], v236
ds_read_b128 a[196:199], v237
ds_read_b128 a[200:203], v236 offset:128
ds_read_b128 a[204:207], v237 offset:128
ds_read_b128 a[208:211], v236 offset:256
ds_read_b128 a[212:215], v237 offset:256
s_waitcnt lgkmcnt(0)
s_branch L_prol_3
L_idle_3:
v_accvgpr_read_b32 v216, a40
v_accvgpr_read_b32 v217, a41
v_accvgpr_read_b32 v218, a42
v_accvgpr_read_b32 v219, a43
v_accvgpr_read_b32 v220, a56
v_accvgpr_read_b32 v221, a57
v_accvgpr_read_b32 v222, a58
v_accvgpr_read_b32 v223, a59
v_mul_f32_e64 v236, -v248, v232
v_mul_f32_e64 v237, -v248, v233
v_mul_f32_e64 v238, -v248, v234
v_mul_f32_e64 v239, -v248, v235
v_fma_f32 v216, v216, v232, v236
v_fma_f32 v217, v217, v233, v237
v_fma_f32 v218, v218, v234, v238
v_fma_f32 v219, v219, v235, v239
v_fma_f32 v220, v220, v232, v236
v_fma_f32 v221, v221, v233, v237
v_fma_f32 v222, v222, v234, v238
v_fma_f32 v223, v223, v235, v239
v_cvt_pk_bf16_f32 v216, v216, v217
v_cvt_pk_bf16_f32 v217, v218, v219
v_cvt_pk_bf16_f32 v218, v220, v221
v_cvt_pk_bf16_f32 v219, v222, v223
s_nop 1
mz v,224,v,216,a,26
mz v,228,v,216,a,24
v_accvgpr_read_b32 v216, a72
v_accvgpr_read_b32 v217, a73
v_accvgpr_read_b32 v218, a74
v_accvgpr_read_b32 v219, a75
v_accvgpr_read_b32 v220, a88
v_accvgpr_read_b32 v221, a89
v_accvgpr_read_b32 v222, a90
v_accvgpr_read_b32 v223, a91
v_cvt_pk_bf16_f32 v224, v224, v225
v_cvt_pk_bf16_f32 v225, v226, v227
v_cvt_pk_bf16_f32 v226, v228, v229
v_cvt_pk_bf16_f32 v227, v230, v231
s_add_u32 s50, s46, 12288
buffer_store_dwordx4 v[224:227], v253, s[20:23], s50 offen offset:1024
v_fma_f32 v216, v216, v232, v236
v_fma_f32 v217, v217, v233, v237
v_fma_f32 v218, v218, v234, v238
v_fma_f32 v219, v219, v235, v239
v_fma_f32 v220, v220, v232, v236
v_fma_f32 v221, v221, v233, v237
v_fma_f32 v222, v222, v234, v238
v_fma_f32 v223, v223, v235, v239
v_cvt_pk_bf16_f32 v216, v216, v217
v_cvt_pk_bf16_f32 v217, v218, v219
v_cvt_pk_bf16_f32 v218, v220, v221
v_cvt_pk_bf16_f32 v219, v222, v223
s_nop 1
mz v,224,v,216,a,26
mz v,228,v,216,a,24
v_accvgpr_read_b32 v216, a104
v_accvgpr_read_b32 v217, a105
v_accvgpr_read_b32 v218, a106
v_accvgpr_read_b32 v219, a107
v_accvgpr_read_b32 v220, a120
v_accvgpr_read_b32 v221, a121
v_accvgpr_read_b32 v222, a122
v_accvgpr_read_b32 v223, a123
v_cvt_pk_bf16_f32 v224, v224, v225
v_cvt_pk_bf16_f32 v225, v226, v227
v_cvt_pk_bf16_f32 v226, v228, v229
v_cvt_pk_bf16_f32 v227, v230, v231
s_add_u32 s50, s46, 12288
buffer_store_dwordx4 v[224:227], v253, s[20:23], s50 offen offset:2048
v_fma_f32 v216, v216, v232, v236
v_fma_f32 v217, v217, v233, v237
v_fma_f32 v218, v218, v234, v238
v_fma_f32 v219, v219, v235, v239
v_fma_f32 v220, v220, v232, v236
v_fma_f32 v221, v221, v233, v237
v_fma_f32 v222, v222, v234, v238
v_fma_f32 v223, v223, v235, v239
v_cvt_pk_bf16_f32 v216, v216, v217
v_cvt_pk_bf16_f32 v217, v218, v219
v_cvt_pk_bf16_f32 v218, v220, v221
v_cvt_pk_bf16_f32 v219, v222, v223
s_nop 1
mz v,224,v,216,a,26
mz v,228,v,216,a,24
v_accvgpr_read_b32 v216, a136
v_accvgpr_read_b32 v217, a137
v_accvgpr_read_b32 v218, a138
v_accvgpr_read_b32 v219, a139
v_accvgpr_read_b32 v220, a152
v_accvgpr_read_b32 v221, a153
v_accvgpr_read_b32 v222, a154
v_accvgpr_read_b32 v223, a155
v_cvt_pk_bf16_f32 v224, v224, v225
v_cvt_pk_bf16_f32 v225, v226, v227
v_cvt_pk_bf16_f32 v226, v228, v229
v_cvt_pk_bf16_f32 v227, v230, v231
s_add_u32 s50, s46, 12288
buffer_store_dwordx4 v[224:227], v253, s[20:23], s50 offen offset:3072
v_fma_f32 v216, v216, v232, v236
v_fma_f32 v217, v217, v233, v237
v_fma_f32 v218, v218, v234, v238
v_fma_f32 v219, v219, v235, v239
v_fma_f32 v220, v220, v232, v236
v_fma_f32 v221, v221, v233, v237
v_fma_f32 v222, v222, v234, v238
v_fma_f32 v223, v223, v235, v239
v_cvt_pk_bf16_f32 v216, v216, v217
v_cvt_pk_bf16_f32 v217, v218, v219
v_cvt_pk_bf16_f32 v218, v220, v221
v_cvt_pk_bf16_f32 v219, v222, v223
s_nop 1
mz v,224,v,216,a,26
mz v,228,v,216,a,24
v_accvgpr_read_b32 v216, a168
v_accvgpr_read_b32 v217, a169
v_accvgpr_read_b32 v218, a170
v_accvgpr_read_b32 v219, a171
v_accvgpr_read_b32 v220, a184
v_accvgpr_read_b32 v221, a185
v_accvgpr_read_b32 v222, a186
v_accvgpr_read_b32 v223, a187
v_cvt_pk_bf16_f32 v224, v224, v225
v_cvt_pk_bf16_f32 v225, v226, v227
v_cvt_pk_bf16_f32 v226, v228, v229
v_cvt_pk_bf16_f32 v227, v230, v231
s_add_u32 s50, s46, 16384
buffer_store_dwordx4 v[224:227], v253, s[20:23], s50 offen
v_fma_f32 v216, v216, v232, v236
v_fma_f32 v217, v217, v233, v237
v_fma_f32 v218, v218, v234, v238
v_fma_f32 v219, v219, v235, v239
v_fma_f32 v220, v220, v232, v236
v_fma_f32 v221, v221, v233, v237
v_fma_f32 v222, v222, v234, v238
v_fma_f32 v223, v223, v235, v239
v_cvt_pk_bf16_f32 v216, v216, v217
v_cvt_pk_bf16_f32 v217, v218, v219
v_cvt_pk_bf16_f32 v218, v220, v221
v_cvt_pk_bf16_f32 v219, v222, v223
s_nop 1
mz v,224,v,216,a,26
mz v,228,v,216,a,24
ds_read_b128 v[232:235], v246 offset:64
v_accvgpr_read_b32 v216, a36
v_accvgpr_read_b32 v217, a37
v_accvgpr_read_b32 v218, a38
v_accvgpr_read_b32 v219, a39
v_accvgpr_read_b32 v220, a52
v_accvgpr_read_b32 v221, a53
v_accvgpr_read_b32 v222, a54
v_accvgpr_read_b32 v223, a55
v_cvt_pk_bf16_f32 v224, v224, v225
v_cvt_pk_bf16_f32 v225, v226, v227
v_cvt_pk_bf16_f32 v226, v228, v229
v_cvt_pk_bf16_f32 v227, v230, v231
s_add_u32 s50, s46, 16384
buffer_store_dwordx4 v[224:227], v253, s[20:23], s50 offen offset:1024
s_waitcnt lgkmcnt(0)
v_mul_f32_e64 v236, -v248, v232
v_mul_f32_e64 v237, -v248, v233
v_mul_f32_e64 v238, -v248, v234
v_mul_f32_e64 v239, -v248, v235
v_fma_f32 v216, v216, v232, v236
v_fma_f32 v217, v217, v233, v237
v_fma_f32 v218, v218, v234, v238
v_fma_f32 v219, v219, v235, v239
v_fma_f32 v220, v220, v232, v236
v_fma_f32 v221, v221, v233, v237
v_fma_f32 v222, v222, v234, v238
v_fma_f32 v223, v223, v235, v239
v_cvt_pk_bf16_f32 v216, v216, v217
v_cvt_pk_bf16_f32 v217, v218, v219
v_cvt_pk_bf16_f32 v218, v220, v221
v_cvt_pk_bf16_f32 v219, v222, v223
s_nop 1
mz v,224,v,216,a,26
mz v,228,v,216,a,24
v_accvgpr_read_b32 v216, a68
v_accvgpr_read_b32 v217, a69
v_accvgpr_read_b32 v218, a70
v_accvgpr_read_b32 v219, a71
v_accvgpr_read_b32 v220, a84
v_accvgpr_read_b32 v221, a85
v_accvgpr_read_b32 v222, a86
v_accvgpr_read_b32 v223, a87
v_cvt_pk_bf16_f32 v224, v224, v225
v_cvt_pk_bf16_f32 v225, v226, v227
v_cvt_pk_bf16_f32 v226, v228, v229
v_cvt_pk_bf16_f32 v227, v230, v231
s_add_u32 s50, s46, 6144
buffer_store_dwordx4 v[224:227], v253, s[20:23], s50 offen offset:1024
v_fma_f32 v216, v216, v232, v236
v_fma_f32 v217, v217, v233, v237
v_fma_f32 v218, v218, v234, v238
v_fma_f32 v219, v219, v235, v239
v_fma_f32 v220, v220, v232, v236
v_fma_f32 v221, v221, v233, v237
v_fma_f32 v222, v222, v234, v238
v_fma_f32 v223, v223, v235, v239
v_cvt_pk_bf16_f32 v216, v216, v217
v_cvt_pk_bf16_f32 v217, v218, v219
v_cvt_pk_bf16_f32 v218, v220, v221
v_cvt_pk_bf16_f32 v219, v222, v223
s_nop 1
mz v,224,v,216,a,26
mz v,228,v,216,a,24
v_accvgpr_read_b32 v216, a100
v_accvgpr_read_b32 v217, a101
v_accvgpr_read_b32 v218, a102
v_accvgpr_read_b32 v219, a103
v_accvgpr_read_b32 v220, a116
v_accvgpr_read_b32 v221, a117
v_accvgpr_read_b32 v222, a118
v_accvgpr_read_b32 v223, a119
v_cvt_pk_bf16_f32 v224, v224, v225
v_cvt_pk_bf16_f32 v225, v226, v227
v_cvt_pk_bf16_f32 v226, v228, v229
v_cvt_pk_bf16_f32 v227, v230, v231
s_add_u32 s50, s46, 6144
buffer_store_dwordx4 v[224:227], v253, s[20:23], s50 offen offset:2048
v_fma_f32 v216, v216, v232, v236
v_fma_f32 v217, v217, v233, v237
v_fma_f32 v218, v218, v234, v238
v_fma_f32 v219, v219, v235, v239
v_fma_f32 v220, v220, v232, v236
v_fma_f32 v221, v221, v233, v237
v_fma_f32 v222, v222, v234, v238
v_fma_f32 v223, v223, v235, v239
v_cvt_pk_bf16_f32 v216, v216, v217
v_cvt_pk_bf16_f32 v217, v218, v219
v_cvt_pk_bf16_f32 v218, v220, v221
v_cvt_pk_bf16_f32 v219, v222, v223
s_nop 1
mz v,224,v,216,a,26
mz v,228,v,216,a,24
v_accvgpr_read_b32 v216, a132
v_accvgpr_read_b32 v217, a133
v_accvgpr_read_b32 v218, a134
v_accvgpr_read_b32 v219, a135
v_accvgpr_read_b32 v220, a148
v_accvgpr_read_b32 v221, a149
v_accvgpr_read_b32 v222, a150
v_accvgpr_read_b32 v223, a151
v_cvt_pk_bf16_f32 v224, v224, v225
v_cvt_pk_bf16_f32 v225, v226, v227
v_cvt_pk_bf16_f32 v226, v228, v229
v_cvt_pk_bf16_f32 v227, v230, v231
s_add_u32 s50, s46, 6144
buffer_store_dwordx4 v[224:227], v253, s[20:23], s50 offen offset:3072
v_fma_f32 v216, v216, v232, v236
v_fma_f32 v217, v217, v233, v237
v_fma_f32 v218, v218, v234, v238
v_fma_f32 v219, v219, v235, v239
v_fma_f32 v220, v220, v232, v236
v_fma_f32 v221, v221, v233, v237
v_fma_f32 v222, v222, v234, v238
v_fma_f32 v223, v223, v235, v239
v_cvt_pk_bf16_f32 v216, v216, v217
v_cvt_pk_bf16_f32 v217, v218, v219
v_cvt_pk_bf16_f32 v218, v220, v221
v_cvt_pk_bf16_f32 v219, v222, v223
s_nop 1
mz v,224,v,216,a,26
mz v,228,v,216,a,24
v_accvgpr_read_b32 v216, a164
v_accvgpr_read_b32 v217, a165
v_accvgpr_read_b32 v218, a166
v_accvgpr_read_b32 v219, a167
v_accvgpr_read_b32 v220, a180
v_accvgpr_read_b32 v221, a181
v_accvgpr_read_b32 v222, a182
v_accvgpr_read_b32 v223, a183
v_cvt_pk_bf16_f32 v224, v224, v225
v_cvt_pk_bf16_f32 v225, v226, v227
v_cvt_pk_bf16_f32 v226, v228, v229
v_cvt_pk_bf16_f32 v227, v230, v231
s_add_u32 s50, s46, 10240
buffer_store_dwordx4 v[224:227], v253, s[20:23], s50 offen
v_fma_f32 v216, v216, v232, v236
v_fma_f32 v217, v217, v233, v237
v_fma_f32 v218, v218, v234, v238
v_fma_f32 v219, v219, v235, v239
v_fma_f32 v220, v220, v232, v236
v_fma_f32 v221, v221, v233, v237
v_fma_f32 v222, v222, v234, v238
v_fma_f32 v223, v223, v235, v239
v_cvt_pk_bf16_f32 v216, v216, v217
v_cvt_pk_bf16_f32 v217, v218, v219
v_cvt_pk_bf16_f32 v218, v220, v221
v_cvt_pk_bf16_f32 v219, v222, v223
s_nop 1
mz v,224,v,216,a,26
mz v,228,v,216,a,24
ds_read_b128 v[232:235], v246
v_accvgpr_read_b32 v216, a32
v_accvgpr_read_b32 v217, a33
v_accvgpr_read_b32 v218, a34
v_accvgpr_read_b32 v219, a35
v_accvgpr_read_b32 v220, a48
v_accvgpr_read_b32 v221, a49
v_accvgpr_read_b32 v222, a50
v_accvgpr_read_b32 v223, a51
v_cvt_pk_bf16_f32 v224, v224, v225
v_cvt_pk_bf16_f32 v225, v226, v227
v_cvt_pk_bf16_f32 v226, v228, v229
v_cvt_pk_bf16_f32 v227, v230, v231
s_add_u32 s50, s46, 10240
buffer_store_dwordx4 v[224:227], v253, s[20:23], s50 offen offset:1024
s_waitcnt lgkmcnt(0)
v_mul_f32_e64 v236, -v248, v232
v_mul_f32_e64 v237, -v248, v233
v_mul_f32_e64 v238, -v248, v234
v_mul_f32_e64 v239, -v248, v235
v_fma_f32 v216, v216, v232, v236
v_fma_f32 v217, v217, v233, v237
v_fma_f32 v218, v218, v234, v238
v_fma_f32 v219, v219, v235, v239
v_fma_f32 v220, v220, v232, v236
v_fma_f32 v221, v221, v233, v237
v_fma_f32 v222, v222, v234, v238
v_fma_f32 v223, v223, v235, v239
v_cvt_pk_bf16_f32 v216, v216, v217
v_cvt_pk_bf16_f32 v217, v218, v219
v_cvt_pk_bf16_f32 v218, v220, v221
v_cvt_pk_bf16_f32 v219, v222, v223
s_nop 1
mz v,224,v,216,a,26
mz v,228,v,216,a,24
v_accvgpr_read_b32 v216, a64
v_accvgpr_read_b32 v217, a65
v_accvgpr_read_b32 v218, a66
v_accvgpr_read_b32 v219, a67
v_accvgpr_read_b32 v220, a80
v_accvgpr_read_b32 v221, a81
v_accvgpr_read_b32 v222, a82
v_accvgpr_read_b32 v223, a83
v_cvt_pk_bf16_f32 v224, v224, v225
v_cvt_pk_bf16_f32 v225, v226, v227
v_cvt_pk_bf16_f32 v226, v228, v229
v_cvt_pk_bf16_f32 v227, v230, v231
s_add_u32 s50, s46, 0
buffer_store_dwordx4 v[224:227], v253, s[20:23], s50 offen offset:1024
v_fma_f32 v216, v216, v232, v236
v_fma_f32 v217, v217, v233, v237
v_fma_f32 v218, v218, v234, v238
v_fma_f32 v219, v219, v235, v239
v_fma_f32 v220, v220, v232, v236
v_fma_f32 v221, v221, v233, v237
v_fma_f32 v222, v222, v234, v238
v_fma_f32 v223, v223, v235, v239
v_cvt_pk_bf16_f32 v216, v216, v217
v_cvt_pk_bf16_f32 v217, v218, v219
v_cvt_pk_bf16_f32 v218, v220, v221
v_cvt_pk_bf16_f32 v219, v222, v223
s_nop 1
mz v,224,v,216,a,26
mz v,228,v,216,a,24
v_accvgpr_read_b32 v216, a96
v_accvgpr_read_b32 v217, a97
v_accvgpr_read_b32 v218, a98
v_accvgpr_read_b32 v219, a99
v_accvgpr_read_b32 v220, a112
v_accvgpr_read_b32 v221, a113
v_accvgpr_read_b32 v222, a114
v_accvgpr_read_b32 v223, a115
v_cvt_pk_bf16_f32 v224, v224, v225
v_cvt_pk_bf16_f32 v225, v226, v227
v_cvt_pk_bf16_f32 v226, v228, v229
v_cvt_pk_bf16_f32 v227, v230, v231
s_add_u32 s50, s46, 0
buffer_store_dwordx4 v[224:227], v253, s[20:23], s50 offen offset:2048
v_fma_f32 v216, v216, v232, v236
v_fma_f32 v217, v217, v233, v237
v_fma_f32 v218, v218, v234, v238
v_fma_f32 v219, v219, v235, v239
v_fma_f32 v220, v220, v232, v236
v_fma_f32 v221, v221, v233, v237
v_fma_f32 v222, v222, v234, v238
v_fma_f32 v223, v223, v235, v239
v_cvt_pk_bf16_f32 v216, v216, v217
v_cvt_pk_bf16_f32 v217, v218, v219
v_cvt_pk_bf16_f32 v218, v220, v221
v_cvt_pk_bf16_f32 v219, v222, v223
s_nop 1
mz v,224,v,216,a,26
mz v,228,v,216,a,24
v_accvgpr_read_b32 v216, a128
v_accvgpr_read_b32 v217, a129
v_accvgpr_read_b32 v218, a130
v_accvgpr_read_b32 v219, a131
v_accvgpr_read_b32 v220, a144
v_accvgpr_read_b32 v221, a145
v_accvgpr_read_b32 v222, a146
v_accvgpr_read_b32 v223, a147
v_cvt_pk_bf16_f32 v224, v224, v225
v_cvt_pk_bf16_f32 v225, v226, v227
v_cvt_pk_bf16_f32 v226, v228, v229
v_cvt_pk_bf16_f32 v227, v230, v231
s_add_u32 s50, s46, 0
buffer_store_dwordx4 v[224:227], v253, s[20:23], s50 offen offset:3072
v_fma_f32 v216, v216, v232, v236
v_fma_f32 v217, v217, v233, v237
v_fma_f32 v218, v218, v234, v238
v_fma_f32 v219, v219, v235, v239
v_fma_f32 v220, v220, v232, v236
v_fma_f32 v221, v221, v233, v237
v_fma_f32 v222, v222, v234, v238
v_fma_f32 v223, v223, v235, v239
v_cvt_pk_bf16_f32 v216, v216, v217
v_cvt_pk_bf16_f32 v217, v218, v219
v_cvt_pk_bf16_f32 v218, v220, v221
v_cvt_pk_bf16_f32 v219, v222, v223
s_nop 1
mz v,224,v,216,a,26
mz v,228,v,216,a,24
v_accvgpr_read_b32 v216, a160
v_accvgpr_read_b32 v217, a161
v_accvgpr_read_b32 v218, a162
v_accvgpr_read_b32 v219, a163
v_accvgpr_read_b32 v220, a176
v_accvgpr_read_b32 v221, a177
v_accvgpr_read_b32 v222, a178
v_accvgpr_read_b32 v223, a179
v_cvt_pk_bf16_f32 v224, v224, v225
v_cvt_pk_bf16_f32 v225, v226, v227
v_cvt_pk_bf16_f32 v226, v228, v229
v_cvt_pk_bf16_f32 v227, v230, v231
s_add_u32 s50, s46, 4096
buffer_store_dwordx4 v[224:227], v253, s[20:23], s50 offen
v_fma_f32 v216, v216, v232, v236
v_fma_f32 v217, v217, v233, v237
v_fma_f32 v218, v218, v234, v238
v_fma_f32 v219, v219, v235, v239
v_fma_f32 v220, v220, v232, v236
v_fma_f32 v221, v221, v233, v237
v_fma_f32 v222, v222, v234, v238
v_fma_f32 v223, v223, v235, v239
v_cvt_pk_bf16_f32 v216, v216, v217
v_cvt_pk_bf16_f32 v217, v218, v219
v_cvt_pk_bf16_f32 v218, v220, v221
v_cvt_pk_bf16_f32 v219, v222, v223
s_nop 1
mz v,224,v,216,a,26
mz v,228,v,216,a,24
s_nop 7
v_cvt_pk_bf16_f32 v224, v224, v225
v_cvt_pk_bf16_f32 v225, v226, v227
v_cvt_pk_bf16_f32 v226, v228, v229
v_cvt_pk_bf16_f32 v227, v230, v231
s_add_u32 s50, s46, 4096
buffer_store_dwordx4 v[224:227], v253, s[20:23], s50 offen offset:1024
s_waitcnt vmcnt(0)
s_barrier
s_cmp_eq_u32 s35, 0
s_cbranch_scc1 L_rel78
buffer_wbl2 sc1
s_waitcnt vmcnt(0)
L_rel78:
s_add_u32 s84, s86, 64
v_mov_b32 v254, 1
s_mov_b64 exec, 1
buffer_atomic_add v254, off, s[72:75], s84 sc1
s_mov_b64 exec, -1
s_endpgm
.p2align 12
L_tail2_4:
L_b13_4:
L_pg42:
s_cbranch_execz L_ir39
mm v,132,a,192,v,0,164
v_lshrrev_b32 v224, 6, v253
v_and_b32 v225, 6, v224
mm v,132,a,196,v,8,132
tr 216,241,0
v_lshlrev_b32 v224, 7, v224
mm v,132,a,200,v,16,132
tr 218,241,6144
v_bfe_u32 v249, v253, 4, 1
mm v,132,a,204,v,24,132
s_waitcnt lgkmcnt(2)
v_exp_f32 v156, v156
mm v,132,a,208,v,32,132
tr 220,241,12288
v_lshl_add_u32 v224, v249, 3, v224
mm v,132,a,212,v,40,132
v_exp_f32 v157, v157
mm a,0,v,68,v,192,0
tr 222,241,18432
v_bfe_u32 v249, v253, 5, 1
mm a,0,v,76,v,196,0
v_exp_f32 v158, v158
mm a,4,v,84,v,192,4
ds_read_b128 a[216:219], v236 offset:6144
v_cvt_pk_bf16_f32 v126, v156, v157
mm a,4,v,92,v,196,4
v_exp_f32 v159, v159
mm a,8,v,100,v,192,8
ds_read_b128 a[220:223], v237 offset:6144
v_cvt_pk_bf16_f32 v127, v158, v159
mm a,8,v,108,v,196,8
v_xor_b32 v225, v225, v249
v_lshlrev_b32 v225, 4, v225
mm a,12,v,116,v,192,12
s_lshr_b32 s101, s24, 1
s_lshl_b32 s101, s101, 6
v_xor_b32 v225, s101, v225
mm a,12,v,124,v,196,12
s_lshr_b32 s101, s24, 1
s_mul_i32 s101, s101, 74496
s_add_u32 s101, s101, 1024
mm v,140,a,192,v,48,172
v_exp_f32 v132, v132
mm v,140,a,196,v,56,140
tr 192,238,128
v_add_u32 v224, s101, v224
mm v,140,a,200,v,64,140
v_exp_f32 v133, v133
mm v,140,a,204,v,72,140
tr 194,238,6272
v_xor_b32 v249, 0, v225
mm v,140,a,208,v,80,140
v_exp_f32 v134, v134
mm v,140,a,212,v,88,140
tr 196,238,12416
v_cvt_pk_bf16_f32 v4, v132, v133
mm a,16,v,68,v,200,16
v_exp_f32 v135, v135
mm a,16,v,76,v,204,16
tr 198,238,18560
v_cvt_pk_bf16_f32 v5, v134, v135
mm a,20,v,84,v,200,20
v_add_u32 v249, v249, v224
v_xor_b32 v250, 32, v225
mm a,20,v,92,v,204,20
ds_read_b128 a[224:227], v236 offset:6272
v_add_u32 v250, v250, v224
mm a,24,v,100,v,200,24
v_xor_b32 v251, 64, v225
v_add_u32 v251, v251, v224
mm a,24,v,108,v,204,24
ds_read_b128 a[228:231], v237 offset:6272
v_xor_b32 v242, 96, v225
mm a,28,v,116,v,200,28
v_add_u32 v242, v242, v224
mm a,28,v,124,v,204,28
mm v,148,a,192,v,96,180
v_exp_f32 v140, v140
mm v,148,a,196,v,104,148
tr 200,239,128
mm v,148,a,200,v,112,148
v_exp_f32 v141, v141
mm v,148,a,204,v,120,148
tr 202,239,6272
mm v,148,a,208,v,128,148
v_exp_f32 v142, v142
mm v,148,a,212,v,136,148
tr 204,239,12416
v_cvt_pk_bf16_f32 v20, v140, v141
mm a,32,v,68,v,208,32
v_exp_f32 v143, v143
mm a,32,v,76,v,212,32
tr 206,239,18560
v_cvt_pk_bf16_f32 v21, v142, v143
mm a,36,v,84,v,208,36
mm a,36,v,92,v,212,36
ds_read_b128 a[232:235], v236 offset:6400
mm a,40,v,100,v,208,40
mm a,40,v,108,v,212,40
ds_read_b128 a[236:239], v237 offset:6400
mm a,44,v,116,v,208,44
mm a,44,v,124,v,212,44
mm v,156,a,192,v,144,188
v_exp_f32 v148, v148
mm v,156,a,196,v,152,156
mm v,156,a,200,v,160,156
v_exp_f32 v149, v149
mm v,156,a,204,v,168,156
mm v,156,a,208,v,176,156
v_exp_f32 v150, v150
mm v,156,a,212,v,184,156
v_cvt_pk_bf16_f32 v36, v148, v149
mm a,240,v,232,v,68,240
v_exp_f32 v151, v151
mm a,240,v,232,v,76,240
s_waitcnt lgkmcnt(13)
v_cvt_pk_bf16_f32 v37, v150, v151
mm v,132,a,216,v,0,164
s_waitcnt lgkmcnt(12)
mm v,132,a,220,v,8,132
tr 208,240,128
s_waitcnt lgkmcnt(8)
mm v,132,a,224,v,16,132
tr 210,240,6272
s_waitcnt lgkmcnt(8)
mm v,132,a,228,v,24,132
s_waitcnt lgkmcnt(3)
v_exp_f32 v156, v156
mm v,132,a,232,v,32,132
tr 212,240,12416
s_waitcnt lgkmcnt(3)
mm v,132,a,236,v,40,132
v_exp_f32 v157, v157
mm a,48,v,68,v,216,48
tr 214,240,18560
mm a,48,v,76,v,220,48
v_exp_f32 v158, v158
mm a,52,v,84,v,216,52
ds_read_b128 a[192:195], v236 offset:12288
v_cvt_pk_bf16_f32 v52, v156, v157
mm a,52,v,92,v,220,52
v_exp_f32 v159, v159
mm a,56,v,100,v,216,56
ds_read_b128 a[196:199], v237 offset:12288
v_cvt_pk_bf16_f32 v53, v158, v159
mm a,56,v,108,v,220,56
mm a,60,v,116,v,216,60
mm a,60,v,124,v,220,60
mm v,140,a,216,v,48,172
v_exp_f32 v132, v132
mm v,140,a,220,v,56,140
tr 216,241,128
mm v,140,a,224,v,64,140
v_exp_f32 v133, v133
mm v,140,a,228,v,72,140
tr 218,241,6272
mm v,140,a,232,v,80,140
v_exp_f32 v134, v134
mm v,140,a,236,v,88,140
tr 220,241,12416
v_cvt_pk_bf16_f32 v6, v132, v133
mm a,64,v,68,v,192,64
v_exp_f32 v135, v135
mm a,64,v,76,v,196,64
tr 222,241,18560
v_cvt_pk_bf16_f32 v7, v134, v135
mm a,68,v,84,v,192,68
mm a,68,v,92,v,196,68
ds_read_b128 a[200:203], v236 offset:12416
mm a,72,v,100,v,192,72
mm a,72,v,108,v,196,72
ds_read_b128 a[204:207], v237 offset:12416
mm a,76,v,116,v,192,76
mm a,76,v,124,v,196,76
mm v,148,a,216,v,96,180
v_exp_f32 v140, v140
mm v,148,a,220,v,104,148
tr 192,238,256
mm v,148,a,224,v,112,148
v_exp_f32 v141, v141
mm v,148,a,228,v,120,148
tr 194,238,6400
mm v,148,a,232,v,128,148
v_exp_f32 v142, v142
mm v,148,a,236,v,136,148
tr 196,238,12544
v_cvt_pk_bf16_f32 v22, v140, v141
mm a,80,v,68,v,200,80
v_exp_f32 v143, v143
mm a,80,v,76,v,204,80
tr 198,238,18688
v_cvt_pk_bf16_f32 v23, v142, v143
mm a,84,v,84,v,200,84
mm a,84,v,92,v,204,84
ds_read_b128 a[208:211], v236 offset:12544
mm a,88,v,100,v,200,88
mm a,88,v,108,v,204,88
ds_read_b128 a[212:215], v237 offset:12544
mm a,92,v,116,v,200,92
mm a,92,v,124,v,204,92
mm v,156,a,216,v,144,188
v_exp_f32 v148, v148
mm v,156,a,220,v,152,156
mm v,156,a,224,v,160,156
v_exp_f32 v149, v149
mm v,156,a,228,v,168,156
mm v,156,a,232,v,176,156
v_exp_f32 v150, v150
mm v,156,a,236,v,184,156
v_cvt_pk_bf16_f32 v38, v148, v149
mm a,244,v,232,v,84,244
v_exp_f32 v151, v151
mm a,244,v,232,v,92,244
s_waitcnt lgkmcnt(13)
v_cvt_pk_bf16_f32 v39, v150, v151
mm v,132,a,192,v,0,164
s_waitcnt lgkmcnt(12)
mm v,132,a,196,v,8,132
tr 200,239,256
s_waitcnt lgkmcnt(8)
mm v,132,a,200,v,16,132
tr 202,239,6400
s_waitcnt lgkmcnt(8)
mm v,132,a,204,v,24,132
s_waitcnt lgkmcnt(3)
v_exp_f32 v156, v156
mm v,132,a,208,v,32,132
tr 204,239,12544
s_waitcnt lgkmcnt(3)
mm v,132,a,212,v,40,132
v_exp_f32 v157, v157
mm a,96,v,68,v,208,96
tr 206,239,18688
mm a,96,v,76,v,212,96
v_exp_f32 v158, v158
mm a,100,v,84,v,208,100
ds_read_b128 a[216:219], v236 offset:18432
v_cvt_pk_bf16_f32 v54, v156, v157
mm a,100,v,92,v,212,100
v_exp_f32 v159, v159
mm a,104,v,100,v,208,104
ds_read_b128 a[220:223], v237 offset:18432
v_cvt_pk_bf16_f32 v55, v158, v159
mm a,104,v,108,v,212,104
mm a,108,v,116,v,208,108
mm a,108,v,124,v,212,108
mm v,140,a,192,v,48,172
v_exp_f32 v132, v132
mm v,140,a,196,v,56,140
tr 208,240,256
mm v,140,a,200,v,64,140
v_exp_f32 v133, v133
mm v,140,a,204,v,72,140
tr 210,240,6400
mm v,140,a,208,v,80,140
v_exp_f32 v134, v134
mm v,140,a,212,v,88,140
tr 212,240,12544
v_cvt_pk_bf16_f32 v12, v132, v133
mm a,112,v,68,v,216,112
v_exp_f32 v135, v135
mm a,112,v,76,v,220,112
tr 214,240,18688
v_cvt_pk_bf16_f32 v13, v134, v135
mm a,116,v,84,v,216,116
mm a,116,v,92,v,220,116
ds_read_b128 a[224:227], v236 offset:18560
mm a,120,v,100,v,216,120
mm a,120,v,108,v,220,120
ds_read_b128 a[228:231], v237 offset:18560
mm a,124,v,116,v,216,124
mm a,124,v,124,v,220,124
mm v,148,a,192,v,96,180
v_exp_f32 v140, v140
mm v,148,a,196,v,104,148
tr 216,241,256
mm v,148,a,200,v,112,148
v_exp_f32 v141, v141
mm v,148,a,204,v,120,148
tr 218,241,6400
mm v,148,a,208,v,128,148
v_exp_f32 v142, v142
mm v,148,a,212,v,136,148
tr 220,241,12544
v_cvt_pk_bf16_f32 v28, v140, v141
mm a,128,v,68,v,192,128
v_exp_f32 v143, v143
mm a,128,v,76,v,196,128
tr 222,241,18688
v_cvt_pk_bf16_f32 v29, v142, v143
mm a,132,v,84,v,192,132
mm a,132,v,92,v,196,132
ds_read_b128 a[232:235], v236 offset:18688
mm a,136,v,100,v,192,136
mm a,136,v,108,v,196,136
ds_read_b128 a[236:239], v237 offset:18688
s_sub_u32 s42, s29, s49
mm a,140,v,116,v,192,140
s_mov_b32 s49, s29
v_add_u32 v238, s42, v238
v_add_u32 v239, s42, v239
mm a,140,v,124,v,196,140
v_add_u32 v240, s42, v240
v_add_u32 v241, s42, v241
mm v,156,a,192,v,144,188
s_sub_u32 s47, s26, s25
v_exp_f32 v148, v148
mm v,156,a,196,v,152,156
v_add_u32 v236, s47, v236
v_add_u32 v237, s47, v237
mm v,156,a,200,v,160,156
v_exp_f32 v149, v149
mm v,156,a,204,v,168,156
mm v,156,a,208,v,176,156
v_exp_f32 v150, v150
mm v,156,a,212,v,184,156
v_cvt_pk_bf16_f32 v44, v148, v149
mm a,248,v,232,v,100,248
v_exp_f32 v151, v151
mm a,248,v,232,v,108,248
s_waitcnt lgkmcnt(13)
v_cvt_pk_bf16_f32 v45, v150, v151
mm v,132,a,216,v,0,164
s_waitcnt lgkmcnt(0)
s_barrier
mm v,132,a,220,v,8,132
tr 192,238,0
s_mov_b32 s43, s28
mm v,132,a,224,v,16,132
tr 194,238,6144
s_mov_b32 s28, s29
mm v,132,a,228,v,24,132
s_mov_b32 s29, s30
v_exp_f32 v156, v156
mm v,132,a,232,v,32,132
tr 196,238,12288
s_mov_b32 s30, s43
mm v,132,a,236,v,40,132
s_mov_b32 s43, s25
v_exp_f32 v157, v157
mm a,144,v,68,v,200,144
tr 198,238,18432
s_mov_b32 s25, s26
mm a,144,v,76,v,204,144
s_mov_b32 s26, s27
v_exp_f32 v158, v158
mm a,148,v,84,v,200,148
ds_read_b128 a[192:195], v236
v_cvt_pk_bf16_f32 v60, v156, v157
mm a,148,v,92,v,204,148
s_mov_b32 s27, s43
v_exp_f32 v159, v159
mm a,152,v,100,v,200,152
ds_read_b128 a[196:199], v237
v_cvt_pk_bf16_f32 v61, v158, v159
mm a,152,v,108,v,204,152
mm a,156,v,116,v,200,156
mm a,156,v,124,v,204,156
mm v,140,a,216,v,48,172
v_exp_f32 v132, v132
mm v,140,a,220,v,56,140
tr 200,239,0
mm v,140,a,224,v,64,140
v_exp_f32 v133, v133
mm v,140,a,228,v,72,140
tr 202,239,6144
mm v,140,a,232,v,80,140
v_exp_f32 v134, v134
mm v,140,a,236,v,88,140
tr 204,239,12288
v_cvt_pk_bf16_f32 v14, v132, v133
mm a,160,v,68,v,208,160
v_exp_f32 v135, v135
mm a,160,v,76,v,212,160
tr 206,239,18432
v_cvt_pk_bf16_f32 v15, v134, v135
mm a,164,v,84,v,208,164
mm a,164,v,92,v,212,164
ds_read_b128 a[200:203], v236 offset:128
mm a,168,v,100,v,208,168
mm a,168,v,108,v,212,168
ds_read_b128 a[204:207], v237 offset:128
mm a,172,v,116,v,208,172
mm a,172,v,124,v,212,172
mm v,148,a,216,v,96,180
v_exp_f32 v140, v140
mm v,148,a,220,v,104,148
tr 208,240,0
mm v,148,a,224,v,112,148
v_exp_f32 v141, v141
mm v,148,a,228,v,120,148
tr 210,240,6144
mm v,148,a,232,v,128,148
v_exp_f32 v142, v142
mm v,148,a,236,v,136,148
tr 212,240,12288
v_cvt_pk_bf16_f32 v30, v140, v141
mm a,176,v,68,v,216,176
v_exp_f32 v143, v143
mm a,176,v,76,v,220,176
tr 214,240,18432
v_cvt_pk_bf16_f32 v31, v142, v143
mm a,180,v,84,v,216,180
mm a,180,v,92,v,220,180
ds_read_b128 a[208:211], v236 offset:256
mm a,184,v,100,v,216,184
mm a,184,v,108,v,220,184
ds_read_b128 a[212:215], v237 offset:256
mm a,188,v,116,v,216,188
mm a,188,v,124,v,220,188
mm v,156,a,216,v,144,188
v_exp_f32 v148, v148
mm v,156,a,220,v,152,156
mm v,156,a,224,v,160,156
v_exp_f32 v149, v149
mm v,156,a,228,v,168,156
mm v,156,a,232,v,176,156
v_exp_f32 v150, v150
mm v,156,a,236,v,184,156
v_cvt_pk_bf16_f32 v46, v148, v149
mm a,252,v,232,v,116,252
v_exp_f32 v151, v151
mm a,252,v,232,v,124,252
s_waitcnt lgkmcnt(13)
v_cvt_pk_bf16_f32 v47, v150, v151
mm v,132,a,192,v,0,164
s_add_u32 m0, s78, 23808
s_add_u32 s51, s77, 0
s_waitcnt lgkmcnt(12)
mm v,132,a,196,v,8,132
tr 216,241,0
s_waitcnt lgkmcnt(8)
mm v,132,a,200,v,16,132
tr 218,241,6144
s_waitcnt lgkmcnt(8)
mm v,132,a,204,v,24,132
s_waitcnt lgkmcnt(3)
v_exp_f32 v156, v156
mm v,132,a,208,v,32,132
tr 220,241,12288
s_waitcnt lgkmcnt(3)
mm v,132,a,212,v,40,132
v_exp_f32 v157, v157
mm a,0,v,4,v,192,0
tr 222,241,18432
mm a,0,v,12,v,196,0
v_exp_f32 v158, v158
mm a,4,v,20,v,192,4
ds_read_b128 a[216:219], v236 offset:6144
v_cvt_pk_bf16_f32 v62, v156, v157
mm a,4,v,28,v,196,4
v_exp_f32 v159, v159
mm a,8,v,36,v,192,8
ds_read_b128 a[220:223], v237 offset:6144
v_cvt_pk_bf16_f32 v63, v158, v159
mm a,8,v,44,v,196,8
buffer_load_dwordx4 v252, s[96:99], s51 offen lds
mm a,12,v,52,v,192,12
s_add_u32 s51, s77, 9216
mm a,12,v,60,v,196,12
mm v,140,a,192,v,48,172
v_exp_f32 v132, v132
mm v,140,a,196,v,56,140
tr 192,238,128
mm v,140,a,200,v,64,140
v_exp_f32 v133, v133
mm v,140,a,204,v,72,140
tr 194,238,6272
mm v,140,a,208,v,80,140
v_exp_f32 v134, v134
mm v,140,a,212,v,88,140
tr 196,238,12416
v_cvt_pk_bf16_f32 v68, v132, v133
mm a,16,v,4,v,200,16
v_exp_f32 v135, v135
mm a,16,v,12,v,204,16
tr 198,238,18560
v_cvt_pk_bf16_f32 v69, v134, v135
mm a,20,v,20,v,200,20
buffer_load_dwordx4 v252, s[96:99], s51 offen offset:1024 lds
mm a,20,v,28,v,204,20
ds_read_b128 a[224:227], v236 offset:6272
s_add_u32 s51, s77, 18432
mm a,24,v,36,v,200,24
mm a,24,v,44,v,204,24
ds_read_b128 a[228:231], v237 offset:6272
mm a,28,v,52,v,200,28
mm a,28,v,60,v,204,28
mm v,148,a,192,v,96,180
v_exp_f32 v140, v140
mm v,148,a,196,v,104,148
tr 200,239,128
mm v,148,a,200,v,112,148
v_exp_f32 v141, v141
mm v,148,a,204,v,120,148
tr 202,239,6272
mm v,148,a,208,v,128,148
v_exp_f32 v142, v142
mm v,148,a,212,v,136,148
tr 204,239,12416
v_cvt_pk_bf16_f32 v84, v140, v141
mm a,32,v,4,v,208,32
v_exp_f32 v143, v143
mm a,32,v,12,v,212,32
tr 206,239,18560
v_cvt_pk_bf16_f32 v85, v142, v143
mm a,36,v,20,v,208,36
buffer_load_dwordx4 v252, s[96:99], s51 offen offset:2048 lds
mm a,36,v,28,v,212,36
ds_read_b128 a[232:235], v236 offset:6400
s_add_u32 s51, s77, 27648
mm a,40,v,36,v,208,40
mm a,40,v,44,v,212,40
ds_read_b128 a[236:239], v237 offset:6400
mm a,44,v,52,v,208,44
mm a,44,v,60,v,212,44
mm v,156,a,192,v,144,188
v_exp_f32 v148, v148
mm v,156,a,196,v,152,156
mm v,156,a,200,v,160,156
v_exp_f32 v149, v149
mm v,156,a,204,v,168,156
mm v,156,a,208,v,176,156
v_exp_f32 v150, v150
mm v,156,a,212,v,184,156
v_cvt_pk_bf16_f32 v100, v148, v149
mm a,240,v,232,v,4,240
v_exp_f32 v151, v151
mm a,240,v,232,v,12,240
s_waitcnt lgkmcnt(13)
v_cvt_pk_bf16_f32 v101, v150, v151
mm v,132,a,216,v,0,164
s_waitcnt lgkmcnt(12)
mm v,132,a,220,v,8,132
tr 208,240,128
s_waitcnt lgkmcnt(8)
mm v,132,a,224,v,16,132
tr 210,240,6272
s_waitcnt lgkmcnt(8)
mm v,132,a,228,v,24,132
s_waitcnt lgkmcnt(3)
v_exp_f32 v156, v156
mm v,132,a,232,v,32,132
tr 212,240,12416
s_waitcnt lgkmcnt(3)
mm v,132,a,236,v,40,132
v_exp_f32 v157, v157
mm a,48,v,4,v,216,48
tr 214,240,18560
mm a,48,v,12,v,220,48
v_exp_f32 v158, v158
mm a,52,v,20,v,216,52
ds_read_b128 a[192:195], v236 offset:12288
v_cvt_pk_bf16_f32 v116, v156, v157
mm a,52,v,28,v,220,52
v_exp_f32 v159, v159
mm a,56,v,36,v,216,56
ds_read_b128 a[196:199], v237 offset:12288
v_cvt_pk_bf16_f32 v117, v158, v159
mm a,56,v,44,v,220,56
buffer_load_dwordx4 v252, s[96:99], s51 offen offset:3072 lds
mm a,60,v,52,v,216,60
s_add_u32 m0, s78, 27904
s_add_u32 s51, s77, 40960
mm a,60,v,60,v,220,60
mm v,140,a,216,v,48,172
v_exp_f32 v132, v132
mm v,140,a,220,v,56,140
tr 216,241,128
mm v,140,a,224,v,64,140
v_exp_f32 v133, v133
mm v,140,a,228,v,72,140
tr 218,241,6272
mm v,140,a,232,v,80,140
v_exp_f32 v134, v134
mm v,140,a,236,v,88,140
tr 220,241,12416
v_cvt_pk_bf16_f32 v70, v132, v133
mm a,64,v,4,v,192,64
v_exp_f32 v135, v135
mm a,64,v,12,v,196,64
tr 222,241,18560
v_cvt_pk_bf16_f32 v71, v134, v135
mm a,68,v,20,v,192,68
buffer_load_dwordx4 v252, s[96:99], s51 offen lds
mm a,68,v,28,v,196,68
ds_read_b128 a[200:203], v236 offset:12416
s_add_u32 s51, s77, 50176
mm a,72,v,36,v,192,72
L_pg47:
s_cbranch_execz L_ir44
mm a,72,v,44,v,196,72
ds_read_b128 a[204:207], v237 offset:12416
mm a,76,v,52,v,192,76
mm a,76,v,60,v,196,76
mm v,148,a,216,v,96,180
v_exp_f32 v140, v140
mm v,148,a,220,v,104,148
tr 192,238,256
mm v,148,a,224,v,112,148
v_exp_f32 v141, v141
mm v,148,a,228,v,120,148
tr 194,238,6400
mm v,148,a,232,v,128,148
v_exp_f32 v142, v142
mm v,148,a,236,v,136,148
tr 196,238,12544
v_cvt_pk_bf16_f32 v86, v140, v141
mm a,80,v,4,v,200,80
v_exp_f32 v143, v143
mm a,80,v,12,v,204,80
tr 198,238,18688
v_cvt_pk_bf16_f32 v87, v142, v143
mm a,84,v,20,v,200,84
mm a,84,v,28,v,204,84
ds_read_b128 a[208:211], v236 offset:12544
mm a,88,v,36,v,200,88
buffer_load_dwordx4 v252, s[96:99], s51 offen offset:1024 lds
mm a,88,v,44,v,204,88
ds_read_b128 a[212:215], v237 offset:12544
s_add_u32 s51, s77, 59392
mm a,92,v,52,v,200,92
mm a,92,v,60,v,204,92
mm v,156,a,216,v,144,188
v_exp_f32 v148, v148
mm v,156,a,220,v,152,156
mm v,156,a,224,v,160,156
v_exp_f32 v149, v149
mm v,156,a,228,v,168,156
mm v,156,a,232,v,176,156
v_exp_f32 v150, v150
mm v,156,a,236,v,184,156
v_cvt_pk_bf16_f32 v102, v148, v149
mm a,244,v,232,v,20,244
v_exp_f32 v151, v151
mm a,244,v,232,v,28,244
s_waitcnt lgkmcnt(13)
v_cvt_pk_bf16_f32 v103, v150, v151
mm v,132,a,192,v,0,164
s_waitcnt lgkmcnt(12)
mm v,132,a,196,v,8,132
tr 200,239,256
s_waitcnt lgkmcnt(8)
mm v,132,a,200,v,16,132
tr 202,239,6400
s_waitcnt lgkmcnt(8)
mm v,132,a,204,v,24,132
s_waitcnt lgkmcnt(3)
v_exp_f32 v156, v156
mm v,132,a,208,v,32,132
tr 204,239,12544
s_waitcnt lgkmcnt(3)
mm v,132,a,212,v,40,132
v_exp_f32 v157, v157
mm a,96,v,4,v,208,96
tr 206,239,18688
mm a,96,v,12,v,212,96
v_exp_f32 v158, v158
mm a,100,v,20,v,208,100
ds_read_b128 a[216:219], v236 offset:18432
v_cvt_pk_bf16_f32 v118, v156, v157
mm a,100,v,28,v,212,100
v_exp_f32 v159, v159
mm a,104,v,36,v,208,104
ds_read_b128 a[220:223], v237 offset:18432
v_cvt_pk_bf16_f32 v119, v158, v159
mm a,104,v,44,v,212,104
buffer_load_dwordx4 v252, s[96:99], s51 offen offset:2048 lds
mm a,108,v,52,v,208,108
s_add_u32 s51, s77, 68608
mm a,108,v,60,v,212,108
mm v,140,a,192,v,48,172
v_exp_f32 v132, v132
mm v,140,a,196,v,56,140
tr 208,240,256
mm v,140,a,200,v,64,140
v_exp_f32 v133, v133
mm v,140,a,204,v,72,140
tr 210,240,6400
mm v,140,a,208,v,80,140
v_exp_f32 v134, v134
mm v,140,a,212,v,88,140
tr 212,240,12544
v_cvt_pk_bf16_f32 v76, v132, v133
mm a,112,v,4,v,216,112
v_exp_f32 v135, v135
mm a,112,v,12,v,220,112
tr 214,240,18688
v_cvt_pk_bf16_f32 v77, v134, v135
mm a,116,v,20,v,216,116
mm a,116,v,28,v,220,116
ds_read_b128 a[224:227], v236 offset:18560
mm a,120,v,36,v,216,120
buffer_load_dwordx4 v252, s[96:99], s51 offen offset:3072 lds
mm a,120,v,44,v,220,120
ds_read_b128 a[228:231], v237 offset:18560
mm a,124,v,52,v,216,124
mm a,124,v,60,v,220,124
mm v,148,a,192,v,96,180
v_exp_f32 v140, v140
mm v,148,a,196,v,104,148
tr 216,241,256
mm v,148,a,200,v,112,148
v_exp_f32 v141, v141
mm v,148,a,204,v,120,148
tr 218,241,6400
mm v,148,a,208,v,128,148
v_exp_f32 v142, v142
mm v,148,a,212,v,136,148
tr 220,241,12544
v_cvt_pk_bf16_f32 v92, v140, v141
mm a,128,v,4,v,192,128
v_exp_f32 v143, v143
mm a,128,v,12,v,196,128
tr 222,241,18688
v_cvt_pk_bf16_f32 v93, v142, v143
mm a,132,v,20,v,192,132
mm a,132,v,28,v,196,132
ds_read_b128 a[232:235], v236 offset:18688
mm a,136,v,36,v,192,136
mm a,136,v,44,v,196,136
ds_read_b128 a[236:239], v237 offset:18688
s_sub_u32 s42, s29, s49
mm a,140,v,52,v,192,140
s_mov_b32 s49, s29
v_add_u32 v238, s42, v238
v_add_u32 v239, s42, v239
mm a,140,v,60,v,196,140
v_add_u32 v240, s42, v240
v_add_u32 v241, s42, v241
mm v,156,a,192,v,144,188
v_exp_f32 v148, v148
mm v,156,a,196,v,152,156
mm v,156,a,200,v,160,156
v_exp_f32 v149, v149
mm v,156,a,204,v,168,156
mm v,156,a,208,v,176,156
v_exp_f32 v150, v150
mm v,156,a,212,v,184,156
v_cvt_pk_bf16_f32 v108, v148, v149
mm a,248,v,232,v,36,248
v_exp_f32 v151, v151
mm a,248,v,232,v,44,248
s_waitcnt lgkmcnt(13)
v_cvt_pk_bf16_f32 v109, v150, v151
mm v,132,a,216,v,0,164
s_waitcnt lgkmcnt(0)
s_barrier
mm v,132,a,220,v,8,132
tr 192,238,0
s_mov_b32 s43, s28
mm v,132,a,224,v,16,132
tr 194,238,6144
s_mov_b32 s28, s29
mm v,132,a,228,v,24,132
s_mov_b32 s29, s30
v_exp_f32 v156, v156
mm v,132,a,232,v,32,132
tr 196,238,12288
s_mov_b32 s30, s43
mm v,132,a,236,v,40,132
s_add_u32 m0, s78, 48640
v_exp_f32 v157, v157
mm a,144,v,4,v,200,144
tr 198,238,18432
s_add_u32 s51, s77, 81920
mm a,144,v,12,v,204,144
v_exp_f32 v158, v158
mm a,148,v,20,v,200,148
buffer_load_dwordx4 v252, s[96:99], s51 offen lds
v_cvt_pk_bf16_f32 v124, v156, v157
mm a,148,v,28,v,204,148
s_add_u32 s101, s76, 0
v_exp_f32 v159, v159
mm a,152,v,36,v,200,152
v_cvt_pk_bf16_f32 v125, v158, v159
mm a,152,v,44,v,204,152
buffer_load_dwordx4 a[192:195], v253, s[60:63], s101 offen sc1
mm a,156,v,52,v,200,156
s_add_u32 s51, s77, 91136
mm a,156,v,60,v,204,156
buffer_load_dwordx4 v252, s[96:99], s51 offen offset:1024 lds
mm v,140,a,216,v,48,172
buffer_load_dwordx4 a[196:199], v253, s[60:63], s101 offen offset:1024 sc1
v_exp_f32 v132, v132
mm v,140,a,220,v,56,140
tr 200,239,0
s_add_u32 s51, s77, 100352
mm v,140,a,224,v,64,140
v_exp_f32 v133, v133
mm v,140,a,228,v,72,140
tr 202,239,6144
buffer_load_dwordx4 v252, s[96:99], s51 offen offset:2048 lds
mm v,140,a,232,v,80,140
s_add_u32 s101, s76, 6144
v_exp_f32 v134, v134
mm v,140,a,236,v,88,140
tr 204,239,12288
v_cvt_pk_bf16_f32 v78, v132, v133
mm a,160,v,4,v,208,160
v_exp_f32 v135, v135
mm a,160,v,12,v,212,160
tr 206,239,18432
v_cvt_pk_bf16_f32 v79, v134, v135
mm a,164,v,20,v,208,164
buffer_load_dwordx4 a[200:203], v253, s[60:63], s101 offen sc1
mm a,164,v,28,v,212,164
s_add_u32 s51, s77, 109568
mm a,168,v,36,v,208,168
buffer_load_dwordx4 v252, s[96:99], s51 offen offset:3072 lds
mm a,168,v,44,v,212,168
s_add_u32 m0, s78, 52736
s_add_u32 s51, s77, 122880
mm a,172,v,52,v,208,172
mm a,172,v,60,v,212,172
buffer_load_dwordx4 v252, s[96:99], s51 offen lds
mm v,148,a,216,v,96,180
v_exp_f32 v140, v140
mm v,148,a,220,v,104,148
tr 208,240,0
mm v,148,a,224,v,112,148
buffer_load_dwordx4 a[204:207], v253, s[60:63], s101 offen offset:1024 sc1
v_exp_f32 v141, v141
mm v,148,a,228,v,120,148
tr 210,240,6144
s_add_u32 s51, s77, 132096
mm v,148,a,232,v,128,148
v_exp_f32 v142, v142
mm v,148,a,236,v,136,148
tr 212,240,12288
v_cvt_pk_bf16_f32 v94, v140, v141
mm a,176,v,4,v,216,176
v_exp_f32 v143, v143
mm a,176,v,12,v,220,176
tr 214,240,18432
v_cvt_pk_bf16_f32 v95, v142, v143
mm a,180,v,20,v,216,180
buffer_load_dwordx4 v252, s[96:99], s51 offen offset:1024 lds
mm a,180,v,28,v,220,180
s_add_u32 s101, s76, 12288
mm a,184,v,36,v,216,184
buffer_load_dwordx4 a[208:211], v253, s[60:63], s101 offen sc1
mm a,184,v,44,v,220,184
s_add_u32 s51, s77, 141312
mm a,188,v,52,v,216,188
buffer_load_dwordx4 v252, s[96:99], s51 offen offset:2048 lds
mm a,188,v,60,v,220,188
mm v,156,a,216,v,144,188
v_exp_f32 v148, v148
mm v,156,a,220,v,152,156
buffer_load_dwordx4 a[212:215], v253, s[60:63], s101 offen offset:1024 sc1
mm v,156,a,224,v,160,156
s_add_u32 s51, s77, 150528
v_exp_f32 v149, v149
mm v,156,a,228,v,168,156
buffer_load_dwordx4 v252, s[96:99], s51 offen offset:3072 lds
mm v,156,a,232,v,176,156
v_exp_f32 v150, v150
mm v,156,a,236,v,184,156
v_cvt_pk_bf16_f32 v110, v148, v149
mm a,252,v,232,v,52,252
v_exp_f32 v151, v151
mm a,252,v,232,v,60,252
s_waitcnt lgkmcnt(10)
v_cvt_pk_bf16_f32 v111, v150, v151
mm a,0,v,68,v,192,0
s_waitcnt lgkmcnt(8)
mm a,0,v,76,v,196,0
buffer_load_dwordx4 v[36:39], v253, s[60:63], 0 offen sc1
mm a,4,v,84,v,192,4
v_exp_f32 v156, v156
v_exp_f32 v157, v157
mm a,4,v,92,v,196,4
v_exp_f32 v158, v158
v_exp_f32 v159, v159
mm a,8,v,100,v,192,8
s_waitcnt lgkmcnt(4)
v_cvt_pk_bf16_f32 v126, v156, v157
v_cvt_pk_bf16_f32 v127, v158, v159
mm a,8,v,108,v,196,8
s_nop 0
buffer_load_dwordx4 v[44:47], v253, s[60:63], 0 offen offset:1024 sc1
mm a,12,v,116,v,192,12
tr 216,241,0
v_bfe_u32 v134, v253, 4, 4
mm a,12,v,124,v,196,12
tr 218,241,6144
v_lshrrev_b32 v135, 8, v253
mm a,240,v,232,v,68,240
mm a,240,v,232,v,76,240
mm a,244,v,232,v,84,244
mm a,244,v,232,v,92,244
mm a,248,v,232,v,100,248
mm a,248,v,232,v,108,248
mm a,252,v,232,v,116,252
mm a,252,v,232,v,124,252
mm a,16,v,68,v,200,16
tr 220,241,12288
v_lshlrev_b32 v135, 2, v135
mm a,16,v,76,v,204,16
tr 222,241,18432
mm a,20,v,84,v,200,20
tr 192,238,128
v_sub_u32 v134, v134, v135
mm a,20,v,92,v,204,20
tr 194,238,6272
v_min_u32 v134, 4, v134
mm a,24,v,100,v,200,24
tr 196,238,12416
v_lshlrev_b32 v134, 4, v134
mm a,24,v,108,v,204,24
tr 198,238,18560
s_waitcnt lgkmcnt(8)
mm a,28,v,116,v,200,28
buffer_load_dwordx4 v[52:55], v253, s[96:99], 0 offen
v_mov_b32 v140, 0x3f80
v_mov_b32 v141, 0
mm a,28,v,124,v,204,28
buffer_load_dwordx4 v[60:63], v253, s[96:99], 0 offen offset:1024
v_lshlrev_b64 v[132:133], v134, v[140:141]
v_cmp_gt_u32 vcc, 64, v134
mm a,32,v,68,v,208,32
tr 200,239,128
v_accvgpr_read_b32 v232, a240
v_mov_b32 v140, 0
mm a,32,v,76,v,212,32
tr 202,239,6272
v_accvgpr_read_b32 v233, a244
v_mov_b32 v134, 0
mm a,36,v,84,v,208,36
tr 204,239,12416
v_accvgpr_read_b32 v234, a248
v_mov_b32 v135, 0
mm a,36,v,92,v,212,36
tr 206,239,18560
v_cndmask_b32 v132, 0, v132, vcc
mm a,40,v,100,v,208,40
v_accvgpr_read_b32 v235, a252
v_add_f32 v224, v232, v233
mm a,40,v,108,v,212,40
v_add_f32 v224, v224, v234
v_add_f32 v224, v224, v235
mm a,44,v,116,v,208,44
v_cmp_ngt_f32 s[52:53], s37, v224
v_mov_b32 v143, v133
v_mov_b32 v142, v132
mm a,44,v,124,v,212,44
s_waitcnt lgkmcnt(10)
v_rcp_f32 v232, v232
mm a,48,v,68,v,216,48
tr 208,240,128
s_waitcnt lgkmcnt(9)
mm a,48,v,76,v,220,48
tr 210,240,6272
mm a,52,v,84,v,216,52
tr 212,240,12416
mm a,52,v,92,v,220,52
tr 214,240,18560
mm a,56,v,100,v,216,56
v_rcp_f32 v233, v233
mm a,56,v,108,v,220,56
v_rcp_f32 v234, v234
mm a,60,v,116,v,216,60
s_waitcnt lgkmcnt(8)
v_rcp_f32 v235, v235
mm a,60,v,124,v,220,60
s_lshl_b32 s101, s24, 8
s_add_u32 s101, s101, 161536
v_bfe_u32 v225, v253, 4, 4
mm a,64,v,68,v,192,64
tr 216,241,128
v_lshl_add_u32 v225, v225, 2, s101
mm a,64,v,76,v,196,64
tr 218,241,6272
mm a,68,v,84,v,192,68
tr 220,241,12416
mm a,68,v,92,v,196,68
tr 222,241,18560
mm a,72,v,100,v,192,72
ds_write_b32 v225, v232
mm a,72,v,108,v,196,72
ds_write_b32 v225, v233 offset:64
mm a,76,v,116,v,192,76
ds_write_b32 v225, v234 offset:128
mm a,76,v,124,v,196,76
ds_write_b32 v225, v235 offset:192
s_waitcnt lgkmcnt(14)
mm a,80,v,68,v,200,80
tr 192,238,256
s_waitcnt lgkmcnt(13)
mm a,80,v,76,v,204,80
tr 194,238,6400
mm a,84,v,84,v,200,84
tr 196,238,12544
mm a,84,v,92,v,204,84
tr 198,238,18688
s_waitcnt lgkmcnt(12)
mm a,88,v,100,v,200,88
s_cmp_lg_u64 s[52:53], 0
s_cselect_b32 s52, 1, 0
s_lshl_b32 s101, s24, 2
mm a,88,v,108,v,204,88
s_add_u32 s101, s101, 161280
v_mov_b32 v224, s52
v_mov_b32 v225, s101
mm a,92,v,116,v,200,92
ds_write_b32 v225, v224
v_mov_b32 v254, 161280
mm a,92,v,124,v,204,92
s_add_u32 s101, s76, 18432
buffer_load_dwordx4 a[216:219], v253, s[60:63], s101 offen sc1
ds_read_b128 v[232:235], v246
v_accvgpr_read_b32 v4, a0
v_accvgpr_read_b32 v5, a1
mm a,96,v,68,v,208,96
tr 200,239,256
v_accvgpr_read_b32 v6, a2
v_accvgpr_read_b32 v7, a3
v_accvgpr_read_b32 v12, a16
v_accvgpr_read_b32 v13, a17
mm a,96,v,76,v,212,96
tr 202,239,6400
v_accvgpr_read_b32 v14, a18
v_accvgpr_read_b32 v15, a19
mm a,100,v,84,v,208,100
tr 204,239,12544
s_waitcnt lgkmcnt(3)
v_mul_f32_e64 v148, -v248, v232
v_mul_f32_e64 v149, -v248, v233
v_mul_f32_e64 v150, -v248, v234
v_mul_f32_e64 v151, -v248, v235
mm a,100,v,92,v,212,100
tr 206,239,18688
v_fma_f32 v4, v4, v232, v148
v_fma_f32 v5, v5, v233, v149
v_fma_f32 v6, v6, v234, v150
mm a,104,v,100,v,208,104
buffer_load_dwordx4 a[220:223], v253, s[60:63], s101 offen offset:1024 sc1
v_fma_f32 v7, v7, v235, v151
v_fma_f32 v12, v12, v232, v148
v_fma_f32 v13, v13, v233, v149
v_fma_f32 v14, v14, v234, v150
mm a,104,v,108,v,212,104
s_add_u32 s101, s76, 24576
v_fma_f32 v15, v15, v235, v151
v_cvt_pk_bf16_f32 v4, v4, v5
v_cvt_pk_bf16_f32 v5, v6, v7
mm a,108,v,116,v,208,108
buffer_load_dwordx4 a[224:227], v253, s[60:63], s101 offen sc1
v_cvt_pk_bf16_f32 v6, v12, v13
v_cvt_pk_bf16_f32 v7, v14, v15
mm a,108,v,124,v,212,108
mm a,112,v,68,v,216,112
tr 208,240,256
mm a,112,v,76,v,220,112
tr 210,240,6400
mz v,20,v,4,v,132
mz v,28,v,4,v,140
mm a,116,v,84,v,216,116
tr 212,240,12544
ds_read_b128 v[232:235], v246 offset:64
v_accvgpr_read_b32 v4, a4
v_accvgpr_read_b32 v5, a5
v_accvgpr_read_b32 v6, a6
v_accvgpr_read_b32 v7, a7
v_accvgpr_read_b32 v12, a20
v_accvgpr_read_b32 v13, a21
v_accvgpr_read_b32 v14, a22
v_accvgpr_read_b32 v15, a23
v_cvt_pk_bf16_f32 v20, v20, v21
v_cvt_pk_bf16_f32 v21, v22, v23
v_cvt_pk_bf16_f32 v22, v28, v29
v_cvt_pk_bf16_f32 v23, v30, v31
mm a,116,v,92,v,220,116
tr 214,240,18688
s_add_u32 s50, s46, 0
buffer_store_dwordx4 v[20:23], v253, s[20:23], s50 offen
s_waitcnt lgkmcnt(1)
v_mul_f32_e64 v148, -v248, v232
v_mul_f32_e64 v149, -v248, v233
mm a,120,v,100,v,216,120
buffer_load_dwordx4 a[228:231], v253, s[60:63], s101 offen offset:1024 sc1
v_mul_f32_e64 v150, -v248, v234
v_mul_f32_e64 v151, -v248, v235
v_fma_f32 v4, v4, v232, v148
v_fma_f32 v5, v5, v233, v149
mm a,120,v,108,v,220,120
s_add_u32 s101, s76, 2048
v_fma_f32 v6, v6, v234, v150
v_fma_f32 v7, v7, v235, v151
v_fma_f32 v12, v12, v232, v148
mm a,124,v,116,v,216,124
buffer_load_dwordx4 a[232:235], v253, s[60:63], s101 offen sc1
v_fma_f32 v13, v13, v233, v149
v_fma_f32 v14, v14, v234, v150
v_fma_f32 v15, v15, v235, v151
v_cvt_pk_bf16_f32 v4, v4, v5
mm a,124,v,124,v,220,124
s_lshl_b32 s42, s24, 30
s_and_b32 s42, s42, 0x80000000
s_waitcnt vmcnt(9)
v_cvt_pk_bf16_f32 v5, v6, v7
v_cvt_pk_bf16_f32 v6, v12, v13
v_cvt_pk_bf16_f32 v7, v14, v15
mm a,128,v,68,v,192,128
tr 216,241,256
buffer_load_dwordx4 a[236:239], v253, s[60:63], s101 offen offset:1024 sc1
mm a,128,v,76,v,196,128
tr 218,241,6400
s_add_u32 s101, s76, 8192
mz v,20,v,4,v,132
mz v,28,v,4,v,140
mm a,132,v,84,v,192,132
tr 220,241,12544
ds_read_b128 v[232:235], v246 offset:128
v_max3_f32 v157, |v36|, |v37|, |v38|
v_accvgpr_read_b32 v4, a8
v_accvgpr_read_b32 v5, a9
v_accvgpr_read_b32 v6, a10
v_accvgpr_read_b32 v7, a11
v_accvgpr_read_b32 v12, a24
v_accvgpr_read_b32 v13, a25
v_accvgpr_read_b32 v14, a26
v_accvgpr_read_b32 v15, a27
v_cvt_pk_bf16_f32 v20, v20, v21
mm a,132,v,92,v,196,132
tr 222,241,18688
v_cvt_pk_bf16_f32 v21, v22, v23
v_cvt_pk_bf16_f32 v22, v28, v29
v_cvt_pk_bf16_f32 v23, v30, v31
mm a,136,v,100,v,192,136
buffer_load_dwordx4 a[240:243], v253, s[60:63], s101 offen sc1
s_add_u32 s50, s46, 6144
buffer_store_dwordx4 v[20:23], v253, s[20:23], s50 offen
s_waitcnt lgkmcnt(1)
v_mul_f32_e64 v148, -v248, v232
mm a,136,v,108,v,196,136
s_waitcnt vmcnt(11)
v_max3_f32 v157, v157, |v39|, |v44|
v_max3_f32 v157, v157, |v45|, |v46|
v_mul_f32_e64 v149, -v248, v233
v_mul_f32_e64 v150, -v248, v234
v_mul_f32_e64 v151, -v248, v235
mm a,140,v,116,v,192,140
s_waitcnt vmcnt(9)
v_max3_f32 v157, v157, |v47|, |v47|
v_max3_f32 v156, |v52|, |v53|, |v54|
v_fma_f32 v4, v4, v232, v148
v_fma_f32 v5, v5, v233, v149
v_fma_f32 v6, v6, v234, v150
v_fma_f32 v7, v7, v235, v151
mm a,140,v,124,v,196,140
buffer_load_dwordx4 a[244:247], v253, s[60:63], s101 offen offset:1024 sc1
v_fma_f32 v12, v12, v232, v148
v_fma_f32 v13, v13, v233, v149
v_fma_f32 v14, v14, v234, v150
mm a,144,v,68,v,200,144
L_pg48:
s_cbranch_execz L_ir44
s_add_u32 s101, s76, 14336
v_max3_f32 v156, v156, |v55|, |v60|
v_max3_f32 v156, v156, |v61|, |v62|
v_fma_f32 v15, v15, v235, v151
v_cvt_pk_bf16_f32 v4, v4, v5
v_cvt_pk_bf16_f32 v5, v6, v7
v_cvt_pk_bf16_f32 v6, v12, v13
mm a,144,v,76,v,204,144
v_max3_f32 v156, v156, |v63|, |v63|
v_mul_f32 v156, v156, v157
v_cvt_pk_bf16_f32 v7, v14, v15
mm a,148,v,84,v,200,148
v_and_b32 v156, 0x7f800000, v156
v_mul_f32 v156, 0x43c00000, v156
mm a,148,v,92,v,204,148
buffer_load_dwordx4 a[248:251], v253, s[60:63], s101 offen sc1
mz v,20,v,4,v,132
mz v,28,v,4,v,140
mm a,152,v,100,v,200,152
ds_read_b128 v[232:235], v246 offset:192
v_min_f32 v156, 0x71800000, v156
v_accvgpr_read_b32 v4, a12
v_accvgpr_read_b32 v5, a13
v_accvgpr_read_b32 v6, a14
v_accvgpr_read_b32 v7, a15
v_accvgpr_read_b32 v12, a28
v_accvgpr_read_b32 v13, a29
v_accvgpr_read_b32 v14, a30
v_accvgpr_read_b32 v15, a31
v_cvt_pk_bf16_f32 v20, v20, v21
v_cvt_pk_bf16_f32 v21, v22, v23
v_cvt_pk_bf16_f32 v22, v28, v29
mm a,152,v,108,v,204,152
s_nop 0
v_readlane_b32 s57, v156, 0
v_readlane_b32 s58, v156, 21
v_readlane_b32 s59, v156, 42
s_nop 3
s_min_u32 s57, s57, s58
s_min_u32 s57, s57, s59
v_mov_b32 v156, s57
v_cvt_pk_bf16_f32 v23, v30, v31
mm a,156,v,116,v,200,156
buffer_load_dwordx4 a[252:255], v253, s[60:63], s101 offen offset:1024 sc1
s_add_u32 s50, s46, 12288
buffer_store_dwordx4 v[20:23], v253, s[20:23], s50 offen
s_waitcnt lgkmcnt(0)
v_mul_f32_e64 v148, -v248, v232
v_mul_f32_e64 v149, -v248, v233
v_mul_f32_e64 v150, -v248, v234
mm a,156,v,124,v,204,156
s_add_u32 s101, s76, 20480
v_xor_b32 v156, s42, v156
v_mov_b32 v157, v156
v_mul_f32_e64 v151, -v248, v235
v_fma_f32 v4, v4, v232, v148
v_fma_f32 v5, v5, v233, v149
mm a,160,v,68,v,208,160
s_waitcnt lgkmcnt(0)
v_mov_b32 v158, v156
v_mov_b32 v159, v156
v_fma_f32 v6, v6, v234, v150
v_fma_f32 v7, v7, v235, v151
v_fma_f32 v12, v12, v232, v148
v_fma_f32 v13, v13, v233, v149
mm a,160,v,76,v,212,160
s_barrier
v_fma_f32 v14, v14, v234, v150
v_fma_f32 v15, v15, v235, v151
v_cvt_pk_bf16_f32 v4, v4, v5
mm a,164,v,84,v,208,164
buffer_load_dwordx4 v[164:167], v253, s[60:63], s101 offen sc1
v_cvt_pk_bf16_f32 v5, v6, v7
v_cvt_pk_bf16_f32 v6, v12, v13
v_cvt_pk_bf16_f32 v7, v14, v15
mm a,164,v,92,v,212,164
ds_read_b128 v[228:231], v254
mz v,20,v,4,v,132
mz v,28,v,4,v,140
mm a,168,v,100,v,208,168
tr 192,249,23808
mm a,168,v,108,v,212,168
buffer_load_dwordx4 v[172:175], v253, s[60:63], s101 offen offset:1024 sc1
mm a,172,v,116,v,208,172
s_add_u32 s101, s76, 26624
tr 194,249,25856
mm a,172,v,124,v,212,172
tr 196,249,27904
mm a,176,v,68,v,216,176
tr 198,249,29952
v_accvgpr_write_b32 a24, v140
mm a,176,v,76,v,220,176
buffer_load_dwordx4 v[180:183], v253, s[60:63], s101 offen sc1
v_accvgpr_write_b32 a25, v141
mm a,180,v,84,v,216,180
tr 200,250,23808
v_cvt_pk_bf16_f32 v20, v20, v21
v_accvgpr_write_b32 a26, v142
s_waitcnt lgkmcnt(5)
v_or3_b32 v228, v228, v229, v230
v_or_b32 v228, v228, v231
mm a,180,v,92,v,220,180
tr 202,250,25856
v_cvt_pk_bf16_f32 v21, v22, v23
v_accvgpr_write_b32 a27, v143
v_readfirstlane_b32 s52, v228
mm a,184,v,100,v,216,184
buffer_load_dwordx4 v[188:191], v253, s[60:63], s101 offen offset:1024 sc1
mm a,184,v,108,v,220,184
tr 204,250,27904
v_cvt_pk_bf16_f32 v22, v28, v29
v_cvt_pk_bf16_f32 v23, v30, v31
mm a,188,v,116,v,216,188
tr 206,250,29952
s_add_u32 s50, s46, 18432
buffer_store_dwordx4 v[20:23], v253, s[20:23], s50 offen
mm a,188,v,124,v,220,188
v_accvgpr_write_b32 a28, 0
v_accvgpr_write_b32 a29, 0
s_and_b32 s53, s52, 1
s_andn2_b32 s53, s53, s87
s_cbranch_scc1 L_slow_4
s_mov_b32 s87, 0
s_cmp_lg_u32 s88, 0
s_cbranch_scc1 L_idle_4
s_waitcnt lgkmcnt(4)
mm v,0,a,192,v,192,156
tr 208,251,23808
s_add_u32 s101, s76, 4096
s_lshr_b32 s27, s52, 1
mm v,0,a,196,v,196,0
tr 210,251,25856
s_sub_u32 s27, 4, s27
mm v,4,a,200,v,192,156
buffer_load_dwordx4 v[160:163], v253, s[60:63], s101 offen sc1
mm v,4,a,204,v,196,4
s_add_u32 m0, s78, 0
s_add_u32 s51, s77, 163840
s_waitcnt vmcnt(18)
mm v,8,a,208,v,192,156
buffer_load_dwordx4 v252, s[96:99], s51 offen lds
v_accvgpr_read_b32 v216, a44
v_accvgpr_read_b32 v217, a45
mm v,8,a,212,v,196,8
tr 212,251,27904
v_accvgpr_read_b32 v218, a46
v_accvgpr_read_b32 v219, a47
mm v,12,a,216,v,192,156
tr 214,251,29952
s_waitcnt vmcnt(18)
v_accvgpr_read_b32 v220, a60
v_accvgpr_read_b32 v221, a61
v_accvgpr_read_b32 v222, a62
mm v,12,a,220,v,196,12
s_waitcnt vmcnt(15) lgkmcnt(4)
v_accvgpr_read_b32 v223, a63
v_mul_f32_e64 v236, -v248, v232
v_mul_f32_e64 v237, -v248, v233
mm v,16,a,224,v,192,156
buffer_load_dwordx4 v[168:171], v253, s[60:63], s101 offen offset:1024 sc1
v_mul_f32_e64 v238, -v248, v234
v_mul_f32_e64 v239, -v248, v235
mm v,16,a,228,v,196,16
s_add_u32 s51, s77, 173056
v_fma_f32 v216, v216, v232, v236
v_fma_f32 v217, v217, v233, v237
mm v,20,a,192,v,200,156
tr 192,242,23808
v_fma_f32 v218, v218, v234, v238
v_fma_f32 v219, v219, v235, v239
v_fma_f32 v220, v220, v232, v236
mm v,20,a,196,v,204,20
tr 194,242,25856
v_fma_f32 v221, v221, v233, v237
v_fma_f32 v222, v222, v234, v238
mm v,24,a,200,v,200,156
v_fma_f32 v223, v223, v235, v239
v_cvt_pk_bf16_f32 v216, v216, v217
v_cvt_pk_bf16_f32 v217, v218, v219
mm v,24,a,204,v,204,24
buffer_load_dwordx4 v252, s[96:99], s51 offen offset:1024 lds
v_cvt_pk_bf16_f32 v218, v220, v221
v_cvt_pk_bf16_f32 v219, v222, v223
mm v,28,a,208,v,200,156
s_add_u32 s101, s76, 10240
mm v,28,a,212,v,204,28
tr 196,242,27904
mz v,224,v,216,a,26
mz v,228,v,216,a,24
v_accvgpr_read_b32 v216, a76
v_accvgpr_read_b32 v217, a77
v_accvgpr_read_b32 v218, a78
v_accvgpr_read_b32 v219, a79
mm v,32,a,216,v,200,156
tr 198,242,29952
s_waitcnt lgkmcnt(4)
v_accvgpr_read_b32 v220, a92
v_accvgpr_read_b32 v221, a93
v_accvgpr_read_b32 v222, a94
mm v,32,a,220,v,204,32
buffer_load_dwordx4 v[176:179], v253, s[60:63], s101 offen sc1
v_accvgpr_read_b32 v223, a95
v_cvt_pk_bf16_f32 v224, v224, v225
mm v,36,a,224,v,200,156
s_add_u32 s51, s77, 182272
v_cvt_pk_bf16_f32 v225, v226, v227
v_cvt_pk_bf16_f32 v226, v228, v229
v_cvt_pk_bf16_f32 v227, v230, v231
mm v,36,a,228,v,204,36
s_add_u32 s50, s46, 18432
buffer_store_dwordx4 v[224:227], v253, s[20:23], s50 offen offset:1024
mm v,40,a,192,v,208,156
tr 200,249,32000
v_fma_f32 v216, v216, v232, v236
v_fma_f32 v217, v217, v233, v237
v_fma_f32 v218, v218, v234, v238
mm v,40,a,196,v,212,40
tr 202,249,34048
v_fma_f32 v219, v219, v235, v239
v_fma_f32 v220, v220, v232, v236
mm v,44,a,200,v,208,156
buffer_load_dwordx4 v252, s[96:99], s51 offen offset:2048 lds
v_fma_f32 v221, v221, v233, v237
v_fma_f32 v222, v222, v234, v238
mm v,44,a,204,v,212,44
v_fma_f32 v223, v223, v235, v239
v_cvt_pk_bf16_f32 v216, v216, v217
v_cvt_pk_bf16_f32 v217, v218, v219
mm v,48,a,208,v,208,156
v_cvt_pk_bf16_f32 v218, v220, v221
v_cvt_pk_bf16_f32 v219, v222, v223
mm v,48,a,212,v,212,48
tr 204,249,36096
mz v,224,v,216,a,26
mz v,228,v,216,a,24
v_accvgpr_read_b32 v216, a108
v_accvgpr_read_b32 v217, a109
mm v,52,a,216,v,208,156
tr 206,249,38144
v_accvgpr_read_b32 v218, a110
v_accvgpr_read_b32 v219, a111
mm v,52,a,220,v,212,52
buffer_load_dwordx4 v[184:187], v253, s[60:63], s101 offen offset:1024 sc1
v_accvgpr_read_b32 v220, a124
v_accvgpr_read_b32 v221, a125
v_accvgpr_read_b32 v222, a126
mm v,56,a,224,v,208,156
s_add_u32 s51, s77, 191488
v_accvgpr_read_b32 v223, a127
v_cvt_pk_bf16_f32 v224, v224, v225
mm v,56,a,228,v,212,56
s_waitcnt lgkmcnt(4)
v_cvt_pk_bf16_f32 v225, v226, v227
v_cvt_pk_bf16_f32 v226, v228, v229
v_cvt_pk_bf16_f32 v227, v230, v231
mm v,60,a,192,v,192,156
tr 208,250,32000
s_add_u32 s50, s46, 18432
buffer_store_dwordx4 v[224:227], v253, s[20:23], s50 offen offset:2048
mm v,60,a,196,v,196,60
tr 210,250,34048
v_fma_f32 v216, v216, v232, v236
v_fma_f32 v217, v217, v233, v237
v_fma_f32 v218, v218, v234, v238
mm v,64,a,200,v,192,156
buffer_load_dwordx4 v252, s[96:99], s51 offen offset:3072 lds
v_fma_f32 v219, v219, v235, v239
v_fma_f32 v220, v220, v232, v236
mm v,64,a,204,v,196,64
s_add_u32 s101, s76, 16384
v_fma_f32 v221, v221, v233, v237
v_fma_f32 v222, v222, v234, v238
v_fma_f32 v223, v223, v235, v239
mm v,68,a,208,v,192,156
v_cvt_pk_bf16_f32 v216, v216, v217
v_cvt_pk_bf16_f32 v217, v218, v219
mm v,68,a,212,v,196,68
tr 212,250,36096
v_cvt_pk_bf16_f32 v218, v220, v221
v_cvt_pk_bf16_f32 v219, v222, v223
mm v,72,a,216,v,192,156
tr 214,250,38144
mm v,72,a,220,v,196,72
buffer_load_dwordx4 a[0:3], v253, s[60:63], s101 offen sc1
mz v,224,v,216,a,26
mz v,228,v,216,a,24
v_accvgpr_read_b32 v216, a140
v_accvgpr_read_b32 v217, a141
v_accvgpr_read_b32 v218, a142
v_accvgpr_read_b32 v219, a143
v_accvgpr_read_b32 v220, a156
mm v,76,a,224,v,192,156
s_waitcnt lgkmcnt(4)
v_accvgpr_read_b32 v221, a157
v_accvgpr_read_b32 v222, a158
v_accvgpr_read_b32 v223, a159
mm v,76,a,228,v,196,76
buffer_load_dwordx4 a[4:7], v253, s[60:63], s101 offen offset:1024 sc1
v_cvt_pk_bf16_f32 v224, v224, v225
mm v,80,a,192,v,200,156
tr 192,251,32000
s_add_u32 m0, s78, 4096
v_cvt_pk_bf16_f32 v225, v226, v227
v_cvt_pk_bf16_f32 v226, v228, v229
v_cvt_pk_bf16_f32 v227, v230, v231
mm v,80,a,196,v,204,80
tr 194,251,34048
s_add_u32 s51, s77, 204800
s_add_u32 s50, s46, 18432
buffer_store_dwordx4 v[224:227], v253, s[20:23], s50 offen offset:3072
mm v,84,a,200,v,200,156
v_fma_f32 v216, v216, v232, v236
v_fma_f32 v217, v217, v233, v237
v_fma_f32 v218, v218, v234, v238
mm v,84,a,204,v,204,84
buffer_load_dwordx4 v252, s[96:99], s51 offen lds
v_fma_f32 v219, v219, v235, v239
v_fma_f32 v220, v220, v232, v236
mm v,88,a,208,v,200,156
s_add_u32 s101, s76, 22528
v_fma_f32 v221, v221, v233, v237
v_fma_f32 v222, v222, v234, v238
v_fma_f32 v223, v223, v235, v239
mm v,88,a,212,v,204,88
tr 196,251,36096
v_cvt_pk_bf16_f32 v216, v216, v217
v_cvt_pk_bf16_f32 v217, v218, v219
mm v,92,a,216,v,200,156
tr 198,251,38144
v_cvt_pk_bf16_f32 v218, v220, v221
v_cvt_pk_bf16_f32 v219, v222, v223
mm v,92,a,220,v,204,92
s_waitcnt lgkmcnt(4)
mm v,96,a,224,v,200,156
buffer_load_dwordx4 a[8:11], v253, s[60:63], s101 offen sc1
mm v,96,a,228,v,204,96
s_add_u32 s51, s77, 214016
mz v,224,v,216,a,26
mz v,228,v,216,a,24
v_accvgpr_read_b32 v216, a172
v_accvgpr_read_b32 v217, a173
v_accvgpr_read_b32 v218, a174
v_accvgpr_read_b32 v219, a175
v_accvgpr_read_b32 v220, a188
v_accvgpr_read_b32 v221, a189
v_accvgpr_read_b32 v222, a190
mm v,100,a,192,v,208,156
tr 200,242,32000
v_accvgpr_read_b32 v223, a191
v_cvt_pk_bf16_f32 v224, v224, v225
v_cvt_pk_bf16_f32 v225, v226, v227
mm v,100,a,196,v,212,100
tr 202,242,34048
v_cvt_pk_bf16_f32 v226, v228, v229
v_cvt_pk_bf16_f32 v227, v230, v231
mm v,104,a,200,v,208,156
buffer_load_dwordx4 v252, s[96:99], s51 offen offset:1024 lds
s_add_u32 s50, s46, 22528
buffer_store_dwordx4 v[224:227], v253, s[20:23], s50 offen
v_fma_f32 v216, v216, v232, v236
mm v,104,a,204,v,212,104
tr 204,242,36096
v_fma_f32 v217, v217, v233, v237
v_fma_f32 v218, v218, v234, v238
mm v,108,a,208,v,208,156
tr 206,242,38144
v_fma_f32 v219, v219, v235, v239
v_fma_f32 v220, v220, v232, v236
v_fma_f32 v221, v221, v233, v237
mm v,108,a,212,v,212,108
v_fma_f32 v222, v222, v234, v238
v_fma_f32 v223, v223, v235, v239
mm v,112,a,216,v,208,156
v_cvt_pk_bf16_f32 v216, v216, v217
v_cvt_pk_bf16_f32 v217, v218, v219
v_cvt_pk_bf16_f32 v218, v220, v221
mm v,112,a,220,v,212,112
buffer_load_dwordx4 a[12:15], v253, s[60:63], s101 offen offset:1024 sc1
v_cvt_pk_bf16_f32 v219, v222, v223
mm v,116,a,224,v,208,156
s_add_u32 s51, s77, 223232
s_waitcnt lgkmcnt(6)
mm v,116,a,228,v,212,116
mz v,224,v,216,a,26
mz v,228,v,216,a,24
mm v,120,a,192,v,192,156
s_waitcnt lgkmcnt(0)
s_barrier
ds_read_b128 v[232:235], v246 offset:128
v_accvgpr_read_b32 v216, a40
v_accvgpr_read_b32 v217, a41
v_accvgpr_read_b32 v218, a42
v_accvgpr_read_b32 v219, a43
v_accvgpr_read_b32 v220, a56
v_accvgpr_read_b32 v221, a57
mm v,120,a,196,v,196,120
tr 208,249,48640
v_accvgpr_read_b32 v222, a58
v_accvgpr_read_b32 v223, a59
v_cvt_pk_bf16_f32 v224, v224, v225
mm v,124,a,200,v,192,156
buffer_load_dwordx4 v252, s[96:99], s51 offen offset:2048 lds
v_cvt_pk_bf16_f32 v225, v226, v227
v_cvt_pk_bf16_f32 v226, v228, v229
mm v,124,a,204,v,196,124
tr 210,249,50688
s_add_u32 s101, s76, 28672
v_cvt_pk_bf16_f32 v227, v230, v231
mm v,128,a,208,v,192,156
s_add_u32 s50, s46, 22528
buffer_store_dwordx4 v[224:227], v253, s[20:23], s50 offen offset:1024
s_waitcnt lgkmcnt(2)
v_mul_f32_e64 v236, -v248, v232
mm v,128,a,212,v,196,128
tr 212,249,52736
v_mul_f32_e64 v237, -v248, v233
v_mul_f32_e64 v238, -v248, v234
v_mul_f32_e64 v239, -v248, v235
mm v,132,a,216,v,192,156
tr 214,249,54784
v_fma_f32 v216, v216, v232, v236
v_fma_f32 v217, v217, v233, v237
mm v,132,a,220,v,196,132
buffer_load_dwordx4 a[16:19], v253, s[60:63], s101 offen sc1
v_fma_f32 v218, v218, v234, v238
v_fma_f32 v219, v219, v235, v239
v_fma_f32 v220, v220, v232, v236
mm v,136,a,224,v,192,156
s_add_u32 s51, s77, 232448
v_fma_f32 v221, v221, v233, v237
v_fma_f32 v222, v222, v234, v238
mm v,136,a,228,v,196,136
v_fma_f32 v223, v223, v235, v239
v_cvt_pk_bf16_f32 v216, v216, v217
v_cvt_pk_bf16_f32 v217, v218, v219
mm v,140,a,192,v,200,156
tr 192,250,48640
v_cvt_pk_bf16_f32 v218, v220, v221
v_cvt_pk_bf16_f32 v219, v222, v223
mm v,140,a,196,v,204,140
tr 194,250,50688
mz v,224,v,216,a,26
mz v,228,v,216,a,24
v_accvgpr_read_b32 v216, a72
v_accvgpr_read_b32 v217, a73
mm v,144,a,200,v,200,156
buffer_load_dwordx4 v252, s[96:99], s51 offen offset:3072 lds
v_accvgpr_read_b32 v218, a74
v_accvgpr_read_b32 v219, a75
mm v,144,a,204,v,204,144
v_accvgpr_read_b32 v220, a88
v_accvgpr_read_b32 v221, a89
v_accvgpr_read_b32 v222, a90
mm v,148,a,208,v,200,156
buffer_load_dwordx4 a[20:23], v253, s[60:63], s101 offen offset:1024 sc1
v_accvgpr_read_b32 v223, a91
v_cvt_pk_bf16_f32 v224, v224, v225
mm v,148,a,212,v,204,148
tr 196,250,52736
v_cvt_pk_bf16_f32 v225, v226, v227
v_cvt_pk_bf16_f32 v226, v228, v229
mm v,152,a,216,v,200,156
tr 198,250,54784
v_cvt_pk_bf16_f32 v227, v230, v231
mm v,152,a,220,v,204,152
s_add_u32 s50, s46, 12288
buffer_store_dwordx4 v[224:227], v253, s[20:23], s50 offen offset:1024
v_fma_f32 v216, v216, v232, v236
v_fma_f32 v217, v217, v233, v237
mm v,156,a,224,v,200,156
v_fma_f32 v218, v218, v234, v238
v_fma_f32 v219, v219, v235, v239
v_fma_f32 v220, v220, v232, v236
mm v,156,a,228,v,204,156
s_waitcnt vmcnt(28) lgkmcnt(4)
v_fma_f32 v221, v221, v233, v237
v_fma_f32 v222, v222, v234, v238
v_fma_f32 v223, v223, v235, v239
mm v,0,a,232,v,208,0
tr 200,251,48640
s_add_u32 s101, s76, 92160
v_cvt_pk_bf16_f32 v216, v216, v217
v_cvt_pk_bf16_f32 v217, v218, v219
mm v,0,a,236,v,212,0
tr 202,251,50688
v_cvt_pk_bf16_f32 v218, v220, v221
v_cvt_pk_bf16_f32 v219, v222, v223
mm v,4,a,240,v,208,4
buffer_load_dwordx4 a[192:195], v253, s[60:63], s101 offen sc1
mm v,4,a,244,v,212,4
s_add_u32 m0, s78, 23808
s_add_u32 s51, s77, 245760
mz v,224,v,216,a,26
mz v,228,v,216,a,24
v_accvgpr_read_b32 v216, a104
v_accvgpr_read_b32 v217, a105
v_accvgpr_read_b32 v218, a106
v_accvgpr_read_b32 v219, a107
mm v,8,a,248,v,208,8
buffer_load_dwordx4 v252, s[96:99], s51 offen lds
v_accvgpr_read_b32 v220, a120
v_accvgpr_read_b32 v221, a121
v_accvgpr_read_b32 v222, a122
mm v,8,a,252,v,212,8
tr 204,251,52736
v_accvgpr_read_b32 v223, a123
v_cvt_pk_bf16_f32 v224, v224, v225
mm v,12,v,164,v,208,12
tr 206,251,54784
s_waitcnt vmcnt(27) lgkmcnt(4)
v_cvt_pk_bf16_f32 v225, v226, v227
v_cvt_pk_bf16_f32 v226, v228, v229
v_cvt_pk_bf16_f32 v227, v230, v231
mm v,12,v,172,v,212,12
s_add_u32 s50, s46, 12288
buffer_store_dwordx4 v[224:227], v253, s[20:23], s50 offen offset:2048
mm v,16,v,180,v,208,16
buffer_load_dwordx4 a[196:199], v253, s[60:63], s101 offen offset:1024 sc1
v_fma_f32 v216, v216, v232, v236
v_fma_f32 v217, v217, v233, v237
v_fma_f32 v218, v218, v234, v238
mm v,16,v,188,v,212,16
s_add_u32 s51, s77, 254976
v_fma_f32 v219, v219, v235, v239
v_fma_f32 v220, v220, v232, v236
mm v,20,a,232,v,192,20
tr 208,242,48640
v_fma_f32 v221, v221, v233, v237
v_fma_f32 v222, v222, v234, v238
mm v,20,a,236,v,196,20
L_pg60:
s_cbranch_execz L_ir59
tr 210,242,50688
v_fma_f32 v223, v223, v235, v239
v_cvt_pk_bf16_f32 v216, v216, v217
v_cvt_pk_bf16_f32 v217, v218, v219
mm v,24,a,240,v,192,24
v_cvt_pk_bf16_f32 v218, v220, v221
v_cvt_pk_bf16_f32 v219, v222, v223
mm v,24,a,244,v,196,24
buffer_load_dwordx4 v252, s[96:99], s51 offen offset:1024 lds
mz v,224,v,216,a,26
mz v,228,v,216,a,24
v_accvgpr_read_b32 v216, a136
v_accvgpr_read_b32 v217, a137
mm v,28,a,248,v,192,28
s_add_u32 s101, s76, 98304
v_accvgpr_read_b32 v218, a138
v_accvgpr_read_b32 v219, a139
mm v,28,a,252,v,196,28
tr 212,242,52736
v_accvgpr_read_b32 v220, a152
v_accvgpr_read_b32 v221, a153
v_accvgpr_read_b32 v222, a154
mm v,32,v,164,v,192,32
tr 214,242,54784
v_accvgpr_read_b32 v223, a155
v_cvt_pk_bf16_f32 v224, v224, v225
mm v,32,v,172,v,196,32
buffer_load_dwordx4 a[200:203], v253, s[60:63], s101 offen sc1
v_cvt_pk_bf16_f32 v225, v226, v227
v_cvt_pk_bf16_f32 v226, v228, v229
v_cvt_pk_bf16_f32 v227, v230, v231
mm v,36,v,180,v,192,36
s_add_u32 s51, s77, 264192
s_add_u32 s50, s46, 12288
buffer_store_dwordx4 v[224:227], v253, s[20:23], s50 offen offset:3072
mm v,36,v,188,v,196,36
s_waitcnt lgkmcnt(4)
v_fma_f32 v216, v216, v232, v236
v_fma_f32 v217, v217, v233, v237
v_fma_f32 v218, v218, v234, v238
mm v,40,a,232,v,200,40
tr 192,249,56832
v_fma_f32 v219, v219, v235, v239
v_fma_f32 v220, v220, v232, v236
mm v,40,a,236,v,204,40
tr 194,249,58880
v_fma_f32 v221, v221, v233, v237
v_fma_f32 v222, v222, v234, v238
v_fma_f32 v223, v223, v235, v239
mm v,44,a,240,v,200,44
buffer_load_dwordx4 v252, s[96:99], s51 offen offset:2048 lds
v_cvt_pk_bf16_f32 v216, v216, v217
v_cvt_pk_bf16_f32 v217, v218, v219
mm v,44,a,244,v,204,44
v_cvt_pk_bf16_f32 v218, v220, v221
v_cvt_pk_bf16_f32 v219, v222, v223
mm v,48,a,248,v,200,48
mm v,48,a,252,v,204,48
tr 196,249,60928
mz v,224,v,216,a,26
mz v,228,v,216,a,24
v_accvgpr_read_b32 v216, a168
v_accvgpr_read_b32 v217, a169
v_accvgpr_read_b32 v218, a170
v_accvgpr_read_b32 v219, a171
v_accvgpr_read_b32 v220, a184
mm v,52,v,164,v,200,52
tr 198,249,62976
s_waitcnt lgkmcnt(4)
v_accvgpr_read_b32 v221, a185
v_accvgpr_read_b32 v222, a186
mm v,52,v,172,v,204,52
buffer_load_dwordx4 a[204:207], v253, s[60:63], s101 offen offset:1024 sc1
v_accvgpr_read_b32 v223, a187
v_cvt_pk_bf16_f32 v224, v224, v225
mm v,56,v,180,v,200,56
s_add_u32 s51, s77, 273408
v_cvt_pk_bf16_f32 v225, v226, v227
v_cvt_pk_bf16_f32 v226, v228, v229
v_cvt_pk_bf16_f32 v227, v230, v231
mm v,56,v,188,v,204,56
s_add_u32 s50, s46, 16384
buffer_store_dwordx4 v[224:227], v253, s[20:23], s50 offen
mm v,60,a,232,v,208,60
tr 200,250,56832
v_fma_f32 v216, v216, v232, v236
v_fma_f32 v217, v217, v233, v237
v_fma_f32 v218, v218, v234, v238
mm v,60,a,236,v,212,60
tr 202,250,58880
v_fma_f32 v219, v219, v235, v239
v_fma_f32 v220, v220, v232, v236
mm v,64,a,240,v,208,64
buffer_load_dwordx4 v252, s[96:99], s51 offen offset:3072 lds
v_fma_f32 v221, v221, v233, v237
v_fma_f32 v222, v222, v234, v238
v_fma_f32 v223, v223, v235, v239
mm v,64,a,244,v,212,64
s_add_u32 s101, s76, 104448
v_cvt_pk_bf16_f32 v216, v216, v217
v_cvt_pk_bf16_f32 v217, v218, v219
mm v,68,a,248,v,208,68
v_cvt_pk_bf16_f32 v218, v220, v221
v_cvt_pk_bf16_f32 v219, v222, v223
mm v,68,a,252,v,212,68
tr 204,250,60928
mz v,224,v,216,a,26
mz v,228,v,216,a,24
mm v,72,v,164,v,208,72
tr 206,250,62976
ds_read_b128 v[232:235], v246 offset:64
v_accvgpr_read_b32 v216, a36
v_accvgpr_read_b32 v217, a37
v_accvgpr_read_b32 v218, a38
v_accvgpr_read_b32 v219, a39
mm v,72,v,172,v,212,72
buffer_load_dwordx4 a[208:211], v253, s[60:63], s101 offen sc1
v_accvgpr_read_b32 v220, a52
v_accvgpr_read_b32 v221, a53
mm v,76,v,180,v,208,76
s_waitcnt lgkmcnt(5)
v_accvgpr_read_b32 v222, a54
v_accvgpr_read_b32 v223, a55
v_cvt_pk_bf16_f32 v224, v224, v225
mm v,76,v,188,v,212,76
buffer_load_dwordx4 a[212:215], v253, s[60:63], s101 offen offset:1024 sc1
v_cvt_pk_bf16_f32 v225, v226, v227
v_cvt_pk_bf16_f32 v226, v228, v229
mm v,80,a,232,v,192,80
tr 208,251,56832
s_add_u32 m0, s78, 27904
v_cvt_pk_bf16_f32 v227, v230, v231
mm v,80,a,236,v,196,80
tr 210,251,58880
s_add_u32 s51, s77, 286720
s_add_u32 s50, s46, 16384
buffer_store_dwordx4 v[224:227], v253, s[20:23], s50 offen offset:1024
s_waitcnt lgkmcnt(2)
v_mul_f32_e64 v236, -v248, v232
mm v,84,a,240,v,192,84
v_mul_f32_e64 v237, -v248, v233
v_mul_f32_e64 v238, -v248, v234
v_mul_f32_e64 v239, -v248, v235
mm v,84,a,244,v,196,84
buffer_load_dwordx4 v252, s[96:99], s51 offen lds
v_fma_f32 v216, v216, v232, v236
v_fma_f32 v217, v217, v233, v237
mm v,88,a,248,v,192,88
s_add_u32 s101, s76, 110592
v_fma_f32 v218, v218, v234, v238
v_fma_f32 v219, v219, v235, v239
v_fma_f32 v220, v220, v232, v236
mm v,88,a,252,v,196,88
tr 212,251,60928
v_fma_f32 v221, v221, v233, v237
v_fma_f32 v222, v222, v234, v238
mm v,92,v,164,v,192,92
tr 214,251,62976
v_fma_f32 v223, v223, v235, v239
v_cvt_pk_bf16_f32 v216, v216, v217
mm v,92,v,172,v,196,92
v_cvt_pk_bf16_f32 v217, v218, v219
v_cvt_pk_bf16_f32 v218, v220, v221
v_cvt_pk_bf16_f32 v219, v222, v223
mm v,96,v,180,v,192,96
buffer_load_dwordx4 a[216:219], v253, s[60:63], s101 offen sc1
mm v,96,v,188,v,196,96
s_add_u32 s51, s77, 295936
mz v,224,v,216,a,26
mz v,228,v,216,a,24
v_accvgpr_read_b32 v216, a68
v_accvgpr_read_b32 v217, a69
v_accvgpr_read_b32 v218, a70
v_accvgpr_read_b32 v219, a71
mm v,100,a,232,v,200,100
tr 192,242,56832
v_accvgpr_read_b32 v220, a84
v_accvgpr_read_b32 v221, a85
mm v,100,a,236,v,204,100
tr 194,242,58880
v_accvgpr_read_b32 v222, a86
v_accvgpr_read_b32 v223, a87
v_cvt_pk_bf16_f32 v224, v224, v225
mm v,104,a,240,v,200,104
buffer_load_dwordx4 v252, s[96:99], s51 offen offset:1024 lds
v_cvt_pk_bf16_f32 v225, v226, v227
v_cvt_pk_bf16_f32 v226, v228, v229
mm v,104,a,244,v,204,104
tr 196,242,60928
v_cvt_pk_bf16_f32 v227, v230, v231
mm v,108,a,248,v,200,108
tr 198,242,62976
s_add_u32 s50, s46, 6144
buffer_store_dwordx4 v[224:227], v253, s[20:23], s50 offen offset:1024
v_fma_f32 v216, v216, v232, v236
v_fma_f32 v217, v217, v233, v237
mm v,108,a,252,v,204,108
v_fma_f32 v218, v218, v234, v238
v_fma_f32 v219, v219, v235, v239
v_fma_f32 v220, v220, v232, v236
mm v,112,v,164,v,200,112
v_fma_f32 v221, v221, v233, v237
v_fma_f32 v222, v222, v234, v238
v_fma_f32 v223, v223, v235, v239
mm v,112,v,172,v,204,112
buffer_load_dwordx4 a[220:223], v253, s[60:63], s101 offen offset:1024 sc1
v_cvt_pk_bf16_f32 v216, v216, v217
v_cvt_pk_bf16_f32 v217, v218, v219
mm v,116,v,180,v,200,116
s_add_u32 s51, s77, 305152
v_cvt_pk_bf16_f32 v218, v220, v221
v_cvt_pk_bf16_f32 v219, v222, v223
mm v,116,v,188,v,204,116
s_waitcnt lgkmcnt(6)
mm v,120,a,232,v,208,120
s_waitcnt vmcnt(21) lgkmcnt(0)
s_barrier
mm v,120,a,236,v,212,120
tr 200,249,0
mz v,224,v,216,a,26
mz v,228,v,216,a,24
v_accvgpr_read_b32 v216, a100
v_accvgpr_read_b32 v217, a101
v_accvgpr_read_b32 v218, a102
v_accvgpr_read_b32 v219, a103
v_accvgpr_read_b32 v220, a116
v_accvgpr_read_b32 v221, a117
v_accvgpr_read_b32 v222, a118
mm v,124,a,240,v,208,124
buffer_load_dwordx4 v252, s[96:99], s51 offen offset:2048 lds
v_accvgpr_read_b32 v223, a119
v_cvt_pk_bf16_f32 v224, v224, v225
mm v,124,a,244,v,212,124
tr 202,249,2048
s_add_u32 s101, s76, 116736
v_cvt_pk_bf16_f32 v225, v226, v227
v_cvt_pk_bf16_f32 v226, v228, v229
mm v,128,a,248,v,208,128
v_cvt_pk_bf16_f32 v227, v230, v231
mm v,128,a,252,v,212,128
tr 204,249,4096
s_add_u32 s50, s46, 6144
buffer_store_dwordx4 v[224:227], v253, s[20:23], s50 offen offset:2048
v_fma_f32 v216, v216, v232, v236
v_fma_f32 v217, v217, v233, v237
mm v,132,v,164,v,208,132
tr 206,249,6144
v_fma_f32 v218, v218, v234, v238
v_fma_f32 v219, v219, v235, v239
v_fma_f32 v220, v220, v232, v236
mm v,132,v,172,v,212,132
buffer_load_dwordx4 a[224:227], v253, s[60:63], s101 offen sc1
v_fma_f32 v221, v221, v233, v237
v_fma_f32 v222, v222, v234, v238
mm v,136,v,180,v,208,136
s_add_u32 s51, s77, 314368
v_fma_f32 v223, v223, v235, v239
v_cvt_pk_bf16_f32 v216, v216, v217
v_cvt_pk_bf16_f32 v217, v218, v219
mm v,136,v,188,v,212,136
v_cvt_pk_bf16_f32 v218, v220, v221
v_cvt_pk_bf16_f32 v219, v222, v223
mm v,140,a,232,v,192,140
tr 208,250,0
mm v,140,a,236,v,196,140
tr 210,250,2048
mz v,224,v,216,a,26
mz v,228,v,216,a,24
v_accvgpr_read_b32 v216, a132
v_accvgpr_read_b32 v217, a133
v_accvgpr_read_b32 v218, a134
v_accvgpr_read_b32 v219, a135
mm v,144,a,240,v,192,144
buffer_load_dwordx4 v252, s[96:99], s51 offen offset:3072 lds
v_accvgpr_read_b32 v220, a148
v_accvgpr_read_b32 v221, a149
v_accvgpr_read_b32 v222, a150
mm v,144,a,244,v,196,144
v_accvgpr_read_b32 v223, a151
v_cvt_pk_bf16_f32 v224, v224, v225
v_cvt_pk_bf16_f32 v225, v226, v227
mm v,148,a,248,v,192,148
buffer_load_dwordx4 a[228:231], v253, s[60:63], s101 offen offset:1024 sc1
v_cvt_pk_bf16_f32 v226, v228, v229
v_cvt_pk_bf16_f32 v227, v230, v231
mm v,148,a,252,v,196,148
tr 212,250,4096
s_add_u32 s50, s46, 6144
buffer_store_dwordx4 v[224:227], v253, s[20:23], s50 offen offset:3072
mm v,152,v,164,v,192,152
tr 214,250,6144
v_fma_f32 v216, v216, v232, v236
v_fma_f32 v217, v217, v233, v237
v_fma_f32 v218, v218, v234, v238
mm v,152,v,172,v,196,152
v_fma_f32 v219, v219, v235, v239
v_fma_f32 v220, v220, v232, v236
mm v,156,v,180,v,192,156
v_fma_f32 v221, v221, v233, v237
v_fma_f32 v222, v222, v234, v238
v_fma_f32 v223, v223, v235, v239
mm v,156,v,188,v,196,156
s_waitcnt lgkmcnt(4)
v_cvt_pk_bf16_f32 v216, v216, v217
v_cvt_pk_bf16_f32 v217, v218, v219
v_cvt_pk_bf16_f32 v218, v220, v221
mm v,0,v,160,v,200,0
tr 192,251,0
s_add_u32 s101, s76, 94208
v_cvt_pk_bf16_f32 v219, v222, v223
mm v,0,v,168,v,204,0
tr 194,251,2048
mz v,224,v,216,a,26
mz v,228,v,216,a,24
v_accvgpr_read_b32 v216, a164
v_accvgpr_read_b32 v217, a165
mm v,4,v,176,v,200,4
buffer_load_dwordx4 a[232:235], v253, s[60:63], s101 offen sc1
v_accvgpr_read_b32 v218, a166
v_accvgpr_read_b32 v219, a167
mm v,4,v,184,v,204,4
s_add_u32 m0, s78, 48640
s_add_u32 s51, s77, 327680
v_accvgpr_read_b32 v220, a180
v_accvgpr_read_b32 v221, a181
v_accvgpr_read_b32 v222, a182
mm v,8,a,0,v,200,8
buffer_load_dwordx4 v252, s[96:99], s51 offen lds
v_accvgpr_read_b32 v223, a183
v_cvt_pk_bf16_f32 v224, v224, v225
mm v,8,a,4,v,204,8
tr 196,251,4096
v_cvt_pk_bf16_f32 v225, v226, v227
v_cvt_pk_bf16_f32 v226, v228, v229
v_cvt_pk_bf16_f32 v227, v230, v231
mm v,12,a,8,v,200,12
tr 198,251,6144
s_add_u32 s50, s46, 10240
buffer_store_dwordx4 v[224:227], v253, s[20:23], s50 offen
mm v,12,a,12,v,204,12
s_waitcnt vmcnt(29) lgkmcnt(4)
v_fma_f32 v216, v216, v232, v236
v_fma_f32 v217, v217, v233, v237
v_fma_f32 v218, v218, v234, v238
mm v,16,a,16,v,200,16
buffer_load_dwordx4 a[236:239], v253, s[60:63], s101 offen offset:1024 sc1
v_fma_f32 v219, v219, v235, v239
v_fma_f32 v220, v220, v232, v236
mm v,16,a,20,v,204,16
s_add_u32 s51, s77, 336896
v_fma_f32 v221, v221, v233, v237
v_fma_f32 v222, v222, v234, v238
v_fma_f32 v223, v223, v235, v239
mm v,20,v,160,v,208,20
tr 200,242,0
v_cvt_pk_bf16_f32 v216, v216, v217
v_cvt_pk_bf16_f32 v217, v218, v219
mm v,20,v,168,v,212,20
tr 202,242,2048
v_cvt_pk_bf16_f32 v218, v220, v221
v_cvt_pk_bf16_f32 v219, v222, v223
mm v,24,v,176,v,208,24
mm v,24,v,184,v,212,24
buffer_load_dwordx4 v252, s[96:99], s51 offen offset:1024 lds
mz v,224,v,216,a,26
mz v,228,v,216,a,24
mm v,28,a,0,v,208,28
s_add_u32 s101, s76, 100352
ds_read_b128 v[232:235], v246
v_accvgpr_read_b32 v216, a32
v_accvgpr_read_b32 v217, a33
v_accvgpr_read_b32 v218, a34
v_accvgpr_read_b32 v219, a35
v_accvgpr_read_b32 v220, a48
v_accvgpr_read_b32 v221, a49
mm v,28,a,4,v,212,28
tr 204,242,4096
v_accvgpr_read_b32 v222, a50
v_accvgpr_read_b32 v223, a51
v_cvt_pk_bf16_f32 v224, v224, v225
mm v,32,a,8,v,208,32
tr 206,242,6144
v_cvt_pk_bf16_f32 v225, v226, v227
v_cvt_pk_bf16_f32 v226, v228, v229
mm v,32,a,12,v,212,32
buffer_load_dwordx4 a[240:243], v253, s[60:63], s101 offen sc1
v_cvt_pk_bf16_f32 v227, v230, v231
mm v,36,a,16,v,208,36
s_add_u32 s51, s77, 346112
s_add_u32 s50, s46, 10240
buffer_store_dwordx4 v[224:227], v253, s[20:23], s50 offen offset:1024
s_waitcnt lgkmcnt(2)
v_mul_f32_e64 v236, -v248, v232
mm v,36,a,20,v,212,36
v_mul_f32_e64 v237, -v248, v233
v_mul_f32_e64 v238, -v248, v234
mm v,40,v,160,v,192,40
tr 208,249,8192
v_mul_f32_e64 v239, -v248, v235
v_fma_f32 v216, v216, v232, v236
v_fma_f32 v217, v217, v233, v237
mm v,40,v,168,v,196,40
tr 210,249,10240
v_fma_f32 v218, v218, v234, v238
v_fma_f32 v219, v219, v235, v239
mm v,44,v,176,v,192,44
buffer_load_dwordx4 v252, s[96:99], s51 offen offset:2048 lds
v_fma_f32 v220, v220, v232, v236
v_fma_f32 v221, v221, v233, v237
v_fma_f32 v222, v222, v234, v238
mm v,44,v,184,v,196,44
v_fma_f32 v223, v223, v235, v239
v_cvt_pk_bf16_f32 v216, v216, v217
mm v,48,a,0,v,192,48
v_cvt_pk_bf16_f32 v217, v218, v219
v_cvt_pk_bf16_f32 v218, v220, v221
v_cvt_pk_bf16_f32 v219, v222, v223
mm v,48,a,4,v,196,48
tr 212,249,12288
mz v,224,v,216,a,26
mz v,228,v,216,a,24
v_accvgpr_read_b32 v216, a64
mm v,52,a,8,v,192,52
tr 214,249,14336
v_accvgpr_read_b32 v217, a65
v_accvgpr_read_b32 v218, a66
v_accvgpr_read_b32 v219, a67
mm v,52,a,12,v,196,52
buffer_load_dwordx4 a[244:247], v253, s[60:63], s101 offen offset:1024 sc1
v_accvgpr_read_b32 v220, a80
v_accvgpr_read_b32 v221, a81
mm v,56,a,16,v,192,56
s_add_u32 s51, s77, 355328
v_accvgpr_read_b32 v222, a82
v_accvgpr_read_b32 v223, a83
v_cvt_pk_bf16_f32 v224, v224, v225
mm v,56,a,20,v,196,56
s_waitcnt lgkmcnt(4)
v_cvt_pk_bf16_f32 v225, v226, v227
v_cvt_pk_bf16_f32 v226, v228, v229
mm v,60,v,160,v,200,60
tr 192,250,8192
v_cvt_pk_bf16_f32 v227, v230, v231
mm v,60,v,168,v,204,60
tr 194,250,10240
s_add_u32 s50, s46, 0
buffer_store_dwordx4 v[224:227], v253, s[20:23], s50 offen offset:1024
v_fma_f32 v216, v216, v232, v236
v_fma_f32 v217, v217, v233, v237
mm v,64,v,176,v,200,64
buffer_load_dwordx4 v252, s[96:99], s51 offen offset:3072 lds
v_fma_f32 v218, v218, v234, v238
v_fma_f32 v219, v219, v235, v239
v_fma_f32 v220, v220, v232, v236
mm v,64,v,184,v,204,64
s_add_u32 s101, s76, 106496
v_fma_f32 v221, v221, v233, v237
v_fma_f32 v222, v222, v234, v238
mm v,68,a,0,v,200,68
v_fma_f32 v223, v223, v235, v239
v_cvt_pk_bf16_f32 v216, v216, v217
mm v,68,a,4,v,204,68
tr 196,250,12288
v_cvt_pk_bf16_f32 v217, v218, v219
v_cvt_pk_bf16_f32 v218, v220, v221
v_cvt_pk_bf16_f32 v219, v222, v223
mm v,72,a,8,v,200,72
tr 198,250,14336
mm v,72,a,12,v,204,72
buffer_load_dwordx4 a[248:251], v253, s[60:63], s101 offen sc1
mz v,224,v,216,a,26
mz v,228,v,216,a,24
v_accvgpr_read_b32 v216, a96
v_accvgpr_read_b32 v217, a97
v_accvgpr_read_b32 v218, a98
v_accvgpr_read_b32 v219, a99
mm v,76,a,16,v,200,76
s_waitcnt lgkmcnt(4)
v_accvgpr_read_b32 v220, a112
v_accvgpr_read_b32 v221, a113
v_accvgpr_read_b32 v222, a114
mm v,76,a,20,v,204,76
buffer_load_dwordx4 a[252:255], v253, s[60:63], s101 offen offset:1024 sc1
v_accvgpr_read_b32 v223, a115
v_cvt_pk_bf16_f32 v224, v224, v225
mm v,80,v,160,v,208,80
tr 200,251,8192
s_add_u32 m0, s78, 52736
v_cvt_pk_bf16_f32 v225, v226, v227
v_cvt_pk_bf16_f32 v226, v228, v229
mm v,80,v,168,v,212,80
tr 202,251,10240
s_add_u32 s51, s77, 368640
v_cvt_pk_bf16_f32 v227, v230, v231
mm v,84,v,176,v,208,84
s_add_u32 s50, s46, 0
buffer_store_dwordx4 v[224:227], v253, s[20:23], s50 offen offset:2048
v_fma_f32 v216, v216, v232, v236
v_fma_f32 v217, v217, v233, v237
mm v,84,v,184,v,212,84
buffer_load_dwordx4 v252, s[96:99], s51 offen lds
v_fma_f32 v218, v218, v234, v238
v_fma_f32 v219, v219, v235, v239
v_fma_f32 v220, v220, v232, v236
mm v,88,a,0,v,208,88
s_add_u32 s101, s76, 112640
v_fma_f32 v221, v221, v233, v237
v_fma_f32 v222, v222, v234, v238
mm v,88,a,4,v,212,88
tr 204,251,12288
v_fma_f32 v223, v223, v235, v239
v_cvt_pk_bf16_f32 v216, v216, v217
v_cvt_pk_bf16_f32 v217, v218, v219
mm v,92,a,8,v,208,92
tr 206,251,14336
v_cvt_pk_bf16_f32 v218, v220, v221
v_cvt_pk_bf16_f32 v219, v222, v223
mm v,92,a,12,v,212,92
L_pg64:
s_cbranch_execz L_ir63
s_waitcnt lgkmcnt(4)
mm v,96,a,16,v,208,96
buffer_load_dwordx4 v[164:167], v253, s[60:63], s101 offen sc1
mm v,96,a,20,v,212,96
s_add_u32 s51, s77, 377856
mz v,224,v,216,a,26
mz v,228,v,216,a,24
v_accvgpr_read_b32 v216, a128
v_accvgpr_read_b32 v217, a129
v_accvgpr_read_b32 v218, a130
v_accvgpr_read_b32 v219, a131
v_accvgpr_read_b32 v220, a144
v_accvgpr_read_b32 v221, a145
v_accvgpr_read_b32 v222, a146
mm v,100,v,160,v,192,100
tr 208,242,8192
v_accvgpr_read_b32 v223, a147
v_cvt_pk_bf16_f32 v224, v224, v225
mm v,100,v,168,v,196,100
tr 210,242,10240
v_cvt_pk_bf16_f32 v225, v226, v227
v_cvt_pk_bf16_f32 v226, v228, v229
mm v,104,v,176,v,192,104
buffer_load_dwordx4 v252, s[96:99], s51 offen offset:1024 lds
v_cvt_pk_bf16_f32 v227, v230, v231
mm v,104,v,184,v,196,104
tr 212,242,12288
s_add_u32 s50, s46, 0
buffer_store_dwordx4 v[224:227], v253, s[20:23], s50 offen offset:3072
v_fma_f32 v216, v216, v232, v236
v_fma_f32 v217, v217, v233, v237
mm v,108,a,0,v,192,108
tr 214,242,14336
v_fma_f32 v218, v218, v234, v238
v_fma_f32 v219, v219, v235, v239
v_fma_f32 v220, v220, v232, v236
mm v,108,a,4,v,196,108
v_fma_f32 v221, v221, v233, v237
v_fma_f32 v222, v222, v234, v238
mm v,112,a,8,v,192,112
v_fma_f32 v223, v223, v235, v239
v_cvt_pk_bf16_f32 v216, v216, v217
v_cvt_pk_bf16_f32 v217, v218, v219
mm v,112,a,12,v,196,112
buffer_load_dwordx4 v[172:175], v253, s[60:63], s101 offen offset:1024 sc1
v_cvt_pk_bf16_f32 v218, v220, v221
v_cvt_pk_bf16_f32 v219, v222, v223
mm v,116,a,16,v,192,116
s_add_u32 s51, s77, 387072
s_waitcnt lgkmcnt(6)
mm v,116,a,20,v,196,116
mz v,224,v,216,a,26
mz v,228,v,216,a,24
v_accvgpr_read_b32 v216, a160
v_accvgpr_read_b32 v217, a161
v_accvgpr_read_b32 v218, a162
v_accvgpr_read_b32 v219, a163
mm v,120,v,160,v,200,120
s_waitcnt vmcnt(21) lgkmcnt(0)
s_barrier
v_accvgpr_read_b32 v220, a176
v_accvgpr_read_b32 v221, a177
v_accvgpr_read_b32 v222, a178
mm v,120,v,168,v,204,120
tr 192,249,23808
v_accvgpr_read_b32 v223, a179
v_cvt_pk_bf16_f32 v224, v224, v225
mm v,124,v,176,v,200,124
buffer_load_dwordx4 v252, s[96:99], s51 offen offset:2048 lds
v_cvt_pk_bf16_f32 v225, v226, v227
v_cvt_pk_bf16_f32 v226, v228, v229
v_cvt_pk_bf16_f32 v227, v230, v231
mm v,124,v,184,v,204,124
tr 194,249,25856
s_add_u32 s101, s76, 118784
s_add_u32 s50, s46, 4096
buffer_store_dwordx4 v[224:227], v253, s[20:23], s50 offen
mm v,128,a,0,v,200,128
v_fma_f32 v216, v216, v232, v236
v_fma_f32 v217, v217, v233, v237
v_fma_f32 v218, v218, v234, v238
mm v,128,a,4,v,204,128
tr 196,249,27904
v_fma_f32 v219, v219, v235, v239
v_fma_f32 v220, v220, v232, v236
mm v,132,a,8,v,200,132
tr 198,249,29952
v_fma_f32 v221, v221, v233, v237
v_fma_f32 v222, v222, v234, v238
v_fma_f32 v223, v223, v235, v239
mm v,132,a,12,v,204,132
buffer_load_dwordx4 v[180:183], v253, s[60:63], s101 offen sc1
v_cvt_pk_bf16_f32 v216, v216, v217
v_cvt_pk_bf16_f32 v217, v218, v219
mm v,136,a,16,v,200,136
s_add_u32 s51, s77, 396288
v_cvt_pk_bf16_f32 v218, v220, v221
v_cvt_pk_bf16_f32 v219, v222, v223
mm v,136,a,20,v,204,136
mm v,140,v,160,v,208,140
tr 200,250,23808
mz v,224,v,216,a,26
mz v,228,v,216,a,24
mm v,140,v,168,v,212,140
tr 202,250,25856
mm v,144,v,176,v,208,144
buffer_load_dwordx4 v252, s[96:99], s51 offen offset:3072 lds
mm v,144,v,184,v,212,144
mm v,148,a,0,v,208,148
buffer_load_dwordx4 v[188:191], v253, s[60:63], s101 offen offset:1024 sc1
mm v,148,a,4,v,212,148
tr 204,250,27904
mm v,152,a,8,v,208,152
tr 206,250,29952
mm v,152,a,12,v,212,152
v_cvt_pk_bf16_f32 v224, v224, v225
v_cvt_pk_bf16_f32 v225, v226, v227
mm v,156,a,16,v,208,156
v_cvt_pk_bf16_f32 v226, v228, v229
v_cvt_pk_bf16_f32 v227, v230, v231
mm v,156,a,20,v,212,156
s_waitcnt lgkmcnt(4)
s_add_u32 s50, s46, 4096
buffer_store_dwordx4 v[224:227], v253, s[20:23], s50 offen offset:1024
mm v,0,a,192,v,192,0
tr 208,251,23808
s_add_u32 s101, s76, 96256
mm v,0,a,196,v,196,0
tr 210,251,25856
mm v,4,a,200,v,192,4
buffer_load_dwordx4 v[160:163], v253, s[60:63], s101 offen sc1
mm v,4,a,204,v,196,4
s_add_u32 m0, s78, 0
s_add_u32 s51, s77, 409600
mm v,8,a,208,v,192,8
buffer_load_dwordx4 v252, s[96:99], s51 offen lds
mm v,8,a,212,v,196,8
tr 212,251,27904
mm v,12,a,216,v,192,12
tr 214,251,29952
mm v,12,a,220,v,196,12
s_waitcnt vmcnt(28)
mm v,16,a,224,v,192,16
buffer_load_dwordx4 v[168:171], v253, s[60:63], s101 offen offset:1024 sc1
mm v,16,a,228,v,196,16
s_add_u32 s51, s77, 418816
s_waitcnt lgkmcnt(6)
mm v,20,a,192,v,200,20
tr 192,242,23808
s_waitcnt lgkmcnt(5)
mm v,20,a,196,v,204,20
tr 194,242,25856
mm v,24,a,200,v,200,24
mm v,24,a,204,v,204,24
buffer_load_dwordx4 v252, s[96:99], s51 offen offset:1024 lds
mm v,28,a,208,v,200,28
s_add_u32 s101, s76, 102400
mm v,28,a,212,v,204,28
tr 196,242,27904
mm v,32,a,216,v,200,32
tr 198,242,29952
mm v,32,a,220,v,204,32
buffer_load_dwordx4 v[176:179], v253, s[60:63], s101 offen sc1
mm v,36,a,224,v,200,36
s_add_u32 s51, s77, 428032
mm v,36,a,228,v,204,36
s_waitcnt lgkmcnt(6)
mm v,40,a,192,v,208,40
tr 200,249,32000
s_waitcnt lgkmcnt(5)
mm v,40,a,196,v,212,40
tr 202,249,34048
mm v,44,a,200,v,208,44
buffer_load_dwordx4 v252, s[96:99], s51 offen offset:2048 lds
mm v,44,a,204,v,212,44
mm v,48,a,208,v,208,48
mm v,48,a,212,v,212,48
tr 204,249,36096
mm v,52,a,216,v,208,52
tr 206,249,38144
mm v,52,a,220,v,212,52
buffer_load_dwordx4 v[184:187], v253, s[60:63], s101 offen offset:1024 sc1
mm v,56,a,224,v,208,56
s_add_u32 s51, s77, 437248
mm v,56,a,228,v,212,56
s_waitcnt lgkmcnt(6)
mm v,60,a,192,v,192,60
tr 208,250,32000
s_waitcnt lgkmcnt(5)
mm v,60,a,196,v,196,60
tr 210,250,34048
mm v,64,a,200,v,192,64
buffer_load_dwordx4 v252, s[96:99], s51 offen offset:3072 lds
mm v,64,a,204,v,196,64
s_add_u32 s101, s76, 108544
mm v,68,a,208,v,192,68
mm v,68,a,212,v,196,68
tr 212,250,36096
mm v,72,a,216,v,192,72
tr 214,250,38144
mm v,72,a,220,v,196,72
buffer_load_dwordx4 a[0:3], v253, s[60:63], s101 offen sc1
mm v,76,a,224,v,192,76
s_waitcnt lgkmcnt(4)
mm v,76,a,228,v,196,76
buffer_load_dwordx4 a[4:7], v253, s[60:63], s101 offen offset:1024 sc1
mm v,80,a,192,v,200,80
tr 192,251,32000
s_add_u32 m0, s78, 4096
mm v,80,a,196,v,204,80
tr 194,251,34048
s_add_u32 s51, s77, 450560
mm v,84,a,200,v,200,84
mm v,84,a,204,v,204,84
buffer_load_dwordx4 v252, s[96:99], s51 offen lds
mm v,88,a,208,v,200,88
s_add_u32 s101, s76, 114688
mm v,88,a,212,v,204,88
tr 196,251,36096
mm v,92,a,216,v,200,92
tr 198,251,38144
mm v,92,a,220,v,204,92
mm v,96,a,224,v,200,96
buffer_load_dwordx4 a[8:11], v253, s[60:63], s101 offen sc1
mm v,96,a,228,v,204,96
s_add_u32 s51, s77, 459776
s_waitcnt lgkmcnt(6)
mm v,100,a,192,v,208,100
tr 200,242,32000
s_waitcnt lgkmcnt(5)
mm v,100,a,196,v,212,100
tr 202,242,34048
mm v,104,a,200,v,208,104
buffer_load_dwordx4 v252, s[96:99], s51 offen offset:1024 lds
mm v,104,a,204,v,212,104
tr 204,242,36096
mm v,108,a,208,v,208,108
tr 206,242,38144
mm v,108,a,212,v,212,108
mm v,112,a,216,v,208,112
mm v,112,a,220,v,212,112
buffer_load_dwordx4 a[12:15], v253, s[60:63], s101 offen offset:1024 sc1
mm v,116,a,224,v,208,116
s_add_u32 s51, s77, 468992
mm v,116,a,228,v,212,116
s_waitcnt lgkmcnt(6)
mm v,120,a,192,v,192,120
s_waitcnt vmcnt(14) lgkmcnt(0)
s_barrier
mm v,120,a,196,v,196,120
tr 208,249,48640
mm v,124,a,200,v,192,124
buffer_load_dwordx4 v252, s[96:99], s51 offen offset:2048 lds
mm v,124,a,204,v,196,124
tr 210,249,50688
s_add_u32 s101, s76, 120832
mm v,128,a,208,v,192,128
mm v,128,a,212,v,196,128
tr 212,249,52736
mm v,132,a,216,v,192,132
tr 214,249,54784
mm v,132,a,220,v,196,132
buffer_load_dwordx4 a[16:19], v253, s[60:63], s101 offen sc1
mm v,136,a,224,v,192,136
s_add_u32 s51, s77, 478208
mm v,136,a,228,v,196,136
mm v,140,a,192,v,200,140
tr 192,250,48640
mm v,140,a,196,v,204,140
tr 194,250,50688
mm v,144,a,200,v,200,144
buffer_load_dwordx4 v252, s[96:99], s51 offen offset:3072 lds
mm v,144,a,204,v,204,144
mm v,148,a,208,v,200,148
buffer_load_dwordx4 a[20:23], v253, s[60:63], s101 offen offset:1024 sc1
mm v,148,a,212,v,204,148
tr 196,250,52736
mm v,152,a,216,v,200,152
tr 198,250,54784
mm v,152,a,220,v,204,152
mm v,156,a,224,v,200,156
mm v,156,a,228,v,204,156
s_waitcnt lgkmcnt(4)
mm v,0,a,232,v,208,0
tr 200,251,48640
s_add_u32 s101, s76, 184320
mm v,0,a,236,v,212,0
tr 202,251,50688
mm v,4,a,240,v,208,4
buffer_load_dwordx4 a[192:195], v253, s[60:63], s101 offen sc1
mm v,4,a,244,v,212,4
s_add_u32 m0, s78, 23808
s_add_u32 s51, s77, 491520
mm v,8,a,248,v,208,8
buffer_load_dwordx4 v252, s[96:99], s51 offen lds
mm v,8,a,252,v,212,8
tr 204,251,52736
mm v,12,v,164,v,208,12
tr 206,251,54784
mm v,12,v,172,v,212,12
mm v,16,v,180,v,208,16
buffer_load_dwordx4 a[196:199], v253, s[60:63], s101 offen offset:1024 sc1
mm v,16,v,188,v,212,16
s_add_u32 s51, s77, 500736
s_waitcnt lgkmcnt(6)
mm v,20,a,232,v,192,20
tr 208,242,48640
s_waitcnt lgkmcnt(5)
mm v,20,a,236,v,196,20
tr 210,242,50688
mm v,24,a,240,v,192,24
mm v,24,a,244,v,196,24
buffer_load_dwordx4 v252, s[96:99], s51 offen offset:1024 lds
mm v,28,a,248,v,192,28
s_add_u32 s101, s76, 190464
mm v,28,a,252,v,196,28
tr 212,242,52736
mm v,32,v,164,v,192,32
tr 214,242,54784
mm v,32,v,172,v,196,32
buffer_load_dwordx4 a[200:203], v253, s[60:63], s101 offen sc1
mm v,36,v,180,v,192,36
s_add_u32 s51, s77, 509952
mm v,36,v,188,v,196,36
s_waitcnt lgkmcnt(6)
mm v,40,a,232,v,200,40
tr 192,249,56832
s_waitcnt lgkmcnt(5)
mm v,40,a,236,v,204,40
tr 194,249,58880
mm v,44,a,240,v,200,44
buffer_load_dwordx4 v252, s[96:99], s51 offen offset:2048 lds
mm v,44,a,244,v,204,44
mm v,48,a,248,v,200,48
mm v,48,a,252,v,204,48
tr 196,249,60928
mm v,52,v,164,v,200,52
tr 198,249,62976
mm v,52,v,172,v,204,52
buffer_load_dwordx4 a[204:207], v253, s[60:63], s101 offen offset:1024 sc1
mm v,56,v,180,v,200,56
s_add_u32 s51, s77, 519168
mm v,56,v,188,v,204,56
s_waitcnt lgkmcnt(6)
mm v,60,a,232,v,208,60
tr 200,250,56832
s_waitcnt lgkmcnt(5)
mm v,60,a,236,v,212,60
tr 202,250,58880
mm v,64,a,240,v,208,64
buffer_load_dwordx4 v252, s[96:99], s51 offen offset:3072 lds
mm v,64,a,244,v,212,64
s_add_u32 s101, s76, 196608
mm v,68,a,248,v,208,68
mm v,68,a,252,v,212,68
tr 204,250,60928
mm v,72,v,164,v,208,72
tr 206,250,62976
mm v,72,v,172,v,212,72
buffer_load_dwordx4 a[208:211], v253, s[60:63], s101 offen sc1
mm v,76,v,180,v,208,76
s_waitcnt lgkmcnt(4)
mm v,76,v,188,v,212,76
buffer_load_dwordx4 a[212:215], v253, s[60:63], s101 offen offset:1024 sc1
mm v,80,a,232,v,192,80
tr 208,251,56832
s_add_u32 m0, s78, 27904
mm v,80,a,236,v,196,80
tr 210,251,58880
s_add_u32 s51, s77, 532480
mm v,84,a,240,v,192,84
mm v,84,a,244,v,196,84
buffer_load_dwordx4 v252, s[96:99], s51 offen lds
mm v,88,a,248,v,192,88
s_add_u32 s101, s76, 202752
mm v,88,a,252,v,196,88
tr 212,251,60928
mm v,92,v,164,v,192,92
tr 214,251,62976
mm v,92,v,172,v,196,92
mm v,96,v,180,v,192,96
buffer_load_dwordx4 a[216:219], v253, s[60:63], s101 offen sc1
mm v,96,v,188,v,196,96
s_add_u32 s51, s77, 541696
s_waitcnt lgkmcnt(6)
mm v,100,a,232,v,200,100
tr 192,242,56832
s_waitcnt lgkmcnt(5)
mm v,100,a,236,v,204,100
tr 194,242,58880
mm v,104,a,240,v,200,104
buffer_load_dwordx4 v252, s[96:99], s51 offen offset:1024 lds
mm v,104,a,244,v,204,104
tr 196,242,60928
mm v,108,a,248,v,200,108
tr 198,242,62976
mm v,108,a,252,v,204,108
mm v,112,v,164,v,200,112
mm v,112,v,172,v,204,112
buffer_load_dwordx4 a[220:223], v253, s[60:63], s101 offen offset:1024 sc1
mm v,116,v,180,v,200,116
s_add_u32 s51, s77, 550912
mm v,116,v,188,v,204,116
s_waitcnt lgkmcnt(6)
mm v,120,a,232,v,208,120
s_waitcnt vmcnt(15) lgkmcnt(0)
s_barrier
mm v,120,a,236,v,212,120
tr 200,249,0
mm v,124,a,240,v,208,124
buffer_load_dwordx4 v252, s[96:99], s51 offen offset:2048 lds
mm v,124,a,244,v,212,124
tr 202,249,2048
s_add_u32 s101, s76, 208896
mm v,128,a,248,v,208,128
mm v,128,a,252,v,212,128
tr 204,249,4096
mm v,132,v,164,v,208,132
tr 206,249,6144
mm v,132,v,172,v,212,132
buffer_load_dwordx4 a[224:227], v253, s[60:63], s101 offen sc1
mm v,136,v,180,v,208,136
s_add_u32 s51, s77, 560128
mm v,136,v,188,v,212,136
mm v,140,a,232,v,192,140
tr 208,250,0
mm v,140,a,236,v,196,140
tr 210,250,2048
mm v,144,a,240,v,192,144
buffer_load_dwordx4 v252, s[96:99], s51 offen offset:3072 lds
mm v,144,a,244,v,196,144
mm v,148,a,248,v,192,148
buffer_load_dwordx4 a[228:231], v253, s[60:63], s101 offen offset:1024 sc1
mm v,148,a,252,v,196,148
tr 212,250,4096
mm v,152,v,164,v,192,152
tr 214,250,6144
mm v,152,v,172,v,196,152
mm v,156,v,180,v,192,156
mm v,156,v,188,v,196,156
s_waitcnt lgkmcnt(4)
mm v,0,v,160,v,200,0
tr 192,251,0
s_add_u32 s101, s76, 186368
mm v,0,v,168,v,204,0
tr 194,251,2048
mm v,4,v,176,v,200,4
buffer_load_dwordx4 a[232:235], v253, s[60:63], s101 offen sc1
mm v,4,v,184,v,204,4
s_add_u32 m0, s78, 48640
s_add_u32 s51, s77, 573440
mm v,8,a,0,v,200,8
buffer_load_dwordx4 v252, s[96:99], s51 offen lds
mm v,8,a,4,v,204,8
tr 196,251,4096
mm v,12,a,8,v,200,12
tr 198,251,6144
mm v,12,a,12,v,204,12
s_waitcnt vmcnt(20)
s_and_b32 s28, s2, 1
s_lshl_b32 s28, s28, 4
mm v,16,a,16,v,200,16
buffer_load_dwordx4 a[236:239], v253, s[60:63], s101 offen offset:1024 sc1
mm v,16,a,20,v,204,16
s_add_u32 s51, s77, 582656
s_waitcnt lgkmcnt(6)
s_sub_u32 s28, 11, s28
mm v,20,v,160,v,208,20
tr 200,242,0
s_waitcnt lgkmcnt(5)
mm v,20,v,168,v,212,20
tr 202,242,2048
mm v,24,v,176,v,208,24
s_mov_b32 s33, 19
s_mov_b32 s26, 2
mm v,24,v,184,v,212,24
buffer_load_dwordx4 v252, s[96:99], s51 offen offset:1024 lds
mm v,28,a,0,v,208,28
s_add_u32 s101, s76, 192512
s_add_u32 s31, s76, 184320
mm v,28,a,4,v,212,28
tr 204,242,4096
mm v,32,a,8,v,208,32
tr 206,242,6144
mm v,32,a,12,v,212,32
buffer_load_dwordx4 a[240:243], v253, s[60:63], s101 offen sc1
mm v,36,a,16,v,208,36
s_add_u32 s51, s77, 591872
s_add_u32 s32, s77, 491520
mm v,36,a,20,v,212,36
s_waitcnt lgkmcnt(6)
s_mov_b32 s25, s26
s_mov_b32 s29, s31
mm v,40,v,160,v,192,40
tr 208,249,8192
s_waitcnt lgkmcnt(5)
mm v,40,v,168,v,196,40
tr 210,249,10240
mm v,44,v,176,v,192,44
buffer_load_dwordx4 v252, s[96:99], s51 offen offset:2048 lds
mm v,44,v,184,v,196,44
s_mov_b32 s30, s32
s_add_u32 s26, s25, 1
mm v,48,a,0,v,192,48
s_cmp_eq_u32 s26, s27
s_cselect_b32 s26, 16, s26
mm v,48,a,4,v,196,48
tr 212,249,12288
mm v,52,a,8,v,192,52
tr 214,249,14336
mm v,52,a,12,v,196,52
buffer_load_dwordx4 a[244:247], v253, s[60:63], s101 offen offset:1024 sc1
mm v,56,a,16,v,192,56
s_add_u32 s51, s77, 601088
mm v,56,a,20,v,196,56
s_waitcnt lgkmcnt(6)
s_cmp_eq_u32 s25, 18
s_cselect_b32 s26, s33, s26
mm v,60,v,160,v,200,60
tr 192,250,8192
s_waitcnt lgkmcnt(5)
mm v,60,v,168,v,204,60
tr 194,250,10240
mm v,64,v,176,v,200,64
buffer_load_dwordx4 v252, s[96:99], s51 offen offset:3072 lds
mm v,64,v,184,v,204,64
s_add_u32 s101, s76, 198656
mm v,68,a,0,v,200,68
s_cmp_eq_u32 s25, s28
s_cselect_b32 s26, 19, s26
mm v,68,a,4,v,204,68
tr 196,250,12288
mm v,72,a,8,v,200,72
tr 198,250,14336
mm v,72,a,12,v,204,72
buffer_load_dwordx4 a[248:251], v253, s[60:63], s101 offen sc1
mm v,76,a,16,v,200,76
s_waitcnt lgkmcnt(4)
s_mul_i32 s31, s26, 92160
s_add_u32 s31, s31, s76
mm v,76,a,20,v,204,76
L_pg68:
s_cbranch_execz L_ir67
buffer_load_dwordx4 a[252:255], v253, s[60:63], s101 offen offset:1024 sc1
mm v,80,v,160,v,208,80
tr 200,251,8192
s_add_u32 m0, s78, 52736
mm v,80,v,168,v,212,80
tr 202,251,10240
s_add_u32 s51, s77, 614400
mm v,84,v,176,v,208,84
s_mul_i32 s32, s26, 245760
s_add_u32 s32, s32, s77
mm v,84,v,184,v,212,84
buffer_load_dwordx4 v252, s[96:99], s51 offen lds
mm v,88,a,0,v,208,88
s_add_u32 s101, s76, 204800
mm v,88,a,4,v,212,88
tr 204,251,12288
mm v,92,a,8,v,208,92
tr 206,251,14336
mm v,92,a,12,v,212,92
mm v,96,a,16,v,208,96
buffer_load_dwordx4 v[164:167], v253, s[60:63], s101 offen sc1
mm v,96,a,20,v,212,96
s_add_u32 s51, s77, 623616
s_waitcnt lgkmcnt(6)
mm v,100,v,160,v,192,100
tr 208,242,8192
s_waitcnt lgkmcnt(5)
mm v,100,v,168,v,196,100
tr 210,242,10240
mm v,104,v,176,v,192,104
buffer_load_dwordx4 v252, s[96:99], s51 offen offset:1024 lds
mm v,104,v,184,v,196,104
tr 212,242,12288
mm v,108,a,0,v,192,108
tr 214,242,14336
mm v,108,a,4,v,196,108
mm v,112,a,8,v,192,112
mm v,112,a,12,v,196,112
buffer_load_dwordx4 v[172:175], v253, s[60:63], s101 offen offset:1024 sc1
mm v,116,a,16,v,192,116
s_add_u32 s51, s77, 632832
mm v,116,a,20,v,196,116
s_waitcnt lgkmcnt(6)
mm v,120,v,160,v,200,120
s_waitcnt vmcnt(15) lgkmcnt(0)
s_barrier
mm v,120,v,168,v,204,120
tr 192,249,23808
mm v,124,v,176,v,200,124
buffer_load_dwordx4 v252, s[96:99], s51 offen offset:2048 lds
mm v,124,v,184,v,204,124
tr 194,249,25856
s_add_u32 s101, s76, 210944
mm v,128,a,0,v,200,128
mm v,128,a,4,v,204,128
tr 196,249,27904
mm v,132,a,8,v,200,132
tr 198,249,29952
mm v,132,a,12,v,204,132
buffer_load_dwordx4 v[180:183], v253, s[60:63], s101 offen sc1
mm v,136,a,16,v,200,136
s_add_u32 s51, s77, 642048
mm v,136,a,20,v,204,136
mm v,140,v,160,v,208,140
tr 200,250,23808
mm v,140,v,168,v,212,140
tr 202,250,25856
mm v,144,v,176,v,208,144
buffer_load_dwordx4 v252, s[96:99], s51 offen offset:3072 lds
mm v,144,v,184,v,212,144
mm v,148,a,0,v,208,148
buffer_load_dwordx4 v[188:191], v253, s[60:63], s101 offen offset:1024 sc1
mm v,148,a,4,v,212,148
tr 204,250,27904
mm v,152,a,8,v,208,152
tr 206,250,29952
mm v,152,a,12,v,212,152
mm v,156,a,16,v,208,156
mm v,156,a,20,v,212,156
s_waitcnt lgkmcnt(4)
L_pcommon:
.p2align 3
L_ploop:
mm v,0,a,192,v,192,0
tr 208,251,23808
s_add_u32 s101, s29, 4096
mm v,0,a,196,v,196,0
tr 210,251,25856
mm v,4,a,200,v,192,4
buffer_load_dwordx4 v[160:163], v253, s[60:63], s101 offen sc1
mm v,4,a,204,v,196,4
s_add_u32 m0, s78, 0
s_add_u32 s51, s30, 163840
mm v,8,a,208,v,192,8
buffer_load_dwordx4 v252, s[96:99], s51 offen lds
mm v,8,a,212,v,196,8
tr 212,251,27904
mm v,12,a,216,v,192,12
tr 214,251,29952
mm v,12,a,220,v,196,12
s_waitcnt vmcnt(20) lgkmcnt(4)
mm v,16,a,224,v,192,16
s_lshl_b32 s43, s26, 2
s_add_u32 s43, s43, s24
s_cmp_eq_u32 s43, 67
s_cselect_b32 s41, 0, 0x7ff00000
v_mov_b32 v228, s41
mm v,16,a,228,v,196,16
buffer_load_dwordx4 v[168:171], v253, s[60:63], s101 offen offset:1024 sc1
mm v,20,a,192,v,200,20
tr 192,242,23808
s_add_u32 s51, s30, 173056
mm v,20,a,196,v,204,20
tr 194,242,25856
mm v,24,a,200,v,200,24
mm v,24,a,204,v,204,24
buffer_load_dwordx4 v252, s[96:99], s51 offen offset:1024 lds
mm v,28,a,208,v,200,28
buffer_load_dword v226, v228, s[72:75], s86 offen offset:64 sc1
mm v,28,a,212,v,204,28
tr 196,242,27904
s_add_u32 s101, s29, 10240
mm v,32,a,216,v,200,32
tr 198,242,29952
mm v,32,a,220,v,204,32
buffer_load_dwordx4 v[176:179], v253, s[60:63], s101 offen sc1
mm v,36,a,224,v,200,36
s_add_u32 s51, s30, 182272
mm v,36,a,228,v,204,36
s_waitcnt lgkmcnt(6)
mm v,40,a,192,v,208,40
tr 200,249,32000
s_waitcnt lgkmcnt(5)
mm v,40,a,196,v,212,40
tr 202,249,34048
mm v,44,a,200,v,208,44
buffer_load_dwordx4 v252, s[96:99], s51 offen offset:2048 lds
mm v,44,a,204,v,212,44
mm v,48,a,208,v,208,48
mm v,48,a,212,v,212,48
tr 204,249,36096
mm v,52,a,216,v,208,52
tr 206,249,38144
mm v,52,a,220,v,212,52
buffer_load_dwordx4 v[184:187], v253, s[60:63], s101 offen offset:1024 sc1
mm v,56,a,224,v,208,56
s_add_u32 s51, s30, 191488
mm v,56,a,228,v,212,56
s_waitcnt lgkmcnt(6)
mm v,60,a,192,v,192,60
tr 208,250,32000
s_waitcnt lgkmcnt(5)
mm v,60,a,196,v,196,60
tr 210,250,34048
mm v,64,a,200,v,192,64
buffer_load_dwordx4 v252, s[96:99], s51 offen offset:3072 lds
mm v,64,a,204,v,196,64
s_add_u32 s101, s29, 16384
mm v,68,a,208,v,192,68
mm v,68,a,212,v,196,68
tr 212,250,36096
mm v,72,a,216,v,192,72
tr 214,250,38144
mm v,72,a,220,v,196,72
buffer_load_dwordx4 a[0:3], v253, s[60:63], s101 offen sc1
mm v,76,a,224,v,192,76
s_waitcnt lgkmcnt(4)
mm v,76,a,228,v,196,76
buffer_load_dwordx4 a[4:7], v253, s[60:63], s101 offen offset:1024 sc1
mm v,80,a,192,v,200,80
tr 192,251,32000
s_add_u32 m0, s78, 4096
mm v,80,a,196,v,204,80
tr 194,251,34048
s_add_u32 s51, s30, 204800
mm v,84,a,200,v,200,84
mm v,84,a,204,v,204,84
buffer_load_dwordx4 v252, s[96:99], s51 offen lds
mm v,88,a,208,v,200,88
s_add_u32 s101, s29, 22528
mm v,88,a,212,v,204,88
tr 196,251,36096
mm v,92,a,216,v,200,92
tr 198,251,38144
mm v,92,a,220,v,204,92
mm v,96,a,224,v,200,96
buffer_load_dwordx4 a[8:11], v253, s[60:63], s101 offen sc1
mm v,96,a,228,v,204,96
s_add_u32 s51, s30, 214016
s_waitcnt lgkmcnt(6)
mm v,100,a,192,v,208,100
tr 200,242,32000
s_waitcnt lgkmcnt(5)
mm v,100,a,196,v,212,100
tr 202,242,34048
mm v,104,a,200,v,208,104
buffer_load_dwordx4 v252, s[96:99], s51 offen offset:1024 lds
mm v,104,a,204,v,212,104
tr 204,242,36096
mm v,108,a,208,v,208,108
tr 206,242,38144
mm v,108,a,212,v,212,108
mm v,112,a,216,v,208,112
mm v,112,a,220,v,212,112
buffer_load_dwordx4 a[12:15], v253, s[60:63], s101 offen offset:1024 sc1
mm v,116,a,224,v,208,116
s_add_u32 s51, s30, 223232
mm v,116,a,228,v,212,116
s_waitcnt vmcnt(10) lgkmcnt(6)
s_cmp_eq_u32 s43, 67
s_cbranch_scc1 L_rare11
L_back11:
mm v,120,a,192,v,192,120
s_waitcnt lgkmcnt(0)
s_barrier
mm v,120,a,196,v,196,120
tr 208,249,48640
mm v,124,a,200,v,192,124
buffer_load_dwordx4 v252, s[96:99], s51 offen offset:2048 lds
mm v,124,a,204,v,196,124
tr 210,249,50688
s_add_u32 s101, s29, 28672
mm v,128,a,208,v,192,128
mm v,128,a,212,v,196,128
tr 212,249,52736
mm v,132,a,216,v,192,132
tr 214,249,54784
mm v,132,a,220,v,196,132
buffer_load_dwordx4 a[16:19], v253, s[60:63], s101 offen sc1
mm v,136,a,224,v,192,136
s_add_u32 s51, s30, 232448
mm v,136,a,228,v,196,136
mm v,140,a,192,v,200,140
tr 192,250,48640
mm v,140,a,196,v,204,140
tr 194,250,50688
mm v,144,a,200,v,200,144
buffer_load_dwordx4 v252, s[96:99], s51 offen offset:3072 lds
mm v,144,a,204,v,204,144
mm v,148,a,208,v,200,148
buffer_load_dwordx4 a[20:23], v253, s[60:63], s101 offen offset:1024 sc1
mm v,148,a,212,v,204,148
tr 196,250,52736
mm v,152,a,216,v,200,152
tr 198,250,54784
mm v,152,a,220,v,204,152
mm v,156,a,224,v,200,156
mm v,156,a,228,v,204,156
s_waitcnt lgkmcnt(4)
mm v,0,a,232,v,208,0
tr 200,251,48640
s_add_u32 s101, s31, 0
mm v,0,a,236,v,212,0
tr 202,251,50688
mm v,4,a,240,v,208,4
buffer_load_dwordx4 a[192:195], v253, s[60:63], s101 offen sc1
mm v,4,a,244,v,212,4
s_add_u32 m0, s78, 23808
s_add_u32 s51, s32, 0
mm v,8,a,248,v,208,8
buffer_load_dwordx4 v252, s[96:99], s51 offen lds
mm v,8,a,252,v,212,8
tr 204,251,52736
mm v,12,v,164,v,208,12
tr 206,251,54784
mm v,12,v,172,v,212,12
s_waitcnt lgkmcnt(4)
mm v,16,v,180,v,208,16
s_cmp_eq_u32 s25, 17
s_cselect_b32 s41, 0, 0x7ff00000
v_mov_b32 v229, s41
mm v,16,v,188,v,212,16
buffer_load_dwordx4 a[196:199], v253, s[60:63], s101 offen offset:1024 sc1
mm v,20,a,232,v,192,20
tr 208,242,48640
s_add_u32 s51, s32, 9216
mm v,20,a,236,v,196,20
tr 210,242,50688
mm v,24,a,240,v,192,24
mm v,24,a,244,v,196,24
buffer_load_dwordx4 v252, s[96:99], s51 offen offset:1024 lds
mm v,28,a,248,v,192,28
buffer_load_dword v227, v229, s[68:71], s83 offen offset:8 sc1
mm v,28,a,252,v,196,28
tr 212,242,52736
s_add_u32 s101, s31, 6144
mm v,32,v,164,v,192,32
tr 214,242,54784
mm v,32,v,172,v,196,32
buffer_load_dwordx4 a[200:203], v253, s[60:63], s101 offen sc1
mm v,36,v,180,v,192,36
s_add_u32 s51, s32, 18432
mm v,36,v,188,v,196,36
s_waitcnt lgkmcnt(6)
mm v,40,a,232,v,200,40
tr 192,249,56832
s_waitcnt lgkmcnt(5)
mm v,40,a,236,v,204,40
tr 194,249,58880
mm v,44,a,240,v,200,44
buffer_load_dwordx4 v252, s[96:99], s51 offen offset:2048 lds
mm v,44,a,244,v,204,44
mm v,48,a,248,v,200,48
mm v,48,a,252,v,204,48
tr 196,249,60928
mm v,52,v,164,v,200,52
tr 198,249,62976
mm v,52,v,172,v,204,52
buffer_load_dwordx4 a[204:207], v253, s[60:63], s101 offen offset:1024 sc1
mm v,56,v,180,v,200,56
s_add_u32 s51, s32, 27648
mm v,56,v,188,v,204,56
s_waitcnt lgkmcnt(6)
mm v,60,a,232,v,208,60
tr 200,250,56832
s_waitcnt lgkmcnt(5)
mm v,60,a,236,v,212,60
tr 202,250,58880
mm v,64,a,240,v,208,64
buffer_load_dwordx4 v252, s[96:99], s51 offen offset:3072 lds
mm v,64,a,244,v,212,64
s_add_u32 s101, s31, 12288
mm v,68,a,248,v,208,68
mm v,68,a,252,v,212,68
tr 204,250,60928
mm v,72,v,164,v,208,72
tr 206,250,62976
mm v,72,v,172,v,212,72
buffer_load_dwordx4 a[208:211], v253, s[60:63], s101 offen sc1
mm v,76,v,180,v,208,76
s_waitcnt lgkmcnt(4)
mm v,76,v,188,v,212,76
buffer_load_dwordx4 a[212:215], v253, s[60:63], s101 offen offset:1024 sc1
mm v,80,a,232,v,192,80
tr 208,251,56832
s_add_u32 m0, s78, 27904
mm v,80,a,236,v,196,80
tr 210,251,58880
s_add_u32 s51, s32, 40960
mm v,84,a,240,v,192,84
mm v,84,a,244,v,196,84
buffer_load_dwordx4 v252, s[96:99], s51 offen lds
mm v,88,a,248,v,192,88
s_add_u32 s101, s31, 18432
mm v,88,a,252,v,196,88
tr 212,251,60928
mm v,92,v,164,v,192,92
tr 214,251,62976
mm v,92,v,172,v,196,92
mm v,96,v,180,v,192,96
buffer_load_dwordx4 a[216:219], v253, s[60:63], s101 offen sc1
mm v,96,v,188,v,196,96
s_add_u32 s51, s32, 50176
s_waitcnt lgkmcnt(6)
mm v,100,a,232,v,200,100
tr 192,242,56832
s_waitcnt lgkmcnt(5)
mm v,100,a,236,v,204,100
tr 194,242,58880
mm v,104,a,240,v,200,104
buffer_load_dwordx4 v252, s[96:99], s51 offen offset:1024 lds
mm v,104,a,244,v,204,104
tr 196,242,60928
mm v,108,a,248,v,200,108
tr 198,242,62976
mm v,108,a,252,v,204,108
mm v,112,v,164,v,200,112
mm v,112,v,172,v,204,112
buffer_load_dwordx4 a[220:223], v253, s[60:63], s101 offen offset:1024 sc1
mm v,116,v,180,v,200,116
s_add_u32 s51, s32, 59392
mm v,116,v,188,v,204,116
s_waitcnt lgkmcnt(6)
mm v,120,a,232,v,208,120
s_waitcnt vmcnt(16) lgkmcnt(0)
s_barrier
mm v,120,a,236,v,212,120
tr 200,249,0
mm v,124,a,240,v,208,124
buffer_load_dwordx4 v252, s[96:99], s51 offen offset:2048 lds
mm v,124,a,244,v,212,124
tr 202,249,2048
s_add_u32 s101, s31, 24576
mm v,128,a,248,v,208,128
mm v,128,a,252,v,212,128
tr 204,249,4096
mm v,132,v,164,v,208,132
tr 206,249,6144
mm v,132,v,172,v,212,132
buffer_load_dwordx4 a[224:227], v253, s[60:63], s101 offen sc1
mm v,136,v,180,v,208,136
s_add_u32 s51, s32, 68608
mm v,136,v,188,v,212,136
mm v,140,a,232,v,192,140
tr 208,250,0
mm v,140,a,236,v,196,140
tr 210,250,2048
mm v,144,a,240,v,192,144
buffer_load_dwordx4 v252, s[96:99], s51 offen offset:3072 lds
mm v,144,a,244,v,196,144
mm v,148,a,248,v,192,148
buffer_load_dwordx4 a[228:231], v253, s[60:63], s101 offen offset:1024 sc1
mm v,148,a,252,v,196,148
tr 212,250,4096
mm v,152,v,164,v,192,152
tr 214,250,6144
mm v,152,v,172,v,196,152
mm v,156,v,180,v,192,156
mm v,156,v,188,v,196,156
s_waitcnt lgkmcnt(4)
mm v,0,v,160,v,200,0
tr 192,251,0
s_add_u32 s101, s31, 2048
mm v,0,v,168,v,204,0
tr 194,251,2048
mm v,4,v,176,v,200,4
buffer_load_dwordx4 a[232:235], v253, s[60:63], s101 offen sc1
mm v,4,v,184,v,204,4
s_add_u32 m0, s78, 48640
s_add_u32 s51, s32, 81920
mm v,8,a,0,v,200,8
buffer_load_dwordx4 v252, s[96:99], s51 offen lds
mm v,8,a,4,v,204,8
tr 196,251,4096
mm v,12,a,8,v,200,12
tr 198,251,6144
mm v,12,a,12,v,204,12
s_waitcnt vmcnt(21)
mm v,16,a,16,v,200,16
buffer_load_dwordx4 a[236:239], v253, s[60:63], s101 offen offset:1024 sc1
mm v,16,a,20,v,204,16
s_waitcnt vmcnt(17) lgkmcnt(4)
s_cmp_eq_u32 s25, 17
s_cbranch_scc1 L_rare15
L_back15:
mm v,20,v,160,v,208,20
tr 200,242,0
s_add_u32 s51, s32, 91136
mm v,20,v,168,v,212,20
tr 202,242,2048
mm v,24,v,176,v,208,24
buffer_load_dwordx4 v252, s[96:99], s51 offen offset:1024 lds
mm v,24,v,184,v,212,24
s_add_u32 s101, s31, 8192
mm v,28,a,0,v,208,28
mm v,28,a,4,v,212,28
tr 204,242,4096
mm v,32,a,8,v,208,32
tr 206,242,6144
mm v,32,a,12,v,212,32
buffer_load_dwordx4 a[240:243], v253, s[60:63], s101 offen sc1
mm v,36,a,16,v,208,36
s_add_u32 s51, s32, 100352
mm v,36,a,20,v,212,36
s_waitcnt lgkmcnt(6)
mm v,40,v,160,v,192,40
tr 208,249,8192
s_waitcnt lgkmcnt(5)
mm v,40,v,168,v,196,40
tr 210,249,10240
mm v,44,v,176,v,192,44
buffer_load_dwordx4 v252, s[96:99], s51 offen offset:2048 lds
mm v,44,v,184,v,196,44
mm v,48,a,0,v,192,48
buffer_load_dwordx4 a[244:247], v253, s[60:63], s101 offen offset:1024 sc1
mm v,48,a,4,v,196,48
tr 212,249,12288
s_add_u32 s51, s32, 109568
mm v,52,a,8,v,192,52
tr 214,249,14336
mm v,52,a,12,v,196,52
mm v,56,a,16,v,192,56
buffer_load_dwordx4 v252, s[96:99], s51 offen offset:3072 lds
mm v,56,a,20,v,196,56
s_add_u32 s101, s31, 14336
s_waitcnt lgkmcnt(6)
mm v,60,v,160,v,200,60
tr 192,250,8192
s_waitcnt lgkmcnt(5)
mm v,60,v,168,v,204,60
tr 194,250,10240
mm v,64,v,176,v,200,64
buffer_load_dwordx4 a[248:251], v253, s[60:63], s101 offen sc1
mm v,64,v,184,v,204,64
mm v,68,a,0,v,200,68
mm v,68,a,4,v,204,68
tr 196,250,12288
mm v,72,a,8,v,200,72
tr 198,250,14336
mm v,72,a,12,v,204,72
buffer_load_dwordx4 a[252:255], v253, s[60:63], s101 offen offset:1024 sc1
mm v,76,a,16,v,200,76
s_add_u32 m0, s78, 52736
s_add_u32 s51, s32, 122880
mm v,76,a,20,v,204,76
s_waitcnt lgkmcnt(6)
mm v,80,v,160,v,208,80
tr 200,251,8192
s_waitcnt lgkmcnt(5)
mm v,80,v,168,v,212,80
tr 202,251,10240
mm v,84,v,176,v,208,84
buffer_load_dwordx4 v252, s[96:99], s51 offen lds
mm v,84,v,184,v,212,84
s_add_u32 s101, s31, 20480
mm v,88,a,0,v,208,88
buffer_load_dwordx4 v[164:167], v253, s[60:63], s101 offen sc1
mm v,88,a,4,v,212,88
tr 204,251,12288
s_add_u32 s51, s32, 132096
mm v,92,a,8,v,208,92
tr 206,251,14336
mm v,92,a,12,v,212,92
mm v,96,a,16,v,208,96
buffer_load_dwordx4 v252, s[96:99], s51 offen offset:1024 lds
mm v,96,a,20,v,212,96
s_waitcnt lgkmcnt(6)
mm v,100,v,160,v,192,100
tr 208,242,8192
s_waitcnt lgkmcnt(5)
mm v,100,v,168,v,196,100
tr 210,242,10240
mm v,104,v,176,v,192,104
buffer_load_dwordx4 v[172:175], v253, s[60:63], s101 offen offset:1024 sc1
mm v,104,v,184,v,196,104
tr 212,242,12288
s_add_u32 s51, s32, 141312
mm v,108,a,0,v,192,108
tr 214,242,14336
mm v,108,a,4,v,196,108
mm v,112,a,8,v,192,112
buffer_load_dwordx4 v252, s[96:99], s51 offen offset:2048 lds
mm v,112,a,12,v,196,112
s_add_u32 s101, s31, 26624
mm v,116,a,16,v,192,116
mm v,116,a,20,v,196,116
s_waitcnt lgkmcnt(6)
mm v,120,v,160,v,200,120
s_waitcnt vmcnt(16) lgkmcnt(0)
s_barrier
mm v,120,v,168,v,204,120
tr 192,249,23808
mm v,124,v,176,v,200,124
buffer_load_dwordx4 v[180:183], v253, s[60:63], s101 offen sc1
mm v,124,v,184,v,204,124
tr 194,249,25856
s_add_u32 s51, s32, 150528
mm v,128,a,0,v,200,128
buffer_load_dwordx4 v252, s[96:99], s51 offen offset:3072 lds
mm v,128,a,4,v,204,128
tr 196,249,27904
mm v,132,a,8,v,200,132
tr 198,249,29952
mm v,132,a,12,v,204,132
mm v,136,a,16,v,200,136
buffer_load_dwordx4 v[188:191], v253, s[60:63], s101 offen offset:1024 sc1
mm v,136,a,20,v,204,136
s_mov_b32 s25, s26
s_mov_b32 s29, s31
s_mov_b32 s30, s32
mm v,140,v,160,v,208,140
tr 200,250,23808
s_add_u32 s26, s25, 1
mm v,140,v,168,v,212,140
tr 202,250,25856
mm v,144,v,176,v,208,144
s_cmp_eq_u32 s26, s27
s_cselect_b32 s26, 16, s26
mm v,144,v,184,v,212,144
s_cmp_eq_u32 s25, 18
s_cselect_b32 s26, s33, s26
mm v,148,a,0,v,208,148
s_cmp_eq_u32 s25, s28
s_cselect_b32 s26, 19, s26
s_mul_i32 s31, s26, 92160
mm v,148,a,4,v,212,148
tr 204,250,27904
s_add_u32 s31, s31, s76
mm v,152,a,8,v,208,152
tr 206,250,29952
mm v,152,a,12,v,212,152
s_mul_i32 s32, s26, 245760
s_add_u32 s32, s32, s77
mm v,156,a,16,v,208,156
mm v,156,a,20,v,212,156
s_waitcnt lgkmcnt(4)
s_cmp_lg_u32 s25, 19
s_cbranch_scc1 L_ploop
L_ptail:
mm v,0,a,192,v,192,0
tr 208,251,23808
s_add_u32 s101, s76, 1755136
mm v,0,a,196,v,196,0
tr 210,251,25856
mm v,4,a,200,v,192,4
buffer_load_dwordx4 v[160:163], v253, s[60:63], s101 offen sc1
mm v,4,a,204,v,196,4
s_add_u32 m0, s78, 0
s_add_u32 s51, s77, 4833280
mm v,8,a,208,v,192,8
buffer_load_dwordx4 v252, s[96:99], s51 offen lds
mm v,8,a,212,v,196,8
tr 212,251,27904
mm v,12,a,216,v,192,12
tr 214,251,29952
mm v,12,a,220,v,196,12
buffer_load_dwordx4 v[168:171], v253, s[60:63], s101 offen offset:1024 sc1
mm v,16,a,224,v,192,16
s_add_u32 s51, s77, 4842496
s_waitcnt vmcnt(21) lgkmcnt(4)
mm v,16,a,228,v,196,16
buffer_load_dwordx4 v252, s[96:99], s51 offen offset:1024 lds
mm v,20,a,192,v,200,20
tr 192,242,23808
s_add_u32 s101, s76, 1761280
mm v,20,a,196,v,204,20
tr 194,242,25856
mm v,24,a,200,v,200,24
mm v,24,a,204,v,204,24
buffer_load_dwordx4 v[176:179], v253, s[60:63], s101 offen sc1
mm v,28,a,208,v,200,28
s_add_u32 s51, s77, 4851712
mm v,28,a,212,v,204,28
tr 196,242,27904
mm v,32,a,216,v,200,32
tr 198,242,29952
mm v,32,a,220,v,204,32
buffer_load_dwordx4 v252, s[96:99], s51 offen offset:2048 lds
mm v,36,a,224,v,200,36
s_waitcnt lgkmcnt(4)
mm v,36,a,228,v,204,36
buffer_load_dwordx4 v[184:187], v253, s[60:63], s101 offen offset:1024 sc1
mm v,40,a,192,v,208,40
tr 200,249,32000
s_add_u32 s51, s77, 4860928
mm v,40,a,196,v,212,40
tr 202,249,34048
mm v,44,a,200,v,208,44
buffer_load_dwordx4 v252, s[96:99], s51 offen offset:3072 lds
mm v,44,a,204,v,212,44
s_add_u32 s101, s76, 1767424
mm v,48,a,208,v,208,48
mm v,48,a,212,v,212,48
tr 204,249,36096
mm v,52,a,216,v,208,52
tr 206,249,38144
mm v,52,a,220,v,212,52
buffer_load_dwordx4 a[0:3], v253, s[60:63], s101 offen sc1
mm v,56,a,224,v,208,56
s_waitcnt lgkmcnt(4)
mm v,56,a,228,v,212,56
buffer_load_dwordx4 a[4:7], v253, s[60:63], s101 offen offset:1024 sc1
mm v,60,a,192,v,192,60
tr 208,250,32000
s_add_u32 m0, s78, 4096
mm v,60,a,196,v,196,60
tr 210,250,34048
s_add_u32 s51, s77, 4874240
mm v,64,a,200,v,192,64
buffer_load_dwordx4 v252, s[96:99], s51 offen lds
mm v,64,a,204,v,196,64
s_add_u32 s101, s76, 1773568
mm v,68,a,208,v,192,68
mm v,68,a,212,v,196,68
tr 212,250,36096
mm v,72,a,216,v,192,72
tr 214,250,38144
mm v,72,a,220,v,196,72
buffer_load_dwordx4 a[8:11], v253, s[60:63], s101 offen sc1
mm v,76,a,224,v,192,76
s_add_u32 s51, s77, 4883456
s_waitcnt lgkmcnt(6)
mm v,76,a,228,v,196,76
buffer_load_dwordx4 v252, s[96:99], s51 offen offset:1024 lds
mm v,80,a,192,v,200,80
tr 192,251,32000
s_waitcnt lgkmcnt(5)
mm v,80,a,196,v,204,80
tr 194,251,34048
mm v,84,a,200,v,200,84
buffer_load_dwordx4 a[12:15], v253, s[60:63], s101 offen offset:1024 sc1
mm v,84,a,204,v,204,84
s_add_u32 s51, s77, 4892672
mm v,88,a,208,v,200,88
mm v,88,a,212,v,204,88
tr 196,251,36096
mm v,92,a,216,v,200,92
tr 198,251,38144
mm v,92,a,220,v,204,92
buffer_load_dwordx4 v252, s[96:99], s51 offen offset:2048 lds
mm v,96,a,224,v,200,96
s_add_u32 s101, s76, 1779712
s_waitcnt lgkmcnt(4)
mm v,96,a,228,v,204,96
buffer_load_dwordx4 a[16:19], v253, s[60:63], s101 offen sc1
mm v,100,a,192,v,208,100
tr 200,242,32000
s_add_u32 s51, s77, 4901888
mm v,100,a,196,v,212,100
tr 202,242,34048
mm v,104,a,200,v,208,104
buffer_load_dwordx4 v252, s[96:99], s51 offen offset:3072 lds
mm v,104,a,204,v,212,104
tr 204,242,36096
mm v,108,a,208,v,208,108
tr 206,242,38144
mm v,108,a,212,v,212,108
buffer_load_dwordx4 a[20:23], v253, s[60:63], s101 offen offset:1024 sc1
mm v,112,a,216,v,208,112
mm v,112,a,220,v,212,112
mm v,116,a,224,v,208,116
mm v,116,a,228,v,212,116
s_waitcnt lgkmcnt(6)
mm v,120,a,192,v,192,120
s_waitcnt vmcnt(19) lgkmcnt(0)
s_barrier
mm v,120,a,196,v,196,120
tr 208,251,56832
mm v,124,a,200,v,192,124
mm v,124,a,204,v,196,124
tr 210,251,58880
mm v,128,a,208,v,192,128
mm v,128,a,212,v,196,128
tr 212,251,60928
mm v,132,a,216,v,192,132
tr 214,251,62976
mm v,132,a,220,v,196,132
mm v,136,a,224,v,192,136
mm v,136,a,228,v,196,136
mm v,140,a,192,v,200,140
tr 192,242,56832
mm v,140,a,196,v,204,140
tr 194,242,58880
mm v,144,a,200,v,200,144
mm v,144,a,204,v,204,144
mm v,148,a,208,v,200,148
mm v,148,a,212,v,204,148
tr 196,242,60928
mm v,152,a,216,v,200,152
tr 198,242,62976
mm v,152,a,220,v,204,152
mm v,156,a,224,v,200,156
mm v,156,a,228,v,204,156
s_waitcnt lgkmcnt(4)
mm v,120,a,232,v,208,120
tr 200,249,56832
s_and_b32 s101, s24, 1
mm v,120,a,236,v,212,120
tr 202,249,58880
s_lshr_b32 s51, s24, 1
mm v,124,a,240,v,208,124
tr 204,249,60928
s_mul_i32 s51, s51, 74496
mm v,124,a,244,v,212,124
tr 206,249,62976
mm v,128,a,248,v,208,128
s_sub_u32 s42, 74496, s51
s_mul_i32 s41, s101, 10240
s_add_u32 s41, s41, 24832
mm v,128,a,252,v,212,128
v_add_u32 v224, s41, v253
v_add_u32 v236, s51, v224
mm v,132,v,164,v,208,132
v_add_u32 v237, s42, v224
mm v,132,v,172,v,212,132
s_mul_i32 s41, s101, 49664
s_add_u32 s41, s41, 9216
v_add_u32 v224, s41, v253
mm v,136,v,180,v,208,136
s_waitcnt vmcnt(18)
v_add_u32 v238, s51, v224
v_add_u32 v239, s42, v224
mm v,136,v,188,v,212,136
s_waitcnt lgkmcnt(4)
v_bfe_u32 v240, v253, 4, 4
v_mul_u32_u24 v240, 2560, v240
mm v,140,a,232,v,192,140
tr 208,250,56832
v_lshrrev_b32 v224, 8, v253
mm v,140,a,236,v,196,140
tr 210,250,58880
v_lshl_add_u32 v240, v224, 4, v240
mm v,144,a,240,v,192,144
tr 212,250,60928
v_sub_u32 v225, v236, v253
mm v,144,a,244,v,196,144
tr 214,250,62976
mm v,148,a,248,v,192,148
v_bfe_u32 v224, v253, 5, 2
v_lshrrev_b32 v241, 8, v253
mm v,148,a,252,v,196,148
v_xor_b32 v224, v224, v241
v_lshl_add_u32 v241, v224, 4, v225
mm v,152,v,164,v,192,152
v_bfe_u32 v224, v253, 4, 4
v_lshl_add_u32 v241, v224, 6, v241
mm v,152,v,172,v,196,152
v_lshrrev_b32 v224, 9, v253
v_lshl_add_u32 v225, v224, 3, v225
mm v,156,v,180,v,192,156
v_bfe_u32 v224, v253, 8, 1
v_lshl_add_u32 v225, v224, 9, v225
mm v,156,v,188,v,196,156
s_waitcnt lgkmcnt(4)
v_bfe_u32 v224, v253, 6, 2
v_lshl_add_u32 v225, v224, 6, v225
mm v,80,a,232,v,200,80
s_waitcnt vmcnt(1)
s_barrier
v_bfe_u32 v224, v253, 7, 1
mm v,80,a,236,v,204,80
tr 192,251,8192
v_bfe_u32 v244, v253, 4, 2
mm v,84,a,240,v,200,84
tr 194,251,10240
v_xor_b32 v224, v224, v244
mm v,84,a,244,v,204,84
tr 196,251,12288
v_lshl_add_u32 v243, v224, 4, v225
mm v,88,a,248,v,200,88
tr 198,251,14336
mm v,88,a,252,v,204,88
v_xor_b32 v224, 2, v224
v_lshl_add_u32 v244, v224, 4, v225
mm v,92,v,164,v,200,92
mm v,92,v,172,v,204,92
mm v,96,v,180,v,200,96
mm v,96,v,188,v,204,96
s_waitcnt lgkmcnt(6)
mm v,100,a,232,v,208,100
tr 200,242,8192
s_waitcnt lgkmcnt(5)
mm v,100,a,236,v,212,100
tr 202,242,10240
mm v,104,a,240,v,208,104
tr 204,242,12288
mm v,104,a,244,v,212,104
tr 206,242,14336
mm v,108,a,248,v,208,108
mm v,108,a,252,v,212,108
mm v,112,v,164,v,208,112
mm v,112,v,172,v,212,112
mm v,116,v,180,v,208,116
mm v,116,v,188,v,212,116
s_waitcnt lgkmcnt(6)
mm v,120,v,160,v,192,120
tr 208,249,8192
s_waitcnt lgkmcnt(5)
mm v,120,v,168,v,196,120
tr 210,249,10240
mm v,124,v,176,v,192,124
tr 212,249,12288
mm v,124,v,184,v,196,124
tr 214,249,14336
mm v,128,a,0,v,192,128
mm v,128,a,4,v,196,128
mm v,132,a,8,v,192,132
mm v,132,a,12,v,196,132
mm v,136,a,16,v,192,136
s_waitcnt vmcnt(0)
mm v,136,a,20,v,196,136
s_waitcnt lgkmcnt(6)
mm v,140,v,160,v,200,140
tr 192,250,8192
s_waitcnt lgkmcnt(5)
mm v,140,v,168,v,204,140
tr 194,250,10240
mm v,144,v,176,v,200,144
tr 196,250,12288
mm v,144,v,184,v,204,144
tr 198,250,14336
mm v,148,a,0,v,200,148
mm v,148,a,4,v,204,148
s_waitcnt lgkmcnt(6)
mm v,152,a,8,v,200,152
ds_write_b128 v236, v[120:123]
mm v,152,a,12,v,204,152
ds_write_b128 v236, v[124:127] offset:1024
mm v,156,a,16,v,200,156
ds_write_b128 v236, v[128:131] offset:2048
mm v,156,a,20,v,204,156
ds_write_b128 v236, v[132:135] offset:3072
mm v,80,v,160,v,208,80
tr 200,249,48640
s_waitcnt lgkmcnt(9)
mm v,80,v,168,v,212,80
tr 202,249,50688
mm v,84,v,176,v,208,84
tr 204,249,52736
mm v,84,v,184,v,212,84
tr 206,249,54784
s_waitcnt lgkmcnt(10)
mm v,88,a,0,v,208,88
ds_write_b128 v236, v[136:139] offset:4096
mm v,88,a,4,v,212,88
ds_write_b128 v236, v[140:143] offset:5120
mm v,92,a,8,v,208,92
ds_write_b128 v236, v[144:147] offset:6144
mm v,92,a,12,v,212,92
ds_write_b128 v236, v[148:151] offset:7168
mm v,96,a,16,v,208,96
ds_write_b128 v236, v[152:155] offset:8192
mm v,96,a,20,v,212,96
ds_write_b128 v236, v[156:159] offset:9216
mm v,100,v,160,v,192,100
tr 208,250,48640
s_waitcnt lgkmcnt(15)
mm v,100,v,168,v,196,100
tr 210,250,50688
mm v,104,v,176,v,192,104
tr 212,250,52736
mm v,104,v,184,v,196,104
tr 214,250,54784
mm v,108,a,0,v,192,108
mm v,108,a,4,v,196,108
mm v,112,a,8,v,192,112
mm v,112,a,12,v,196,112
mm v,116,a,16,v,192,116
s_waitcnt lgkmcnt(0)
s_barrier
mm v,116,a,20,v,196,116
ds_read_b128 v[120:123], v237
mm v,0,a,232,v,200,0
tr 192,251,48640
mm v,0,a,236,v,204,0
tr 194,251,50688
mm v,4,a,240,v,200,4
tr 196,251,52736
mm v,4,a,244,v,204,4
tr 198,251,54784
mm v,8,a,248,v,200,8
ds_read_b128 v[124:127], v237 offset:1024
mm v,8,a,252,v,204,8
ds_read_b128 v[128:131], v237 offset:2048
mm v,12,v,164,v,200,12
ds_read_b128 v[132:135], v237 offset:3072
mm v,12,v,172,v,204,12
ds_read_b128 v[136:139], v237 offset:4096
mm v,16,v,180,v,200,16
ds_read_b128 v[140:143], v237 offset:5120
mm v,16,v,188,v,204,16
ds_read_b128 v[144:147], v237 offset:6144
mm v,20,a,232,v,208,20
tr 200,242,48640
s_waitcnt lgkmcnt(11)
mm v,20,a,236,v,212,20
tr 202,242,50688
v_add_f32 v80, v80, v120
mm v,24,a,240,v,208,24
tr 204,242,52736
v_add_f32 v81, v81, v121
mm v,24,a,244,v,212,24
tr 206,242,54784
mm v,28,a,248,v,208,28
ds_read_b128 v[148:151], v237 offset:7168
v_add_f32 v82, v82, v122
mm v,28,a,252,v,212,28
ds_read_b128 v[152:155], v237 offset:8192
v_add_f32 v83, v83, v123
mm v,32,v,164,v,208,32
ds_read_b128 v[156:159], v237 offset:9216
v_cvt_pk_bf16_f32 v80, v80, v81
mm v,32,v,172,v,212,32
v_cvt_pk_bf16_f32 v81, v82, v83
mm v,36,v,180,v,208,36
s_waitcnt lgkmcnt(12)
v_add_f32 v84, v84, v124
v_add_f32 v85, v85, v125
mm v,36,v,188,v,212,36
v_add_f32 v86, v86, v126
v_add_f32 v87, v87, v127
mm v,40,a,232,v,192,40
tr 208,251,0
v_cvt_pk_bf16_f32 v82, v84, v85
mm v,40,a,236,v,196,40
tr 210,251,2048
v_cvt_pk_bf16_f32 v83, v86, v87
mm v,44,a,240,v,192,44
tr 212,251,4096
mm v,44,a,244,v,196,44
tr 214,251,6144
mm v,48,a,248,v,192,48
buffer_store_dwordx4 v[80:83], v253, s[68:71], s80 offen sc1
mm v,48,a,252,v,196,48
s_waitcnt lgkmcnt(15)
v_add_f32 v88, v88, v128
v_add_f32 v89, v89, v129
mm v,52,v,164,v,192,52
v_add_f32 v90, v90, v130
v_add_f32 v91, v91, v131
mm v,52,v,172,v,196,52
v_cvt_pk_bf16_f32 v88, v88, v89
v_cvt_pk_bf16_f32 v89, v90, v91
mm v,56,v,180,v,192,56
s_waitcnt lgkmcnt(14)
v_add_f32 v92, v92, v132
v_add_f32 v93, v93, v133
mm v,56,v,188,v,196,56
s_waitcnt lgkmcnt(7)
v_add_f32 v94, v94, v134
v_add_f32 v95, v95, v135
mm v,60,a,232,v,200,60
tr 192,242,0
v_cvt_pk_bf16_f32 v90, v92, v93
mm v,60,a,236,v,204,60
tr 194,242,2048
v_cvt_pk_bf16_f32 v91, v94, v95
mm v,64,a,240,v,200,64
tr 196,242,4096
buffer_store_dwordx4 v[88:91], v253, s[68:71], s80 offen offset:1024 sc1
mm v,64,a,244,v,204,64
tr 198,242,6144
mm v,68,a,248,v,200,68
v_add_f32 v96, v96, v136
v_add_f32 v97, v97, v137
mm v,68,a,252,v,204,68
v_add_f32 v98, v98, v138
v_add_f32 v99, v99, v139
mm v,72,v,164,v,200,72
v_cvt_pk_bf16_f32 v96, v96, v97
v_cvt_pk_bf16_f32 v97, v98, v99
mm v,72,v,172,v,204,72
v_add_f32 v100, v100, v140
v_add_f32 v101, v101, v141
mm v,76,v,180,v,200,76
v_add_f32 v102, v102, v142
v_add_f32 v103, v103, v143
mm v,76,v,188,v,204,76
s_waitcnt lgkmcnt(4)
v_cvt_pk_bf16_f32 v98, v100, v101
v_cvt_pk_bf16_f32 v99, v102, v103
mm v,40,v,160,v,208,40
tr 200,249,0
buffer_store_dwordx4 v[96:99], v253, s[68:71], s80 offen offset:2048 sc1
mm v,40,v,168,v,212,40
tr 202,249,2048
mm v,44,v,176,v,208,44
tr 204,249,4096
v_add_f32 v104, v104, v144
v_add_f32 v105, v105, v145
mm v,44,v,184,v,212,44
tr 206,249,6144
v_add_f32 v106, v106, v146
v_add_f32 v107, v107, v147
mm v,48,a,0,v,208,48
v_cvt_pk_bf16_f32 v104, v104, v105
v_cvt_pk_bf16_f32 v105, v106, v107
mm v,48,a,4,v,212,48
v_add_f32 v108, v108, v148
v_add_f32 v109, v109, v149
mm v,52,a,8,v,208,52
v_add_f32 v110, v110, v150
v_add_f32 v111, v111, v151
mm v,52,a,12,v,212,52
v_cvt_pk_bf16_f32 v106, v108, v109
v_cvt_pk_bf16_f32 v107, v110, v111
mm v,56,a,16,v,208,56
buffer_store_dwordx4 v[104:107], v253, s[68:71], s80 offen offset:3072 sc1
mm v,56,a,20,v,212,56
s_waitcnt lgkmcnt(4)
v_add_f32 v112, v112, v152
v_add_f32 v113, v113, v153
mm v,60,v,160,v,192,60
tr 208,250,0
v_add_f32 v114, v114, v154
mm v,60,v,168,v,196,60
tr 210,250,2048
v_add_f32 v115, v115, v155
v_cvt_pk_bf16_f32 v112, v112, v113
mm v,64,v,176,v,192,64
tr 212,250,4096
v_cvt_pk_bf16_f32 v113, v114, v115
mm v,64,v,184,v,196,64
tr 214,250,6144
v_add_f32 v116, v116, v156
v_add_f32 v117, v117, v157
mm v,68,a,0,v,192,68
v_add_f32 v118, v118, v158
v_add_f32 v119, v119, v159
mm v,68,a,4,v,196,68
s_waitcnt lgkmcnt(6)
v_cvt_pk_bf16_f32 v114, v116, v117
v_cvt_pk_bf16_f32 v115, v118, v119
mm v,72,a,8,v,192,72
s_add_u32 s101, s80, 4096
buffer_store_dwordx4 v[112:115], v253, s[68:71], s101 offen sc1
ds_write_b128 v238, v[40:43]
mm v,72,a,12,v,196,72
ds_write_b128 v238, v[44:47] offset:1024
mm v,76,a,16,v,192,76
ds_write_b128 v238, v[48:51] offset:2048
mm v,76,a,20,v,196,76
ds_write_b128 v238, v[52:55] offset:3072
mm v,0,v,160,v,200,0
s_waitcnt lgkmcnt(8)
mm v,0,v,168,v,204,0
mm v,4,v,176,v,200,4
mm v,4,v,184,v,204,4
mm v,8,a,0,v,200,8
ds_write_b128 v238, v[56:59] offset:4096
mm v,8,a,4,v,204,8
mm v,12,a,8,v,200,12
ds_write_b128 v238, v[60:63] offset:5120
mm v,12,a,12,v,204,12
mm v,16,a,16,v,200,16
ds_write_b128 v238, v[64:67] offset:6144
mm v,16,a,20,v,204,16
s_waitcnt lgkmcnt(7)
mm v,20,v,160,v,208,20
ds_write_b128 v238, v[68:71] offset:7168
mm v,20,v,168,v,212,20
mm v,24,v,176,v,208,24
ds_write_b128 v238, v[72:75] offset:8192
mm v,24,v,184,v,212,24
mm v,28,a,0,v,208,28
ds_write_b128 v238, v[76:79] offset:9216
mm v,28,a,4,v,212,28
mm v,32,a,8,v,208,32
mm v,32,a,12,v,212,32
mm v,36,a,16,v,208,36
mm v,36,a,20,v,212,36
s_waitcnt vmcnt(0) lgkmcnt(0)
s_barrier
s_cmp_lg_u32 s24, 3
s_cbranch_scc1 L_xset
v_mov_b32 v254, 1
s_mov_b64 exec, 1
buffer_store_dword v254, off, s[68:71], s82 sc1
s_mov_b64 exec, -1
buffer_load_dword v226, off, s[68:71], s83 sc1
L_xset:
ds_read_b128 v[40:43], v239
ds_read_b128 v[44:47], v239 offset:1024
ds_read_b128 v[48:51], v239 offset:2048
ds_read_b128 v[52:55], v239 offset:3072
ds_read_b128 v[56:59], v239 offset:4096
ds_read_b128 v[60:63], v239 offset:5120
ds_read_b128 v[64:67], v239 offset:6144
ds_read_b128 v[68:71], v239 offset:7168
ds_read_b128 v[72:75], v239 offset:8192
ds_read_b128 v[76:79], v239 offset:9216
s_waitcnt lgkmcnt(9)
v_pk_add_f32 v[0:1], v[0:1], v[40:41]
v_pk_add_f32 v[2:3], v[2:3], v[42:43]
s_waitcnt lgkmcnt(8)
v_pk_add_f32 v[4:5], v[4:5], v[44:45]
v_pk_add_f32 v[6:7], v[6:7], v[46:47]
s_waitcnt lgkmcnt(7)
v_pk_add_f32 v[8:9], v[8:9], v[48:49]
v_pk_add_f32 v[10:11], v[10:11], v[50:51]
s_waitcnt lgkmcnt(6)
v_pk_add_f32 v[12:13], v[12:13], v[52:53]
v_pk_add_f32 v[14:15], v[14:15], v[54:55]
s_waitcnt lgkmcnt(5)
v_pk_add_f32 v[16:17], v[16:17], v[56:57]
v_pk_add_f32 v[18:19], v[18:19], v[58:59]
s_waitcnt lgkmcnt(4)
v_pk_add_f32 v[20:21], v[20:21], v[60:61]
v_pk_add_f32 v[22:23], v[22:23], v[62:63]
s_waitcnt lgkmcnt(3)
v_pk_add_f32 v[24:25], v[24:25], v[64:65]
v_pk_add_f32 v[26:27], v[26:27], v[66:67]
s_waitcnt lgkmcnt(2)
v_pk_add_f32 v[28:29], v[28:29], v[68:69]
v_pk_add_f32 v[30:31], v[30:31], v[70:71]
s_waitcnt lgkmcnt(1)
v_pk_add_f32 v[32:33], v[32:33], v[72:73]
v_pk_add_f32 v[34:35], v[34:35], v[74:75]
s_waitcnt lgkmcnt(0)
v_pk_add_f32 v[36:37], v[36:37], v[76:77]
v_pk_add_f32 v[38:39], v[38:39], v[78:79]
s_cmp_lg_u32 s24, 3
s_cbranch_scc1 L_xok
s_mov_b32 s100, 0x20000
L_xpoll:
s_waitcnt vmcnt(0)
v_readfirstlane_b32 s101, v226
s_sub_u32 s100, s100, 1
s_cmp_eq_u32 s100, 0
s_cbranch_scc1 L_xok
s_nop 0
s_cmp_eq_u32 s101, 1
s_cbranch_scc1 L_xok
buffer_load_dword v226, off, s[68:71], s83 sc1
s_branch L_xpoll
L_xok:
s_barrier
s_add_u32 s101, s81, 4096
s_add_u32 s51, s81, 8192
buffer_load_dwordx4 v[140:143], v253, s[68:71], s81 offen sc1
buffer_load_dwordx4 v[144:147], v253, s[68:71], s81 offen offset:1024 sc1
buffer_load_dwordx4 v[148:151], v253, s[68:71], s81 offen offset:2048 sc1
buffer_load_dwordx4 v[152:155], v253, s[68:71], s81 offen offset:3072 sc1
buffer_load_dwordx4 v[156:159], v253, s[68:71], s101 offen sc1
s_waitcnt vmcnt(4)
v_lshlrev_b32 v40, 16, v140
v_and_b32 v41, 0xffff0000, v140
v_lshlrev_b32 v42, 16, v141
v_and_b32 v43, 0xffff0000, v141
v_lshlrev_b32 v44, 16, v142
v_and_b32 v45, 0xffff0000, v142
v_lshlrev_b32 v46, 16, v143
v_and_b32 v47, 0xffff0000, v143
s_waitcnt vmcnt(3)
v_lshlrev_b32 v48, 16, v144
v_and_b32 v49, 0xffff0000, v144
v_lshlrev_b32 v50, 16, v145
v_and_b32 v51, 0xffff0000, v145
v_lshlrev_b32 v52, 16, v146
v_and_b32 v53, 0xffff0000, v146
v_lshlrev_b32 v54, 16, v147
v_and_b32 v55, 0xffff0000, v147
s_waitcnt vmcnt(2)
v_lshlrev_b32 v56, 16, v148
v_and_b32 v57, 0xffff0000, v148
v_lshlrev_b32 v58, 16, v149
v_and_b32 v59, 0xffff0000, v149
v_lshlrev_b32 v60, 16, v150
v_and_b32 v61, 0xffff0000, v150
v_lshlrev_b32 v62, 16, v151
v_and_b32 v63, 0xffff0000, v151
s_waitcnt vmcnt(1)
v_lshlrev_b32 v64, 16, v152
v_and_b32 v65, 0xffff0000, v152
v_lshlrev_b32 v66, 16, v153
v_and_b32 v67, 0xffff0000, v153
v_lshlrev_b32 v68, 16, v154
v_and_b32 v69, 0xffff0000, v154
v_lshlrev_b32 v70, 16, v155
v_and_b32 v71, 0xffff0000, v155
s_waitcnt vmcnt(0)
v_lshlrev_b32 v72, 16, v156
v_and_b32 v73, 0xffff0000, v156
v_lshlrev_b32 v74, 16, v157
v_and_b32 v75, 0xffff0000, v157
v_lshlrev_b32 v76, 16, v158
v_and_b32 v77, 0xffff0000, v158
v_lshlrev_b32 v78, 16, v159
v_and_b32 v79, 0xffff0000, v159
v_pk_add_f32 v[0:1], v[0:1], v[40:41]
v_pk_add_f32 v[2:3], v[2:3], v[42:43]
v_cvt_pk_bf16_f32 v80, v0, v1
v_cvt_pk_bf16_f32 v81, v2, v3
v_pk_add_f32 v[20:21], v[20:21], v[60:61]
v_pk_add_f32 v[22:23], v[22:23], v[62:63]
v_cvt_pk_bf16_f32 v82, v20, v21
v_cvt_pk_bf16_f32 v83, v22, v23
ds_write_b128 v241, v[80:83]
tr 120,243,0
tr 122,244,256
v_pk_add_f32 v[4:5], v[4:5], v[44:45]
v_pk_add_f32 v[6:7], v[6:7], v[46:47]
v_cvt_pk_bf16_f32 v84, v4, v5
v_cvt_pk_bf16_f32 v85, v6, v7
v_pk_add_f32 v[24:25], v[24:25], v[64:65]
v_pk_add_f32 v[26:27], v[26:27], v[66:67]
v_cvt_pk_bf16_f32 v86, v24, v25
v_cvt_pk_bf16_f32 v87, v26, v27
ds_write_b128 v241, v[84:87] offset:1024
tr 124,243,1024
tr 126,244,1280
v_pk_add_f32 v[8:9], v[8:9], v[48:49]
v_pk_add_f32 v[10:11], v[10:11], v[50:51]
v_cvt_pk_bf16_f32 v88, v8, v9
v_cvt_pk_bf16_f32 v89, v10, v11
v_pk_add_f32 v[28:29], v[28:29], v[68:69]
v_pk_add_f32 v[30:31], v[30:31], v[70:71]
v_cvt_pk_bf16_f32 v90, v28, v29
v_cvt_pk_bf16_f32 v91, v30, v31
ds_write_b128 v241, v[88:91] offset:2048
tr 128,243,2048
tr 130,244,2304
v_pk_add_f32 v[12:13], v[12:13], v[52:53]
v_pk_add_f32 v[14:15], v[14:15], v[54:55]
v_cvt_pk_bf16_f32 v92, v12, v13
v_cvt_pk_bf16_f32 v93, v14, v15
v_pk_add_f32 v[32:33], v[32:33], v[72:73]
v_pk_add_f32 v[34:35], v[34:35], v[74:75]
v_cvt_pk_bf16_f32 v94, v32, v33
v_cvt_pk_bf16_f32 v95, v34, v35
ds_write_b128 v241, v[92:95] offset:3072
tr 132,243,3072
tr 134,244,3328
v_pk_add_f32 v[16:17], v[16:17], v[56:57]
v_pk_add_f32 v[18:19], v[18:19], v[58:59]
v_cvt_pk_bf16_f32 v96, v16, v17
v_cvt_pk_bf16_f32 v97, v18, v19
v_pk_add_f32 v[36:37], v[36:37], v[76:77]
v_pk_add_f32 v[38:39], v[38:39], v[78:79]
v_cvt_pk_bf16_f32 v98, v36, v37
v_cvt_pk_bf16_f32 v99, v38, v39
ds_write_b128 v241, v[96:99] offset:4096
tr 136,243,4096
tr 138,244,4352
s_add_u32 s101, s79, 0
s_waitcnt lgkmcnt(12)
buffer_store_dwordx4 v[120:123], v240, s[64:67], s101 offen nt
s_add_u32 s101, s79, 40960
s_waitcnt lgkmcnt(9)
buffer_store_dwordx4 v[124:127], v240, s[64:67], s101 offen nt
s_add_u32 s101, s79, 81920
s_waitcnt lgkmcnt(6)
buffer_store_dwordx4 v[128:131], v240, s[64:67], s101 offen nt
s_add_u32 s101, s79, 122880
s_waitcnt lgkmcnt(3)
buffer_store_dwordx4 v[132:135], v240, s[64:67], s101 offen nt
s_add_u32 s101, s79, 163840
s_waitcnt lgkmcnt(0)
buffer_store_dwordx4 v[136:139], v240, s[64:67], s101 offen nt
s_endpgm
L_rare11:
s_mov_b32 s100, 0x20000
L_poll10:
v_readfirstlane_b32 s41, v226
s_nop 3
s_cmp_ge_u32 s41, 32
s_cbranch_scc1 L_pok10
s_sleep 2
buffer_load_dword v226, off, s[72:75], s86 offset:64 sc1
s_sub_u32 s100, s100, 1
s_cmp_lg_u32 s100, 0
s_waitcnt vmcnt(0)
s_cbranch_scc1 L_poll10
L_pok10:
s_cmp_eq_u32 s35, 0
s_cbranch_scc1 L_pac10
buffer_inv sc1
s_waitcnt vmcnt(0)
L_pac10:
s_branch L_back11
L_rare15:
s_getpc_b64 s[58:59]
L_ct14:
s_add_u32 s58, s58, L_ptail-L_ct14
s_addc_u32 s59, s59, 0-((L_ptail-L_ct14)>>63)
s_and_b32 s57, s58, 0xf80
s_and_b32 s58, s58, 0xfffff000
v_lshrrev_b32 v224, 7, v253
v_lshlrev_b32 v224, 12, v224
v_max_u32 v224, s57, v224
v_and_b32 v225, 0x70, v253
v_lshl_add_u32 v224, v225, 3, v224
v_min_u32 v224, L_code_end-(L_ptail)-4, v224
v_mov_b32 v225, s59
v_add_co_u32 v224, vcc, s58, v224
s_nop 1
v_addc_co_u32 v225, vcc, 0, v225, vcc
global_load_dword v230, v[224:225], off
L_cts13:
s_mov_b32 s100, 0x20000
L_dp12:
v_readfirstlane_b32 s41, v227
s_nop 3
s_cmp_eq_u32 s41, 1
s_cselect_b32 s33, s28, 19
s_cmp_lg_u32 s41, 0
s_cbranch_scc1 L_dok12
s_sleep 2
buffer_load_dword v227, off, s[68:71], s83 offset:8 sc1
s_sub_u32 s100, s100, 1
s_cmp_lg_u32 s100, 0
s_waitcnt vmcnt(0)
s_cbranch_scc1 L_dp12
L_dok12:
s_branch L_back15
L_cend:
.p2align 12
L_tail2_3:
L_b13_3:
L_pg43:
s_cbranch_execz L_ir39
mm v,132,a,192,v,0,164
s_add_u32 m0, s30, 12288
v_exp_f32 v156, v156
mm v,132,a,196,v,8,132
tr 216,241,0
buffer_load_dwordx4 v160, s[16:19], s32 offen nt lds
v_lshrrev_b32 v224, 6, v253
mm v,132,a,200,v,16,132
s_add_u32 m0, s30, 0
v_exp_f32 v157, v157
mm v,132,a,204,v,24,132
tr 218,241,6144
v_cvt_pk_bf16_f32 v110, v156, v157
mm v,132,a,208,v,32,132
s_waitcnt lgkmcnt(10)
v_exp_f32 v158, v158
mm v,132,a,212,v,40,132
tr 220,241,12288
buffer_load_dwordx4 v144, s[16:19], s32 offen nt lds
s_add_u32 m0, s30, 12288
v_and_b32 v225, 6, v224
mm a,0,v,68,v,192,0
buffer_load_dwordx4 v161, s[16:19], s32 offen offset:1024 nt lds
s_add_u32 m0, s30, 18432
v_exp_f32 v159, v159
mm a,0,v,76,v,196,0
tr 222,241,18432
buffer_load_dwordx4 v168, s[16:19], s32 offen nt lds
v_cvt_pk_bf16_f32 v111, v158, v159
mm a,4,v,84,v,192,4
ds_read_b128 a[216:219], v236 offset:6144
v_lshlrev_b32 v224, 7, v224
mm a,4,v,92,v,196,4
ds_read_b128 a[220:223], v237 offset:6144
v_bfe_u32 v249, v253, 4, 1
mm a,8,v,100,v,192,8
ds_read_b128 a[224:227], v236 offset:6272
v_lshl_add_u32 v224, v249, 3, v224
mm a,8,v,108,v,196,8
ds_read_b128 a[228:231], v237 offset:6272
v_bfe_u32 v249, v253, 5, 1
mm v,140,a,192,v,48,172
s_add_u32 m0, s30, 0
v_exp_f32 v132, v132
mm v,140,a,196,v,56,140
ds_read_b128 a[232:235], v236 offset:6400
v_xor_b32 v225, v225, v249
mm v,140,a,200,v,64,140
v_exp_f32 v133, v133
mm v,140,a,204,v,72,140
ds_read_b128 a[236:239], v237 offset:6400
v_lshlrev_b32 v225, 4, v225
mm v,140,a,208,v,80,140
s_waitcnt lgkmcnt(14)
v_exp_f32 v134, v134
mm v,140,a,212,v,88,140
tr 192,238,128
buffer_load_dwordx4 v145, s[16:19], s32 offen offset:1024 nt lds
s_add_u32 m0, s30, 6144
v_cvt_pk_bf16_f32 v4, v132, v133
mm a,16,v,68,v,200,16
s_lshr_b32 s101, s24, 1
buffer_load_dwordx4 v152, s[16:19], s32 offen nt lds
s_add_u32 m0, s30, 12288
v_exp_f32 v135, v135
mm a,16,v,76,v,204,16
tr 194,238,6272
s_lshl_b32 s101, s101, 6
buffer_load_dwordx4 v162, s[16:19], s32 offen offset:2048 nt lds
s_add_u32 m0, s30, 18432
mm a,20,v,84,v,200,20
tr 196,238,12416
buffer_load_dwordx4 v169, s[16:19], s32 offen offset:1024 nt lds
v_xor_b32 v225, s101, v225
mm a,20,v,92,v,204,20
tr 198,238,18560
v_cvt_pk_bf16_f32 v5, v134, v135
mm a,24,v,100,v,200,24
s_lshr_b32 s101, s24, 1
s_mul_i32 s101, s101, 74496
s_add_u32 s101, s101, 1024
mm a,24,v,108,v,204,24
s_add_u32 m0, s30, 0
v_add_u32 v224, s101, v224
v_xor_b32 v249, 0, v225
mm v,148,a,192,v,96,180
v_exp_f32 v140, v140
mm v,148,a,196,v,104,148
tr 200,239,128
v_add_u32 v249, v249, v224
mm v,148,a,200,v,112,148
v_exp_f32 v141, v141
mm v,148,a,204,v,120,148
tr 202,239,6272
v_xor_b32 v250, 32, v225
mm v,148,a,208,v,128,148
s_waitcnt lgkmcnt(15)
v_exp_f32 v142, v142
mm v,148,a,212,v,136,148
tr 204,239,12416
v_cvt_pk_bf16_f32 v20, v140, v141
mm a,32,v,68,v,208,32
v_exp_f32 v143, v143
mm a,32,v,76,v,212,32
tr 206,239,18560
v_add_u32 v250, v250, v224
mm a,36,v,84,v,208,36
v_xor_b32 v251, 64, v225
v_add_u32 v251, v251, v224
mm a,36,v,92,v,212,36
v_cvt_pk_bf16_f32 v21, v142, v143
v_xor_b32 v242, 96, v225
mm a,40,v,100,v,208,40
buffer_load_dwordx4 v146, s[16:19], s32 offen offset:2048 nt lds
s_add_u32 m0, s30, 6144
v_add_u32 v242, v242, v224
mm a,40,v,108,v,212,40
s_waitcnt lgkmcnt(10)
buffer_load_dwordx4 v153, s[16:19], s32 offen offset:1024 nt lds
s_add_u32 s41, s32, 3072
s_add_u32 m0, s30, 15360
mm a,240,v,232,v,68,240
mm a,240,v,232,v,76,240
mm v,156,a,216,v,0,164
buffer_load_dwordx4 v160, s[16:19], s41 offen nt lds
s_add_u32 m0, s30, 18432
v_exp_f32 v148, v148
mm v,156,a,220,v,8,156
tr 208,240,128
buffer_load_dwordx4 v170, s[16:19], s32 offen offset:2048 nt lds
mm v,156,a,224,v,16,156
s_add_u32 m0, s30, 3072
v_exp_f32 v149, v149
mm v,156,a,228,v,24,156
tr 210,240,6272
s_waitcnt lgkmcnt(11)
mm v,156,a,232,v,32,156
s_waitcnt lgkmcnt(10)
v_exp_f32 v150, v150
mm v,156,a,236,v,40,156
tr 212,240,12416
v_cvt_pk_bf16_f32 v36, v148, v149
mm a,48,v,68,v,216,48
v_exp_f32 v151, v151
mm a,48,v,76,v,220,48
tr 214,240,18560
mm a,52,v,84,v,216,52
ds_read_b128 a[192:195], v236 offset:12288
mm a,52,v,92,v,220,52
ds_read_b128 a[196:199], v237 offset:12288
v_cvt_pk_bf16_f32 v37, v150, v151
mm a,56,v,100,v,216,56
ds_read_b128 a[200:203], v236 offset:12416
mm a,56,v,108,v,220,56
ds_read_b128 a[204:207], v237 offset:12416
mm v,132,a,216,v,48,172
v_exp_f32 v156, v156
mm v,132,a,220,v,56,132
ds_read_b128 a[208:211], v236 offset:12544
mm v,132,a,224,v,64,132
v_exp_f32 v157, v157
mm v,132,a,228,v,72,132
ds_read_b128 a[212:215], v237 offset:12544
mm v,132,a,232,v,80,132
s_waitcnt lgkmcnt(15)
v_exp_f32 v158, v158
mm v,132,a,236,v,88,132
tr 216,241,128
v_cvt_pk_bf16_f32 v6, v156, v157
mm a,64,v,68,v,192,64
s_waitcnt lgkmcnt(15)
v_exp_f32 v159, v159
mm a,64,v,76,v,196,64
tr 218,241,6272
buffer_load_dwordx4 v144, s[16:19], s41 offen nt lds
s_add_u32 m0, s30, 6144
mm a,68,v,84,v,192,68
tr 220,241,12416
buffer_load_dwordx4 v154, s[16:19], s32 offen offset:2048 nt lds
s_add_u32 m0, s30, 15360
mm a,68,v,92,v,196,68
tr 222,241,18560
buffer_load_dwordx4 v161, s[16:19], s41 offen offset:1024 nt lds
s_add_u32 m0, s30, 21504
v_cvt_pk_bf16_f32 v7, v158, v159
mm a,72,v,100,v,192,72
buffer_load_dwordx4 v168, s[16:19], s41 offen nt lds
mm a,72,v,108,v,196,72
s_add_u32 m0, s30, 3072
mm v,140,a,216,v,96,180
v_exp_f32 v132, v132
mm v,140,a,220,v,104,140
tr 192,238,256
mm v,140,a,224,v,112,140
v_exp_f32 v133, v133
mm v,140,a,228,v,120,140
tr 194,238,6400
mm v,140,a,232,v,128,140
s_waitcnt lgkmcnt(15)
v_exp_f32 v134, v134
mm v,140,a,236,v,136,140
tr 196,238,12544
v_cvt_pk_bf16_f32 v22, v132, v133
mm a,80,v,68,v,200,80
v_exp_f32 v135, v135
mm a,80,v,76,v,204,80
tr 198,238,18688
mm a,84,v,84,v,200,84
buffer_load_dwordx4 v145, s[16:19], s41 offen offset:1024 nt lds
s_add_u32 m0, s30, 9216
mm a,84,v,92,v,204,84
buffer_load_dwordx4 v152, s[16:19], s41 offen nt lds
s_add_u32 m0, s30, 15360
v_cvt_pk_bf16_f32 v23, v134, v135
mm a,88,v,100,v,200,88
buffer_load_dwordx4 v162, s[16:19], s41 offen offset:2048 nt lds
s_add_u32 m0, s30, 21504
mm a,88,v,108,v,204,88
s_waitcnt lgkmcnt(12)
buffer_load_dwordx4 v169, s[16:19], s41 offen offset:1024 nt lds
mm v,148,a,192,v,0,164
s_add_u32 m0, s30, 3072
v_exp_f32 v140, v140
mm v,148,a,196,v,8,148
tr 200,239,256
s_waitcnt lgkmcnt(12)
mm v,148,a,200,v,16,148
s_waitcnt lgkmcnt(11)
v_exp_f32 v141, v141
mm v,148,a,204,v,24,148
tr 202,239,6400
s_waitcnt lgkmcnt(11)
mm v,148,a,208,v,32,148
s_waitcnt lgkmcnt(10)
v_exp_f32 v142, v142
mm v,148,a,212,v,40,148
tr 204,239,12544
v_cvt_pk_bf16_f32 v38, v140, v141
mm a,96,v,68,v,208,96
v_exp_f32 v143, v143
mm a,96,v,76,v,212,96
tr 206,239,18688
mm a,100,v,84,v,208,100
ds_read_b128 a[216:219], v236 offset:18432
mm a,100,v,92,v,212,100
ds_read_b128 a[220:223], v237 offset:18432
v_cvt_pk_bf16_f32 v39, v142, v143
mm a,104,v,100,v,208,104
ds_read_b128 a[224:227], v236 offset:18560
buffer_load_dwordx4 v146, s[16:19], s41 offen offset:2048 nt lds
s_add_u32 m0, s30, 9216
mm a,104,v,108,v,212,104
ds_read_b128 a[228:231], v237 offset:18560
buffer_load_dwordx4 v153, s[16:19], s41 offen offset:1024 nt lds
s_add_u32 m0, s30, 21504
mm a,244,v,232,v,84,244
mm a,244,v,232,v,92,244
mm v,156,a,192,v,48,172
buffer_load_dwordx4 v170, s[16:19], s41 offen offset:2048 nt lds
v_exp_f32 v148, v148
mm v,156,a,196,v,56,156
ds_read_b128 a[232:235], v236 offset:18688
s_add_u32 m0, s30, 9216
mm v,156,a,200,v,64,156
v_exp_f32 v149, v149
mm v,156,a,204,v,72,156
ds_read_b128 a[236:239], v237 offset:18688
mm v,156,a,208,v,80,156
s_waitcnt lgkmcnt(15)
v_exp_f32 v150, v150
mm v,156,a,212,v,88,156
tr 208,240,256
v_cvt_pk_bf16_f32 v12, v148, v149
mm a,112,v,68,v,216,112
s_waitcnt lgkmcnt(15)
v_exp_f32 v151, v151
mm a,112,v,76,v,220,112
tr 210,240,6400
mm a,116,v,84,v,216,116
tr 212,240,12544
mm a,116,v,92,v,220,116
tr 214,240,18688
v_cvt_pk_bf16_f32 v13, v150, v151
mm a,120,v,100,v,216,120
buffer_load_dwordx4 v154, s[16:19], s41 offen offset:2048 nt lds
s_add_u32 s93, s93, 1
s_cmp_eq_u32 s93, 15
s_cselect_b32 s93, 0, s93
s_mul_i32 s55, s93, 13
s_lshr_b32 s55, s55, 6
s_mul_i32 s55, s55, 101376
s_mul_i32 s32, s93, 6144
s_add_u32 s32, s32, s55
s_add_u32 s32, s32, s89
v_lshlrev_b32 v184, 3, v253
mm a,120,v,108,v,220,120
s_add_u32 s41, s54, 3932160
s_nop 0
buffer_load_dword v185, v184, s[96:99], s41 offen
mm v,132,a,192,v,96,180
s_add_u32 s41, s54, 3940352
v_exp_f32 v156, v156
mm v,132,a,196,v,104,132
tr 216,241,256
mm v,132,a,200,v,112,132
v_exp_f32 v157, v157
mm v,132,a,204,v,120,132
tr 218,241,6400
buffer_load_dword v185, v184, s[96:99], s41 offen
mm v,132,a,208,v,128,132
s_waitcnt lgkmcnt(15)
v_exp_f32 v158, v158
mm v,132,a,212,v,136,132
tr 220,241,12544
v_cvt_pk_bf16_f32 v28, v156, v157
mm a,128,v,68,v,192,128
v_exp_f32 v159, v159
mm a,128,v,76,v,196,128
tr 222,241,18688
s_sub_u32 s42, s29, s49
mm a,132,v,84,v,192,132
s_mov_b32 s49, s29
v_add_u32 v238, s42, v238
v_add_u32 v239, s42, v239
mm a,132,v,92,v,196,132
v_cvt_pk_bf16_f32 v29, v158, v159
v_add_u32 v240, s42, v240
mm a,136,v,100,v,192,136
v_add_u32 v241, s42, v241
mm a,136,v,108,v,196,136
s_waitcnt lgkmcnt(13)
s_sub_u32 s47, s26, s25
v_add_u32 v236, s47, v236
mm v,140,a,216,v,0,164
s_waitcnt vmcnt(26) lgkmcnt(0)
v_exp_f32 v132, v132
mm v,140,a,220,v,8,140
v_add_u32 v237, s47, v237
mm v,140,a,224,v,16,140
s_barrier
v_exp_f32 v133, v133
mm v,140,a,228,v,24,140
tr 192,238,0
s_mov_b32 s43, s28
s_mov_b32 s28, s29
mm v,140,a,232,v,32,140
s_mov_b32 s29, s30
s_mov_b32 s30, s43
v_exp_f32 v134, v134
s_mov_b64 exec, 0
s_branch L_pg60
L_ir59:
s_mov_b64 exec, -1
L_ir59x:
mm v,140,a,236,v,40,140
tr 194,238,6144
s_mov_b32 s43, s25
s_mov_b32 s25, s26
v_cvt_pk_bf16_f32 v44, v132, v133
mm a,144,v,68,v,200,144
s_mov_b32 s26, s27
s_mov_b32 s27, s43
v_exp_f32 v135, v135
mm a,144,v,76,v,204,144
tr 196,238,12288
v_lshlrev_b32 v184, 3, v253
mm a,148,v,84,v,200,148
tr 198,238,18432
s_add_u32 s41, s54, 3948544
mm a,148,v,92,v,204,148
ds_read_b128 a[192:195], v236
v_cvt_pk_bf16_f32 v45, v134, v135
mm a,152,v,100,v,200,152
ds_read_b128 a[196:199], v237
mm a,152,v,108,v,204,152
ds_read_b128 a[200:203], v236 offset:128
mm v,148,a,216,v,48,172
v_exp_f32 v140, v140
mm v,148,a,220,v,56,148
ds_read_b128 a[204:207], v237 offset:128
mm v,148,a,224,v,64,148
v_exp_f32 v141, v141
mm v,148,a,228,v,72,148
ds_read_b128 a[208:211], v236 offset:256
mm v,148,a,232,v,80,148
v_exp_f32 v142, v142
mm v,148,a,236,v,88,148
ds_read_b128 a[212:215], v237 offset:256
v_cvt_pk_bf16_f32 v14, v140, v141
mm a,160,v,68,v,208,160
v_exp_f32 v143, v143
mm a,160,v,76,v,212,160
tr 200,239,0
mm a,164,v,84,v,208,164
tr 202,239,6144
mm a,164,v,92,v,212,164
tr 204,239,12288
v_cvt_pk_bf16_f32 v15, v142, v143
mm a,168,v,100,v,208,168
tr 206,239,18432
mm a,168,v,108,v,212,168
buffer_load_dword v185, v184, s[96:99], s41 offen
mm a,248,v,232,v,100,248
mm a,248,v,232,v,108,248
mm v,156,a,216,v,96,180
s_add_u32 s41, s54, 3954688
v_exp_f32 v148, v148
mm v,156,a,220,v,104,156
tr 208,240,0
mm v,156,a,224,v,112,156
v_exp_f32 v149, v149
mm v,156,a,228,v,120,156
tr 210,240,6144
mm v,156,a,232,v,128,156
v_exp_f32 v150, v150
mm v,156,a,236,v,136,156
tr 212,240,12288
v_cvt_pk_bf16_f32 v30, v148, v149
mm a,176,v,68,v,216,176
v_exp_f32 v151, v151
mm a,176,v,76,v,220,176
tr 214,240,18432
mm a,180,v,84,v,216,180
buffer_load_dword v185, v184, s[96:99], s41 offen
mm a,180,v,92,v,220,180
v_cvt_pk_bf16_f32 v31, v150, v151
mm a,184,v,100,v,216,184
mm a,184,v,108,v,220,184
s_waitcnt lgkmcnt(9)
mm v,132,a,192,v,0,164
buffer_load_dwordx2 v[226:227], off, s[72:75], s85 offset:0 sc1
v_exp_f32 v156, v156
mm v,132,a,196,v,8,132
tr 216,241,0
s_add_u32 m0, s78, 23808
mm v,132,a,200,v,16,132
s_add_u32 s51, s77, 0
v_exp_f32 v157, v157
mm v,132,a,204,v,24,132
tr 218,241,6144
v_cvt_pk_bf16_f32 v46, v156, v157
mm v,132,a,208,v,32,132
s_waitcnt lgkmcnt(10)
v_exp_f32 v158, v158
mm v,132,a,212,v,40,132
tr 220,241,12288
mm a,0,v,4,v,192,0
v_exp_f32 v159, v159
mm a,0,v,12,v,196,0
tr 222,241,18432
v_cvt_pk_bf16_f32 v47, v158, v159
mm a,4,v,20,v,192,4
ds_read_b128 a[216:219], v236 offset:6144
mm a,4,v,28,v,196,4
ds_read_b128 a[220:223], v237 offset:6144
mm a,8,v,36,v,192,8
ds_read_b128 a[224:227], v236 offset:6272
mm a,8,v,44,v,196,8
ds_read_b128 a[228:231], v237 offset:6272
mm v,140,a,192,v,48,172
v_exp_f32 v132, v132
mm v,140,a,196,v,56,140
ds_read_b128 a[232:235], v236 offset:6400
mm v,140,a,200,v,64,140
v_exp_f32 v133, v133
mm v,140,a,204,v,72,140
ds_read_b128 a[236:239], v237 offset:6400
mm v,140,a,208,v,80,140
s_waitcnt lgkmcnt(15)
v_exp_f32 v134, v134
mm v,140,a,212,v,88,140
tr 192,238,128
v_cvt_pk_bf16_f32 v68, v132, v133
mm a,16,v,4,v,200,16
s_waitcnt lgkmcnt(15)
v_exp_f32 v135, v135
mm a,16,v,12,v,204,16
tr 194,238,6272
mm a,20,v,20,v,200,20
tr 196,238,12416
s_mov_b64 exec, 0
s_branch L_pg62
L_ir61:
s_mov_b64 exec, -1
L_ir61x:
mm a,20,v,28,v,204,20
tr 198,238,18560
v_cvt_pk_bf16_f32 v69, v134, v135
mm a,24,v,36,v,200,24
buffer_load_dwordx4 v252, s[96:99], s51 offen lds
mm a,24,v,44,v,204,24
s_add_u32 s51, s77, 9216
mm v,148,a,192,v,96,180
v_exp_f32 v140, v140
mm v,148,a,196,v,104,148
tr 200,239,128
mm v,148,a,200,v,112,148
v_exp_f32 v141, v141
mm v,148,a,204,v,120,148
tr 202,239,6272
mm v,148,a,208,v,128,148
s_waitcnt lgkmcnt(15)
v_exp_f32 v142, v142
mm v,148,a,212,v,136,148
tr 204,239,12416
v_cvt_pk_bf16_f32 v84, v140, v141
mm a,32,v,4,v,208,32
v_exp_f32 v143, v143
mm a,32,v,12,v,212,32
tr 206,239,18560
mm a,36,v,20,v,208,36
buffer_load_dwordx4 v252, s[96:99], s51 offen offset:1024 lds
mm a,36,v,28,v,212,36
s_add_u32 s51, s77, 18432
v_cvt_pk_bf16_f32 v85, v142, v143
mm a,40,v,36,v,208,40
mm a,40,v,44,v,212,40
s_waitcnt lgkmcnt(12)
buffer_load_dwordx4 v252, s[96:99], s51 offen offset:2048 lds
mm a,240,v,232,v,4,240
mm a,240,v,232,v,12,240
mm v,156,a,216,v,0,164
s_add_u32 s51, s77, 27648
v_exp_f32 v148, v148
mm v,156,a,220,v,8,156
tr 208,240,128
s_waitcnt lgkmcnt(12)
mm v,156,a,224,v,16,156
s_waitcnt lgkmcnt(11)
v_exp_f32 v149, v149
mm v,156,a,228,v,24,156
tr 210,240,6272
s_waitcnt lgkmcnt(11)
mm v,156,a,232,v,32,156
s_waitcnt lgkmcnt(10)
v_exp_f32 v150, v150
mm v,156,a,236,v,40,156
tr 212,240,12416
v_cvt_pk_bf16_f32 v100, v148, v149
mm a,48,v,4,v,216,48
v_exp_f32 v151, v151
mm a,48,v,12,v,220,48
tr 214,240,18560
mm a,52,v,20,v,216,52
ds_read_b128 a[192:195], v236 offset:12288
mm a,52,v,28,v,220,52
ds_read_b128 a[196:199], v237 offset:12288
v_cvt_pk_bf16_f32 v101, v150, v151
mm a,56,v,36,v,216,56
ds_read_b128 a[200:203], v236 offset:12416
mm a,56,v,44,v,220,56
ds_read_b128 a[204:207], v237 offset:12416
buffer_load_dwordx4 v252, s[96:99], s51 offen offset:3072 lds
mm v,132,a,216,v,48,172
s_add_u32 m0, s78, 27904
v_exp_f32 v156, v156
mm v,132,a,220,v,56,132
ds_read_b128 a[208:211], v236 offset:12544
s_add_u32 s51, s77, 40960
mm v,132,a,224,v,64,132
v_exp_f32 v157, v157
mm v,132,a,228,v,72,132
ds_read_b128 a[212:215], v237 offset:12544
mm v,132,a,232,v,80,132
s_waitcnt lgkmcnt(15)
v_exp_f32 v158, v158
mm v,132,a,236,v,88,132
tr 216,241,128
v_cvt_pk_bf16_f32 v70, v156, v157
mm a,64,v,4,v,192,64
s_waitcnt lgkmcnt(15)
v_exp_f32 v159, v159
mm a,64,v,12,v,196,64
tr 218,241,6272
mm a,68,v,20,v,192,68
tr 220,241,12416
mm a,68,v,28,v,196,68
tr 222,241,18560
v_cvt_pk_bf16_f32 v71, v158, v159
mm a,72,v,36,v,192,72
mm a,72,v,44,v,196,72
buffer_load_dwordx4 v252, s[96:99], s51 offen lds
mm v,140,a,216,v,96,180
s_add_u32 s51, s77, 50176
v_exp_f32 v132, v132
s_mov_b64 exec, 0
s_branch L_pg64
L_ir63:
s_mov_b64 exec, -1
L_ir63x:
mm v,140,a,220,v,104,140
tr 192,238,256
mm v,140,a,224,v,112,140
v_exp_f32 v133, v133
mm v,140,a,228,v,120,140
tr 194,238,6400
mm v,140,a,232,v,128,140
s_waitcnt lgkmcnt(15)
v_exp_f32 v134, v134
mm v,140,a,236,v,136,140
tr 196,238,12544
v_cvt_pk_bf16_f32 v86, v132, v133
mm a,80,v,4,v,200,80
v_exp_f32 v135, v135
mm a,80,v,12,v,204,80
tr 198,238,18688
mm a,84,v,20,v,200,84
mm a,84,v,28,v,204,84
v_cvt_pk_bf16_f32 v87, v134, v135
mm a,88,v,36,v,200,88
mm a,88,v,44,v,204,88
s_waitcnt lgkmcnt(12)
buffer_load_dwordx4 v252, s[96:99], s51 offen offset:1024 lds
mm v,148,a,192,v,0,164
s_add_u32 s51, s77, 59392
v_exp_f32 v140, v140
mm v,148,a,196,v,8,148
tr 200,239,256
s_waitcnt lgkmcnt(12)
mm v,148,a,200,v,16,148
s_waitcnt lgkmcnt(11)
v_exp_f32 v141, v141
mm v,148,a,204,v,24,148
tr 202,239,6400
s_waitcnt lgkmcnt(11)
mm v,148,a,208,v,32,148
s_waitcnt lgkmcnt(10)
v_exp_f32 v142, v142
mm v,148,a,212,v,40,148
tr 204,239,12544
v_cvt_pk_bf16_f32 v102, v140, v141
mm a,96,v,4,v,208,96
v_exp_f32 v143, v143
mm a,96,v,12,v,212,96
tr 206,239,18688
mm a,100,v,20,v,208,100
ds_read_b128 a[216:219], v236 offset:18432
mm a,100,v,28,v,212,100
ds_read_b128 a[220:223], v237 offset:18432
v_cvt_pk_bf16_f32 v103, v142, v143
mm a,104,v,36,v,208,104
ds_read_b128 a[224:227], v236 offset:18560
mm a,104,v,44,v,212,104
ds_read_b128 a[228:231], v237 offset:18560
mm a,244,v,232,v,20,244
mm a,244,v,232,v,28,244
mm v,156,a,192,v,48,172
v_exp_f32 v148, v148
mm v,156,a,196,v,56,156
ds_read_b128 a[232:235], v236 offset:18688
mm v,156,a,200,v,64,156
v_exp_f32 v149, v149
mm v,156,a,204,v,72,156
ds_read_b128 a[236:239], v237 offset:18688
mm v,156,a,208,v,80,156
s_waitcnt lgkmcnt(15)
v_exp_f32 v150, v150
mm v,156,a,212,v,88,156
tr 208,240,256
v_cvt_pk_bf16_f32 v76, v148, v149
mm a,112,v,4,v,216,112
s_waitcnt lgkmcnt(15)
v_exp_f32 v151, v151
mm a,112,v,12,v,220,112
tr 210,240,6400
mm a,116,v,20,v,216,116
tr 212,240,12544
mm a,116,v,28,v,220,116
tr 214,240,18688
v_cvt_pk_bf16_f32 v77, v150, v151
mm a,120,v,36,v,216,120
buffer_load_dwordx4 v252, s[96:99], s51 offen offset:2048 lds
mm a,120,v,44,v,220,120
s_add_u32 s51, s77, 68608
buffer_load_dwordx4 v252, s[96:99], s51 offen offset:3072 lds
mm v,132,a,192,v,96,180
v_exp_f32 v156, v156
mm v,132,a,196,v,104,132
tr 216,241,256
mm v,132,a,200,v,112,132
v_exp_f32 v157, v157
mm v,132,a,204,v,120,132
tr 218,241,6400
mm v,132,a,208,v,128,132
s_waitcnt lgkmcnt(15)
v_exp_f32 v158, v158
mm v,132,a,212,v,136,132
tr 220,241,12544
v_cvt_pk_bf16_f32 v92, v156, v157
mm a,128,v,4,v,192,128
v_exp_f32 v159, v159
mm a,128,v,12,v,196,128
tr 222,241,18688
s_sub_u32 s42, s29, s49
mm a,132,v,20,v,192,132
s_mov_b32 s49, s29
v_add_u32 v238, s42, v238
v_add_u32 v239, s42, v239
mm a,132,v,28,v,196,132
v_cvt_pk_bf16_f32 v93, v158, v159
v_add_u32 v240, s42, v240
mm a,136,v,36,v,192,136
v_add_u32 v241, s42, v241
mm a,136,v,44,v,196,136
s_waitcnt vmcnt(8) lgkmcnt(13)
s_mov_b32 s100, 0x20000
L_poll17:
v_readfirstlane_b32 s41, v226
v_readfirstlane_b32 s55, v227
s_nop 3
s_bitcmp1_b32 s2, 0
s_cselect_b32 s35, s55, s41
s_and_b32 s41, s41, 255
s_and_b32 s55, s55, 255
s_min_u32 s41, s41, s55
s_cmp_ge_u32 s41, 32
s_cbranch_scc1 L_pok17
s_sleep 2
buffer_load_dwordx2 v[226:227], off, s[72:75], s85 offset:0 sc1
s_sub_u32 s100, s100, 1
s_cmp_lg_u32 s100, 0
s_waitcnt vmcnt(0)
s_cbranch_scc1 L_poll17
L_pok17:
s_lshl_b32 s41, s40, 5
s_sub_u32 s35, s35, s41
mm v,140,a,216,v,0,164
s_waitcnt lgkmcnt(0)
v_exp_f32 v132, v132
mm v,140,a,220,v,8,140
mm v,140,a,224,v,16,140
s_barrier
v_exp_f32 v133, v133
mm v,140,a,228,v,24,140
tr 192,238,0
s_mov_b32 s43, s28
s_mov_b32 s28, s29
mm v,140,a,232,v,32,140
v_exp_f32 v134, v134
s_mov_b64 exec, 0
s_branch L_pg66
L_ir65:
s_mov_b64 exec, -1
L_ir65x:
mm v,140,a,236,v,40,140
tr 194,238,6144
v_cvt_pk_bf16_f32 v108, v132, v133
mm a,144,v,4,v,200,144
s_mov_b32 s29, s30
s_mov_b32 s30, s43
v_exp_f32 v135, v135
mm a,144,v,12,v,204,144
tr 196,238,12288
s_add_u32 m0, s78, 48640
mm a,148,v,20,v,200,148
tr 198,238,18432
s_add_u32 s51, s77, 81920
mm a,148,v,28,v,204,148
v_cvt_pk_bf16_f32 v109, v134, v135
mm a,152,v,36,v,200,152
buffer_load_dwordx4 v252, s[96:99], s51 offen lds
mm a,152,v,44,v,204,152
s_add_u32 s101, s76, 0
buffer_load_dwordx4 a[192:195], v253, s[60:63], s101 offen sc1
mm v,148,a,216,v,48,172
s_add_u32 s51, s77, 91136
v_exp_f32 v140, v140
mm v,148,a,220,v,56,148
tr 200,239,0
buffer_load_dwordx4 v252, s[96:99], s51 offen offset:1024 lds
mm v,148,a,224,v,64,148
buffer_load_dwordx4 a[196:199], v253, s[60:63], s101 offen offset:1024 sc1
v_exp_f32 v141, v141
mm v,148,a,228,v,72,148
tr 202,239,6144
s_add_u32 s51, s77, 100352
buffer_load_dwordx4 v252, s[96:99], s51 offen offset:2048 lds
mm v,148,a,232,v,80,148
v_exp_f32 v142, v142
mm v,148,a,236,v,88,148
tr 204,239,12288
v_cvt_pk_bf16_f32 v78, v140, v141
mm a,160,v,4,v,208,160
s_add_u32 s101, s76, 6144
v_exp_f32 v143, v143
mm a,160,v,12,v,212,160
tr 206,239,18432
buffer_load_dwordx4 a[200:203], v253, s[60:63], s101 offen sc1
mm a,164,v,20,v,208,164
s_add_u32 s51, s77, 109568
buffer_load_dwordx4 v252, s[96:99], s51 offen offset:3072 lds
mm a,164,v,28,v,212,164
s_add_u32 m0, s78, 52736
s_add_u32 s51, s77, 122880
v_cvt_pk_bf16_f32 v79, v142, v143
mm a,168,v,36,v,208,168
buffer_load_dwordx4 v252, s[96:99], s51 offen lds
mm a,168,v,44,v,212,168
buffer_load_dwordx4 a[204:207], v253, s[60:63], s101 offen offset:1024 sc1
mm a,248,v,232,v,36,248
mm a,248,v,232,v,44,248
mm v,156,a,216,v,96,180
s_add_u32 s51, s77, 132096
v_exp_f32 v148, v148
mm v,156,a,220,v,104,156
tr 208,240,0
buffer_load_dwordx4 v252, s[96:99], s51 offen offset:1024 lds
mm v,156,a,224,v,112,156
s_add_u32 s101, s76, 12288
v_exp_f32 v149, v149
mm v,156,a,228,v,120,156
tr 210,240,6144
buffer_load_dwordx4 a[208:211], v253, s[60:63], s101 offen sc1
mm v,156,a,232,v,128,156
v_exp_f32 v150, v150
mm v,156,a,236,v,136,156
tr 212,240,12288
v_cvt_pk_bf16_f32 v94, v148, v149
mm a,176,v,4,v,216,176
s_add_u32 s51, s77, 141312
v_exp_f32 v151, v151
mm a,176,v,12,v,220,176
tr 214,240,18432
buffer_load_dwordx4 v252, s[96:99], s51 offen offset:2048 lds
mm a,180,v,20,v,216,180
buffer_load_dwordx4 a[212:215], v253, s[60:63], s101 offen offset:1024 sc1
mm a,180,v,28,v,220,180
s_add_u32 s51, s77, 150528
v_cvt_pk_bf16_f32 v95, v150, v151
mm a,184,v,36,v,216,184
buffer_load_dwordx4 v252, s[96:99], s51 offen offset:3072 lds
mm a,184,v,44,v,220,184
s_waitcnt lgkmcnt(8)
mm a,0,v,68,v,192,0
buffer_load_dword v226, off, s[68:71], s83 offset:4 sc1
v_exp_f32 v156, v156
v_exp_f32 v157, v157
mm a,0,v,76,v,196,0
v_exp_f32 v158, v158
v_exp_f32 v159, v159
mm a,4,v,84,v,192,4
s_waitcnt lgkmcnt(4)
v_cvt_pk_bf16_f32 v110, v156, v157
v_cvt_pk_bf16_f32 v111, v158, v159
mm a,4,v,92,v,196,4
s_nop 0
buffer_load_dwordx4 v[36:39], v253, s[60:63], 0 offen sc1
mm a,8,v,100,v,192,8
tr 216,241,0
buffer_load_dwordx4 v[44:47], v253, s[60:63], 0 offen offset:1024 sc1
v_bfe_u32 v134, v253, 4, 4
mm a,8,v,108,v,196,8
tr 218,241,6144
buffer_load_dwordx4 v[52:55], v253, s[96:99], 0 offen
v_lshrrev_b32 v135, 8, v253
mm a,240,v,232,v,68,240
mm a,240,v,232,v,76,240
mm a,244,v,232,v,84,244
mm a,244,v,232,v,92,244
mm a,248,v,232,v,100,248
mm a,248,v,232,v,108,248
mm a,16,v,68,v,200,16
tr 220,241,12288
buffer_load_dwordx4 v[60:63], v253, s[96:99], 0 offen offset:1024
v_lshlrev_b32 v135, 2, v135
mm a,16,v,76,v,204,16
tr 222,241,18432
mm a,20,v,84,v,200,20
tr 192,238,128
v_sub_u32 v134, v134, v135
mm a,20,v,92,v,204,20
tr 194,238,6272
v_min_u32 v134, 4, v134
mm a,24,v,100,v,200,24
tr 196,238,12416
v_lshlrev_b32 v134, 4, v134
mm a,24,v,108,v,204,24
tr 198,238,18560
s_waitcnt lgkmcnt(8)
mm a,32,v,68,v,208,32
tr 200,239,128
v_mov_b32 v140, 0x3f80
s_mov_b64 exec, 0
s_branch L_pg68
L_ir67:
s_mov_b64 exec, -1
L_ir67x:
mm a,32,v,76,v,212,32
tr 202,239,6272
v_mov_b32 v141, 0
v_lshlrev_b64 v[132:133], v134, v[140:141]
mm a,36,v,84,v,208,36
tr 204,239,12416
v_accvgpr_read_b32 v232, a240
v_cmp_gt_u32 vcc, 64, v134
mm a,36,v,92,v,212,36
tr 206,239,18560
v_mov_b32 v140, 0
mm a,40,v,100,v,208,40
v_accvgpr_read_b32 v233, a244
v_accvgpr_read_b32 v234, a248
v_mov_b32 v134, 0
mm a,40,v,108,v,212,40
s_waitcnt lgkmcnt(8)
v_add_f32 v224, v232, v233
v_add_f32 v224, v224, v234
mm a,48,v,68,v,216,48
tr 208,240,128
v_cmp_ngt_f32 s[52:53], s37, v224
mm a,48,v,76,v,220,48
tr 210,240,6272
v_mov_b32 v135, 0
v_cndmask_b32 v132, 0, v132, vcc
mm a,52,v,84,v,216,52
tr 212,240,12416
v_mov_b32 v143, v133
v_mov_b32 v142, v132
mm a,52,v,92,v,220,52
tr 214,240,18560
mm a,56,v,100,v,216,56
v_rcp_f32 v232, v232
mm a,56,v,108,v,220,56
s_waitcnt lgkmcnt(10)
v_rcp_f32 v233, v233
mm a,64,v,68,v,192,64
tr 216,241,128
s_waitcnt lgkmcnt(9)
mm a,64,v,76,v,196,64
tr 218,241,6272
mm a,68,v,84,v,192,68
tr 220,241,12416
mm a,68,v,92,v,196,68
tr 222,241,18560
mm a,72,v,100,v,192,72
s_waitcnt lgkmcnt(8)
v_rcp_f32 v234, v234
mm a,72,v,108,v,196,72
s_lshl_b32 s101, s24, 8
s_add_u32 s101, s101, 161536
v_bfe_u32 v225, v253, 4, 4
mm a,80,v,68,v,200,80
tr 192,238,256
v_lshl_add_u32 v225, v225, 2, s101
mm a,80,v,76,v,204,80
tr 194,238,6400
mm a,84,v,84,v,200,84
tr 196,238,12544
mm a,84,v,92,v,204,84
tr 198,238,18688
mm a,88,v,100,v,200,88
ds_write_b32 v225, v232
mm a,88,v,108,v,204,88
ds_write_b32 v225, v233 offset:64
s_waitcnt lgkmcnt(12)
mm a,96,v,68,v,208,96
tr 200,239,256
s_waitcnt lgkmcnt(11)
mm a,96,v,76,v,212,96
tr 202,239,6400
mm a,100,v,84,v,208,100
tr 204,239,12544
s_lshl_b32 s42, s24, 30
mm a,100,v,92,v,212,100
tr 206,239,18688
s_waitcnt lgkmcnt(10)
mm a,104,v,100,v,208,104
ds_write_b32 v225, v234 offset:128
s_and_b32 s42, s42, 0x80000000
mm a,104,v,108,v,212,104
s_cmp_lg_u64 s[52:53], 0
s_cselect_b32 s52, 1, 0
s_lshl_b32 s101, s24, 2
mm a,112,v,68,v,216,112
tr 208,240,256
s_add_u32 s101, s101, 161280
mm a,112,v,76,v,220,112
tr 210,240,6400
v_mov_b32 v224, s52
mm a,116,v,84,v,216,116
tr 212,240,12544
s_waitcnt vmcnt(4)
v_lshl_or_b32 v224, v226, 1, v224
mm a,116,v,92,v,220,116
tr 214,240,18688
s_waitcnt lgkmcnt(11)
v_mov_b32 v225, s101
mm a,120,v,100,v,216,120
ds_write_b32 v225, v224
v_mov_b32 v254, 161280
mm a,120,v,108,v,220,120
s_add_u32 s101, s76, 18432
buffer_load_dwordx4 a[216:219], v253, s[60:63], s101 offen sc1
ds_read_b128 v[232:235], v246
v_accvgpr_read_b32 v4, a0
v_accvgpr_read_b32 v5, a1
v_accvgpr_read_b32 v6, a2
v_accvgpr_read_b32 v7, a3
v_accvgpr_read_b32 v12, a16
v_accvgpr_read_b32 v13, a17
mm a,128,v,68,v,192,128
tr 216,241,256
buffer_load_dwordx4 a[220:223], v253, s[60:63], s101 offen offset:1024 sc1
v_accvgpr_read_b32 v14, a18
v_accvgpr_read_b32 v15, a19
mm a,128,v,76,v,196,128
tr 218,241,6400
s_add_u32 s101, s76, 24576
s_waitcnt lgkmcnt(2)
v_mul_f32_e64 v148, -v248, v232
v_mul_f32_e64 v149, -v248, v233
v_mul_f32_e64 v150, -v248, v234
v_mul_f32_e64 v151, -v248, v235
v_fma_f32 v4, v4, v232, v148
v_fma_f32 v5, v5, v233, v149
v_fma_f32 v6, v6, v234, v150
v_fma_f32 v7, v7, v235, v151
v_fma_f32 v12, v12, v232, v148
v_fma_f32 v13, v13, v233, v149
v_fma_f32 v14, v14, v234, v150
v_fma_f32 v15, v15, v235, v151
v_cvt_pk_bf16_f32 v4, v4, v5
mm a,132,v,84,v,192,132
tr 220,241,12544
v_cvt_pk_bf16_f32 v5, v6, v7
v_cvt_pk_bf16_f32 v6, v12, v13
v_cvt_pk_bf16_f32 v7, v14, v15
mm a,132,v,92,v,196,132
tr 222,241,18688
mz v,20,v,4,v,132
mz v,28,v,4,v,140
mm a,136,v,100,v,192,136
buffer_load_dwordx4 a[224:227], v253, s[60:63], s101 offen sc1
ds_read_b128 v[232:235], v246 offset:64
v_accvgpr_read_b32 v4, a4
v_accvgpr_read_b32 v5, a5
v_accvgpr_read_b32 v6, a6
v_accvgpr_read_b32 v7, a7
v_accvgpr_read_b32 v12, a20
v_accvgpr_read_b32 v13, a21
v_accvgpr_read_b32 v14, a22
v_accvgpr_read_b32 v15, a23
v_cvt_pk_bf16_f32 v20, v20, v21
v_cvt_pk_bf16_f32 v21, v22, v23
v_cvt_pk_bf16_f32 v22, v28, v29
v_cvt_pk_bf16_f32 v23, v30, v31
mm a,136,v,108,v,196,136
buffer_load_dwordx4 a[228:231], v253, s[60:63], s101 offen offset:1024 sc1
s_add_u32 s50, s46, 0
buffer_store_dwordx4 v[20:23], v253, s[20:23], s50 offen
s_waitcnt vmcnt(6) lgkmcnt(0)
v_mul_f32_e64 v148, -v248, v232
v_mul_f32_e64 v149, -v248, v233
v_mul_f32_e64 v150, -v248, v234
v_mul_f32_e64 v151, -v248, v235
v_fma_f32 v4, v4, v232, v148
v_fma_f32 v5, v5, v233, v149
v_fma_f32 v6, v6, v234, v150
v_fma_f32 v7, v7, v235, v151
v_fma_f32 v12, v12, v232, v148
v_fma_f32 v13, v13, v233, v149
v_fma_f32 v14, v14, v234, v150
mm a,144,v,68,v,200,144
s_add_u32 s101, s76, 2048
v_max3_f32 v157, |v36|, |v37|, |v38|
v_max3_f32 v157, v157, |v39|, |v44|
v_max3_f32 v157, v157, |v45|, |v46|
v_fma_f32 v15, v15, v235, v151
v_cvt_pk_bf16_f32 v4, v4, v5
v_cvt_pk_bf16_f32 v5, v6, v7
v_cvt_pk_bf16_f32 v6, v12, v13
v_cvt_pk_bf16_f32 v7, v14, v15
mm a,144,v,76,v,204,144
buffer_load_dwordx4 a[232:235], v253, s[60:63], s101 offen sc1
v_max3_f32 v157, v157, |v47|, |v47|
mz v,20,v,4,v,132
mz v,28,v,4,v,140
mm a,148,v,84,v,200,148
buffer_load_dwordx4 a[236:239], v253, s[60:63], s101 offen offset:1024 sc1
ds_read_b128 v[232:235], v246 offset:128
v_max3_f32 v156, |v52|, |v53|, |v54|
v_accvgpr_read_b32 v4, a8
v_accvgpr_read_b32 v5, a9
v_accvgpr_read_b32 v6, a10
v_accvgpr_read_b32 v7, a11
v_accvgpr_read_b32 v12, a24
v_accvgpr_read_b32 v13, a25
v_accvgpr_read_b32 v14, a26
v_accvgpr_read_b32 v15, a27
v_cvt_pk_bf16_f32 v20, v20, v21
v_cvt_pk_bf16_f32 v21, v22, v23
v_cvt_pk_bf16_f32 v22, v28, v29
v_cvt_pk_bf16_f32 v23, v30, v31
mm a,148,v,92,v,204,148
s_add_u32 s101, s76, 8192
s_add_u32 s50, s46, 6144
buffer_store_dwordx4 v[20:23], v253, s[20:23], s50 offen
s_waitcnt vmcnt(8) lgkmcnt(0)
v_max3_f32 v156, v156, |v55|, |v60|
v_max3_f32 v156, v156, |v61|, |v62|
v_max3_f32 v156, v156, |v63|, |v63|
v_mul_f32_e64 v148, -v248, v232
v_mul_f32_e64 v149, -v248, v233
v_mul_f32_e64 v150, -v248, v234
v_mul_f32_e64 v151, -v248, v235
v_fma_f32 v4, v4, v232, v148
v_fma_f32 v5, v5, v233, v149
v_fma_f32 v6, v6, v234, v150
v_fma_f32 v7, v7, v235, v151
v_fma_f32 v12, v12, v232, v148
mm a,152,v,100,v,200,152
buffer_load_dwordx4 a[240:243], v253, s[60:63], s101 offen sc1
v_mul_f32 v156, v156, v157
v_fma_f32 v13, v13, v233, v149
v_fma_f32 v14, v14, v234, v150
v_fma_f32 v15, v15, v235, v151
v_cvt_pk_bf16_f32 v4, v4, v5
v_cvt_pk_bf16_f32 v5, v6, v7
v_cvt_pk_bf16_f32 v6, v12, v13
v_cvt_pk_bf16_f32 v7, v14, v15
mm a,152,v,108,v,204,152
buffer_load_dwordx4 a[244:247], v253, s[60:63], s101 offen offset:1024 sc1
s_waitcnt lgkmcnt(0)
v_and_b32 v156, 0x7f800000, v156
v_mul_f32 v156, 0x43c00000, v156
mz v,20,v,4,v,132
mz v,28,v,4,v,140
mm a,160,v,68,v,208,160
s_add_u32 s101, s76, 14336
v_min_f32 v156, 0x71800000, v156
s_nop 0
v_readlane_b32 s57, v156, 0
v_readlane_b32 s58, v156, 21
v_readlane_b32 s59, v156, 42
s_nop 3
s_min_u32 s57, s57, s58
s_min_u32 s57, s57, s59
v_mov_b32 v156, s57
mm a,160,v,76,v,212,160
buffer_load_dwordx4 a[248:251], v253, s[60:63], s101 offen sc1
s_barrier
v_xor_b32 v156, s42, v156
v_mov_b32 v157, v156
mm a,164,v,84,v,208,164
ds_read_b128 v[228:231], v254
v_mov_b32 v158, v156
v_mov_b32 v159, v156
mm a,164,v,92,v,212,164
buffer_load_dwordx4 a[252:255], v253, s[60:63], s101 offen offset:1024 sc1
mm a,168,v,100,v,208,168
s_add_u32 s101, s76, 20480
tr 192,249,23808
v_accvgpr_write_b32 a24, v140
v_accvgpr_write_b32 a25, v141
mm a,168,v,108,v,212,168
buffer_load_dwordx4 v[164:167], v253, s[60:63], s101 offen sc1
tr 194,249,25856
mm a,176,v,68,v,216,176
buffer_load_dwordx4 v[172:175], v253, s[60:63], s101 offen offset:1024 sc1
v_cvt_pk_bf16_f32 v20, v20, v21
v_accvgpr_write_b32 a26, v142
s_waitcnt lgkmcnt(2)
v_or3_b32 v228, v228, v229, v230
v_or_b32 v228, v228, v231
mm a,176,v,76,v,220,176
s_add_u32 s101, s76, 26624
tr 196,249,27904
v_cvt_pk_bf16_f32 v21, v22, v23
v_accvgpr_write_b32 a27, v143
v_readfirstlane_b32 s52, v228
mm a,180,v,84,v,216,180
buffer_load_dwordx4 v[180:183], v253, s[60:63], s101 offen sc1
v_cvt_pk_bf16_f32 v22, v28, v29
v_accvgpr_write_b32 a28, 0
mm a,180,v,92,v,220,180
tr 198,249,29952
v_cvt_pk_bf16_f32 v23, v30, v31
v_accvgpr_write_b32 a29, 0
mm a,184,v,100,v,216,184
buffer_load_dwordx4 v[188:191], v253, s[60:63], s101 offen offset:1024 sc1
s_add_u32 s50, s46, 12288
buffer_store_dwordx4 v[20:23], v253, s[20:23], s50 offen
mm a,184,v,108,v,220,184
tr 200,250,23808
tr 202,250,25856
tr 204,250,27904
tr 206,250,29952
s_and_b32 s53, s52, 1
s_andn2_b32 s53, s53, s87
s_cbranch_scc1 L_slow_3
s_mov_b32 s87, 0
s_cmp_lg_u32 s88, 0
s_cbranch_scc1 L_idle_3
s_waitcnt lgkmcnt(4)
mm v,0,a,192,v,192,156
tr 208,251,23808
s_add_u32 s101, s76, 4096
s_lshr_b32 s27, s52, 1
mm v,0,a,196,v,196,0
tr 210,251,25856
s_sub_u32 s27, 4, s27
mm v,4,a,200,v,192,156
buffer_load_dwordx4 v[160:163], v253, s[60:63], s101 offen sc1
mm v,4,a,204,v,196,4
s_add_u32 m0, s78, 0
s_add_u32 s51, s77, 163840
s_waitcnt vmcnt(17)
mm v,8,a,208,v,192,156
buffer_load_dwordx4 v252, s[96:99], s51 offen lds
v_accvgpr_read_b32 v216, a40
mm v,8,a,212,v,196,8
tr 212,251,27904
v_accvgpr_read_b32 v217, a41
v_accvgpr_read_b32 v218, a42
mm v,12,a,216,v,192,156
tr 214,251,29952
s_waitcnt vmcnt(17)
v_accvgpr_read_b32 v219, a43
v_accvgpr_read_b32 v220, a56
mm v,12,a,220,v,196,12
s_waitcnt vmcnt(15) lgkmcnt(4)
v_accvgpr_read_b32 v221, a57
v_accvgpr_read_b32 v222, a58
v_accvgpr_read_b32 v223, a59
mm v,16,a,224,v,192,156
buffer_load_dwordx4 v[168:171], v253, s[60:63], s101 offen offset:1024 sc1
v_mul_f32_e64 v236, -v248, v232
v_mul_f32_e64 v237, -v248, v233
v_mul_f32_e64 v238, -v248, v234
mm v,16,a,228,v,196,16
s_sub_u32 s41, s27, 2
v_mov_b32 v254, s41
s_mov_b64 exec, 1
buffer_store_dword v254, off, s[68:71], s82 offset:8 sc1
s_mov_b64 exec, -1
mm v,20,a,192,v,200,156
tr 192,242,23808
s_add_u32 s51, s77, 173056
v_mul_f32_e64 v239, -v248, v235
mm v,20,a,196,v,204,20
tr 194,242,25856
v_fma_f32 v216, v216, v232, v236
v_fma_f32 v217, v217, v233, v237
mm v,24,a,200,v,200,156
v_fma_f32 v218, v218, v234, v238
v_fma_f32 v219, v219, v235, v239
v_fma_f32 v220, v220, v232, v236
mm v,24,a,204,v,204,24
buffer_load_dwordx4 v252, s[96:99], s51 offen offset:1024 lds
v_fma_f32 v221, v221, v233, v237
mm v,28,a,208,v,200,156
s_add_u32 s101, s76, 10240
v_fma_f32 v222, v222, v234, v238
v_fma_f32 v223, v223, v235, v239
mm v,28,a,212,v,204,28
tr 196,242,27904
v_cvt_pk_bf16_f32 v216, v216, v217
v_cvt_pk_bf16_f32 v217, v218, v219
mm v,32,a,216,v,200,156
tr 198,242,29952
v_cvt_pk_bf16_f32 v218, v220, v221
mm v,32,a,220,v,204,32
buffer_load_dwordx4 v[176:179], v253, s[60:63], s101 offen sc1
v_cvt_pk_bf16_f32 v219, v222, v223
mm v,36,a,224,v,200,156
s_add_u32 s51, s77, 182272
s_waitcnt lgkmcnt(4)
mm v,36,a,228,v,204,36
mz v,224,v,216,a,26
mz v,228,v,216,a,24
v_accvgpr_read_b32 v216, a72
v_accvgpr_read_b32 v217, a73
v_accvgpr_read_b32 v218, a74
v_accvgpr_read_b32 v219, a75
mm v,40,a,192,v,208,156
tr 200,249,32000
v_accvgpr_read_b32 v220, a88
v_accvgpr_read_b32 v221, a89
mm v,40,a,196,v,212,40
tr 202,249,34048
v_accvgpr_read_b32 v222, a90
v_accvgpr_read_b32 v223, a91
mm v,44,a,200,v,208,156
buffer_load_dwordx4 v252, s[96:99], s51 offen offset:2048 lds
v_cvt_pk_bf16_f32 v224, v224, v225
v_cvt_pk_bf16_f32 v225, v226, v227
mm v,44,a,204,v,212,44
v_cvt_pk_bf16_f32 v226, v228, v229
v_cvt_pk_bf16_f32 v227, v230, v231
mm v,48,a,208,v,208,156
s_add_u32 s50, s46, 12288
buffer_store_dwordx4 v[224:227], v253, s[20:23], s50 offen offset:1024
mm v,48,a,212,v,212,48
tr 204,249,36096
v_fma_f32 v216, v216, v232, v236
v_fma_f32 v217, v217, v233, v237
mm v,52,a,216,v,208,156
tr 206,249,38144
v_fma_f32 v218, v218, v234, v238
mm v,52,a,220,v,212,52
buffer_load_dwordx4 v[184:187], v253, s[60:63], s101 offen offset:1024 sc1
v_fma_f32 v219, v219, v235, v239
v_fma_f32 v220, v220, v232, v236
mm v,56,a,224,v,208,156
s_add_u32 s51, s77, 191488
v_fma_f32 v221, v221, v233, v237
v_fma_f32 v222, v222, v234, v238
mm v,56,a,228,v,212,56
s_waitcnt lgkmcnt(4)
v_fma_f32 v223, v223, v235, v239
v_cvt_pk_bf16_f32 v216, v216, v217
mm v,60,a,192,v,192,156
tr 208,250,32000
v_cvt_pk_bf16_f32 v217, v218, v219
mm v,60,a,196,v,196,60
tr 210,250,34048
v_cvt_pk_bf16_f32 v218, v220, v221
v_cvt_pk_bf16_f32 v219, v222, v223
mm v,64,a,200,v,192,156
buffer_load_dwordx4 v252, s[96:99], s51 offen offset:3072 lds
mm v,64,a,204,v,196,64
s_add_u32 s101, s76, 16384
mz v,224,v,216,a,26
mz v,228,v,216,a,24
v_accvgpr_read_b32 v216, a104
v_accvgpr_read_b32 v217, a105
v_accvgpr_read_b32 v218, a106
mm v,68,a,208,v,192,156
v_accvgpr_read_b32 v219, a107
v_accvgpr_read_b32 v220, a120
mm v,68,a,212,v,196,68
tr 212,250,36096
v_accvgpr_read_b32 v221, a121
v_accvgpr_read_b32 v222, a122
mm v,72,a,216,v,192,156
tr 214,250,38144
v_accvgpr_read_b32 v223, a123
mm v,72,a,220,v,196,72
buffer_load_dwordx4 a[0:3], v253, s[60:63], s101 offen sc1
v_cvt_pk_bf16_f32 v224, v224, v225
v_cvt_pk_bf16_f32 v225, v226, v227
mm v,76,a,224,v,192,156
s_waitcnt lgkmcnt(4)
v_cvt_pk_bf16_f32 v226, v228, v229
v_cvt_pk_bf16_f32 v227, v230, v231
mm v,76,a,228,v,196,76
buffer_load_dwordx4 a[4:7], v253, s[60:63], s101 offen offset:1024 sc1
s_add_u32 s50, s46, 12288
buffer_store_dwordx4 v[224:227], v253, s[20:23], s50 offen offset:2048
mm v,80,a,192,v,200,156
tr 192,251,32000
s_add_u32 m0, s78, 4096
v_fma_f32 v216, v216, v232, v236
v_fma_f32 v217, v217, v233, v237
mm v,80,a,196,v,204,80
tr 194,251,34048
s_add_u32 s51, s77, 204800
v_fma_f32 v218, v218, v234, v238
v_fma_f32 v219, v219, v235, v239
mm v,84,a,200,v,200,156
v_fma_f32 v220, v220, v232, v236
v_fma_f32 v221, v221, v233, v237
v_fma_f32 v222, v222, v234, v238
mm v,84,a,204,v,204,84
buffer_load_dwordx4 v252, s[96:99], s51 offen lds
mm v,88,a,208,v,200,156
s_add_u32 s101, s76, 22528
v_fma_f32 v223, v223, v235, v239
v_cvt_pk_bf16_f32 v216, v216, v217
mm v,88,a,212,v,204,88
tr 196,251,36096
v_cvt_pk_bf16_f32 v217, v218, v219
v_cvt_pk_bf16_f32 v218, v220, v221
mm v,92,a,216,v,200,156
tr 198,251,38144
v_cvt_pk_bf16_f32 v219, v222, v223
mm v,92,a,220,v,204,92
s_waitcnt lgkmcnt(4)
mm v,96,a,224,v,200,156
buffer_load_dwordx4 a[8:11], v253, s[60:63], s101 offen sc1
mm v,96,a,228,v,204,96
s_add_u32 s51, s77, 214016
mz v,224,v,216,a,26
mz v,228,v,216,a,24
v_accvgpr_read_b32 v216, a136
v_accvgpr_read_b32 v217, a137
v_accvgpr_read_b32 v218, a138
v_accvgpr_read_b32 v219, a139
v_accvgpr_read_b32 v220, a152
mm v,100,a,192,v,208,156
tr 200,242,32000
v_accvgpr_read_b32 v221, a153
v_accvgpr_read_b32 v222, a154
mm v,100,a,196,v,212,100
tr 202,242,34048
v_accvgpr_read_b32 v223, a155
v_cvt_pk_bf16_f32 v224, v224, v225
mm v,104,a,200,v,208,156
buffer_load_dwordx4 v252, s[96:99], s51 offen offset:1024 lds
v_cvt_pk_bf16_f32 v225, v226, v227
v_cvt_pk_bf16_f32 v226, v228, v229
mm v,104,a,204,v,212,104
tr 204,242,36096
v_cvt_pk_bf16_f32 v227, v230, v231
mm v,108,a,208,v,208,156
tr 206,242,38144
s_add_u32 s50, s46, 12288
buffer_store_dwordx4 v[224:227], v253, s[20:23], s50 offen offset:3072
v_fma_f32 v216, v216, v232, v236
mm v,108,a,212,v,212,108
v_fma_f32 v217, v217, v233, v237
v_fma_f32 v218, v218, v234, v238
mm v,112,a,216,v,208,156
v_fma_f32 v219, v219, v235, v239
v_fma_f32 v220, v220, v232, v236
v_fma_f32 v221, v221, v233, v237
mm v,112,a,220,v,212,112
buffer_load_dwordx4 a[12:15], v253, s[60:63], s101 offen offset:1024 sc1
mm v,116,a,224,v,208,156
s_add_u32 s51, s77, 223232
v_fma_f32 v222, v222, v234, v238
v_fma_f32 v223, v223, v235, v239
mm v,116,a,228,v,212,116
s_waitcnt lgkmcnt(6)
v_cvt_pk_bf16_f32 v216, v216, v217
v_cvt_pk_bf16_f32 v217, v218, v219
mm v,120,a,192,v,192,156
s_waitcnt lgkmcnt(0)
s_barrier
v_cvt_pk_bf16_f32 v218, v220, v221
v_cvt_pk_bf16_f32 v219, v222, v223
mm v,120,a,196,v,196,120
tr 208,249,48640
mz v,224,v,216,a,26
mz v,228,v,216,a,24
mm v,124,a,200,v,192,156
buffer_load_dwordx4 v252, s[96:99], s51 offen offset:2048 lds
v_accvgpr_read_b32 v216, a168
v_accvgpr_read_b32 v217, a169
mm v,124,a,204,v,196,124
tr 210,249,50688
s_add_u32 s101, s76, 28672
v_accvgpr_read_b32 v218, a170
v_accvgpr_read_b32 v219, a171
mm v,128,a,208,v,192,156
v_accvgpr_read_b32 v220, a184
v_accvgpr_read_b32 v221, a185
mm v,128,a,212,v,196,128
tr 212,249,52736
v_accvgpr_read_b32 v222, a186
v_accvgpr_read_b32 v223, a187
mm v,132,a,216,v,192,156
tr 214,249,54784
v_cvt_pk_bf16_f32 v224, v224, v225
v_cvt_pk_bf16_f32 v225, v226, v227
mm v,132,a,220,v,196,132
buffer_load_dwordx4 a[16:19], v253, s[60:63], s101 offen sc1
v_cvt_pk_bf16_f32 v226, v228, v229
v_cvt_pk_bf16_f32 v227, v230, v231
mm v,136,a,224,v,192,156
s_add_u32 s51, s77, 232448
s_add_u32 s50, s46, 16384
mm v,136,a,228,v,196,136
buffer_store_dwordx4 v[224:227], v253, s[20:23], s50 offen
v_fma_f32 v216, v216, v232, v236
mm v,140,a,192,v,200,156
tr 192,250,48640
v_fma_f32 v217, v217, v233, v237
v_fma_f32 v218, v218, v234, v238
mm v,140,a,196,v,204,140
tr 194,250,50688
v_fma_f32 v219, v219, v235, v239
v_fma_f32 v220, v220, v232, v236
mm v,144,a,200,v,200,156
buffer_load_dwordx4 v252, s[96:99], s51 offen offset:3072 lds
v_fma_f32 v221, v221, v233, v237
v_fma_f32 v222, v222, v234, v238
mm v,144,a,204,v,204,144
v_fma_f32 v223, v223, v235, v239
v_cvt_pk_bf16_f32 v216, v216, v217
v_cvt_pk_bf16_f32 v217, v218, v219
mm v,148,a,208,v,200,156
buffer_load_dwordx4 a[20:23], v253, s[60:63], s101 offen offset:1024 sc1
mm v,148,a,212,v,204,148
tr 196,250,52736
v_cvt_pk_bf16_f32 v218, v220, v221
v_cvt_pk_bf16_f32 v219, v222, v223
mm v,152,a,216,v,200,156
tr 198,250,54784
mm v,152,a,220,v,204,152
mz v,224,v,216,a,26
mz v,228,v,216,a,24
mm v,156,a,224,v,200,156
ds_read_b128 v[232:235], v246 offset:64
v_accvgpr_read_b32 v216, a36
v_accvgpr_read_b32 v217, a37
v_accvgpr_read_b32 v218, a38
v_accvgpr_read_b32 v219, a39
mm v,156,a,228,v,204,156
s_waitcnt vmcnt(28) lgkmcnt(5)
v_accvgpr_read_b32 v220, a52
v_accvgpr_read_b32 v221, a53
v_accvgpr_read_b32 v222, a54
mm v,0,a,232,v,208,0
tr 200,251,48640
s_add_u32 s101, s76, 92160
v_accvgpr_read_b32 v223, a55
mm v,0,a,236,v,212,0
tr 202,251,50688
v_cvt_pk_bf16_f32 v224, v224, v225
v_cvt_pk_bf16_f32 v225, v226, v227
mm v,4,a,240,v,208,4
buffer_load_dwordx4 a[192:195], v253, s[60:63], s101 offen sc1
v_cvt_pk_bf16_f32 v226, v228, v229
mm v,4,a,244,v,212,4
s_add_u32 m0, s78, 23808
s_add_u32 s51, s77, 245760
v_cvt_pk_bf16_f32 v227, v230, v231
mm v,8,a,248,v,208,8
buffer_load_dwordx4 v252, s[96:99], s51 offen lds
s_add_u32 s50, s46, 16384
buffer_store_dwordx4 v[224:227], v253, s[20:23], s50 offen offset:1024
s_waitcnt vmcnt(29) lgkmcnt(2)
mm v,8,a,252,v,212,8
tr 204,251,52736
v_mul_f32_e64 v236, -v248, v232
v_mul_f32_e64 v237, -v248, v233
mm v,12,v,164,v,208,12
tr 206,251,54784
s_waitcnt vmcnt(28)
v_mul_f32_e64 v238, -v248, v234
v_mul_f32_e64 v239, -v248, v235
mm v,12,v,172,v,212,12
s_waitcnt vmcnt(26)
v_fma_f32 v216, v216, v232, v236
v_fma_f32 v217, v217, v233, v237
v_fma_f32 v218, v218, v234, v238
mm v,16,v,180,v,208,16
buffer_load_dwordx4 a[196:199], v253, s[60:63], s101 offen offset:1024 sc1
mm v,16,v,188,v,212,16
s_add_u32 s51, s77, 254976
v_fma_f32 v219, v219, v235, v239
v_fma_f32 v220, v220, v232, v236
mm v,20,a,232,v,192,20
tr 208,242,48640
v_fma_f32 v221, v221, v233, v237
v_fma_f32 v222, v222, v234, v238
mm v,20,a,236,v,196,20
tr 210,242,50688
v_fma_f32 v223, v223, v235, v239
v_cvt_pk_bf16_f32 v216, v216, v217
mm v,24,a,240,v,192,24
v_cvt_pk_bf16_f32 v217, v218, v219
v_cvt_pk_bf16_f32 v218, v220, v221
v_cvt_pk_bf16_f32 v219, v222, v223
mm v,24,a,244,v,196,24
buffer_load_dwordx4 v252, s[96:99], s51 offen offset:1024 lds
mz v,224,v,216,a,26
mz v,228,v,216,a,24
mm v,28,a,248,v,192,28
s_add_u32 s101, s76, 98304
v_accvgpr_read_b32 v216, a68
v_accvgpr_read_b32 v217, a69
mm v,28,a,252,v,196,28
tr 212,242,52736
v_accvgpr_read_b32 v218, a70
v_accvgpr_read_b32 v219, a71
mm v,32,v,164,v,192,32
tr 214,242,54784
v_accvgpr_read_b32 v220, a84
mm v,32,v,172,v,196,32
buffer_load_dwordx4 a[200:203], v253, s[60:63], s101 offen sc1
v_accvgpr_read_b32 v221, a85
v_accvgpr_read_b32 v222, a86
mm v,36,v,180,v,192,36
s_add_u32 s51, s77, 264192
v_accvgpr_read_b32 v223, a87
v_cvt_pk_bf16_f32 v224, v224, v225
mm v,36,v,188,v,196,36
s_waitcnt lgkmcnt(4)
v_cvt_pk_bf16_f32 v225, v226, v227
v_cvt_pk_bf16_f32 v226, v228, v229
mm v,40,a,232,v,200,40
tr 192,249,56832
v_cvt_pk_bf16_f32 v227, v230, v231
mm v,40,a,236,v,204,40
tr 194,249,58880
s_add_u32 s50, s46, 6144
buffer_store_dwordx4 v[224:227], v253, s[20:23], s50 offen offset:1024
mm v,44,a,240,v,200,44
buffer_load_dwordx4 v252, s[96:99], s51 offen offset:2048 lds
v_fma_f32 v216, v216, v232, v236
v_fma_f32 v217, v217, v233, v237
mm v,44,a,244,v,204,44
v_fma_f32 v218, v218, v234, v238
v_fma_f32 v219, v219, v235, v239
mm v,48,a,248,v,200,48
v_fma_f32 v220, v220, v232, v236
v_fma_f32 v221, v221, v233, v237
mm v,48,a,252,v,204,48
tr 196,249,60928
v_fma_f32 v222, v222, v234, v238
v_fma_f32 v223, v223, v235, v239
mm v,52,v,164,v,200,52
tr 198,249,62976
v_cvt_pk_bf16_f32 v216, v216, v217
mm v,52,v,172,v,204,52
buffer_load_dwordx4 a[204:207], v253, s[60:63], s101 offen offset:1024 sc1
v_cvt_pk_bf16_f32 v217, v218, v219
v_cvt_pk_bf16_f32 v218, v220, v221
mm v,56,v,180,v,200,56
s_add_u32 s51, s77, 273408
v_cvt_pk_bf16_f32 v219, v222, v223
mm v,56,v,188,v,204,56
s_waitcnt lgkmcnt(6)
mm v,60,a,232,v,208,60
tr 200,250,56832
s_waitcnt lgkmcnt(5)
mm v,60,a,236,v,212,60
tr 202,250,58880
mz v,224,v,216,a,26
mz v,228,v,216,a,24
v_accvgpr_read_b32 v216, a100
v_accvgpr_read_b32 v217, a101
v_accvgpr_read_b32 v218, a102
v_accvgpr_read_b32 v219, a103
v_accvgpr_read_b32 v220, a116
v_accvgpr_read_b32 v221, a117
mm v,64,a,240,v,208,64
buffer_load_dwordx4 v252, s[96:99], s51 offen offset:3072 lds
v_accvgpr_read_b32 v222, a118
v_accvgpr_read_b32 v223, a119
mm v,64,a,244,v,212,64
s_add_u32 s101, s76, 104448
v_cvt_pk_bf16_f32 v224, v224, v225
v_cvt_pk_bf16_f32 v225, v226, v227
mm v,68,a,248,v,208,68
v_cvt_pk_bf16_f32 v226, v228, v229
v_cvt_pk_bf16_f32 v227, v230, v231
mm v,68,a,252,v,212,68
tr 204,250,60928
s_add_u32 s50, s46, 6144
buffer_store_dwordx4 v[224:227], v253, s[20:23], s50 offen offset:2048
mm v,72,v,164,v,208,72
tr 206,250,62976
v_fma_f32 v216, v216, v232, v236
mm v,72,v,172,v,212,72
buffer_load_dwordx4 a[208:211], v253, s[60:63], s101 offen sc1
v_fma_f32 v217, v217, v233, v237
v_fma_f32 v218, v218, v234, v238
mm v,76,v,180,v,208,76
s_waitcnt lgkmcnt(4)
v_fma_f32 v219, v219, v235, v239
v_fma_f32 v220, v220, v232, v236
v_fma_f32 v221, v221, v233, v237
mm v,76,v,188,v,212,76
buffer_load_dwordx4 a[212:215], v253, s[60:63], s101 offen offset:1024 sc1
v_fma_f32 v222, v222, v234, v238
mm v,80,a,232,v,192,80
tr 208,251,56832
s_add_u32 m0, s78, 27904
v_fma_f32 v223, v223, v235, v239
mm v,80,a,236,v,196,80
tr 210,251,58880
s_add_u32 s51, s77, 286720
v_cvt_pk_bf16_f32 v216, v216, v217
v_cvt_pk_bf16_f32 v217, v218, v219
mm v,84,a,240,v,192,84
v_cvt_pk_bf16_f32 v218, v220, v221
v_cvt_pk_bf16_f32 v219, v222, v223
mm v,84,a,244,v,196,84
buffer_load_dwordx4 v252, s[96:99], s51 offen lds
mz v,224,v,216,a,26
mz v,228,v,216,a,24
v_accvgpr_read_b32 v216, a132
mm v,88,a,248,v,192,88
s_add_u32 s101, s76, 110592
v_accvgpr_read_b32 v217, a133
v_accvgpr_read_b32 v218, a134
mm v,88,a,252,v,196,88
tr 212,251,60928
v_accvgpr_read_b32 v219, a135
v_accvgpr_read_b32 v220, a148
mm v,92,v,164,v,192,92
tr 214,251,62976
v_accvgpr_read_b32 v221, a149
mm v,92,v,172,v,196,92
s_waitcnt lgkmcnt(4)
v_accvgpr_read_b32 v222, a150
v_accvgpr_read_b32 v223, a151
v_cvt_pk_bf16_f32 v224, v224, v225
mm v,96,v,180,v,192,96
buffer_load_dwordx4 a[216:219], v253, s[60:63], s101 offen sc1
v_cvt_pk_bf16_f32 v225, v226, v227
mm v,96,v,188,v,196,96
s_add_u32 s51, s77, 295936
v_cvt_pk_bf16_f32 v226, v228, v229
v_cvt_pk_bf16_f32 v227, v230, v231
mm v,100,a,232,v,200,100
tr 192,242,56832
s_add_u32 s50, s46, 6144
buffer_store_dwordx4 v[224:227], v253, s[20:23], s50 offen offset:3072
mm v,100,a,236,v,204,100
tr 194,242,58880
v_fma_f32 v216, v216, v232, v236
v_fma_f32 v217, v217, v233, v237
mm v,104,a,240,v,200,104
buffer_load_dwordx4 v252, s[96:99], s51 offen offset:1024 lds
v_fma_f32 v218, v218, v234, v238
mm v,104,a,244,v,204,104
L_pg62:
s_cbranch_execz L_ir61
tr 196,242,60928
v_fma_f32 v219, v219, v235, v239
v_fma_f32 v220, v220, v232, v236
mm v,108,a,248,v,200,108
tr 198,242,62976
v_fma_f32 v221, v221, v233, v237
v_fma_f32 v222, v222, v234, v238
mm v,108,a,252,v,204,108
v_fma_f32 v223, v223, v235, v239
v_cvt_pk_bf16_f32 v216, v216, v217
mm v,112,v,164,v,200,112
v_cvt_pk_bf16_f32 v217, v218, v219
v_cvt_pk_bf16_f32 v218, v220, v221
v_cvt_pk_bf16_f32 v219, v222, v223
mm v,112,v,172,v,204,112
buffer_load_dwordx4 a[220:223], v253, s[60:63], s101 offen offset:1024 sc1
mz v,224,v,216,a,26
mz v,228,v,216,a,24
mm v,116,v,180,v,200,116
s_add_u32 s51, s77, 305152
v_accvgpr_read_b32 v216, a164
v_accvgpr_read_b32 v217, a165
mm v,116,v,188,v,204,116
s_waitcnt lgkmcnt(6)
v_accvgpr_read_b32 v218, a166
v_accvgpr_read_b32 v219, a167
v_accvgpr_read_b32 v220, a180
mm v,120,a,232,v,208,120
s_waitcnt vmcnt(19) lgkmcnt(0)
s_barrier
v_mov_b32 v254, 1
s_mov_b64 exec, 1
buffer_store_dword v254, off, s[68:71], s82 offset:4 sc1
s_mov_b64 exec, -1
mm v,120,a,236,v,212,120
tr 200,249,0
v_accvgpr_read_b32 v221, a181
v_accvgpr_read_b32 v222, a182
mm v,124,a,240,v,208,124
buffer_load_dwordx4 v252, s[96:99], s51 offen offset:2048 lds
v_accvgpr_read_b32 v223, a183
v_cvt_pk_bf16_f32 v224, v224, v225
mm v,124,a,244,v,212,124
tr 202,249,2048
s_add_u32 s101, s76, 116736
v_cvt_pk_bf16_f32 v225, v226, v227
v_cvt_pk_bf16_f32 v226, v228, v229
mm v,128,a,248,v,208,128
v_cvt_pk_bf16_f32 v227, v230, v231
mm v,128,a,252,v,212,128
tr 204,249,4096
s_add_u32 s50, s46, 10240
buffer_store_dwordx4 v[224:227], v253, s[20:23], s50 offen
mm v,132,v,164,v,208,132
tr 206,249,6144
v_fma_f32 v216, v216, v232, v236
v_fma_f32 v217, v217, v233, v237
mm v,132,v,172,v,212,132
buffer_load_dwordx4 a[224:227], v253, s[60:63], s101 offen sc1
v_fma_f32 v218, v218, v234, v238
v_fma_f32 v219, v219, v235, v239
mm v,136,v,180,v,208,136
s_add_u32 s51, s77, 314368
v_fma_f32 v220, v220, v232, v236
v_fma_f32 v221, v221, v233, v237
mm v,136,v,188,v,212,136
v_fma_f32 v222, v222, v234, v238
v_fma_f32 v223, v223, v235, v239
mm v,140,a,232,v,192,140
tr 208,250,0
v_cvt_pk_bf16_f32 v216, v216, v217
v_cvt_pk_bf16_f32 v217, v218, v219
mm v,140,a,236,v,196,140
tr 210,250,2048
v_cvt_pk_bf16_f32 v218, v220, v221
v_cvt_pk_bf16_f32 v219, v222, v223
mm v,144,a,240,v,192,144
buffer_load_dwordx4 v252, s[96:99], s51 offen offset:3072 lds
mm v,144,a,244,v,196,144
mz v,224,v,216,a,26
mz v,228,v,216,a,24
mm v,148,a,248,v,192,148
buffer_load_dwordx4 a[228:231], v253, s[60:63], s101 offen offset:1024 sc1
ds_read_b128 v[232:235], v246
v_accvgpr_read_b32 v216, a32
v_accvgpr_read_b32 v217, a33
v_accvgpr_read_b32 v218, a34
mm v,148,a,252,v,196,148
tr 212,250,4096
v_accvgpr_read_b32 v219, a35
v_accvgpr_read_b32 v220, a48
mm v,152,v,164,v,192,152
tr 214,250,6144
v_accvgpr_read_b32 v221, a49
v_accvgpr_read_b32 v222, a50
mm v,152,v,172,v,196,152
v_accvgpr_read_b32 v223, a51
v_cvt_pk_bf16_f32 v224, v224, v225
mm v,156,v,180,v,192,156
v_cvt_pk_bf16_f32 v225, v226, v227
v_cvt_pk_bf16_f32 v226, v228, v229
mm v,156,v,188,v,196,156
s_waitcnt lgkmcnt(5)
v_cvt_pk_bf16_f32 v227, v230, v231
mm v,0,v,160,v,200,0
tr 192,251,0
s_add_u32 s101, s76, 94208
s_add_u32 s50, s46, 10240
buffer_store_dwordx4 v[224:227], v253, s[20:23], s50 offen offset:1024
mm v,0,v,168,v,204,0
tr 194,251,2048
s_waitcnt lgkmcnt(4)
v_mul_f32_e64 v236, -v248, v232
mm v,4,v,176,v,200,4
buffer_load_dwordx4 a[232:235], v253, s[60:63], s101 offen sc1
v_mul_f32_e64 v237, -v248, v233
v_mul_f32_e64 v238, -v248, v234
mm v,4,v,184,v,204,4
s_add_u32 m0, s78, 48640
s_add_u32 s51, s77, 327680
v_mul_f32_e64 v239, -v248, v235
v_fma_f32 v216, v216, v232, v236
mm v,8,a,0,v,200,8
buffer_load_dwordx4 v252, s[96:99], s51 offen lds
v_fma_f32 v217, v217, v233, v237
mm v,8,a,4,v,204,8
tr 196,251,4096
v_fma_f32 v218, v218, v234, v238
v_fma_f32 v219, v219, v235, v239
mm v,12,a,8,v,200,12
tr 198,251,6144
v_fma_f32 v220, v220, v232, v236
v_fma_f32 v221, v221, v233, v237
mm v,12,a,12,v,204,12
s_waitcnt vmcnt(26)
v_fma_f32 v222, v222, v234, v238
v_fma_f32 v223, v223, v235, v239
v_cvt_pk_bf16_f32 v216, v216, v217
mm v,16,a,16,v,200,16
buffer_load_dwordx4 a[236:239], v253, s[60:63], s101 offen offset:1024 sc1
v_cvt_pk_bf16_f32 v217, v218, v219
mm v,16,a,20,v,204,16
s_add_u32 s51, s77, 336896
v_cvt_pk_bf16_f32 v218, v220, v221
v_cvt_pk_bf16_f32 v219, v222, v223
mm v,20,v,160,v,208,20
tr 200,242,0
s_waitcnt lgkmcnt(5)
mm v,20,v,168,v,212,20
tr 202,242,2048
mz v,224,v,216,a,26
mz v,228,v,216,a,24
v_accvgpr_read_b32 v216, a64
v_accvgpr_read_b32 v217, a65
mm v,24,v,176,v,208,24
v_accvgpr_read_b32 v218, a66
v_accvgpr_read_b32 v219, a67
v_accvgpr_read_b32 v220, a80
mm v,24,v,184,v,212,24
buffer_load_dwordx4 v252, s[96:99], s51 offen offset:1024 lds
v_accvgpr_read_b32 v221, a81
mm v,28,a,0,v,208,28
s_add_u32 s101, s76, 100352
v_accvgpr_read_b32 v222, a82
v_accvgpr_read_b32 v223, a83
mm v,28,a,4,v,212,28
tr 204,242,4096
v_cvt_pk_bf16_f32 v224, v224, v225
v_cvt_pk_bf16_f32 v225, v226, v227
mm v,32,a,8,v,208,32
tr 206,242,6144
v_cvt_pk_bf16_f32 v226, v228, v229
v_cvt_pk_bf16_f32 v227, v230, v231
mm v,32,a,12,v,212,32
buffer_load_dwordx4 a[240:243], v253, s[60:63], s101 offen sc1
s_add_u32 s50, s46, 0
mm v,36,a,16,v,208,36
s_add_u32 s51, s77, 346112
buffer_store_dwordx4 v[224:227], v253, s[20:23], s50 offen offset:1024
v_fma_f32 v216, v216, v232, v236
mm v,36,a,20,v,212,36
s_waitcnt lgkmcnt(4)
v_fma_f32 v217, v217, v233, v237
v_fma_f32 v218, v218, v234, v238
mm v,40,v,160,v,192,40
tr 208,249,8192
v_fma_f32 v219, v219, v235, v239
v_fma_f32 v220, v220, v232, v236
mm v,40,v,168,v,196,40
tr 210,249,10240
v_fma_f32 v221, v221, v233, v237
v_fma_f32 v222, v222, v234, v238
mm v,44,v,176,v,192,44
buffer_load_dwordx4 v252, s[96:99], s51 offen offset:2048 lds
v_fma_f32 v223, v223, v235, v239
v_cvt_pk_bf16_f32 v216, v216, v217
mm v,44,v,184,v,196,44
v_cvt_pk_bf16_f32 v217, v218, v219
v_cvt_pk_bf16_f32 v218, v220, v221
mm v,48,a,0,v,192,48
v_cvt_pk_bf16_f32 v219, v222, v223
mm v,48,a,4,v,196,48
tr 212,249,12288
mz v,224,v,216,a,26
mz v,228,v,216,a,24
v_accvgpr_read_b32 v216, a96
mm v,52,a,8,v,192,52
tr 214,249,14336
v_accvgpr_read_b32 v217, a97
v_accvgpr_read_b32 v218, a98
mm v,52,a,12,v,196,52
buffer_load_dwordx4 a[244:247], v253, s[60:63], s101 offen offset:1024 sc1
v_accvgpr_read_b32 v219, a99
v_accvgpr_read_b32 v220, a112
mm v,56,a,16,v,192,56
s_add_u32 s51, s77, 355328
v_accvgpr_read_b32 v221, a113
v_accvgpr_read_b32 v222, a114
mm v,56,a,20,v,196,56
s_waitcnt lgkmcnt(4)
v_accvgpr_read_b32 v223, a115
v_cvt_pk_bf16_f32 v224, v224, v225
mm v,60,v,160,v,200,60
tr 192,250,8192
v_cvt_pk_bf16_f32 v225, v226, v227
mm v,60,v,168,v,204,60
tr 194,250,10240
v_cvt_pk_bf16_f32 v226, v228, v229
v_cvt_pk_bf16_f32 v227, v230, v231
mm v,64,v,176,v,200,64
buffer_load_dwordx4 v252, s[96:99], s51 offen offset:3072 lds
s_add_u32 s50, s46, 0
buffer_store_dwordx4 v[224:227], v253, s[20:23], s50 offen offset:2048
mm v,64,v,184,v,204,64
s_add_u32 s101, s76, 106496
v_fma_f32 v216, v216, v232, v236
v_fma_f32 v217, v217, v233, v237
mm v,68,a,0,v,200,68
v_fma_f32 v218, v218, v234, v238
v_fma_f32 v219, v219, v235, v239
mm v,68,a,4,v,204,68
tr 196,250,12288
v_fma_f32 v220, v220, v232, v236
v_fma_f32 v221, v221, v233, v237
mm v,72,a,8,v,200,72
tr 198,250,14336
v_fma_f32 v222, v222, v234, v238
mm v,72,a,12,v,204,72
buffer_load_dwordx4 a[248:251], v253, s[60:63], s101 offen sc1
v_fma_f32 v223, v223, v235, v239
v_cvt_pk_bf16_f32 v216, v216, v217
mm v,76,a,16,v,200,76
s_waitcnt lgkmcnt(4)
v_cvt_pk_bf16_f32 v217, v218, v219
v_cvt_pk_bf16_f32 v218, v220, v221
v_cvt_pk_bf16_f32 v219, v222, v223
mm v,76,a,20,v,204,76
buffer_load_dwordx4 a[252:255], v253, s[60:63], s101 offen offset:1024 sc1
mz v,224,v,216,a,26
mz v,228,v,216,a,24
mm v,80,v,160,v,208,80
tr 200,251,8192
s_add_u32 m0, s78, 52736
v_accvgpr_read_b32 v216, a128
v_accvgpr_read_b32 v217, a129
mm v,80,v,168,v,212,80
tr 202,251,10240
s_add_u32 s51, s77, 368640
v_accvgpr_read_b32 v218, a130
v_accvgpr_read_b32 v219, a131
mm v,84,v,176,v,208,84
v_accvgpr_read_b32 v220, a144
v_accvgpr_read_b32 v221, a145
v_accvgpr_read_b32 v222, a146
mm v,84,v,184,v,212,84
buffer_load_dwordx4 v252, s[96:99], s51 offen lds
mm v,88,a,0,v,208,88
s_add_u32 s101, s76, 112640
v_accvgpr_read_b32 v223, a147
v_cvt_pk_bf16_f32 v224, v224, v225
mm v,88,a,4,v,212,88
tr 204,251,12288
v_cvt_pk_bf16_f32 v225, v226, v227
v_cvt_pk_bf16_f32 v226, v228, v229
mm v,92,a,8,v,208,92
tr 206,251,14336
s_waitcnt lgkmcnt(4)
v_cvt_pk_bf16_f32 v227, v230, v231
mm v,92,a,12,v,212,92
s_add_u32 s50, s46, 0
buffer_store_dwordx4 v[224:227], v253, s[20:23], s50 offen offset:3072
v_fma_f32 v216, v216, v232, v236
mm v,96,a,16,v,208,96
buffer_load_dwordx4 v[164:167], v253, s[60:63], s101 offen sc1
v_fma_f32 v217, v217, v233, v237
v_fma_f32 v218, v218, v234, v238
mm v,96,a,20,v,212,96
s_add_u32 s51, s77, 377856
v_fma_f32 v219, v219, v235, v239
v_fma_f32 v220, v220, v232, v236
mm v,100,v,160,v,192,100
tr 208,242,8192
v_fma_f32 v221, v221, v233, v237
mm v,100,v,168,v,196,100
tr 210,242,10240
v_fma_f32 v222, v222, v234, v238
v_fma_f32 v223, v223, v235, v239
mm v,104,v,176,v,192,104
buffer_load_dwordx4 v252, s[96:99], s51 offen offset:1024 lds
v_cvt_pk_bf16_f32 v216, v216, v217
v_cvt_pk_bf16_f32 v217, v218, v219
mm v,104,v,184,v,196,104
tr 212,242,12288
v_cvt_pk_bf16_f32 v218, v220, v221
v_cvt_pk_bf16_f32 v219, v222, v223
mm v,108,a,0,v,192,108
tr 214,242,14336
mm v,108,a,4,v,196,108
mz v,224,v,216,a,26
mz v,228,v,216,a,24
v_accvgpr_read_b32 v216, a160
v_accvgpr_read_b32 v217, a161
v_accvgpr_read_b32 v218, a162
mm v,112,a,8,v,192,112
v_accvgpr_read_b32 v219, a163
v_accvgpr_read_b32 v220, a176
v_accvgpr_read_b32 v221, a177
mm v,112,a,12,v,196,112
buffer_load_dwordx4 v[172:175], v253, s[60:63], s101 offen offset:1024 sc1
mm v,116,a,16,v,192,116
s_add_u32 s51, s77, 387072
v_accvgpr_read_b32 v222, a178
v_accvgpr_read_b32 v223, a179
mm v,116,a,20,v,196,116
s_waitcnt lgkmcnt(6)
v_cvt_pk_bf16_f32 v224, v224, v225
v_cvt_pk_bf16_f32 v225, v226, v227
mm v,120,v,160,v,200,120
s_waitcnt vmcnt(19) lgkmcnt(0)
s_barrier
v_cvt_pk_bf16_f32 v226, v228, v229
v_cvt_pk_bf16_f32 v227, v230, v231
mm v,120,v,168,v,204,120
tr 192,249,23808
s_add_u32 s50, s46, 4096
buffer_store_dwordx4 v[224:227], v253, s[20:23], s50 offen
mm v,124,v,176,v,200,124
buffer_load_dwordx4 v252, s[96:99], s51 offen offset:2048 lds
v_fma_f32 v216, v216, v232, v236
mm v,124,v,184,v,204,124
tr 194,249,25856
s_add_u32 s101, s76, 118784
v_fma_f32 v217, v217, v233, v237
v_fma_f32 v218, v218, v234, v238
mm v,128,a,0,v,200,128
v_fma_f32 v219, v219, v235, v239
v_fma_f32 v220, v220, v232, v236
mm v,128,a,4,v,204,128
tr 196,249,27904
v_fma_f32 v221, v221, v233, v237
v_fma_f32 v222, v222, v234, v238
mm v,132,a,8,v,200,132
tr 198,249,29952
v_fma_f32 v223, v223, v235, v239
v_cvt_pk_bf16_f32 v216, v216, v217
mm v,132,a,12,v,204,132
buffer_load_dwordx4 v[180:183], v253, s[60:63], s101 offen sc1
v_cvt_pk_bf16_f32 v217, v218, v219
v_cvt_pk_bf16_f32 v218, v220, v221
mm v,136,a,16,v,200,136
s_add_u32 s51, s77, 396288
v_cvt_pk_bf16_f32 v219, v222, v223
mm v,136,a,20,v,204,136
mm v,140,v,160,v,208,140
tr 200,250,23808
mz v,224,v,216,a,26
mz v,228,v,216,a,24
mm v,140,v,168,v,212,140
tr 202,250,25856
mm v,144,v,176,v,208,144
buffer_load_dwordx4 v252, s[96:99], s51 offen offset:3072 lds
mm v,144,v,184,v,212,144
mm v,148,a,0,v,208,148
buffer_load_dwordx4 v[188:191], v253, s[60:63], s101 offen offset:1024 sc1
mm v,148,a,4,v,212,148
tr 204,250,27904
mm v,152,a,8,v,208,152
tr 206,250,29952
mm v,152,a,12,v,212,152
v_cvt_pk_bf16_f32 v224, v224, v225
v_cvt_pk_bf16_f32 v225, v226, v227
mm v,156,a,16,v,208,156
v_cvt_pk_bf16_f32 v226, v228, v229
v_cvt_pk_bf16_f32 v227, v230, v231
mm v,156,a,20,v,212,156
s_waitcnt lgkmcnt(4)
s_add_u32 s50, s46, 4096
buffer_store_dwordx4 v[224:227], v253, s[20:23], s50 offen offset:1024
mm v,0,a,192,v,192,0
tr 208,251,23808
s_add_u32 s101, s76, 96256
mm v,0,a,196,v,196,0
tr 210,251,25856
mm v,4,a,200,v,192,4
buffer_load_dwordx4 v[160:163], v253, s[60:63], s101 offen sc1
mm v,4,a,204,v,196,4
s_add_u32 m0, s78, 0
s_add_u32 s51, s77, 409600
mm v,8,a,208,v,192,8
buffer_load_dwordx4 v252, s[96:99], s51 offen lds
mm v,8,a,212,v,196,8
tr 212,251,27904
mm v,12,a,216,v,192,12
tr 214,251,29952
mm v,12,a,220,v,196,12
s_waitcnt vmcnt(26)
mm v,16,a,224,v,192,16
buffer_load_dwordx4 v[168:171], v253, s[60:63], s101 offen offset:1024 sc1
mm v,16,a,228,v,196,16
s_add_u32 s51, s77, 418816
s_waitcnt lgkmcnt(6)
mm v,20,a,192,v,200,20
tr 192,242,23808
s_waitcnt lgkmcnt(5)
mm v,20,a,196,v,204,20
tr 194,242,25856
mm v,24,a,200,v,200,24
mm v,24,a,204,v,204,24
buffer_load_dwordx4 v252, s[96:99], s51 offen offset:1024 lds
mm v,28,a,208,v,200,28
s_add_u32 s101, s76, 102400
mm v,28,a,212,v,204,28
tr 196,242,27904
mm v,32,a,216,v,200,32
tr 198,242,29952
mm v,32,a,220,v,204,32
buffer_load_dwordx4 v[176:179], v253, s[60:63], s101 offen sc1
mm v,36,a,224,v,200,36
s_add_u32 s51, s77, 428032
mm v,36,a,228,v,204,36
s_waitcnt lgkmcnt(6)
mm v,40,a,192,v,208,40
tr 200,249,32000
s_waitcnt lgkmcnt(5)
mm v,40,a,196,v,212,40
tr 202,249,34048
mm v,44,a,200,v,208,44
buffer_load_dwordx4 v252, s[96:99], s51 offen offset:2048 lds
mm v,44,a,204,v,212,44
mm v,48,a,208,v,208,48
mm v,48,a,212,v,212,48
tr 204,249,36096
mm v,52,a,216,v,208,52
tr 206,249,38144
mm v,52,a,220,v,212,52
buffer_load_dwordx4 v[184:187], v253, s[60:63], s101 offen offset:1024 sc1
mm v,56,a,224,v,208,56
s_add_u32 s51, s77, 437248
mm v,56,a,228,v,212,56
s_waitcnt lgkmcnt(6)
mm v,60,a,192,v,192,60
tr 208,250,32000
s_waitcnt lgkmcnt(5)
mm v,60,a,196,v,196,60
tr 210,250,34048
mm v,64,a,200,v,192,64
buffer_load_dwordx4 v252, s[96:99], s51 offen offset:3072 lds
mm v,64,a,204,v,196,64
s_add_u32 s101, s76, 108544
mm v,68,a,208,v,192,68
mm v,68,a,212,v,196,68
tr 212,250,36096
mm v,72,a,216,v,192,72
tr 214,250,38144
mm v,72,a,220,v,196,72
buffer_load_dwordx4 a[0:3], v253, s[60:63], s101 offen sc1
mm v,76,a,224,v,192,76
s_waitcnt lgkmcnt(4)
mm v,76,a,228,v,196,76
buffer_load_dwordx4 a[4:7], v253, s[60:63], s101 offen offset:1024 sc1
mm v,80,a,192,v,200,80
tr 192,251,32000
s_add_u32 m0, s78, 4096
mm v,80,a,196,v,204,80
tr 194,251,34048
s_add_u32 s51, s77, 450560
mm v,84,a,200,v,200,84
mm v,84,a,204,v,204,84
buffer_load_dwordx4 v252, s[96:99], s51 offen lds
mm v,88,a,208,v,200,88
s_add_u32 s101, s76, 114688
mm v,88,a,212,v,204,88
tr 196,251,36096
mm v,92,a,216,v,200,92
tr 198,251,38144
mm v,92,a,220,v,204,92
mm v,96,a,224,v,200,96
buffer_load_dwordx4 a[8:11], v253, s[60:63], s101 offen sc1
mm v,96,a,228,v,204,96
s_add_u32 s51, s77, 459776
s_waitcnt lgkmcnt(6)
mm v,100,a,192,v,208,100
tr 200,242,32000
s_waitcnt lgkmcnt(5)
mm v,100,a,196,v,212,100
tr 202,242,34048
mm v,104,a,200,v,208,104
buffer_load_dwordx4 v252, s[96:99], s51 offen offset:1024 lds
mm v,104,a,204,v,212,104
tr 204,242,36096
mm v,108,a,208,v,208,108
tr 206,242,38144
mm v,108,a,212,v,212,108
mm v,112,a,216,v,208,112
mm v,112,a,220,v,212,112
buffer_load_dwordx4 a[12:15], v253, s[60:63], s101 offen offset:1024 sc1
mm v,116,a,224,v,208,116
s_add_u32 s51, s77, 468992
mm v,116,a,228,v,212,116
s_waitcnt lgkmcnt(6)
mm v,120,a,192,v,192,120
s_waitcnt vmcnt(14) lgkmcnt(0)
s_barrier
s_cmp_eq_u32 s35, 0
s_cbranch_scc1 L_rel18
buffer_wbl2 sc1
s_waitcnt vmcnt(0)
L_rel18:
s_add_u32 s84, s86, 64
v_mov_b32 v254, 1
s_mov_b64 exec, 1
buffer_atomic_add v254, off, s[72:75], s84 sc1
s_mov_b64 exec, -1
mm v,120,a,196,v,196,120
L_pg66:
s_cbranch_execz L_ir65
tr 208,249,48640
mm v,124,a,200,v,192,124
buffer_load_dwordx4 v252, s[96:99], s51 offen offset:2048 lds
mm v,124,a,204,v,196,124
tr 210,249,50688
s_add_u32 s101, s76, 120832
mm v,128,a,208,v,192,128
mm v,128,a,212,v,196,128
tr 212,249,52736
mm v,132,a,216,v,192,132
tr 214,249,54784
mm v,132,a,220,v,196,132
buffer_load_dwordx4 a[16:19], v253, s[60:63], s101 offen sc1
mm v,136,a,224,v,192,136
s_add_u32 s51, s77, 478208
mm v,136,a,228,v,196,136
mm v,140,a,192,v,200,140
tr 192,250,48640
mm v,140,a,196,v,204,140
tr 194,250,50688
mm v,144,a,200,v,200,144
buffer_load_dwordx4 v252, s[96:99], s51 offen offset:3072 lds
mm v,144,a,204,v,204,144
mm v,148,a,208,v,200,148
buffer_load_dwordx4 a[20:23], v253, s[60:63], s101 offen offset:1024 sc1
mm v,148,a,212,v,204,148
tr 196,250,52736
mm v,152,a,216,v,200,152
tr 198,250,54784
mm v,152,a,220,v,204,152
mm v,156,a,224,v,200,156
mm v,156,a,228,v,204,156
s_waitcnt lgkmcnt(4)
mm v,0,a,232,v,208,0
tr 200,251,48640
s_add_u32 s101, s76, 184320
mm v,0,a,236,v,212,0
tr 202,251,50688
mm v,4,a,240,v,208,4
buffer_load_dwordx4 a[192:195], v253, s[60:63], s101 offen sc1
mm v,4,a,244,v,212,4
s_add_u32 m0, s78, 23808
s_add_u32 s51, s77, 491520
mm v,8,a,248,v,208,8
buffer_load_dwordx4 v252, s[96:99], s51 offen lds
mm v,8,a,252,v,212,8
tr 204,251,52736
mm v,12,v,164,v,208,12
tr 206,251,54784
mm v,12,v,172,v,212,12
mm v,16,v,180,v,208,16
buffer_load_dwordx4 a[196:199], v253, s[60:63], s101 offen offset:1024 sc1
mm v,16,v,188,v,212,16
s_add_u32 s51, s77, 500736
s_waitcnt lgkmcnt(6)
mm v,20,a,232,v,192,20
tr 208,242,48640
s_waitcnt lgkmcnt(5)
mm v,20,a,236,v,196,20
tr 210,242,50688
mm v,24,a,240,v,192,24
mm v,24,a,244,v,196,24
buffer_load_dwordx4 v252, s[96:99], s51 offen offset:1024 lds
mm v,28,a,248,v,192,28
s_add_u32 s101, s76, 190464
mm v,28,a,252,v,196,28
tr 212,242,52736
mm v,32,v,164,v,192,32
tr 214,242,54784
mm v,32,v,172,v,196,32
buffer_load_dwordx4 a[200:203], v253, s[60:63], s101 offen sc1
mm v,36,v,180,v,192,36
s_add_u32 s51, s77, 509952
mm v,36,v,188,v,196,36
s_waitcnt lgkmcnt(6)
mm v,40,a,232,v,200,40
tr 192,249,56832
s_waitcnt lgkmcnt(5)
mm v,40,a,236,v,204,40
tr 194,249,58880
mm v,44,a,240,v,200,44
buffer_load_dwordx4 v252, s[96:99], s51 offen offset:2048 lds
mm v,44,a,244,v,204,44
mm v,48,a,248,v,200,48
mm v,48,a,252,v,204,48
tr 196,249,60928
mm v,52,v,164,v,200,52
tr 198,249,62976
mm v,52,v,172,v,204,52
buffer_load_dwordx4 a[204:207], v253, s[60:63], s101 offen offset:1024 sc1
mm v,56,v,180,v,200,56
s_add_u32 s51, s77, 519168
mm v,56,v,188,v,204,56
s_waitcnt lgkmcnt(6)
mm v,60,a,232,v,208,60
tr 200,250,56832
s_waitcnt lgkmcnt(5)
mm v,60,a,236,v,212,60
tr 202,250,58880
mm v,64,a,240,v,208,64
buffer_load_dwordx4 v252, s[96:99], s51 offen offset:3072 lds
mm v,64,a,244,v,212,64
s_add_u32 s101, s76, 196608
mm v,68,a,248,v,208,68
mm v,68,a,252,v,212,68
tr 204,250,60928
mm v,72,v,164,v,208,72
tr 206,250,62976
mm v,72,v,172,v,212,72
buffer_load_dwordx4 a[208:211], v253, s[60:63], s101 offen sc1
mm v,76,v,180,v,208,76
s_waitcnt lgkmcnt(4)
mm v,76,v,188,v,212,76
buffer_load_dwordx4 a[212:215], v253, s[60:63], s101 offen offset:1024 sc1
mm v,80,a,232,v,192,80
tr 208,251,56832
s_add_u32 m0, s78, 27904
mm v,80,a,236,v,196,80
tr 210,251,58880
s_add_u32 s51, s77, 532480
mm v,84,a,240,v,192,84
mm v,84,a,244,v,196,84
buffer_load_dwordx4 v252, s[96:99], s51 offen lds
mm v,88,a,248,v,192,88
s_add_u32 s101, s76, 202752
mm v,88,a,252,v,196,88
tr 212,251,60928
mm v,92,v,164,v,192,92
tr 214,251,62976
mm v,92,v,172,v,196,92
mm v,96,v,180,v,192,96
buffer_load_dwordx4 a[216:219], v253, s[60:63], s101 offen sc1
mm v,96,v,188,v,196,96
s_add_u32 s51, s77, 541696
s_waitcnt lgkmcnt(6)
mm v,100,a,232,v,200,100
tr 192,242,56832
s_waitcnt lgkmcnt(5)
mm v,100,a,236,v,204,100
tr 194,242,58880
mm v,104,a,240,v,200,104
buffer_load_dwordx4 v252, s[96:99], s51 offen offset:1024 lds
mm v,104,a,244,v,204,104
tr 196,242,60928
mm v,108,a,248,v,200,108
tr 198,242,62976
mm v,108,a,252,v,204,108
mm v,112,v,164,v,200,112
mm v,112,v,172,v,204,112
buffer_load_dwordx4 a[220:223], v253, s[60:63], s101 offen offset:1024 sc1
mm v,116,v,180,v,200,116
s_add_u32 s51, s77, 550912
mm v,116,v,188,v,204,116
s_waitcnt lgkmcnt(6)
mm v,120,a,232,v,208,120
s_waitcnt vmcnt(15) lgkmcnt(0)
s_barrier
mm v,120,a,236,v,212,120
tr 200,249,0
mm v,124,a,240,v,208,124
buffer_load_dwordx4 v252, s[96:99], s51 offen offset:2048 lds
mm v,124,a,244,v,212,124
tr 202,249,2048
s_add_u32 s101, s76, 208896
mm v,128,a,248,v,208,128
mm v,128,a,252,v,212,128
tr 204,249,4096
mm v,132,v,164,v,208,132
tr 206,249,6144
mm v,132,v,172,v,212,132
buffer_load_dwordx4 a[224:227], v253, s[60:63], s101 offen sc1
mm v,136,v,180,v,208,136
s_add_u32 s51, s77, 560128
mm v,136,v,188,v,212,136
mm v,140,a,232,v,192,140
tr 208,250,0
mm v,140,a,236,v,196,140
tr 210,250,2048
mm v,144,a,240,v,192,144
buffer_load_dwordx4 v252, s[96:99], s51 offen offset:3072 lds
mm v,144,a,244,v,196,144
mm v,148,a,248,v,192,148
buffer_load_dwordx4 a[228:231], v253, s[60:63], s101 offen offset:1024 sc1
mm v,148,a,252,v,196,148
tr 212,250,4096
mm v,152,v,164,v,192,152
tr 214,250,6144
mm v,152,v,172,v,196,152
mm v,156,v,180,v,192,156
mm v,156,v,188,v,196,156
s_waitcnt lgkmcnt(4)
mm v,0,v,160,v,200,0
tr 192,251,0
s_add_u32 s101, s76, 186368
mm v,0,v,168,v,204,0
tr 194,251,2048
mm v,4,v,176,v,200,4
buffer_load_dwordx4 a[232:235], v253, s[60:63], s101 offen sc1
mm v,4,v,184,v,204,4
s_add_u32 m0, s78, 48640
s_add_u32 s51, s77, 573440
mm v,8,a,0,v,200,8
buffer_load_dwordx4 v252, s[96:99], s51 offen lds
mm v,8,a,4,v,204,8
tr 196,251,4096
mm v,12,a,8,v,200,12
tr 198,251,6144
mm v,12,a,12,v,204,12
s_waitcnt vmcnt(20)
s_and_b32 s28, s2, 1
s_lshl_b32 s28, s28, 4
mm v,16,a,16,v,200,16
buffer_load_dwordx4 a[236:239], v253, s[60:63], s101 offen offset:1024 sc1
mm v,16,a,20,v,204,16
s_add_u32 s51, s77, 582656
s_waitcnt lgkmcnt(6)
s_sub_u32 s28, 11, s28
mm v,20,v,160,v,208,20
tr 200,242,0
s_waitcnt lgkmcnt(5)
mm v,20,v,168,v,212,20
tr 202,242,2048
mm v,24,v,176,v,208,24
s_mov_b32 s33, 19
s_mov_b32 s26, 2
mm v,24,v,184,v,212,24
buffer_load_dwordx4 v252, s[96:99], s51 offen offset:1024 lds
mm v,28,a,0,v,208,28
s_add_u32 s101, s76, 192512
s_add_u32 s31, s76, 184320
mm v,28,a,4,v,212,28
tr 204,242,4096
mm v,32,a,8,v,208,32
tr 206,242,6144
mm v,32,a,12,v,212,32
buffer_load_dwordx4 a[240:243], v253, s[60:63], s101 offen sc1
mm v,36,a,16,v,208,36
s_add_u32 s51, s77, 591872
s_add_u32 s32, s77, 491520
mm v,36,a,20,v,212,36
s_waitcnt lgkmcnt(6)
s_mov_b32 s25, s26
s_mov_b32 s29, s31
mm v,40,v,160,v,192,40
tr 208,249,8192
s_waitcnt lgkmcnt(5)
mm v,40,v,168,v,196,40
tr 210,249,10240
mm v,44,v,176,v,192,44
buffer_load_dwordx4 v252, s[96:99], s51 offen offset:2048 lds
mm v,44,v,184,v,196,44
s_mov_b32 s30, s32
s_add_u32 s26, s25, 1
mm v,48,a,0,v,192,48
s_cmp_eq_u32 s26, s27
s_cselect_b32 s26, 16, s26
mm v,48,a,4,v,196,48
tr 212,249,12288
mm v,52,a,8,v,192,52
tr 214,249,14336
mm v,52,a,12,v,196,52
buffer_load_dwordx4 a[244:247], v253, s[60:63], s101 offen offset:1024 sc1
mm v,56,a,16,v,192,56
s_add_u32 s51, s77, 601088
mm v,56,a,20,v,196,56
s_waitcnt lgkmcnt(6)
s_cmp_eq_u32 s25, 18
s_cselect_b32 s26, s33, s26
mm v,60,v,160,v,200,60
tr 192,250,8192
s_waitcnt lgkmcnt(5)
mm v,60,v,168,v,204,60
tr 194,250,10240
mm v,64,v,176,v,200,64
buffer_load_dwordx4 v252, s[96:99], s51 offen offset:3072 lds
mm v,64,v,184,v,204,64
s_add_u32 s101, s76, 198656
mm v,68,a,0,v,200,68
s_cmp_eq_u32 s25, s28
s_cselect_b32 s26, 19, s26
mm v,68,a,4,v,204,68
tr 196,250,12288
mm v,72,a,8,v,200,72
tr 198,250,14336
mm v,72,a,12,v,204,72
buffer_load_dwordx4 a[248:251], v253, s[60:63], s101 offen sc1
mm v,76,a,16,v,200,76
s_waitcnt lgkmcnt(4)
s_mul_i32 s31, s26, 92160
s_add_u32 s31, s31, s76
mm v,76,a,20,v,204,76
buffer_load_dwordx4 a[252:255], v253, s[60:63], s101 offen offset:1024 sc1
mm v,80,v,160,v,208,80
tr 200,251,8192
s_add_u32 m0, s78, 52736
mm v,80,v,168,v,212,80
tr 202,251,10240
s_add_u32 s51, s77, 614400
mm v,84,v,176,v,208,84
s_mul_i32 s32, s26, 245760
s_add_u32 s32, s32, s77
mm v,84,v,184,v,212,84
buffer_load_dwordx4 v252, s[96:99], s51 offen lds
mm v,88,a,0,v,208,88
s_add_u32 s101, s76, 204800
mm v,88,a,4,v,212,88
tr 204,251,12288
mm v,92,a,8,v,208,92
tr 206,251,14336
mm v,92,a,12,v,212,92
mm v,96,a,16,v,208,96
buffer_load_dwordx4 v[164:167], v253, s[60:63], s101 offen sc1
mm v,96,a,20,v,212,96
s_add_u32 s51, s77, 623616
s_waitcnt lgkmcnt(6)
mm v,100,v,160,v,192,100
tr 208,242,8192
s_waitcnt lgkmcnt(5)
mm v,100,v,168,v,196,100
tr 210,242,10240
mm v,104,v,176,v,192,104
buffer_load_dwordx4 v252, s[96:99], s51 offen offset:1024 lds
mm v,104,v,184,v,196,104
tr 212,242,12288
mm v,108,a,0,v,192,108
tr 214,242,14336
mm v,108,a,4,v,196,108
mm v,112,a,8,v,192,112
mm v,112,a,12,v,196,112
buffer_load_dwordx4 v[172:175], v253, s[60:63], s101 offen offset:1024 sc1
mm v,116,a,16,v,192,116
s_add_u32 s51, s77, 632832
mm v,116,a,20,v,196,116
s_waitcnt lgkmcnt(6)
mm v,120,v,160,v,200,120
s_waitcnt vmcnt(15) lgkmcnt(0)
s_barrier
mm v,120,v,168,v,204,120
tr 192,249,23808
mm v,124,v,176,v,200,124
buffer_load_dwordx4 v252, s[96:99], s51 offen offset:2048 lds
mm v,124,v,184,v,204,124
tr 194,249,25856
s_add_u32 s101, s76, 210944
mm v,128,a,0,v,200,128
mm v,128,a,4,v,204,128
tr 196,249,27904
mm v,132,a,8,v,200,132
tr 198,249,29952
mm v,132,a,12,v,204,132
buffer_load_dwordx4 v[180:183], v253, s[60:63], s101 offen sc1
mm v,136,a,16,v,200,136
s_add_u32 s51, s77, 642048
mm v,136,a,20,v,204,136
mm v,140,v,160,v,208,140
tr 200,250,23808
mm v,140,v,168,v,212,140
tr 202,250,25856
mm v,144,v,176,v,208,144
buffer_load_dwordx4 v252, s[96:99], s51 offen offset:3072 lds
mm v,144,v,184,v,212,144
mm v,148,a,0,v,208,148
buffer_load_dwordx4 v[188:191], v253, s[60:63], s101 offen offset:1024 sc1
mm v,148,a,4,v,212,148
tr 204,250,27904
mm v,152,a,8,v,208,152
tr 206,250,29952
mm v,152,a,12,v,212,152
mm v,156,a,16,v,208,156
mm v,156,a,20,v,212,156
s_waitcnt lgkmcnt(4)
s_branch L_pcommon
L_code_end:
.section .rodata,"a"
.p2align 6
.amdhsa_kernel concat_heads__gqa_block_cached__gqa_block_cached__near_ridge_kernel
  .amdhsa_next_free_vgpr 512
  .amdhsa_next_free_sgpr 102
  .amdhsa_accum_offset 256
  .amdhsa_group_segment_fixed_size 0
  .amdhsa_kernarg_size 104
  .amdhsa_user_sgpr_count 2
  .amdhsa_user_sgpr_kernarg_segment_ptr 1
  .amdhsa_system_sgpr_workgroup_id_x 1
  .amdhsa_float_denorm_mode_32 3
.end_amdhsa_kernel
```
